```python
import torch

def _softmax(x, axis=-1):
    return torch.softmax(x, dim=axis)

def _gelu(x):
    return torch.nn.functional.gelu(x, approximate='tanh')

def _silu(x):
    return torch.nn.functional.silu(x)

def _sigmoid(x):
    return torch.sigmoid(x)

def _layernorm(x, axis=-1, eps=1e-05):
    m = x.mean(dim=axis, keepdim=True)
    v = x.var(dim=axis, keepdim=True, unbiased=False)
    return (x - m) / torch.sqrt(v + eps)

def _scatter_add(tgt, idx, src, axis=0):
    return tgt.clone().index_add_(axis, idx, src)

def _segment_sum(src, seg, n):
    out = torch.zeros((n,) + src.shape[1:], dtype=src.dtype)
    return out.index_add_(0, seg, src)

def _pad(x, pw):
    flat = tuple((v for pair in reversed(pw) for v in pair))
    return torch.nn.functional.pad(x, flat)
kernel_name = 'interleave_layers__memory_aug_recurrent_mem_tr__dense_activation_relu__prompt'

def setup_inputs():

    _w = lambda a: (lambda t: t.to(torch.bfloat16) if t.is_floating_point() else t)(torch.as_tensor(a))

    def _A_setup():
        B, S, Dm = (1, 2048, 512)
        H, Dh = (32, 128)
        M, seg = (8, 32)
        seg = min(seg, S)
        S = S // seg * seg
        return {'x': _w((lambda *s: torch.randn(*s, dtype=torch.bfloat16) * 0.05)(B, S, Dm)), 'mem0': _w((lambda *s: torch.randn(*s, dtype=torch.bfloat16) * 0.8)(B, M, Dm)), 'Wq': _w((lambda *s: torch.randn(*s, dtype=torch.bfloat16) * 0.8)(Dm, H, Dh) * Dm ** (-0.5)), 'Wk': _w((lambda *s: torch.randn(*s, dtype=torch.bfloat16) * 0.8)(Dm, H, Dh) * Dm ** (-0.5)), 'Wv': _w((lambda *s: torch.randn(*s, dtype=torch.bfloat16) * 0.8)(Dm, H, Dh) * Dm ** (-0.5)), 'Wo': _w((lambda *s: torch.randn(*s, dtype=torch.bfloat16) * 0.8)(H, Dh, Dm) * (H * Dh) ** (-0.5)), 'seg_len': seg}
    _A_in = _A_setup()

    def _B_setup():
        B, S, D, Dff = (1, 2048, 512, 1376)
        return {'x': _w((lambda *s: torch.randn(*s, dtype=torch.bfloat16) * 0.05)(B, S, D)), 'w1': _w((lambda *s: torch.randn(*s, dtype=torch.bfloat16) * 0.05)(D, Dff)), 'w2': _w((lambda *s: torch.randn(*s, dtype=torch.bfloat16) * 0.05)(Dff, D))}
    _B_in = _B_setup()
    return {'A_x': _A_in['x'], 'A_mem0': _A_in['mem0'], 'A_Wq': _A_in['Wq'], 'A_Wk': _A_in['Wk'], 'A_Wv': _A_in['Wv'], 'A_Wo': _A_in['Wo'], 'A_seg_len': _A_in['seg_len'], 'B_x': _B_in['x'], 'B_w1': _B_in['w1'], 'B_w2': _B_in['w2']}

def reference(A_x, A_mem0, A_Wq, A_Wk, A_Wv, A_Wo, A_seg_len, B_x, B_w1, B_w2):

    def _A_ref(x, mem0, Wq, Wk, Wv, Wo, seg_len):
        B, S, Dm = x.shape
        H, Dh = (Wq.shape[1], Wq.shape[2])
        M = mem0.shape[1]
        scale = Dh ** (-0.5)
        n_seg = S // seg_len
        L = M + seg_len
        idx = torch.arange(L)
        mask = (idx[:, None] < M) | (idx[:, None] >= idx[None, :])
        mem = mem0
        outs = []
        for s in range(n_seg):
            xs = x[:, s * seg_len:(s + 1) * seg_len, :].clone()
            h = torch.concatenate([mem, xs], axis=1)
            q = torch.einsum('btd,dhe->bhte', h, Wq)
            k = torch.einsum('btd,dhe->bhte', h, Wk)
            v = torch.einsum('btd,dhe->bhte', h, Wv)
            scores = torch.einsum('bhqe,bhke->bhqk', q, k) * scale
            scores = torch.where(mask[None, None], scores, -1000000000.0)
            p = _softmax(scores, axis=-1)
            o = torch.einsum('bhqk,bhke->bhqe', p, v)
            o = torch.einsum('bhte,hed->btd', o, Wo)
            mem = o[:, :M, :].clone()
            outs.append(o[:, M:, :])
        return torch.concatenate(outs, axis=1)

    def _B_ref(x, w1, w2):
        h = torch.einsum('bsd,df->bsf', x, w1)
        zero = torch.zeros_like(h)
        h = torch.maximum(h, zero)
        return torch.einsum('bsf,fd->bsd', h, w2)
    x = A_x
    x = x + _A_ref(_layernorm(x, axis=-1), A_mem0, A_Wq, A_Wk, A_Wv, A_Wo, A_seg_len)
    x = x + _B_ref(_layernorm(x, axis=-1), B_w1, B_w2)
    x = x + _A_ref(_layernorm(x, axis=-1), A_mem0, A_Wq, A_Wk, A_Wv, A_Wo, A_seg_len)
    x = x + _B_ref(_layernorm(x, axis=-1), B_w1, B_w2)
    return x
```

```asm
; @launch grid=(256,1,1) block=(256,1,1) lds=163840
.amdgcn_target "amdgcn-amd-amdhsa--gfx950"
.text
.globl interleave_layers__memory_aug_recurrent_mem_tr__dense_activation_relu__prompt_kernel
.p2align 8
.type interleave_layers__memory_aug_recurrent_mem_tr__dense_activation_relu__prompt_kernel,@function
interleave_layers__memory_aug_recurrent_mem_tr__dense_activation_relu__prompt_kernel:
  s_cmp_ge_u32 s2, 256
  s_cbranch_scc1 L_end
  s_load_dwordx8 s[4:11], s[0:1], 0
  s_load_dwordx4 s[12:15], s[0:1], 32
  s_load_dwordx8 s[16:23], s[0:1], 64
  s_load_dwordx2 s[24:25], s[0:1], 96
  s_getreg_b32 s31, hwreg(HW_REG_XCC_ID)
  s_and_b32 s31, s31, 15
  v_lshrrev_b32 v1, 6, v0
  s_nop 0
  v_readfirstlane_b32 s26, v1
  s_mov_b32 s48, 0x05040100
  s_mov_b32 s49, 0x07060302
  s_lshr_b32 s28, s2, 3
  s_and_b32 s96, s31, 7
  s_lshl_b32 s96, s96, 2
  s_lshr_b32 s27, 0x27654013, s96
  s_and_b32 s27, s27, 7
  s_mov_b32 s101, 0
  s_waitcnt lgkmcnt(0)
  s_mov_b32 s32, s24
  s_and_b32 s33, s25, 0xffff
  s_mov_b32 s34, 268435456
  s_mov_b32 s35, 0x20000
  s_lshl_b32 s3, 1, s28
  s_cmp_lg_u32 s26, 0
  s_cbranch_scc1 LP_noclaim
  s_lshl_b32 s97, s27, 2
  s_atomic_or s3, s[22:23], s97 glc
  s_lshr_b32 s98, s31, 3
  s_cmp_eq_u32 s98, 0
  s_cbranch_scc1 LP_noclaim
  s_atomic_or s98, s[22:23], 100 glc
  s_waitcnt lgkmcnt(0)
LP_noclaim:
  s_branch LP_role
LP_lost:
  s_waitcnt vmcnt(0) lgkmcnt(0)
  s_cmp_lg_u32 s26, 0
  s_cbranch_scc1 LP_wait
  s_mov_b32 s44, s22
  s_and_b32 s45, s23, 0xffff
  s_mov_b32 s46, 256
  s_mov_b32 s47, 0x20000
  v_mbcnt_lo_u32_b32 v12, -1, 0
  v_mbcnt_hi_u32_b32 v12, -1, v12
  v_lshlrev_b32 v12, 2, v12
  v_and_b32 v12, 127, v12
  s_mov_b32 s100, 0
LCENP:
  buffer_load_dword v13, off, s[44:47], 0 offset:160 sc1
  s_waitcnt vmcnt(0)
  v_readfirstlane_b32 s30, v13
  s_cmp_lg_u32 s30, 0
  s_cbranch_scc1 LCENDP
  s_add_u32 s100, s100, 1
  s_cmp_ge_u32 s100, 32768
  s_cbranch_scc1 L_abort
  s_sleep 4
  s_and_b32 s96, s100, 7
  s_min_u32 s96, s96, s28
  s_cmp_lg_u32 s96, 0
  s_cbranch_scc1 LCENP
  buffer_load_dword v13, v12, s[44:47], 0 offen sc1
  s_waitcnt vmcnt(0)
  s_mov_b32 s96, 0
  s_mov_b32 s30, 2
  v_readlane_b32 s97, v13, 8
  s_add_u32 s96, s96, s97
  s_cmp_eq_u32 s97, 32
  s_cselect_b32 s30, s30, 1
  v_readlane_b32 s97, v13, 9
  s_add_u32 s96, s96, s97
  s_cmp_eq_u32 s97, 32
  s_cselect_b32 s30, s30, 1
  v_readlane_b32 s97, v13, 10
  s_add_u32 s96, s96, s97
  s_cmp_eq_u32 s97, 32
  s_cselect_b32 s30, s30, 1
  v_readlane_b32 s97, v13, 11
  s_add_u32 s96, s96, s97
  s_cmp_eq_u32 s97, 32
  s_cselect_b32 s30, s30, 1
  v_readlane_b32 s97, v13, 12
  s_add_u32 s96, s96, s97
  s_cmp_eq_u32 s97, 32
  s_cselect_b32 s30, s30, 1
  v_readlane_b32 s97, v13, 13
  s_add_u32 s96, s96, s97
  s_cmp_eq_u32 s97, 32
  s_cselect_b32 s30, s30, 1
  v_readlane_b32 s97, v13, 14
  s_add_u32 s96, s96, s97
  s_cmp_eq_u32 s97, 32
  s_cselect_b32 s30, s30, 1
  v_readlane_b32 s97, v13, 15
  s_add_u32 s96, s96, s97
  s_cmp_eq_u32 s97, 32
  s_cselect_b32 s30, s30, 1
  v_readlane_b32 s97, v13, 25
  s_cmp_eq_u32 s97, 0
  s_cselect_b32 s30, s30, 1
  s_cmp_lt_u32 s96, 256
  s_cbranch_scc1 LCENP
  s_branch LCENDP
  v_readlane_b32 s97, v13, 26
  s_cmp_lt_u32 s97, 160
  s_cbranch_scc1 LCENP
  v_mov_b32 v13, s30
  s_mov_b64 exec, 1
  buffer_store_dword v13, off, s[44:47], 0 offset:160 sc1
  s_mov_b64 exec, -1
LCENDP:
  buffer_load_dword v13, v12, s[44:47], 0 offen sc1
  s_waitcnt vmcnt(0)
  s_lshl_b32 s97, s27, 2
  s_add_u32 s97, s97, 64
  s_mov_b32 s96, 1
  s_atomic_add s96, s[22:23], s97 glc
  s_waitcnt lgkmcnt(0)
  v_readlane_b32 s97, v13, s27
  s_not_b32 s97, s97
  s_bcnt1_i32_b32 s98, s97
  s_cmp_lt_u32 s96, s98
  s_cbranch_scc1 LP_pick
  s_mov_b32 s96, 1
  s_atomic_add s96, s[22:23], 96 glc
  s_waitcnt lgkmcnt(0)
  s_mov_b32 s27, 0
LP_ov:
  s_add_u32 s99, s27, 8
  v_readlane_b32 s98, v13, s99
  s_min_u32 s99, s98, 32
  s_sub_u32 s99, 32, s99
  s_cmp_lt_u32 s96, s99
  s_cbranch_scc1 LP_ovf
  s_sub_u32 s96, s96, s99
  s_add_u32 s27, s27, 1
  s_cmp_lt_u32 s27, 8
  s_cbranch_scc1 LP_ov
  s_branch L_abort
LP_ovf:
  v_readlane_b32 s97, v13, s27
  s_bcnt1_i32_b32 s99, s97
  s_sub_u32 s98, s98, s99
  s_add_u32 s96, s96, s98
  s_not_b32 s97, s97
LP_pick:
  s_ff1_i32_b32 s28, s97
  s_cmp_eq_u32 s96, 0
  s_cbranch_scc1 LP_won
  s_bitset0_b32 s97, s28
  s_sub_u32 s96, s96, 1
  s_branch LP_pick
LP_won:
  s_lshl_b32 s96, s27, 8
  s_or_b32 s96, s96, s28
  v_mov_b32 v4, s96
  v_mov_b32 v5, 163828
  ds_write_b32 v5, v4
  s_waitcnt lgkmcnt(0)
LP_wait:
  s_barrier
  v_mov_b32 v5, 163828
  ds_read_b32 v4, v5
  s_waitcnt lgkmcnt(0)
  v_readfirstlane_b32 s96, v4
  s_and_b32 s28, s96, 31
  s_lshr_b32 s27, s96, 8
  s_and_b32 s27, s27, 7
  v_mbcnt_lo_u32_b32 v0, -1, 0
  v_mbcnt_hi_u32_b32 v0, -1, v0
LP_role:
  s_lshr_b32 s29, s27, 2
  s_cmp_lt_u32 s27, 3
  s_cbranch_scc1 L_first
  s_cmp_lg_u32 s101, 0
  s_cbranch_scc1 LCF_1
  s_mov_b32 s101, 1
  s_waitcnt lgkmcnt(0)
  s_lshr_b32 s96, s3, s28
  s_and_b32 s96, s96, 1
  s_cmp_eq_u32 s26, 0
  s_cselect_b32 s97, 0, 8
  s_add_u32 s97, s97, 163824
  v_mov_b32 v12, s96
  v_mov_b32 v13, s97
  ds_write_b32 v13, v12
  v_mov_b32 v13, 163824
  s_waitcnt lgkmcnt(0)
  s_barrier
  ds_read_b32 v12, v13
  s_waitcnt lgkmcnt(0)
  v_readfirstlane_b32 s98, v12
  s_cmp_lg_u32 s26, 0
  s_cbranch_scc1 LCF_1n
  s_lshl_b32 s97, s27, 2
  s_add_u32 s97, s97, 32
  s_mov_b32 s96, 1
  s_atomic_add s96, s[22:23], s97
LCF_1n:
  s_cmp_lg_u32 s98, 0
  s_cbranch_scc1 LP_lost
LCF_1:
  s_sub_u32 s98, s27, 3
  s_lshl_b32 s98, s98, 5
  s_add_u32 s98, s98, s28
  s_mul_i32 s98, s98, 106496
  v_and_b32 v14, 63, v0
  s_lshl_b32 s99, s26, 6
  v_add_u32 v14, s99, v14
  v_lshlrev_b32 v14, 4, v14
  v_mov_b32 v16, 0
  v_mov_b32 v17, 0
  v_mov_b32 v18, 0
  v_mov_b32 v19, 0
  buffer_store_dwordx4 v[16:19], v14, s[32:35], s98 offen sc1
  s_add_u32 s98, s98, 4096
  buffer_store_dwordx4 v[16:19], v14, s[32:35], s98 offen sc1
  s_add_u32 s98, s98, 4096
  buffer_store_dwordx4 v[16:19], v14, s[32:35], s98 offen sc1
  s_add_u32 s98, s98, 4096
  buffer_store_dwordx4 v[16:19], v14, s[32:35], s98 offen sc1
  s_add_u32 s98, s98, 4096
  buffer_store_dwordx4 v[16:19], v14, s[32:35], s98 offen sc1
  s_add_u32 s98, s98, 4096
  buffer_store_dwordx4 v[16:19], v14, s[32:35], s98 offen sc1
  s_add_u32 s98, s98, 4096
  buffer_store_dwordx4 v[16:19], v14, s[32:35], s98 offen sc1
  s_add_u32 s98, s98, 4096
  buffer_store_dwordx4 v[16:19], v14, s[32:35], s98 offen sc1
  s_add_u32 s98, s98, 4096
  buffer_store_dwordx4 v[16:19], v14, s[32:35], s98 offen sc1
  s_add_u32 s98, s98, 4096
  buffer_store_dwordx4 v[16:19], v14, s[32:35], s98 offen sc1
  s_add_u32 s98, s98, 4096
  buffer_store_dwordx4 v[16:19], v14, s[32:35], s98 offen sc1
  s_add_u32 s98, s98, 4096
  buffer_store_dwordx4 v[16:19], v14, s[32:35], s98 offen sc1
  s_add_u32 s98, s98, 4096
  buffer_store_dwordx4 v[16:19], v14, s[32:35], s98 offen sc1
  s_add_u32 s98, s98, 4096
  buffer_store_dwordx4 v[16:19], v14, s[32:35], s98 offen sc1
  s_add_u32 s98, s98, 4096
  buffer_store_dwordx4 v[16:19], v14, s[32:35], s98 offen sc1
  s_add_u32 s98, s98, 4096
  buffer_store_dwordx4 v[16:19], v14, s[32:35], s98 offen sc1
  s_add_u32 s98, s98, 4096
  buffer_store_dwordx4 v[16:19], v14, s[32:35], s98 offen sc1
  s_add_u32 s98, s98, 4096
  buffer_store_dwordx4 v[16:19], v14, s[32:35], s98 offen sc1
  s_add_u32 s98, s98, 4096
  buffer_store_dwordx4 v[16:19], v14, s[32:35], s98 offen sc1
  s_add_u32 s98, s98, 4096
  buffer_store_dwordx4 v[16:19], v14, s[32:35], s98 offen sc1
  s_add_u32 s98, s98, 4096
  buffer_store_dwordx4 v[16:19], v14, s[32:35], s98 offen sc1
  s_add_u32 s98, s98, 4096
  buffer_store_dwordx4 v[16:19], v14, s[32:35], s98 offen sc1
  s_add_u32 s98, s98, 4096
  buffer_store_dwordx4 v[16:19], v14, s[32:35], s98 offen sc1
  s_add_u32 s98, s98, 4096
  buffer_store_dwordx4 v[16:19], v14, s[32:35], s98 offen sc1
  s_add_u32 s98, s98, 4096
  buffer_store_dwordx4 v[16:19], v14, s[32:35], s98 offen sc1
  s_add_u32 s98, s98, 4096
  buffer_store_dwordx4 v[16:19], v14, s[32:35], s98 offen sc1
  s_add_u32 s98, s98, 4096
  v_lshlrev_b32 v1, 3, v14
  s_and_b32 s96, s27, 3
  s_lshl_b32 s96, s96, 5
  s_add_u32 s96, s96, s28
  s_waitcnt vmcnt(0)
  s_barrier
  s_cmp_lg_u32 s26, 0
  s_cbranch_scc1 LFI_2
  s_mov_b32 s99, 1
  s_atomic_add s99, s[22:23], 104
LFI_2:
  s_mov_b32 s44, s22
  s_and_b32 s45, s23, 0xffff
  s_mov_b32 s46, 256
  s_mov_b32 s47, 0x20000
  s_cmp_lg_u32 s26, 0
  s_cbranch_scc1 LCENWW1
  v_mbcnt_lo_u32_b32 v12, -1, 0
  v_mbcnt_hi_u32_b32 v12, -1, v12
  v_lshlrev_b32 v12, 2, v12
  v_and_b32 v12, 127, v12
  s_mov_b32 s100, 0
LCENW1:
  buffer_load_dword v13, off, s[44:47], 0 offset:160 sc1
  s_waitcnt vmcnt(0)
  v_readfirstlane_b32 s30, v13
  s_cmp_lg_u32 s30, 0
  s_cbranch_scc1 LCENDW1
  s_add_u32 s100, s100, 1
  s_cmp_ge_u32 s100, 32768
  s_cbranch_scc1 L_abort
  s_sleep 4
  s_and_b32 s96, s100, 63
  s_min_u32 s96, s96, s28
  s_cmp_lg_u32 s96, 0
  s_cbranch_scc1 LCENW1
  buffer_load_dword v13, v12, s[44:47], 0 offen sc1
  s_waitcnt vmcnt(0)
  s_mov_b32 s96, 0
  s_mov_b32 s30, 2
  v_readlane_b32 s97, v13, 8
  s_add_u32 s96, s96, s97
  s_cmp_eq_u32 s97, 32
  s_cselect_b32 s30, s30, 1
  v_readlane_b32 s97, v13, 9
  s_add_u32 s96, s96, s97
  s_cmp_eq_u32 s97, 32
  s_cselect_b32 s30, s30, 1
  v_readlane_b32 s97, v13, 10
  s_add_u32 s96, s96, s97
  s_cmp_eq_u32 s97, 32
  s_cselect_b32 s30, s30, 1
  v_readlane_b32 s97, v13, 11
  s_add_u32 s96, s96, s97
  s_cmp_eq_u32 s97, 32
  s_cselect_b32 s30, s30, 1
  v_readlane_b32 s97, v13, 12
  s_add_u32 s96, s96, s97
  s_cmp_eq_u32 s97, 32
  s_cselect_b32 s30, s30, 1
  v_readlane_b32 s97, v13, 13
  s_add_u32 s96, s96, s97
  s_cmp_eq_u32 s97, 32
  s_cselect_b32 s30, s30, 1
  v_readlane_b32 s97, v13, 14
  s_add_u32 s96, s96, s97
  s_cmp_eq_u32 s97, 32
  s_cselect_b32 s30, s30, 1
  v_readlane_b32 s97, v13, 15
  s_add_u32 s96, s96, s97
  s_cmp_eq_u32 s97, 32
  s_cselect_b32 s30, s30, 1
  v_readlane_b32 s97, v13, 25
  s_cmp_eq_u32 s97, 0
  s_cselect_b32 s30, s30, 1
  s_cmp_lt_u32 s96, 256
  s_cbranch_scc1 LCENW1
  v_readlane_b32 s97, v13, 26
  s_cmp_lt_u32 s97, 160
  s_cbranch_scc1 LCENW1
  v_mov_b32 v13, s30
  s_mov_b64 exec, 1
  buffer_store_dword v13, off, s[44:47], 0 offset:160 sc1
  s_mov_b64 exec, -1
LCENDW1:
  v_mov_b32 v12, 163836
  v_mov_b32 v13, s30
  ds_write_b32 v12, v13
  s_waitcnt lgkmcnt(0)
LCENWW1:
  s_barrier
  v_mov_b32 v12, 163836
  ds_read_b32 v13, v12
  s_waitcnt lgkmcnt(0)
  v_readfirstlane_b32 s30, v13
  s_sub_u32 s30, s30, 1
  s_and_b32 s97, s27, 3
  s_cmp_eq_u32 s97, 3
  s_cbranch_scc1 LW_go
  s_cmp_eq_u32 s27, 4
  s_cselect_b32 s96, 1, 2
  s_lshl_b32 s96, s96, 11
  s_lshl_b32 s97, s28, 6
  s_add_u32 s96, s96, s97
  s_add_u32 s96, s96, 819200
  s_mov_b32 s100, 0
LW_poll:
  buffer_load_dword v2, off, s[32:35], s96 sc1
  s_waitcnt vmcnt(0)
  v_cmp_ne_u32 vcc, 0, v2
  s_cbranch_vccnz LW_on
  s_sleep 8
  s_add_u32 s100, s100, 1
  s_cmp_lt_u32 s100, 32768
  s_cbranch_scc1 LW_poll
  s_branch L_abort
LW_on:
LW_go:
L_first:
  s_and_b32 s96, s27, 3
  s_cmp_eq_u32 s96, 0
  s_cbranch_scc1 L_chain
  s_cmp_eq_u32 s96, 3
  s_cbranch_scc1 L_post
  v_and_b32 v1, 63, v0
  v_lshlrev_b32 v100, 4, v1
  v_lshrrev_b32 v2, 8, v100
  v_bfe_u32 v3, v100, 4, 4
  v_add_u32 v4, 0, v2
  v_xor_b32 v4, v4, v3
  v_lshlrev_b32 v4, 4, v4
  v_lshl_add_u32 v101, v3, 8, v4
  v_add_u32 v4, 4, v2
  v_xor_b32 v4, v4, v3
  v_lshlrev_b32 v4, 4, v4
  v_lshl_add_u32 v102, v3, 8, v4
  v_add_u32 v4, 8, v2
  v_xor_b32 v4, v4, v3
  v_lshlrev_b32 v4, 4, v4
  v_lshl_add_u32 v103, v3, 8, v4
  v_add_u32 v4, 12, v2
  v_xor_b32 v4, v4, v3
  v_lshlrev_b32 v4, 4, v4
  v_lshl_add_u32 v104, v3, 8, v4
  v_lshlrev_b32 v4, 10, v2
  v_lshl_add_u32 v105, v3, 4, v4
  s_lshl_b32 s54, s26, 10
  v_add_u32 v112, s54, v100
  s_lshl_b32 s54, s26, 6
  s_add_u32 s54, s54, 131072
  v_mul_u32_u24 v4, 544, v2
  v_lshl_add_u32 v4, v3, 2, v4
  v_add_u32 v108, s54, v4
  v_lshrrev_b32 v4, 2, v3
  v_and_b32 v5, 1, v3
  v_lshl_add_u32 v4, v4, 1, v5
  v_mul_u32_u24 v4, 272, v4
  v_lshl_add_u32 v4, v2, 4, v4
  v_add_u32 v109, 131072, v4
  v_lshrrev_b32 v4, 1, v112
  v_add_u32 v110, 133376, v4
  s_lshr_b32 s54, s26, 1
  s_lshl_b32 s54, s54, 10
  s_add_u32 s54, s54, 133376
  v_lshrrev_b32 v4, 1, v100
  v_add_u32 v111, s54, v4
  s_and_b32 s54, s26, 1
  s_lshl_b32 s54, s54, 4
  v_lshlrev_b32 v4, 2, v2
  v_sub_u32 v4, v3, v4
  v_add_u32 v4, s54, v4
  v_cmp_le_i32 s[66:67], 0, v4
  v_cmp_le_i32 s[68:69], 1, v4
  v_cmp_le_i32 s[70:71], 2, v4
  v_cmp_le_i32 s[72:73], 3, v4
  v_cmp_le_i32 s[74:75], 16, v4
  v_cmp_le_i32 s[76:77], 17, v4
  v_cmp_le_i32 s[78:79], 18, v4
  v_cmp_le_i32 s[80:81], 19, v4
  s_mov_b32 s58, 12910592
  s_cmp_eq_u32 s29, 0
  s_cselect_b32 s58, 18874368, s58
  s_lshl_b32 s54, s26, 13
  s_add_u32 s58, s58, s54
  s_lshl_b32 s59, s29, 17
  s_add_u32 s59, s59, 0
  v_bfe_u32 v4, v100, 6, 3
  v_and_b32 v5, 3, v3
  v_lshlrev_b32 v4, 7, v4
  v_lshl_add_u32 v116, v5, 2, v4
  s_lshl_b32 s54, s29, 5
  s_add_u32 s54, s54, s28
  s_mul_i32 s60, s54, 98304
  s_add_u32 s60, s60, 6619136
  s_lshl_b32 s55, s26, 12
  s_add_u32 s60, s60, s55
  s_lshl_b32 s62, s29, 19
  s_add_u32 s62, s62, 5570560
  s_lshl_b32 s55, s26, 11
  s_add_u32 s62, s62, s55
  v_bfe_u32 v4, v3, 1, 1
  s_add_u32 s55, s55, 135424
  v_add_u32 v118, s55, v100
  v_mul_u32_u24 v4, 0xAAAA, v4
  v_add_u32 v119, 0x4444, v4
  s_lshl_b32 s63, s29, 24
  s_add_u32 s63, s63, 23068672
  s_lshl_b32 s55, s28, 13
  s_add_u32 s63, s63, s55
  s_and_b32 s55, s26, 1
  s_lshl_b32 s55, s55, 12
  s_add_u32 s63, s63, s55
  s_lshr_b32 s55, s26, 1
  s_lshl_b32 s55, s55, 11
  s_add_u32 s63, s63, s55
  s_lshl_b32 s55, s26, 2
  s_lshl_b32 s64, s29, 17
  s_lshl_b32 s54, s28, 6
  s_add_u32 s64, s64, s54
  s_add_u32 s64, s64, s55
  s_add_u32 s64, s64, 294912
  s_mov_b32 s57, 0x3e0293ee
  s_mov_b32 s56, 0
  s_and_b32 s50, s27, 3
  s_sub_u32 s50, s50, 1
  s_mov_b32 s51, s50
  s_mov_b32 s52, 65536
  s_mov_b32 s53, 65536
  s_lshl_b32 s90, s26, 11
  s_add_u32 s85, s50, 62
  s_mov_b32 s86, 0x40000000
  s_lshl_b32 s54, s50, 14
  s_add_u32 s60, s60, s54
  s_mov_b32 s91, s60
  s_add_u32 s61, s60, 98304
  s_mov_b32 s65, 1
  s_mov_b32 s92, 0
  v_lshrrev_b32 v96, 8, v100
  v_bfe_u32 v97, v100, 4, 4
  s_lshl_b32 s54, s28, 8
  s_lshl_b32 s55, s26, 6
  s_add_u32 s54, s54, s55
  v_lshlrev_b32 v98, 16, v96
  v_lshl_add_u32 v98, v97, 2, v98
  v_add_u32 v98, s54, v98
  s_mov_b32 s36, s10
  s_and_b32 s37, s11, 0xffff
  s_mov_b32 s38, 4194304
  s_mov_b32 s39, 0x20000
  s_mov_b32 s55, 0
  buffer_load_dword v0, v98, s[36:39], s55 offen
  s_mov_b32 s55, 8192
  buffer_load_dword v1, v98, s[36:39], s55 offen
  s_mov_b32 s55, 16384
  buffer_load_dword v2, v98, s[36:39], s55 offen
  s_mov_b32 s55, 24576
  buffer_load_dword v3, v98, s[36:39], s55 offen
  s_mov_b32 s55, 32768
  buffer_load_dword v4, v98, s[36:39], s55 offen
  s_mov_b32 s55, 40960
  buffer_load_dword v5, v98, s[36:39], s55 offen
  s_mov_b32 s55, 49152
  buffer_load_dword v6, v98, s[36:39], s55 offen
  s_mov_b32 s55, 57344
  buffer_load_dword v7, v98, s[36:39], s55 offen
  s_mov_b32 s55, 262144
  buffer_load_dword v8, v98, s[36:39], s55 offen
  s_mov_b32 s55, 270336
  buffer_load_dword v9, v98, s[36:39], s55 offen
  s_mov_b32 s55, 278528
  buffer_load_dword v10, v98, s[36:39], s55 offen
  s_mov_b32 s55, 286720
  buffer_load_dword v11, v98, s[36:39], s55 offen
  s_mov_b32 s55, 294912
  buffer_load_dword v12, v98, s[36:39], s55 offen
  s_mov_b32 s55, 303104
  buffer_load_dword v13, v98, s[36:39], s55 offen
  s_mov_b32 s55, 311296
  buffer_load_dword v14, v98, s[36:39], s55 offen
  s_mov_b32 s55, 319488
  buffer_load_dword v15, v98, s[36:39], s55 offen
  s_mov_b32 s55, 524288
  buffer_load_dword v16, v98, s[36:39], s55 offen
  s_mov_b32 s55, 532480
  buffer_load_dword v17, v98, s[36:39], s55 offen
  s_mov_b32 s55, 540672
  buffer_load_dword v18, v98, s[36:39], s55 offen
  s_mov_b32 s55, 548864
  buffer_load_dword v19, v98, s[36:39], s55 offen
  s_mov_b32 s55, 557056
  buffer_load_dword v20, v98, s[36:39], s55 offen
  s_mov_b32 s55, 565248
  buffer_load_dword v21, v98, s[36:39], s55 offen
  s_mov_b32 s55, 573440
  buffer_load_dword v22, v98, s[36:39], s55 offen
  s_mov_b32 s55, 581632
  buffer_load_dword v23, v98, s[36:39], s55 offen
  s_mov_b32 s55, 786432
  buffer_load_dword v24, v98, s[36:39], s55 offen
  s_mov_b32 s55, 794624
  buffer_load_dword v25, v98, s[36:39], s55 offen
  s_mov_b32 s55, 802816
  buffer_load_dword v26, v98, s[36:39], s55 offen
  s_mov_b32 s55, 811008
  buffer_load_dword v27, v98, s[36:39], s55 offen
  s_mov_b32 s55, 819200
  buffer_load_dword v28, v98, s[36:39], s55 offen
  s_mov_b32 s55, 827392
  buffer_load_dword v29, v98, s[36:39], s55 offen
  s_mov_b32 s55, 835584
  buffer_load_dword v30, v98, s[36:39], s55 offen
  s_mov_b32 s55, 843776
  buffer_load_dword v31, v98, s[36:39], s55 offen
  s_mov_b32 s55, 1048576
  buffer_load_dword v32, v98, s[36:39], s55 offen
  s_mov_b32 s55, 1056768
  buffer_load_dword v33, v98, s[36:39], s55 offen
  s_mov_b32 s55, 1064960
  buffer_load_dword v34, v98, s[36:39], s55 offen
  s_mov_b32 s55, 1073152
  buffer_load_dword v35, v98, s[36:39], s55 offen
  s_mov_b32 s55, 1081344
  buffer_load_dword v36, v98, s[36:39], s55 offen
  s_mov_b32 s55, 1089536
  buffer_load_dword v37, v98, s[36:39], s55 offen
  s_mov_b32 s55, 1097728
  buffer_load_dword v38, v98, s[36:39], s55 offen
  s_mov_b32 s55, 1105920
  buffer_load_dword v39, v98, s[36:39], s55 offen
  s_mov_b32 s55, 1310720
  buffer_load_dword v40, v98, s[36:39], s55 offen
  s_mov_b32 s55, 1318912
  buffer_load_dword v41, v98, s[36:39], s55 offen
  s_mov_b32 s55, 1327104
  buffer_load_dword v42, v98, s[36:39], s55 offen
  s_mov_b32 s55, 1335296
  buffer_load_dword v43, v98, s[36:39], s55 offen
  s_mov_b32 s55, 1343488
  buffer_load_dword v44, v98, s[36:39], s55 offen
  s_mov_b32 s55, 1351680
  buffer_load_dword v45, v98, s[36:39], s55 offen
  s_mov_b32 s55, 1359872
  buffer_load_dword v46, v98, s[36:39], s55 offen
  s_mov_b32 s55, 1368064
  buffer_load_dword v47, v98, s[36:39], s55 offen
  s_waitcnt vmcnt(32)
  v_perm_b32 v48, v1, v0, s48
  v_perm_b32 v49, v3, v2, s48
  v_perm_b32 v50, v5, v4, s48
  v_perm_b32 v51, v7, v6, s48
  v_accvgpr_write_b32 a0, v48
  v_accvgpr_write_b32 a1, v49
  v_accvgpr_write_b32 a2, v50
  v_accvgpr_write_b32 a3, v51
  v_perm_b32 v48, v1, v0, s49
  v_perm_b32 v49, v3, v2, s49
  v_perm_b32 v50, v5, v4, s49
  v_perm_b32 v51, v7, v6, s49
  v_accvgpr_write_b32 a8, v48
  v_accvgpr_write_b32 a9, v49
  v_accvgpr_write_b32 a10, v50
  v_accvgpr_write_b32 a11, v51
  v_perm_b32 v48, v9, v8, s48
  v_perm_b32 v49, v11, v10, s48
  v_perm_b32 v50, v13, v12, s48
  v_perm_b32 v51, v15, v14, s48
  v_accvgpr_write_b32 a4, v48
  v_accvgpr_write_b32 a5, v49
  v_accvgpr_write_b32 a6, v50
  v_accvgpr_write_b32 a7, v51
  v_perm_b32 v48, v9, v8, s49
  v_perm_b32 v49, v11, v10, s49
  v_perm_b32 v50, v13, v12, s49
  v_perm_b32 v51, v15, v14, s49
  v_accvgpr_write_b32 a12, v48
  v_accvgpr_write_b32 a13, v49
  v_accvgpr_write_b32 a14, v50
  v_accvgpr_write_b32 a15, v51
  s_mov_b32 s55, 1572864
  buffer_load_dword v0, v98, s[36:39], s55 offen
  s_mov_b32 s55, 1581056
  buffer_load_dword v1, v98, s[36:39], s55 offen
  s_mov_b32 s55, 1589248
  buffer_load_dword v2, v98, s[36:39], s55 offen
  s_mov_b32 s55, 1597440
  buffer_load_dword v3, v98, s[36:39], s55 offen
  s_mov_b32 s55, 1605632
  buffer_load_dword v4, v98, s[36:39], s55 offen
  s_mov_b32 s55, 1613824
  buffer_load_dword v5, v98, s[36:39], s55 offen
  s_mov_b32 s55, 1622016
  buffer_load_dword v6, v98, s[36:39], s55 offen
  s_mov_b32 s55, 1630208
  buffer_load_dword v7, v98, s[36:39], s55 offen
  s_mov_b32 s55, 1835008
  buffer_load_dword v8, v98, s[36:39], s55 offen
  s_mov_b32 s55, 1843200
  buffer_load_dword v9, v98, s[36:39], s55 offen
  s_mov_b32 s55, 1851392
  buffer_load_dword v10, v98, s[36:39], s55 offen
  s_mov_b32 s55, 1859584
  buffer_load_dword v11, v98, s[36:39], s55 offen
  s_mov_b32 s55, 1867776
  buffer_load_dword v12, v98, s[36:39], s55 offen
  s_mov_b32 s55, 1875968
  buffer_load_dword v13, v98, s[36:39], s55 offen
  s_mov_b32 s55, 1884160
  buffer_load_dword v14, v98, s[36:39], s55 offen
  s_mov_b32 s55, 1892352
  buffer_load_dword v15, v98, s[36:39], s55 offen
  s_waitcnt vmcnt(32)
  v_perm_b32 v48, v17, v16, s48
  v_perm_b32 v49, v19, v18, s48
  v_perm_b32 v50, v21, v20, s48
  v_perm_b32 v51, v23, v22, s48
  v_accvgpr_write_b32 a16, v48
  v_accvgpr_write_b32 a17, v49
  v_accvgpr_write_b32 a18, v50
  v_accvgpr_write_b32 a19, v51
  v_perm_b32 v48, v17, v16, s49
  v_perm_b32 v49, v19, v18, s49
  v_perm_b32 v50, v21, v20, s49
  v_perm_b32 v51, v23, v22, s49
  v_accvgpr_write_b32 a24, v48
  v_accvgpr_write_b32 a25, v49
  v_accvgpr_write_b32 a26, v50
  v_accvgpr_write_b32 a27, v51
  v_perm_b32 v48, v25, v24, s48
  v_perm_b32 v49, v27, v26, s48
  v_perm_b32 v50, v29, v28, s48
  v_perm_b32 v51, v31, v30, s48
  v_accvgpr_write_b32 a20, v48
  v_accvgpr_write_b32 a21, v49
  v_accvgpr_write_b32 a22, v50
  v_accvgpr_write_b32 a23, v51
  v_perm_b32 v48, v25, v24, s49
  v_perm_b32 v49, v27, v26, s49
  v_perm_b32 v50, v29, v28, s49
  v_perm_b32 v51, v31, v30, s49
  v_accvgpr_write_b32 a28, v48
  v_accvgpr_write_b32 a29, v49
  v_accvgpr_write_b32 a30, v50
  v_accvgpr_write_b32 a31, v51
  s_mov_b32 s55, 2097152
  buffer_load_dword v16, v98, s[36:39], s55 offen
  s_mov_b32 s55, 2105344
  buffer_load_dword v17, v98, s[36:39], s55 offen
  s_mov_b32 s55, 2113536
  buffer_load_dword v18, v98, s[36:39], s55 offen
  s_mov_b32 s55, 2121728
  buffer_load_dword v19, v98, s[36:39], s55 offen
  s_mov_b32 s55, 2129920
  buffer_load_dword v20, v98, s[36:39], s55 offen
  s_mov_b32 s55, 2138112
  buffer_load_dword v21, v98, s[36:39], s55 offen
  s_mov_b32 s55, 2146304
  buffer_load_dword v22, v98, s[36:39], s55 offen
  s_mov_b32 s55, 2154496
  buffer_load_dword v23, v98, s[36:39], s55 offen
  s_mov_b32 s55, 2359296
  buffer_load_dword v24, v98, s[36:39], s55 offen
  s_mov_b32 s55, 2367488
  buffer_load_dword v25, v98, s[36:39], s55 offen
  s_mov_b32 s55, 2375680
  buffer_load_dword v26, v98, s[36:39], s55 offen
  s_mov_b32 s55, 2383872
  buffer_load_dword v27, v98, s[36:39], s55 offen
  s_mov_b32 s55, 2392064
  buffer_load_dword v28, v98, s[36:39], s55 offen
  s_mov_b32 s55, 2400256
  buffer_load_dword v29, v98, s[36:39], s55 offen
  s_mov_b32 s55, 2408448
  buffer_load_dword v30, v98, s[36:39], s55 offen
  s_mov_b32 s55, 2416640
  buffer_load_dword v31, v98, s[36:39], s55 offen
  s_waitcnt vmcnt(32)
  v_perm_b32 v48, v33, v32, s48
  v_perm_b32 v49, v35, v34, s48
  v_perm_b32 v50, v37, v36, s48
  v_perm_b32 v51, v39, v38, s48
  v_accvgpr_write_b32 a32, v48
  v_accvgpr_write_b32 a33, v49
  v_accvgpr_write_b32 a34, v50
  v_accvgpr_write_b32 a35, v51
  v_perm_b32 v48, v33, v32, s49
  v_perm_b32 v49, v35, v34, s49
  v_perm_b32 v50, v37, v36, s49
  v_perm_b32 v51, v39, v38, s49
  v_accvgpr_write_b32 a40, v48
  v_accvgpr_write_b32 a41, v49
  v_accvgpr_write_b32 a42, v50
  v_accvgpr_write_b32 a43, v51
  v_perm_b32 v48, v41, v40, s48
  v_perm_b32 v49, v43, v42, s48
  v_perm_b32 v50, v45, v44, s48
  v_perm_b32 v51, v47, v46, s48
  v_accvgpr_write_b32 a36, v48
  v_accvgpr_write_b32 a37, v49
  v_accvgpr_write_b32 a38, v50
  v_accvgpr_write_b32 a39, v51
  v_perm_b32 v48, v41, v40, s49
  v_perm_b32 v49, v43, v42, s49
  v_perm_b32 v50, v45, v44, s49
  v_perm_b32 v51, v47, v46, s49
  v_accvgpr_write_b32 a44, v48
  v_accvgpr_write_b32 a45, v49
  v_accvgpr_write_b32 a46, v50
  v_accvgpr_write_b32 a47, v51
  s_mov_b32 s55, 2621440
  buffer_load_dword v32, v98, s[36:39], s55 offen
  s_mov_b32 s55, 2629632
  buffer_load_dword v33, v98, s[36:39], s55 offen
  s_mov_b32 s55, 2637824
  buffer_load_dword v34, v98, s[36:39], s55 offen
  s_mov_b32 s55, 2646016
  buffer_load_dword v35, v98, s[36:39], s55 offen
  s_mov_b32 s55, 2654208
  buffer_load_dword v36, v98, s[36:39], s55 offen
  s_mov_b32 s55, 2662400
  buffer_load_dword v37, v98, s[36:39], s55 offen
  s_mov_b32 s55, 2670592
  buffer_load_dword v38, v98, s[36:39], s55 offen
  s_mov_b32 s55, 2678784
  buffer_load_dword v39, v98, s[36:39], s55 offen
  s_mov_b32 s55, 2883584
  buffer_load_dword v40, v98, s[36:39], s55 offen
  s_mov_b32 s55, 2891776
  buffer_load_dword v41, v98, s[36:39], s55 offen
  s_mov_b32 s55, 2899968
  buffer_load_dword v42, v98, s[36:39], s55 offen
  s_mov_b32 s55, 2908160
  buffer_load_dword v43, v98, s[36:39], s55 offen
  s_mov_b32 s55, 2916352
  buffer_load_dword v44, v98, s[36:39], s55 offen
  s_mov_b32 s55, 2924544
  buffer_load_dword v45, v98, s[36:39], s55 offen
  s_mov_b32 s55, 2932736
  buffer_load_dword v46, v98, s[36:39], s55 offen
  s_mov_b32 s55, 2940928
  buffer_load_dword v47, v98, s[36:39], s55 offen
  s_waitcnt vmcnt(32)
  v_perm_b32 v48, v1, v0, s48
  v_perm_b32 v49, v3, v2, s48
  v_perm_b32 v50, v5, v4, s48
  v_perm_b32 v51, v7, v6, s48
  v_accvgpr_write_b32 a48, v48
  v_accvgpr_write_b32 a49, v49
  v_accvgpr_write_b32 a50, v50
  v_accvgpr_write_b32 a51, v51
  v_perm_b32 v48, v1, v0, s49
  v_perm_b32 v49, v3, v2, s49
  v_perm_b32 v50, v5, v4, s49
  v_perm_b32 v51, v7, v6, s49
  v_accvgpr_write_b32 a56, v48
  v_accvgpr_write_b32 a57, v49
  v_accvgpr_write_b32 a58, v50
  v_accvgpr_write_b32 a59, v51
  v_perm_b32 v48, v9, v8, s48
  v_perm_b32 v49, v11, v10, s48
  v_perm_b32 v50, v13, v12, s48
  v_perm_b32 v51, v15, v14, s48
  v_accvgpr_write_b32 a52, v48
  v_accvgpr_write_b32 a53, v49
  v_accvgpr_write_b32 a54, v50
  v_accvgpr_write_b32 a55, v51
  v_perm_b32 v48, v9, v8, s49
  v_perm_b32 v49, v11, v10, s49
  v_perm_b32 v50, v13, v12, s49
  v_perm_b32 v51, v15, v14, s49
  v_accvgpr_write_b32 a60, v48
  v_accvgpr_write_b32 a61, v49
  v_accvgpr_write_b32 a62, v50
  v_accvgpr_write_b32 a63, v51
  s_mov_b32 s55, 3145728
  buffer_load_dword v0, v98, s[36:39], s55 offen
  s_mov_b32 s55, 3153920
  buffer_load_dword v1, v98, s[36:39], s55 offen
  s_mov_b32 s55, 3162112
  buffer_load_dword v2, v98, s[36:39], s55 offen
  s_mov_b32 s55, 3170304
  buffer_load_dword v3, v98, s[36:39], s55 offen
  s_mov_b32 s55, 3178496
  buffer_load_dword v4, v98, s[36:39], s55 offen
  s_mov_b32 s55, 3186688
  buffer_load_dword v5, v98, s[36:39], s55 offen
  s_mov_b32 s55, 3194880
  buffer_load_dword v6, v98, s[36:39], s55 offen
  s_mov_b32 s55, 3203072
  buffer_load_dword v7, v98, s[36:39], s55 offen
  s_mov_b32 s55, 3407872
  buffer_load_dword v8, v98, s[36:39], s55 offen
  s_mov_b32 s55, 3416064
  buffer_load_dword v9, v98, s[36:39], s55 offen
  s_mov_b32 s55, 3424256
  buffer_load_dword v10, v98, s[36:39], s55 offen
  s_mov_b32 s55, 3432448
  buffer_load_dword v11, v98, s[36:39], s55 offen
  s_mov_b32 s55, 3440640
  buffer_load_dword v12, v98, s[36:39], s55 offen
  s_mov_b32 s55, 3448832
  buffer_load_dword v13, v98, s[36:39], s55 offen
  s_mov_b32 s55, 3457024
  buffer_load_dword v14, v98, s[36:39], s55 offen
  s_mov_b32 s55, 3465216
  buffer_load_dword v15, v98, s[36:39], s55 offen
  s_cmp_lg_u32 s101, 0
  s_cbranch_scc1 LCF_3
  s_mov_b32 s101, 1
  s_waitcnt lgkmcnt(0)
  s_lshr_b32 s96, s3, s28
  s_and_b32 s96, s96, 1
  s_cmp_eq_u32 s26, 0
  s_cselect_b32 s97, 0, 8
  s_add_u32 s97, s97, 163824
  v_mov_b32 v126, s96
  v_mov_b32 v127, s97
  ds_write_b32 v127, v126
  v_mov_b32 v127, 163824
  s_waitcnt lgkmcnt(0)
  s_barrier
  ds_read_b32 v126, v127
  s_waitcnt lgkmcnt(0)
  v_readfirstlane_b32 s98, v126
  s_cmp_lg_u32 s26, 0
  s_cbranch_scc1 LCF_3n
  s_lshl_b32 s97, s27, 2
  s_add_u32 s97, s97, 32
  s_mov_b32 s96, 1
  s_atomic_add s96, s[22:23], s97
LCF_3n:
  s_cmp_lg_u32 s98, 0
  s_cbranch_scc1 LP_lost
LCF_3:
  s_waitcnt vmcnt(32)
  v_perm_b32 v48, v17, v16, s48
  v_perm_b32 v49, v19, v18, s48
  v_perm_b32 v50, v21, v20, s48
  v_perm_b32 v51, v23, v22, s48
  v_accvgpr_write_b32 a64, v48
  v_accvgpr_write_b32 a65, v49
  v_accvgpr_write_b32 a66, v50
  v_accvgpr_write_b32 a67, v51
  v_perm_b32 v48, v17, v16, s49
  v_perm_b32 v49, v19, v18, s49
  v_perm_b32 v50, v21, v20, s49
  v_perm_b32 v51, v23, v22, s49
  v_accvgpr_write_b32 a72, v48
  v_accvgpr_write_b32 a73, v49
  v_accvgpr_write_b32 a74, v50
  v_accvgpr_write_b32 a75, v51
  v_perm_b32 v48, v25, v24, s48
  v_perm_b32 v49, v27, v26, s48
  v_perm_b32 v50, v29, v28, s48
  v_perm_b32 v51, v31, v30, s48
  v_accvgpr_write_b32 a68, v48
  v_accvgpr_write_b32 a69, v49
  v_accvgpr_write_b32 a70, v50
  v_accvgpr_write_b32 a71, v51
  v_perm_b32 v48, v25, v24, s49
  v_perm_b32 v49, v27, v26, s49
  v_perm_b32 v50, v29, v28, s49
  v_perm_b32 v51, v31, v30, s49
  v_accvgpr_write_b32 a76, v48
  v_accvgpr_write_b32 a77, v49
  v_accvgpr_write_b32 a78, v50
  v_accvgpr_write_b32 a79, v51
  s_mov_b32 s55, 3670016
  buffer_load_dword v16, v98, s[36:39], s55 offen
  s_mov_b32 s55, 3678208
  buffer_load_dword v17, v98, s[36:39], s55 offen
  s_mov_b32 s55, 3686400
  buffer_load_dword v18, v98, s[36:39], s55 offen
  s_mov_b32 s55, 3694592
  buffer_load_dword v19, v98, s[36:39], s55 offen
  s_mov_b32 s55, 3702784
  buffer_load_dword v20, v98, s[36:39], s55 offen
  s_mov_b32 s55, 3710976
  buffer_load_dword v21, v98, s[36:39], s55 offen
  s_mov_b32 s55, 3719168
  buffer_load_dword v22, v98, s[36:39], s55 offen
  s_mov_b32 s55, 3727360
  buffer_load_dword v23, v98, s[36:39], s55 offen
  s_mov_b32 s55, 3932160
  buffer_load_dword v24, v98, s[36:39], s55 offen
  s_mov_b32 s55, 3940352
  buffer_load_dword v25, v98, s[36:39], s55 offen
  s_mov_b32 s55, 3948544
  buffer_load_dword v26, v98, s[36:39], s55 offen
  s_mov_b32 s55, 3956736
  buffer_load_dword v27, v98, s[36:39], s55 offen
  s_mov_b32 s55, 3964928
  buffer_load_dword v28, v98, s[36:39], s55 offen
  s_mov_b32 s55, 3973120
  buffer_load_dword v29, v98, s[36:39], s55 offen
  s_mov_b32 s55, 3981312
  buffer_load_dword v30, v98, s[36:39], s55 offen
  s_mov_b32 s55, 3989504
  buffer_load_dword v31, v98, s[36:39], s55 offen
  s_waitcnt vmcnt(32)
  v_perm_b32 v48, v33, v32, s48
  v_perm_b32 v49, v35, v34, s48
  v_perm_b32 v50, v37, v36, s48
  v_perm_b32 v51, v39, v38, s48
  v_accvgpr_write_b32 a80, v48
  v_accvgpr_write_b32 a81, v49
  v_accvgpr_write_b32 a82, v50
  v_accvgpr_write_b32 a83, v51
  v_perm_b32 v48, v33, v32, s49
  v_perm_b32 v49, v35, v34, s49
  v_perm_b32 v50, v37, v36, s49
  v_perm_b32 v51, v39, v38, s49
  v_accvgpr_write_b32 a88, v48
  v_accvgpr_write_b32 a89, v49
  v_accvgpr_write_b32 a90, v50
  v_accvgpr_write_b32 a91, v51
  v_perm_b32 v48, v41, v40, s48
  v_perm_b32 v49, v43, v42, s48
  v_perm_b32 v50, v45, v44, s48
  v_perm_b32 v51, v47, v46, s48
  v_accvgpr_write_b32 a84, v48
  v_accvgpr_write_b32 a85, v49
  v_accvgpr_write_b32 a86, v50
  v_accvgpr_write_b32 a87, v51
  v_perm_b32 v48, v41, v40, s49
  v_perm_b32 v49, v43, v42, s49
  v_perm_b32 v50, v45, v44, s49
  v_perm_b32 v51, v47, v46, s49
  v_accvgpr_write_b32 a92, v48
  v_accvgpr_write_b32 a93, v49
  v_accvgpr_write_b32 a94, v50
  v_accvgpr_write_b32 a95, v51
  s_mov_b32 s40, s12
  s_and_b32 s41, s13, 0xffff
  s_mov_b32 s42, 4194304
  s_mov_b32 s43, 0x20000
  s_mov_b32 s55, 0
  buffer_load_dword v32, v98, s[40:43], s55 offen
  s_mov_b32 s55, 8192
  buffer_load_dword v33, v98, s[40:43], s55 offen
  s_mov_b32 s55, 16384
  buffer_load_dword v34, v98, s[40:43], s55 offen
  s_mov_b32 s55, 24576
  buffer_load_dword v35, v98, s[40:43], s55 offen
  s_mov_b32 s55, 32768
  buffer_load_dword v36, v98, s[40:43], s55 offen
  s_mov_b32 s55, 40960
  buffer_load_dword v37, v98, s[40:43], s55 offen
  s_mov_b32 s55, 49152
  buffer_load_dword v38, v98, s[40:43], s55 offen
  s_mov_b32 s55, 57344
  buffer_load_dword v39, v98, s[40:43], s55 offen
  s_mov_b32 s55, 262144
  buffer_load_dword v40, v98, s[40:43], s55 offen
  s_mov_b32 s55, 270336
  buffer_load_dword v41, v98, s[40:43], s55 offen
  s_mov_b32 s55, 278528
  buffer_load_dword v42, v98, s[40:43], s55 offen
  s_mov_b32 s55, 286720
  buffer_load_dword v43, v98, s[40:43], s55 offen
  s_mov_b32 s55, 294912
  buffer_load_dword v44, v98, s[40:43], s55 offen
  s_mov_b32 s55, 303104
  buffer_load_dword v45, v98, s[40:43], s55 offen
  s_mov_b32 s55, 311296
  buffer_load_dword v46, v98, s[40:43], s55 offen
  s_mov_b32 s55, 319488
  buffer_load_dword v47, v98, s[40:43], s55 offen
  s_waitcnt vmcnt(32)
  v_perm_b32 v48, v1, v0, s48
  v_perm_b32 v49, v3, v2, s48
  v_perm_b32 v50, v5, v4, s48
  v_perm_b32 v51, v7, v6, s48
  v_accvgpr_write_b32 a96, v48
  v_accvgpr_write_b32 a97, v49
  v_accvgpr_write_b32 a98, v50
  v_accvgpr_write_b32 a99, v51
  v_perm_b32 v48, v1, v0, s49
  v_perm_b32 v49, v3, v2, s49
  v_perm_b32 v50, v5, v4, s49
  v_perm_b32 v51, v7, v6, s49
  v_accvgpr_write_b32 a104, v48
  v_accvgpr_write_b32 a105, v49
  v_accvgpr_write_b32 a106, v50
  v_accvgpr_write_b32 a107, v51
  v_perm_b32 v48, v9, v8, s48
  v_perm_b32 v49, v11, v10, s48
  v_perm_b32 v50, v13, v12, s48
  v_perm_b32 v51, v15, v14, s48
  v_accvgpr_write_b32 a100, v48
  v_accvgpr_write_b32 a101, v49
  v_accvgpr_write_b32 a102, v50
  v_accvgpr_write_b32 a103, v51
  v_perm_b32 v48, v9, v8, s49
  v_perm_b32 v49, v11, v10, s49
  v_perm_b32 v50, v13, v12, s49
  v_perm_b32 v51, v15, v14, s49
  v_accvgpr_write_b32 a108, v48
  v_accvgpr_write_b32 a109, v49
  v_accvgpr_write_b32 a110, v50
  v_accvgpr_write_b32 a111, v51
  s_mov_b32 s55, 524288
  buffer_load_dword v0, v98, s[40:43], s55 offen
  s_mov_b32 s55, 532480
  buffer_load_dword v1, v98, s[40:43], s55 offen
  s_mov_b32 s55, 540672
  buffer_load_dword v2, v98, s[40:43], s55 offen
  s_mov_b32 s55, 548864
  buffer_load_dword v3, v98, s[40:43], s55 offen
  s_mov_b32 s55, 557056
  buffer_load_dword v4, v98, s[40:43], s55 offen
  s_mov_b32 s55, 565248
  buffer_load_dword v5, v98, s[40:43], s55 offen
  s_mov_b32 s55, 573440
  buffer_load_dword v6, v98, s[40:43], s55 offen
  s_mov_b32 s55, 581632
  buffer_load_dword v7, v98, s[40:43], s55 offen
  s_mov_b32 s55, 786432
  buffer_load_dword v8, v98, s[40:43], s55 offen
  s_mov_b32 s55, 794624
  buffer_load_dword v9, v98, s[40:43], s55 offen
  s_mov_b32 s55, 802816
  buffer_load_dword v10, v98, s[40:43], s55 offen
  s_mov_b32 s55, 811008
  buffer_load_dword v11, v98, s[40:43], s55 offen
  s_mov_b32 s55, 819200
  buffer_load_dword v12, v98, s[40:43], s55 offen
  s_mov_b32 s55, 827392
  buffer_load_dword v13, v98, s[40:43], s55 offen
  s_mov_b32 s55, 835584
  buffer_load_dword v14, v98, s[40:43], s55 offen
  s_mov_b32 s55, 843776
  buffer_load_dword v15, v98, s[40:43], s55 offen
  s_waitcnt vmcnt(32)
  v_perm_b32 v48, v17, v16, s48
  v_perm_b32 v49, v19, v18, s48
  v_perm_b32 v50, v21, v20, s48
  v_perm_b32 v51, v23, v22, s48
  v_accvgpr_write_b32 a112, v48
  v_accvgpr_write_b32 a113, v49
  v_accvgpr_write_b32 a114, v50
  v_accvgpr_write_b32 a115, v51
  v_perm_b32 v48, v17, v16, s49
  v_perm_b32 v49, v19, v18, s49
  v_perm_b32 v50, v21, v20, s49
  v_perm_b32 v51, v23, v22, s49
  v_accvgpr_write_b32 a120, v48
  v_accvgpr_write_b32 a121, v49
  v_accvgpr_write_b32 a122, v50
  v_accvgpr_write_b32 a123, v51
  v_perm_b32 v48, v25, v24, s48
  v_perm_b32 v49, v27, v26, s48
  v_perm_b32 v50, v29, v28, s48
  v_perm_b32 v51, v31, v30, s48
  v_accvgpr_write_b32 a116, v48
  v_accvgpr_write_b32 a117, v49
  v_accvgpr_write_b32 a118, v50
  v_accvgpr_write_b32 a119, v51
  v_perm_b32 v48, v25, v24, s49
  v_perm_b32 v49, v27, v26, s49
  v_perm_b32 v50, v29, v28, s49
  v_perm_b32 v51, v31, v30, s49
  v_accvgpr_write_b32 a124, v48
  v_accvgpr_write_b32 a125, v49
  v_accvgpr_write_b32 a126, v50
  v_accvgpr_write_b32 a127, v51
  s_mov_b32 s55, 1048576
  buffer_load_dword v16, v98, s[40:43], s55 offen
  s_mov_b32 s55, 1056768
  buffer_load_dword v17, v98, s[40:43], s55 offen
  s_mov_b32 s55, 1064960
  buffer_load_dword v18, v98, s[40:43], s55 offen
  s_mov_b32 s55, 1073152
  buffer_load_dword v19, v98, s[40:43], s55 offen
  s_mov_b32 s55, 1081344
  buffer_load_dword v20, v98, s[40:43], s55 offen
  s_mov_b32 s55, 1089536
  buffer_load_dword v21, v98, s[40:43], s55 offen
  s_mov_b32 s55, 1097728
  buffer_load_dword v22, v98, s[40:43], s55 offen
  s_mov_b32 s55, 1105920
  buffer_load_dword v23, v98, s[40:43], s55 offen
  s_mov_b32 s55, 1310720
  buffer_load_dword v24, v98, s[40:43], s55 offen
  s_mov_b32 s55, 1318912
  buffer_load_dword v25, v98, s[40:43], s55 offen
  s_mov_b32 s55, 1327104
  buffer_load_dword v26, v98, s[40:43], s55 offen
  s_mov_b32 s55, 1335296
  buffer_load_dword v27, v98, s[40:43], s55 offen
  s_mov_b32 s55, 1343488
  buffer_load_dword v28, v98, s[40:43], s55 offen
  s_mov_b32 s55, 1351680
  buffer_load_dword v29, v98, s[40:43], s55 offen
  s_mov_b32 s55, 1359872
  buffer_load_dword v30, v98, s[40:43], s55 offen
  s_mov_b32 s55, 1368064
  buffer_load_dword v31, v98, s[40:43], s55 offen
  s_waitcnt vmcnt(32)
  v_perm_b32 v48, v33, v32, s48
  v_perm_b32 v49, v35, v34, s48
  v_perm_b32 v50, v37, v36, s48
  v_perm_b32 v51, v39, v38, s48
  v_accvgpr_write_b32 a128, v48
  v_accvgpr_write_b32 a129, v49
  v_accvgpr_write_b32 a130, v50
  v_accvgpr_write_b32 a131, v51
  v_perm_b32 v48, v33, v32, s49
  v_perm_b32 v49, v35, v34, s49
  v_perm_b32 v50, v37, v36, s49
  v_perm_b32 v51, v39, v38, s49
  v_accvgpr_write_b32 a136, v48
  v_accvgpr_write_b32 a137, v49
  v_accvgpr_write_b32 a138, v50
  v_accvgpr_write_b32 a139, v51
  v_perm_b32 v48, v41, v40, s48
  v_perm_b32 v49, v43, v42, s48
  v_perm_b32 v50, v45, v44, s48
  v_perm_b32 v51, v47, v46, s48
  v_accvgpr_write_b32 a132, v48
  v_accvgpr_write_b32 a133, v49
  v_accvgpr_write_b32 a134, v50
  v_accvgpr_write_b32 a135, v51
  v_perm_b32 v48, v41, v40, s49
  v_perm_b32 v49, v43, v42, s49
  v_perm_b32 v50, v45, v44, s49
  v_perm_b32 v51, v47, v46, s49
  v_accvgpr_write_b32 a140, v48
  v_accvgpr_write_b32 a141, v49
  v_accvgpr_write_b32 a142, v50
  v_accvgpr_write_b32 a143, v51
  s_mov_b32 s55, 1572864
  buffer_load_dword v32, v98, s[40:43], s55 offen
  s_mov_b32 s55, 1581056
  buffer_load_dword v33, v98, s[40:43], s55 offen
  s_mov_b32 s55, 1589248
  buffer_load_dword v34, v98, s[40:43], s55 offen
  s_mov_b32 s55, 1597440
  buffer_load_dword v35, v98, s[40:43], s55 offen
  s_mov_b32 s55, 1605632
  buffer_load_dword v36, v98, s[40:43], s55 offen
  s_mov_b32 s55, 1613824
  buffer_load_dword v37, v98, s[40:43], s55 offen
  s_mov_b32 s55, 1622016
  buffer_load_dword v38, v98, s[40:43], s55 offen
  s_mov_b32 s55, 1630208
  buffer_load_dword v39, v98, s[40:43], s55 offen
  s_mov_b32 s55, 1835008
  buffer_load_dword v40, v98, s[40:43], s55 offen
  s_mov_b32 s55, 1843200
  buffer_load_dword v41, v98, s[40:43], s55 offen
  s_mov_b32 s55, 1851392
  buffer_load_dword v42, v98, s[40:43], s55 offen
  s_mov_b32 s55, 1859584
  buffer_load_dword v43, v98, s[40:43], s55 offen
  s_mov_b32 s55, 1867776
  buffer_load_dword v44, v98, s[40:43], s55 offen
  s_mov_b32 s55, 1875968
  buffer_load_dword v45, v98, s[40:43], s55 offen
  s_mov_b32 s55, 1884160
  buffer_load_dword v46, v98, s[40:43], s55 offen
  s_mov_b32 s55, 1892352
  buffer_load_dword v47, v98, s[40:43], s55 offen
  s_waitcnt vmcnt(32)
  v_perm_b32 v48, v1, v0, s48
  v_perm_b32 v49, v3, v2, s48
  v_perm_b32 v50, v5, v4, s48
  v_perm_b32 v51, v7, v6, s48
  v_accvgpr_write_b32 a144, v48
  v_accvgpr_write_b32 a145, v49
  v_accvgpr_write_b32 a146, v50
  v_accvgpr_write_b32 a147, v51
  v_perm_b32 v48, v1, v0, s49
  v_perm_b32 v49, v3, v2, s49
  v_perm_b32 v50, v5, v4, s49
  v_perm_b32 v51, v7, v6, s49
  v_accvgpr_write_b32 a152, v48
  v_accvgpr_write_b32 a153, v49
  v_accvgpr_write_b32 a154, v50
  v_accvgpr_write_b32 a155, v51
  v_perm_b32 v48, v9, v8, s48
  v_perm_b32 v49, v11, v10, s48
  v_perm_b32 v50, v13, v12, s48
  v_perm_b32 v51, v15, v14, s48
  v_accvgpr_write_b32 a148, v48
  v_accvgpr_write_b32 a149, v49
  v_accvgpr_write_b32 a150, v50
  v_accvgpr_write_b32 a151, v51
  v_perm_b32 v48, v9, v8, s49
  v_perm_b32 v49, v11, v10, s49
  v_perm_b32 v50, v13, v12, s49
  v_perm_b32 v51, v15, v14, s49
  v_accvgpr_write_b32 a156, v48
  v_accvgpr_write_b32 a157, v49
  v_accvgpr_write_b32 a158, v50
  v_accvgpr_write_b32 a159, v51
  s_mov_b32 s55, 2097152
  buffer_load_dword v0, v98, s[40:43], s55 offen
  s_mov_b32 s55, 2105344
  buffer_load_dword v1, v98, s[40:43], s55 offen
  s_mov_b32 s55, 2113536
  buffer_load_dword v2, v98, s[40:43], s55 offen
  s_mov_b32 s55, 2121728
  buffer_load_dword v3, v98, s[40:43], s55 offen
  s_mov_b32 s55, 2129920
  buffer_load_dword v4, v98, s[40:43], s55 offen
  s_mov_b32 s55, 2138112
  buffer_load_dword v5, v98, s[40:43], s55 offen
  s_mov_b32 s55, 2146304
  buffer_load_dword v6, v98, s[40:43], s55 offen
  s_mov_b32 s55, 2154496
  buffer_load_dword v7, v98, s[40:43], s55 offen
  s_mov_b32 s55, 2359296
  buffer_load_dword v8, v98, s[40:43], s55 offen
  s_mov_b32 s55, 2367488
  buffer_load_dword v9, v98, s[40:43], s55 offen
  s_mov_b32 s55, 2375680
  buffer_load_dword v10, v98, s[40:43], s55 offen
  s_mov_b32 s55, 2383872
  buffer_load_dword v11, v98, s[40:43], s55 offen
  s_mov_b32 s55, 2392064
  buffer_load_dword v12, v98, s[40:43], s55 offen
  s_mov_b32 s55, 2400256
  buffer_load_dword v13, v98, s[40:43], s55 offen
  s_mov_b32 s55, 2408448
  buffer_load_dword v14, v98, s[40:43], s55 offen
  s_mov_b32 s55, 2416640
  buffer_load_dword v15, v98, s[40:43], s55 offen
  s_waitcnt vmcnt(32)
  v_perm_b32 v48, v17, v16, s48
  v_perm_b32 v49, v19, v18, s48
  v_perm_b32 v50, v21, v20, s48
  v_perm_b32 v51, v23, v22, s48
  v_accvgpr_write_b32 a160, v48
  v_accvgpr_write_b32 a161, v49
  v_accvgpr_write_b32 a162, v50
  v_accvgpr_write_b32 a163, v51
  v_perm_b32 v48, v17, v16, s49
  v_perm_b32 v49, v19, v18, s49
  v_perm_b32 v50, v21, v20, s49
  v_perm_b32 v51, v23, v22, s49
  v_accvgpr_write_b32 a168, v48
  v_accvgpr_write_b32 a169, v49
  v_accvgpr_write_b32 a170, v50
  v_accvgpr_write_b32 a171, v51
  v_perm_b32 v48, v25, v24, s48
  v_perm_b32 v49, v27, v26, s48
  v_perm_b32 v50, v29, v28, s48
  v_perm_b32 v51, v31, v30, s48
  v_accvgpr_write_b32 a164, v48
  v_accvgpr_write_b32 a165, v49
  v_accvgpr_write_b32 a166, v50
  v_accvgpr_write_b32 a167, v51
  v_perm_b32 v48, v25, v24, s49
  v_perm_b32 v49, v27, v26, s49
  v_perm_b32 v50, v29, v28, s49
  v_perm_b32 v51, v31, v30, s49
  v_accvgpr_write_b32 a172, v48
  v_accvgpr_write_b32 a173, v49
  v_accvgpr_write_b32 a174, v50
  v_accvgpr_write_b32 a175, v51
  s_mov_b32 s55, 2621440
  buffer_load_dword v16, v98, s[40:43], s55 offen
  s_mov_b32 s55, 2629632
  buffer_load_dword v17, v98, s[40:43], s55 offen
  s_mov_b32 s55, 2637824
  buffer_load_dword v18, v98, s[40:43], s55 offen
  s_mov_b32 s55, 2646016
  buffer_load_dword v19, v98, s[40:43], s55 offen
  s_mov_b32 s55, 2654208
  buffer_load_dword v20, v98, s[40:43], s55 offen
  s_mov_b32 s55, 2662400
  buffer_load_dword v21, v98, s[40:43], s55 offen
  s_mov_b32 s55, 2670592
  buffer_load_dword v22, v98, s[40:43], s55 offen
  s_mov_b32 s55, 2678784
  buffer_load_dword v23, v98, s[40:43], s55 offen
  s_mov_b32 s55, 2883584
  buffer_load_dword v24, v98, s[40:43], s55 offen
  s_mov_b32 s55, 2891776
  buffer_load_dword v25, v98, s[40:43], s55 offen
  s_mov_b32 s55, 2899968
  buffer_load_dword v26, v98, s[40:43], s55 offen
  s_mov_b32 s55, 2908160
  buffer_load_dword v27, v98, s[40:43], s55 offen
  s_mov_b32 s55, 2916352
  buffer_load_dword v28, v98, s[40:43], s55 offen
  s_mov_b32 s55, 2924544
  buffer_load_dword v29, v98, s[40:43], s55 offen
  s_mov_b32 s55, 2932736
  buffer_load_dword v30, v98, s[40:43], s55 offen
  s_mov_b32 s55, 2940928
  buffer_load_dword v31, v98, s[40:43], s55 offen
  s_waitcnt vmcnt(32)
  v_perm_b32 v48, v33, v32, s48
  v_perm_b32 v49, v35, v34, s48
  v_perm_b32 v50, v37, v36, s48
  v_perm_b32 v51, v39, v38, s48
  v_accvgpr_write_b32 a176, v48
  v_accvgpr_write_b32 a177, v49
  v_accvgpr_write_b32 a178, v50
  v_accvgpr_write_b32 a179, v51
  v_perm_b32 v48, v33, v32, s49
  v_perm_b32 v49, v35, v34, s49
  v_perm_b32 v50, v37, v36, s49
  v_perm_b32 v51, v39, v38, s49
  v_accvgpr_write_b32 a184, v48
  v_accvgpr_write_b32 a185, v49
  v_accvgpr_write_b32 a186, v50
  v_accvgpr_write_b32 a187, v51
  v_perm_b32 v48, v41, v40, s48
  v_perm_b32 v49, v43, v42, s48
  v_perm_b32 v50, v45, v44, s48
  v_perm_b32 v51, v47, v46, s48
  v_accvgpr_write_b32 a180, v48
  v_accvgpr_write_b32 a181, v49
  v_accvgpr_write_b32 a182, v50
  v_accvgpr_write_b32 a183, v51
  v_perm_b32 v48, v41, v40, s49
  v_perm_b32 v49, v43, v42, s49
  v_perm_b32 v50, v45, v44, s49
  v_perm_b32 v51, v47, v46, s49
  v_accvgpr_write_b32 a188, v48
  v_accvgpr_write_b32 a189, v49
  v_accvgpr_write_b32 a190, v50
  v_accvgpr_write_b32 a191, v51
  s_mov_b32 s55, 3145728
  buffer_load_dword v32, v98, s[40:43], s55 offen
  s_mov_b32 s55, 3153920
  buffer_load_dword v33, v98, s[40:43], s55 offen
  s_mov_b32 s55, 3162112
  buffer_load_dword v34, v98, s[40:43], s55 offen
  s_mov_b32 s55, 3170304
  buffer_load_dword v35, v98, s[40:43], s55 offen
  s_mov_b32 s55, 3178496
  buffer_load_dword v36, v98, s[40:43], s55 offen
  s_mov_b32 s55, 3186688
  buffer_load_dword v37, v98, s[40:43], s55 offen
  s_mov_b32 s55, 3194880
  buffer_load_dword v38, v98, s[40:43], s55 offen
  s_mov_b32 s55, 3203072
  buffer_load_dword v39, v98, s[40:43], s55 offen
  s_mov_b32 s55, 3407872
  buffer_load_dword v40, v98, s[40:43], s55 offen
  s_mov_b32 s55, 3416064
  buffer_load_dword v41, v98, s[40:43], s55 offen
  s_mov_b32 s55, 3424256
  buffer_load_dword v42, v98, s[40:43], s55 offen
  s_mov_b32 s55, 3432448
  buffer_load_dword v43, v98, s[40:43], s55 offen
  s_mov_b32 s55, 3440640
  buffer_load_dword v44, v98, s[40:43], s55 offen
  s_mov_b32 s55, 3448832
  buffer_load_dword v45, v98, s[40:43], s55 offen
  s_mov_b32 s55, 3457024
  buffer_load_dword v46, v98, s[40:43], s55 offen
  s_mov_b32 s55, 3465216
  buffer_load_dword v47, v98, s[40:43], s55 offen
  s_waitcnt vmcnt(32)
  v_perm_b32 v48, v1, v0, s48
  v_perm_b32 v49, v3, v2, s48
  v_perm_b32 v50, v5, v4, s48
  v_perm_b32 v51, v7, v6, s48
  v_accvgpr_write_b32 a192, v48
  v_accvgpr_write_b32 a193, v49
  v_accvgpr_write_b32 a194, v50
  v_accvgpr_write_b32 a195, v51
  v_perm_b32 v48, v1, v0, s49
  v_perm_b32 v49, v3, v2, s49
  v_perm_b32 v50, v5, v4, s49
  v_perm_b32 v51, v7, v6, s49
  v_accvgpr_write_b32 a200, v48
  v_accvgpr_write_b32 a201, v49
  v_accvgpr_write_b32 a202, v50
  v_accvgpr_write_b32 a203, v51
  v_perm_b32 v48, v9, v8, s48
  v_perm_b32 v49, v11, v10, s48
  v_perm_b32 v50, v13, v12, s48
  v_perm_b32 v51, v15, v14, s48
  v_accvgpr_write_b32 a196, v48
  v_accvgpr_write_b32 a197, v49
  v_accvgpr_write_b32 a198, v50
  v_accvgpr_write_b32 a199, v51
  v_perm_b32 v48, v9, v8, s49
  v_perm_b32 v49, v11, v10, s49
  v_perm_b32 v50, v13, v12, s49
  v_perm_b32 v51, v15, v14, s49
  v_accvgpr_write_b32 a204, v48
  v_accvgpr_write_b32 a205, v49
  v_accvgpr_write_b32 a206, v50
  v_accvgpr_write_b32 a207, v51
  s_mov_b32 s55, 3670016
  buffer_load_dword v0, v98, s[40:43], s55 offen
  s_mov_b32 s55, 3678208
  buffer_load_dword v1, v98, s[40:43], s55 offen
  s_mov_b32 s55, 3686400
  buffer_load_dword v2, v98, s[40:43], s55 offen
  s_mov_b32 s55, 3694592
  buffer_load_dword v3, v98, s[40:43], s55 offen
  s_mov_b32 s55, 3702784
  buffer_load_dword v4, v98, s[40:43], s55 offen
  s_mov_b32 s55, 3710976
  buffer_load_dword v5, v98, s[40:43], s55 offen
  s_mov_b32 s55, 3719168
  buffer_load_dword v6, v98, s[40:43], s55 offen
  s_mov_b32 s55, 3727360
  buffer_load_dword v7, v98, s[40:43], s55 offen
  s_mov_b32 s55, 3932160
  buffer_load_dword v8, v98, s[40:43], s55 offen
  s_mov_b32 s55, 3940352
  buffer_load_dword v9, v98, s[40:43], s55 offen
  s_mov_b32 s55, 3948544
  buffer_load_dword v10, v98, s[40:43], s55 offen
  s_mov_b32 s55, 3956736
  buffer_load_dword v11, v98, s[40:43], s55 offen
  s_mov_b32 s55, 3964928
  buffer_load_dword v12, v98, s[40:43], s55 offen
  s_mov_b32 s55, 3973120
  buffer_load_dword v13, v98, s[40:43], s55 offen
  s_mov_b32 s55, 3981312
  buffer_load_dword v14, v98, s[40:43], s55 offen
  s_mov_b32 s55, 3989504
  buffer_load_dword v15, v98, s[40:43], s55 offen
  s_waitcnt vmcnt(32)
  v_perm_b32 v48, v17, v16, s48
  v_perm_b32 v49, v19, v18, s48
  v_perm_b32 v50, v21, v20, s48
  v_perm_b32 v51, v23, v22, s48
  v_accvgpr_write_b32 a208, v48
  v_accvgpr_write_b32 a209, v49
  v_accvgpr_write_b32 a210, v50
  v_accvgpr_write_b32 a211, v51
  v_perm_b32 v48, v17, v16, s49
  v_perm_b32 v49, v19, v18, s49
  v_perm_b32 v50, v21, v20, s49
  v_perm_b32 v51, v23, v22, s49
  v_accvgpr_write_b32 a216, v48
  v_accvgpr_write_b32 a217, v49
  v_accvgpr_write_b32 a218, v50
  v_accvgpr_write_b32 a219, v51
  v_perm_b32 v48, v25, v24, s48
  v_perm_b32 v49, v27, v26, s48
  v_perm_b32 v50, v29, v28, s48
  v_perm_b32 v51, v31, v30, s48
  v_accvgpr_write_b32 a212, v48
  v_accvgpr_write_b32 a213, v49
  v_accvgpr_write_b32 a214, v50
  v_accvgpr_write_b32 a215, v51
  v_perm_b32 v48, v25, v24, s49
  v_perm_b32 v49, v27, v26, s49
  v_perm_b32 v50, v29, v28, s49
  v_perm_b32 v51, v31, v30, s49
  v_accvgpr_write_b32 a220, v48
  v_accvgpr_write_b32 a221, v49
  v_accvgpr_write_b32 a222, v50
  v_accvgpr_write_b32 a223, v51
  s_mov_b32 s36, s8
  s_and_b32 s37, s9, 0xffff
  s_mov_b32 s38, 4194304
  s_mov_b32 s39, 0x20000
  s_mov_b32 s55, 0
  buffer_load_dword v16, v98, s[36:39], s55 offen
  s_mov_b32 s55, 8192
  buffer_load_dword v17, v98, s[36:39], s55 offen
  s_mov_b32 s55, 16384
  buffer_load_dword v18, v98, s[36:39], s55 offen
  s_mov_b32 s55, 24576
  buffer_load_dword v19, v98, s[36:39], s55 offen
  s_mov_b32 s55, 32768
  buffer_load_dword v20, v98, s[36:39], s55 offen
  s_mov_b32 s55, 40960
  buffer_load_dword v21, v98, s[36:39], s55 offen
  s_mov_b32 s55, 49152
  buffer_load_dword v22, v98, s[36:39], s55 offen
  s_mov_b32 s55, 57344
  buffer_load_dword v23, v98, s[36:39], s55 offen
  s_mov_b32 s55, 262144
  buffer_load_dword v24, v98, s[36:39], s55 offen
  s_mov_b32 s55, 270336
  buffer_load_dword v25, v98, s[36:39], s55 offen
  s_mov_b32 s55, 278528
  buffer_load_dword v26, v98, s[36:39], s55 offen
  s_mov_b32 s55, 286720
  buffer_load_dword v27, v98, s[36:39], s55 offen
  s_mov_b32 s55, 294912
  buffer_load_dword v28, v98, s[36:39], s55 offen
  s_mov_b32 s55, 303104
  buffer_load_dword v29, v98, s[36:39], s55 offen
  s_mov_b32 s55, 311296
  buffer_load_dword v30, v98, s[36:39], s55 offen
  s_mov_b32 s55, 319488
  buffer_load_dword v31, v98, s[36:39], s55 offen
  s_waitcnt vmcnt(32)
  v_perm_b32 v48, v33, v32, s48
  v_perm_b32 v49, v35, v34, s48
  v_perm_b32 v50, v37, v36, s48
  v_perm_b32 v51, v39, v38, s48
  v_accvgpr_write_b32 a224, v48
  v_accvgpr_write_b32 a225, v49
  v_accvgpr_write_b32 a226, v50
  v_accvgpr_write_b32 a227, v51
  v_perm_b32 v48, v33, v32, s49
  v_perm_b32 v49, v35, v34, s49
  v_perm_b32 v50, v37, v36, s49
  v_perm_b32 v51, v39, v38, s49
  v_accvgpr_write_b32 a232, v48
  v_accvgpr_write_b32 a233, v49
  v_accvgpr_write_b32 a234, v50
  v_accvgpr_write_b32 a235, v51
  v_perm_b32 v48, v41, v40, s48
  v_perm_b32 v49, v43, v42, s48
  v_perm_b32 v50, v45, v44, s48
  v_perm_b32 v51, v47, v46, s48
  v_accvgpr_write_b32 a228, v48
  v_accvgpr_write_b32 a229, v49
  v_accvgpr_write_b32 a230, v50
  v_accvgpr_write_b32 a231, v51
  v_perm_b32 v48, v41, v40, s49
  v_perm_b32 v49, v43, v42, s49
  v_perm_b32 v50, v45, v44, s49
  v_perm_b32 v51, v47, v46, s49
  v_accvgpr_write_b32 a236, v48
  v_accvgpr_write_b32 a237, v49
  v_accvgpr_write_b32 a238, v50
  v_accvgpr_write_b32 a239, v51
  s_mov_b32 s55, 524288
  buffer_load_dword v32, v98, s[36:39], s55 offen
  s_mov_b32 s55, 532480
  buffer_load_dword v33, v98, s[36:39], s55 offen
  s_mov_b32 s55, 540672
  buffer_load_dword v34, v98, s[36:39], s55 offen
  s_mov_b32 s55, 548864
  buffer_load_dword v35, v98, s[36:39], s55 offen
  s_mov_b32 s55, 557056
  buffer_load_dword v36, v98, s[36:39], s55 offen
  s_mov_b32 s55, 565248
  buffer_load_dword v37, v98, s[36:39], s55 offen
  s_mov_b32 s55, 573440
  buffer_load_dword v38, v98, s[36:39], s55 offen
  s_mov_b32 s55, 581632
  buffer_load_dword v39, v98, s[36:39], s55 offen
  s_mov_b32 s55, 786432
  buffer_load_dword v40, v98, s[36:39], s55 offen
  s_mov_b32 s55, 794624
  buffer_load_dword v41, v98, s[36:39], s55 offen
  s_mov_b32 s55, 802816
  buffer_load_dword v42, v98, s[36:39], s55 offen
  s_mov_b32 s55, 811008
  buffer_load_dword v43, v98, s[36:39], s55 offen
  s_mov_b32 s55, 819200
  buffer_load_dword v44, v98, s[36:39], s55 offen
  s_mov_b32 s55, 827392
  buffer_load_dword v45, v98, s[36:39], s55 offen
  s_mov_b32 s55, 835584
  buffer_load_dword v46, v98, s[36:39], s55 offen
  s_mov_b32 s55, 843776
  buffer_load_dword v47, v98, s[36:39], s55 offen
  s_mov_b32 s44, s22
  s_and_b32 s45, s23, 0xffff
  s_mov_b32 s46, 256
  s_mov_b32 s47, 0x20000
  buffer_load_dword v120, off, s[44:47], 0 offset:160 sc1
  s_waitcnt vmcnt(32)
  v_perm_b32 v48, v1, v0, s48
  v_perm_b32 v49, v3, v2, s48
  v_perm_b32 v50, v5, v4, s48
  v_perm_b32 v51, v7, v6, s48
  v_accvgpr_write_b32 a240, v48
  v_accvgpr_write_b32 a241, v49
  v_accvgpr_write_b32 a242, v50
  v_accvgpr_write_b32 a243, v51
  v_perm_b32 v48, v1, v0, s49
  v_perm_b32 v49, v3, v2, s49
  v_perm_b32 v50, v5, v4, s49
  v_perm_b32 v51, v7, v6, s49
  v_accvgpr_write_b32 a248, v48
  v_accvgpr_write_b32 a249, v49
  v_accvgpr_write_b32 a250, v50
  v_accvgpr_write_b32 a251, v51
  v_perm_b32 v48, v9, v8, s48
  v_perm_b32 v49, v11, v10, s48
  v_perm_b32 v50, v13, v12, s48
  v_perm_b32 v51, v15, v14, s48
  v_accvgpr_write_b32 a244, v48
  v_accvgpr_write_b32 a245, v49
  v_accvgpr_write_b32 a246, v50
  v_accvgpr_write_b32 a247, v51
  v_perm_b32 v48, v9, v8, s49
  v_perm_b32 v49, v11, v10, s49
  v_perm_b32 v50, v13, v12, s49
  v_perm_b32 v51, v15, v14, s49
  v_accvgpr_write_b32 a252, v48
  v_accvgpr_write_b32 a253, v49
  v_accvgpr_write_b32 a254, v50
  v_accvgpr_write_b32 a255, v51
  s_mov_b32 s55, 1048576
  buffer_load_dword v0, v98, s[36:39], s55 offen
  s_mov_b32 s55, 1056768
  buffer_load_dword v1, v98, s[36:39], s55 offen
  s_mov_b32 s55, 1064960
  buffer_load_dword v2, v98, s[36:39], s55 offen
  s_mov_b32 s55, 1073152
  buffer_load_dword v3, v98, s[36:39], s55 offen
  s_mov_b32 s55, 1081344
  buffer_load_dword v4, v98, s[36:39], s55 offen
  s_mov_b32 s55, 1089536
  buffer_load_dword v5, v98, s[36:39], s55 offen
  s_mov_b32 s55, 1097728
  buffer_load_dword v6, v98, s[36:39], s55 offen
  s_mov_b32 s55, 1105920
  buffer_load_dword v7, v98, s[36:39], s55 offen
  s_mov_b32 s55, 1310720
  buffer_load_dword v8, v98, s[36:39], s55 offen
  s_mov_b32 s55, 1318912
  buffer_load_dword v9, v98, s[36:39], s55 offen
  s_mov_b32 s55, 1327104
  buffer_load_dword v10, v98, s[36:39], s55 offen
  s_mov_b32 s55, 1335296
  buffer_load_dword v11, v98, s[36:39], s55 offen
  s_mov_b32 s55, 1343488
  buffer_load_dword v12, v98, s[36:39], s55 offen
  s_mov_b32 s55, 1351680
  buffer_load_dword v13, v98, s[36:39], s55 offen
  s_mov_b32 s55, 1359872
  buffer_load_dword v14, v98, s[36:39], s55 offen
  s_mov_b32 s55, 1368064
  buffer_load_dword v15, v98, s[36:39], s55 offen
  s_waitcnt vmcnt(32)
  v_perm_b32 v128, v17, v16, s48
  v_perm_b32 v129, v19, v18, s48
  v_perm_b32 v130, v21, v20, s48
  v_perm_b32 v131, v23, v22, s48
  v_perm_b32 v136, v17, v16, s49
  v_perm_b32 v137, v19, v18, s49
  v_perm_b32 v138, v21, v20, s49
  v_perm_b32 v139, v23, v22, s49
  v_perm_b32 v132, v25, v24, s48
  v_perm_b32 v133, v27, v26, s48
  v_perm_b32 v134, v29, v28, s48
  v_perm_b32 v135, v31, v30, s48
  v_perm_b32 v140, v25, v24, s49
  v_perm_b32 v141, v27, v26, s49
  v_perm_b32 v142, v29, v28, s49
  v_perm_b32 v143, v31, v30, s49
  s_mov_b32 s55, 1572864
  buffer_load_dword v16, v98, s[36:39], s55 offen
  s_mov_b32 s55, 1581056
  buffer_load_dword v17, v98, s[36:39], s55 offen
  s_mov_b32 s55, 1589248
  buffer_load_dword v18, v98, s[36:39], s55 offen
  s_mov_b32 s55, 1597440
  buffer_load_dword v19, v98, s[36:39], s55 offen
  s_mov_b32 s55, 1605632
  buffer_load_dword v20, v98, s[36:39], s55 offen
  s_mov_b32 s55, 1613824
  buffer_load_dword v21, v98, s[36:39], s55 offen
  s_mov_b32 s55, 1622016
  buffer_load_dword v22, v98, s[36:39], s55 offen
  s_mov_b32 s55, 1630208
  buffer_load_dword v23, v98, s[36:39], s55 offen
  s_mov_b32 s55, 1835008
  buffer_load_dword v24, v98, s[36:39], s55 offen
  s_mov_b32 s55, 1843200
  buffer_load_dword v25, v98, s[36:39], s55 offen
  s_mov_b32 s55, 1851392
  buffer_load_dword v26, v98, s[36:39], s55 offen
  s_mov_b32 s55, 1859584
  buffer_load_dword v27, v98, s[36:39], s55 offen
  s_mov_b32 s55, 1867776
  buffer_load_dword v28, v98, s[36:39], s55 offen
  s_mov_b32 s55, 1875968
  buffer_load_dword v29, v98, s[36:39], s55 offen
  s_mov_b32 s55, 1884160
  buffer_load_dword v30, v98, s[36:39], s55 offen
  s_mov_b32 s55, 1892352
  buffer_load_dword v31, v98, s[36:39], s55 offen
  s_waitcnt vmcnt(32)
  v_perm_b32 v144, v33, v32, s48
  v_perm_b32 v145, v35, v34, s48
  v_perm_b32 v146, v37, v36, s48
  v_perm_b32 v147, v39, v38, s48
  v_perm_b32 v152, v33, v32, s49
  v_perm_b32 v153, v35, v34, s49
  v_perm_b32 v154, v37, v36, s49
  v_perm_b32 v155, v39, v38, s49
  v_perm_b32 v148, v41, v40, s48
  v_perm_b32 v149, v43, v42, s48
  v_perm_b32 v150, v45, v44, s48
  v_perm_b32 v151, v47, v46, s48
  v_perm_b32 v156, v41, v40, s49
  v_perm_b32 v157, v43, v42, s49
  v_perm_b32 v158, v45, v44, s49
  v_perm_b32 v159, v47, v46, s49
  s_mov_b32 s55, 2097152
  buffer_load_dword v32, v98, s[36:39], s55 offen
  s_mov_b32 s55, 2105344
  buffer_load_dword v33, v98, s[36:39], s55 offen
  s_mov_b32 s55, 2113536
  buffer_load_dword v34, v98, s[36:39], s55 offen
  s_mov_b32 s55, 2121728
  buffer_load_dword v35, v98, s[36:39], s55 offen
  s_mov_b32 s55, 2129920
  buffer_load_dword v36, v98, s[36:39], s55 offen
  s_mov_b32 s55, 2138112
  buffer_load_dword v37, v98, s[36:39], s55 offen
  s_mov_b32 s55, 2146304
  buffer_load_dword v38, v98, s[36:39], s55 offen
  s_mov_b32 s55, 2154496
  buffer_load_dword v39, v98, s[36:39], s55 offen
  s_mov_b32 s55, 2359296
  buffer_load_dword v40, v98, s[36:39], s55 offen
  s_mov_b32 s55, 2367488
  buffer_load_dword v41, v98, s[36:39], s55 offen
  s_mov_b32 s55, 2375680
  buffer_load_dword v42, v98, s[36:39], s55 offen
  s_mov_b32 s55, 2383872
  buffer_load_dword v43, v98, s[36:39], s55 offen
  s_mov_b32 s55, 2392064
  buffer_load_dword v44, v98, s[36:39], s55 offen
  s_mov_b32 s55, 2400256
  buffer_load_dword v45, v98, s[36:39], s55 offen
  s_mov_b32 s55, 2408448
  buffer_load_dword v46, v98, s[36:39], s55 offen
  s_mov_b32 s55, 2416640
  buffer_load_dword v47, v98, s[36:39], s55 offen
  v_readfirstlane_b32 s93, v120
  s_add_u32 s88, s50, 0
  s_min_u32 s88, s88, s85
  s_lshl_b32 s84, s88, 11
  s_add_u32 s84, s84, s59
  s_lshl_b32 s88, s88, 15
  s_add_u32 s88, s88, s58
  s_add_u32 s89, s88, 4096
  buffer_load_dword v117, v116, s[32:35], s84 offen sc1
  s_add_u32 s84, s84, 4096
  buffer_load_dword v120, v116, s[32:35], s84 offen sc1
  s_waitcnt vmcnt(32)
  v_perm_b32 v160, v1, v0, s48
  v_perm_b32 v161, v3, v2, s48
  v_perm_b32 v162, v5, v4, s48
  v_perm_b32 v163, v7, v6, s48
  v_perm_b32 v168, v1, v0, s49
  v_perm_b32 v169, v3, v2, s49
  v_perm_b32 v170, v5, v4, s49
  v_perm_b32 v171, v7, v6, s49
  v_perm_b32 v164, v9, v8, s48
  v_perm_b32 v165, v11, v10, s48
  v_perm_b32 v166, v13, v12, s48
  v_perm_b32 v167, v15, v14, s48
  v_perm_b32 v172, v9, v8, s49
  v_perm_b32 v173, v11, v10, s49
  v_perm_b32 v174, v13, v12, s49
  v_perm_b32 v175, v15, v14, s49
  s_mov_b32 s55, 2621440
  buffer_load_dword v0, v98, s[36:39], s55 offen
  s_mov_b32 s55, 2629632
  buffer_load_dword v1, v98, s[36:39], s55 offen
  s_mov_b32 s55, 2637824
  buffer_load_dword v2, v98, s[36:39], s55 offen
  s_mov_b32 s55, 2646016
  buffer_load_dword v3, v98, s[36:39], s55 offen
  s_mov_b32 s55, 2654208
  buffer_load_dword v4, v98, s[36:39], s55 offen
  s_mov_b32 s55, 2662400
  buffer_load_dword v5, v98, s[36:39], s55 offen
  s_mov_b32 s55, 2670592
  buffer_load_dword v6, v98, s[36:39], s55 offen
  s_mov_b32 s55, 2678784
  buffer_load_dword v7, v98, s[36:39], s55 offen
  s_mov_b32 s55, 2883584
  buffer_load_dword v8, v98, s[36:39], s55 offen
  s_mov_b32 s55, 2891776
  buffer_load_dword v9, v98, s[36:39], s55 offen
  s_mov_b32 s55, 2899968
  buffer_load_dword v10, v98, s[36:39], s55 offen
  s_mov_b32 s55, 2908160
  buffer_load_dword v11, v98, s[36:39], s55 offen
  s_mov_b32 s55, 2916352
  buffer_load_dword v12, v98, s[36:39], s55 offen
  s_mov_b32 s55, 2924544
  buffer_load_dword v13, v98, s[36:39], s55 offen
  s_mov_b32 s55, 2932736
  buffer_load_dword v14, v98, s[36:39], s55 offen
  s_mov_b32 s55, 2940928
  buffer_load_dword v15, v98, s[36:39], s55 offen
  s_waitcnt vmcnt(32)
  v_perm_b32 v176, v17, v16, s48
  v_perm_b32 v177, v19, v18, s48
  v_perm_b32 v178, v21, v20, s48
  v_perm_b32 v179, v23, v22, s48
  v_perm_b32 v184, v17, v16, s49
  v_perm_b32 v185, v19, v18, s49
  v_perm_b32 v186, v21, v20, s49
  v_perm_b32 v187, v23, v22, s49
  v_perm_b32 v180, v25, v24, s48
  v_perm_b32 v181, v27, v26, s48
  v_perm_b32 v182, v29, v28, s48
  v_perm_b32 v183, v31, v30, s48
  v_perm_b32 v188, v25, v24, s49
  v_perm_b32 v189, v27, v26, s49
  v_perm_b32 v190, v29, v28, s49
  v_perm_b32 v191, v31, v30, s49
  s_mov_b32 s55, 3145728
  buffer_load_dword v16, v98, s[36:39], s55 offen
  s_mov_b32 s55, 3153920
  buffer_load_dword v17, v98, s[36:39], s55 offen
  s_mov_b32 s55, 3162112
  buffer_load_dword v18, v98, s[36:39], s55 offen
  s_mov_b32 s55, 3170304
  buffer_load_dword v19, v98, s[36:39], s55 offen
  s_mov_b32 s55, 3178496
  buffer_load_dword v20, v98, s[36:39], s55 offen
  s_mov_b32 s55, 3186688
  buffer_load_dword v21, v98, s[36:39], s55 offen
  s_mov_b32 s55, 3194880
  buffer_load_dword v22, v98, s[36:39], s55 offen
  s_mov_b32 s55, 3203072
  buffer_load_dword v23, v98, s[36:39], s55 offen
  s_mov_b32 s55, 3407872
  buffer_load_dword v24, v98, s[36:39], s55 offen
  s_mov_b32 s55, 3416064
  buffer_load_dword v25, v98, s[36:39], s55 offen
  s_mov_b32 s55, 3424256
  buffer_load_dword v26, v98, s[36:39], s55 offen
  s_mov_b32 s55, 3432448
  buffer_load_dword v27, v98, s[36:39], s55 offen
  s_mov_b32 s55, 3440640
  buffer_load_dword v28, v98, s[36:39], s55 offen
  s_mov_b32 s55, 3448832
  buffer_load_dword v29, v98, s[36:39], s55 offen
  s_mov_b32 s55, 3457024
  buffer_load_dword v30, v98, s[36:39], s55 offen
  s_mov_b32 s55, 3465216
  buffer_load_dword v31, v98, s[36:39], s55 offen
  s_waitcnt vmcnt(32)
  v_perm_b32 v192, v33, v32, s48
  v_perm_b32 v193, v35, v34, s48
  v_perm_b32 v194, v37, v36, s48
  v_perm_b32 v195, v39, v38, s48
  v_perm_b32 v200, v33, v32, s49
  v_perm_b32 v201, v35, v34, s49
  v_perm_b32 v202, v37, v36, s49
  v_perm_b32 v203, v39, v38, s49
  v_perm_b32 v196, v41, v40, s48
  v_perm_b32 v197, v43, v42, s48
  v_perm_b32 v198, v45, v44, s48
  v_perm_b32 v199, v47, v46, s48
  v_perm_b32 v204, v41, v40, s49
  v_perm_b32 v205, v43, v42, s49
  v_perm_b32 v206, v45, v44, s49
  v_perm_b32 v207, v47, v46, s49
  s_mov_b32 s55, 3670016
  buffer_load_dword v32, v98, s[36:39], s55 offen
  s_mov_b32 s55, 3678208
  buffer_load_dword v33, v98, s[36:39], s55 offen
  s_mov_b32 s55, 3686400
  buffer_load_dword v34, v98, s[36:39], s55 offen
  s_mov_b32 s55, 3694592
  buffer_load_dword v35, v98, s[36:39], s55 offen
  s_mov_b32 s55, 3702784
  buffer_load_dword v36, v98, s[36:39], s55 offen
  s_mov_b32 s55, 3710976
  buffer_load_dword v37, v98, s[36:39], s55 offen
  s_mov_b32 s55, 3719168
  buffer_load_dword v38, v98, s[36:39], s55 offen
  s_mov_b32 s55, 3727360
  buffer_load_dword v39, v98, s[36:39], s55 offen
  s_mov_b32 s55, 3932160
  buffer_load_dword v40, v98, s[36:39], s55 offen
  s_mov_b32 s55, 3940352
  buffer_load_dword v41, v98, s[36:39], s55 offen
  s_mov_b32 s55, 3948544
  buffer_load_dword v42, v98, s[36:39], s55 offen
  s_mov_b32 s55, 3956736
  buffer_load_dword v43, v98, s[36:39], s55 offen
  s_mov_b32 s55, 3964928
  buffer_load_dword v44, v98, s[36:39], s55 offen
  s_mov_b32 s55, 3973120
  buffer_load_dword v45, v98, s[36:39], s55 offen
  s_mov_b32 s55, 3981312
  buffer_load_dword v46, v98, s[36:39], s55 offen
  s_mov_b32 s55, 3989504
  buffer_load_dword v47, v98, s[36:39], s55 offen
  s_cmp_eq_u32 s93, 0
  s_cbranch_scc1 LH_e1
  s_lshl_b32 s96, s27, 11
  s_lshl_b32 s97, s28, 6
  s_add_u32 s96, s96, s97
  s_add_u32 s96, s96, 819200
  v_mov_b32 v121, 1
  s_mov_b64 exec, 1
  buffer_store_dword v121, off, s[32:35], s96 sc1
  s_mov_b64 exec, -1
LH_e1:
  v_min_u32 v120, v120, v117
  v_cmp_eq_u32 vcc, 0, v120
  s_cmp_eq_u32 s93, 0
  s_cbranch_scc1 LH_e2
  s_cbranch_vccnz LH_e2
  s_mov_b32 s92, 1
  s_add_u32 m0, s90, 0
  s_nop 0
  buffer_load_dwordx4 v105, s[32:35], s88 offen offset:0 sc1 lds
  s_add_u32 m0, s90, 1024
  s_nop 0
  buffer_load_dwordx4 v105, s[32:35], s89 offen offset:0 sc1 lds
  s_add_u32 m0, s90, 7936
  s_nop 0
  buffer_load_dwordx4 v105, s[32:35], s88 offen offset:256 sc1 lds
  s_add_u32 m0, s90, 8960
  s_nop 0
  buffer_load_dwordx4 v105, s[32:35], s89 offen offset:256 sc1 lds
  s_add_u32 m0, s90, 15872
  s_nop 0
  buffer_load_dwordx4 v105, s[32:35], s88 offen offset:512 sc1 lds
  s_add_u32 m0, s90, 16896
  s_nop 0
  buffer_load_dwordx4 v105, s[32:35], s89 offen offset:512 sc1 lds
  s_add_u32 m0, s90, 23808
  s_nop 0
  buffer_load_dwordx4 v105, s[32:35], s88 offen offset:768 sc1 lds
  s_add_u32 m0, s90, 24832
  s_nop 0
  buffer_load_dwordx4 v105, s[32:35], s89 offen offset:768 sc1 lds
LH_e2:
  s_waitcnt vmcnt(32)
  v_perm_b32 v208, v1, v0, s48
  v_perm_b32 v209, v3, v2, s48
  v_perm_b32 v210, v5, v4, s48
  v_perm_b32 v211, v7, v6, s48
  v_perm_b32 v216, v1, v0, s49
  v_perm_b32 v217, v3, v2, s49
  v_perm_b32 v218, v5, v4, s49
  v_perm_b32 v219, v7, v6, s49
  v_perm_b32 v212, v9, v8, s48
  v_perm_b32 v213, v11, v10, s48
  v_perm_b32 v214, v13, v12, s48
  v_perm_b32 v215, v15, v14, s48
  v_perm_b32 v220, v9, v8, s49
  v_perm_b32 v221, v11, v10, s49
  v_perm_b32 v222, v13, v12, s49
  v_perm_b32 v223, v15, v14, s49
  s_cmp_eq_u32 s92, 0
  s_cbranch_scc1 LH_e3
  s_add_u32 s88, s50, 2
  s_min_u32 s88, s88, s85
  s_lshl_b32 s84, s88, 11
  s_add_u32 s84, s84, s59
  s_lshl_b32 s88, s88, 15
  s_add_u32 s88, s88, s58
  s_add_u32 s89, s88, 4096
  s_xor_b32 s90, s90, 32768
  s_add_u32 m0, s90, 0
  s_nop 0
  buffer_load_dwordx4 v105, s[32:35], s88 offen offset:0 sc1 lds
  s_add_u32 m0, s90, 1024
  s_nop 0
  buffer_load_dwordx4 v105, s[32:35], s89 offen offset:0 sc1 lds
  s_add_u32 m0, s90, 7936
  s_nop 0
  buffer_load_dwordx4 v105, s[32:35], s88 offen offset:256 sc1 lds
  s_add_u32 m0, s90, 8960
  s_nop 0
  buffer_load_dwordx4 v105, s[32:35], s89 offen offset:256 sc1 lds
  s_add_u32 m0, s90, 15872
  s_nop 0
  buffer_load_dwordx4 v105, s[32:35], s88 offen offset:512 sc1 lds
  s_add_u32 m0, s90, 16896
  s_nop 0
  buffer_load_dwordx4 v105, s[32:35], s89 offen offset:512 sc1 lds
  s_add_u32 m0, s90, 23808
  s_nop 0
  buffer_load_dwordx4 v105, s[32:35], s88 offen offset:768 sc1 lds
  s_add_u32 m0, s90, 24832
  s_nop 0
  buffer_load_dwordx4 v105, s[32:35], s89 offen offset:768 sc1 lds
  s_xor_b32 s90, s90, 32768
LH_e3:
  s_waitcnt vmcnt(16)
  v_perm_b32 v224, v17, v16, s48
  v_perm_b32 v225, v19, v18, s48
  v_perm_b32 v226, v21, v20, s48
  v_perm_b32 v227, v23, v22, s48
  v_perm_b32 v232, v17, v16, s49
  v_perm_b32 v233, v19, v18, s49
  v_perm_b32 v234, v21, v20, s49
  v_perm_b32 v235, v23, v22, s49
  v_perm_b32 v228, v25, v24, s48
  v_perm_b32 v229, v27, v26, s48
  v_perm_b32 v230, v29, v28, s48
  v_perm_b32 v231, v31, v30, s48
  v_perm_b32 v236, v25, v24, s49
  v_perm_b32 v237, v27, v26, s49
  v_perm_b32 v238, v29, v28, s49
  v_perm_b32 v239, v31, v30, s49
  s_waitcnt vmcnt(0)
  v_perm_b32 v240, v33, v32, s48
  v_perm_b32 v241, v35, v34, s48
  v_perm_b32 v242, v37, v36, s48
  v_perm_b32 v243, v39, v38, s48
  v_perm_b32 v248, v33, v32, s49
  v_perm_b32 v249, v35, v34, s49
  v_perm_b32 v250, v37, v36, s49
  v_perm_b32 v251, v39, v38, s49
  v_perm_b32 v244, v41, v40, s48
  v_perm_b32 v245, v43, v42, s48
  v_perm_b32 v246, v45, v44, s48
  v_perm_b32 v247, v47, v46, s48
  v_perm_b32 v252, v41, v40, s49
  v_perm_b32 v253, v43, v42, s49
  v_perm_b32 v254, v45, v44, s49
  v_perm_b32 v255, v47, v46, s49
  s_cmp_lg_u32 s93, 0
  s_cbranch_scc1 L_hc
  s_mov_b32 s44, s22
  s_and_b32 s45, s23, 0xffff
  s_mov_b32 s46, 256
  s_mov_b32 s47, 0x20000
  v_mbcnt_lo_u32_b32 v0, -1, 0
  v_mbcnt_hi_u32_b32 v0, -1, v0
  v_lshlrev_b32 v0, 2, v0
  v_and_b32 v0, 127, v0
  s_mov_b32 s100, 0
LCENH:
  buffer_load_dword v1, off, s[44:47], 0 offset:160 sc1
  s_waitcnt vmcnt(0)
  v_readfirstlane_b32 s30, v1
  s_cmp_lg_u32 s30, 0
  s_cbranch_scc1 LCENDH
  s_add_u32 s100, s100, 1
  s_cmp_ge_u32 s100, 32768
  s_cbranch_scc1 L_abort
  s_sleep 4
  s_and_b32 s96, s100, 63
  s_min_u32 s96, s96, s28
  s_cmp_lg_u32 s96, 0
  s_cbranch_scc1 LCENH
  buffer_load_dword v1, v0, s[44:47], 0 offen sc1
  s_waitcnt vmcnt(0)
  s_mov_b32 s96, 0
  s_mov_b32 s30, 2
  v_readlane_b32 s97, v1, 8
  s_add_u32 s96, s96, s97
  s_cmp_eq_u32 s97, 32
  s_cselect_b32 s30, s30, 1
  v_readlane_b32 s97, v1, 9
  s_add_u32 s96, s96, s97
  s_cmp_eq_u32 s97, 32
  s_cselect_b32 s30, s30, 1
  v_readlane_b32 s97, v1, 10
  s_add_u32 s96, s96, s97
  s_cmp_eq_u32 s97, 32
  s_cselect_b32 s30, s30, 1
  v_readlane_b32 s97, v1, 11
  s_add_u32 s96, s96, s97
  s_cmp_eq_u32 s97, 32
  s_cselect_b32 s30, s30, 1
  v_readlane_b32 s97, v1, 12
  s_add_u32 s96, s96, s97
  s_cmp_eq_u32 s97, 32
  s_cselect_b32 s30, s30, 1
  v_readlane_b32 s97, v1, 13
  s_add_u32 s96, s96, s97
  s_cmp_eq_u32 s97, 32
  s_cselect_b32 s30, s30, 1
  v_readlane_b32 s97, v1, 14
  s_add_u32 s96, s96, s97
  s_cmp_eq_u32 s97, 32
  s_cselect_b32 s30, s30, 1
  v_readlane_b32 s97, v1, 15
  s_add_u32 s96, s96, s97
  s_cmp_eq_u32 s97, 32
  s_cselect_b32 s30, s30, 1
  v_readlane_b32 s97, v1, 25
  s_cmp_eq_u32 s97, 0
  s_cselect_b32 s30, s30, 1
  s_cmp_lt_u32 s96, 256
  s_cbranch_scc1 LCENH
  v_readlane_b32 s97, v1, 26
  s_cmp_lt_u32 s97, 160
  s_cbranch_scc1 LCENH
  v_mov_b32 v1, s30
  s_mov_b64 exec, 1
  buffer_store_dword v1, off, s[44:47], 0 offset:160 sc1
  s_mov_b64 exec, -1
LCENDH:
  s_lshl_b32 s96, s27, 11
  s_lshl_b32 s97, s28, 6
  s_add_u32 s96, s96, s97
  s_add_u32 s96, s96, 819200
  v_mov_b32 v2, 1
  s_mov_b64 exec, 1
  buffer_store_dword v2, off, s[32:35], s96 sc1
  s_mov_b64 exec, -1
L_hc:
  s_cmp_lg_u32 s92, 0
  s_cbranch_scc1 LH_top
  s_branch LH_first
LH_redo:
  s_xor_b32 s90, s90, 32768
  s_mov_b32 s86, 0x40000000
  s_waitcnt lgkmcnt(0)
  s_barrier
LH_first:
  s_add_u32 s88, s50, 0
  s_min_u32 s88, s88, s85
  s_lshl_b32 s84, s88, 11
  s_add_u32 s84, s84, s59
  s_lshl_b32 s88, s88, 15
  s_add_u32 s88, s88, s58
  s_add_u32 s89, s88, 4096
LH_more:
LH_y_w:
  s_add_u32 s56, s56, 1
  s_cmp_ge_u32 s56, 65536
  s_cbranch_scc1 L_abort
  buffer_load_dword v117, v116, s[32:35], s84 offen sc1
  s_waitcnt vmcnt(0)
  v_cmp_eq_u32 vcc, 0, v117
  s_cbranch_vccz LH_y
  s_sleep 1
  s_branch LH_y_w
LH_y:
  s_add_u32 m0, s90, 0
  s_nop 0
  buffer_load_dwordx4 v105, s[32:35], s88 offen offset:0 sc1 lds
  s_add_u32 m0, s90, 1024
  s_nop 0
  buffer_load_dwordx4 v105, s[32:35], s89 offen offset:0 sc1 lds
  s_add_u32 m0, s90, 7936
  s_nop 0
  buffer_load_dwordx4 v105, s[32:35], s88 offen offset:256 sc1 lds
  s_add_u32 m0, s90, 8960
  s_nop 0
  buffer_load_dwordx4 v105, s[32:35], s89 offen offset:256 sc1 lds
  s_add_u32 m0, s90, 15872
  s_nop 0
  buffer_load_dwordx4 v105, s[32:35], s88 offen offset:512 sc1 lds
  s_add_u32 m0, s90, 16896
  s_nop 0
  buffer_load_dwordx4 v105, s[32:35], s89 offen offset:512 sc1 lds
  s_add_u32 m0, s90, 23808
  s_nop 0
  buffer_load_dwordx4 v105, s[32:35], s88 offen offset:768 sc1 lds
  s_add_u32 m0, s90, 24832
  s_nop 0
  buffer_load_dwordx4 v105, s[32:35], s89 offen offset:768 sc1 lds
  buffer_store_dword v109, off, s[32:35], s86 sc1
  buffer_store_dword v109, off, s[32:35], s86 sc1
LH_top:
LH_go:
  s_waitcnt vmcnt(8)
  s_barrier
  ds_read_b128 v[0:3], v101 offset:0
  ds_read_b128 v[4:7], v101 offset:4096
  ds_read_b128 v[8:11], v102 offset:0
  ds_read_b128 v[12:15], v102 offset:4096
  ds_read_b128 v[16:19], v103 offset:0
  ds_read_b128 v[20:23], v103 offset:4096
  s_waitcnt lgkmcnt(4)
  v_mfma_f32_16x16x32_bf16 v[32:35], a[0:3], v[0:3], 0
  ds_read_b128 v[24:27], v104 offset:0
  ds_read_b128 v[28:31], v104 offset:4096
  v_mfma_f32_16x16x32_bf16 v[36:39], a[8:11], v[0:3], 0
  v_bitop3_b32 v117, v0, v4, 1 bitop3:0x80
  v_add_u32 v106, s52, v112
  v_mfma_f32_16x16x32_bf16 v[40:43], a[0:3], v[4:7], 0
  s_lshl_b32 s54, s26, 10
  v_add_u32 v107, s54, v106
  s_xor_b32 s90, s90, 32768
  v_mfma_f32_16x16x32_bf16 v[44:47], a[8:11], v[4:7], 0
  s_waitcnt lgkmcnt(4)
  s_add_u32 s88, s50, 2
  s_min_u32 s88, s88, s85
  v_mfma_f32_16x16x32_bf16 v[32:35], a[4:7], v[8:11], v[32:35]
  s_waitcnt vmcnt(6)
  s_barrier
  ds_read_b128 v[0:3], v101 offset:8192
  ds_read_b128 v[4:7], v101 offset:12288
  v_mfma_f32_16x16x32_bf16 v[36:39], a[12:15], v[8:11], v[36:39]
  v_bitop3_b32 v117, v8, v12, v117 bitop3:0x80
  s_lshl_b32 s84, s88, 11
  v_mfma_f32_16x16x32_bf16 v[40:43], a[4:7], v[12:15], v[40:43]
  s_add_u32 s84, s84, s59
  s_lshl_b32 s88, s88, 15
  s_add_u32 s88, s88, s58
  v_mfma_f32_16x16x32_bf16 v[44:47], a[12:15], v[12:15], v[44:47]
  s_waitcnt lgkmcnt(4)
  s_add_u32 s89, s88, 4096
  s_lshl_b32 s87, s51, 13
  v_mfma_f32_16x16x32_bf16 v[32:35], a[16:19], v[16:19], v[32:35]
  ds_read_b128 v[8:11], v102 offset:8192
  ds_read_b128 v[12:15], v102 offset:12288
  s_add_u32 s87, s87, s62
  v_mfma_f32_16x16x32_bf16 v[36:39], a[24:27], v[16:19], v[36:39]
  v_bitop3_b32 v117, v16, v20, v117 bitop3:0x80
  v_mfma_f32_16x16x32_bf16 v[40:43], a[16:19], v[20:23], v[40:43]
  v_mfma_f32_16x16x32_bf16 v[44:47], a[24:27], v[20:23], v[44:47]
  s_waitcnt lgkmcnt(4)
  v_mfma_f32_16x16x32_bf16 v[32:35], a[20:23], v[24:27], v[32:35]
  ds_read_b128 v[16:19], v103 offset:8192
  ds_read_b128 v[20:23], v103 offset:12288
  v_mfma_f32_16x16x32_bf16 v[36:39], a[28:31], v[24:27], v[36:39]
  v_bitop3_b32 v117, v24, v28, v117 bitop3:0x80
  v_mfma_f32_16x16x32_bf16 v[40:43], a[20:23], v[28:31], v[40:43]
  v_mfma_f32_16x16x32_bf16 v[44:47], a[28:31], v[28:31], v[44:47]
  s_waitcnt lgkmcnt(4)
  v_mfma_f32_16x16x32_bf16 v[32:35], a[32:35], v[0:3], v[32:35]
  ds_read_b128 v[24:27], v104 offset:8192
  ds_read_b128 v[28:31], v104 offset:12288
  v_mfma_f32_16x16x32_bf16 v[36:39], a[40:43], v[0:3], v[36:39]
  v_bitop3_b32 v117, v0, v4, v117 bitop3:0x80
  v_mfma_f32_16x16x32_bf16 v[40:43], a[32:35], v[4:7], v[40:43]
  v_mfma_f32_16x16x32_bf16 v[44:47], a[40:43], v[4:7], v[44:47]
  s_waitcnt lgkmcnt(4)
  v_mfma_f32_16x16x32_bf16 v[32:35], a[36:39], v[8:11], v[32:35]
  s_waitcnt vmcnt(2)
  s_barrier
  ds_read_b128 v[0:3], v101 offset:16384
  ds_read_b128 v[4:7], v101 offset:20480
  v_mfma_f32_16x16x32_bf16 v[36:39], a[44:47], v[8:11], v[36:39]
  v_bitop3_b32 v117, v8, v12, v117 bitop3:0x80
  v_mfma_f32_16x16x32_bf16 v[40:43], a[36:39], v[12:15], v[40:43]
  v_mfma_f32_16x16x32_bf16 v[44:47], a[44:47], v[12:15], v[44:47]
  s_waitcnt lgkmcnt(4)
  v_mfma_f32_16x16x32_bf16 v[32:35], a[48:51], v[16:19], v[32:35]
  ds_read_b128 v[8:11], v102 offset:16384
  ds_read_b128 v[12:15], v102 offset:20480
  v_mfma_f32_16x16x32_bf16 v[36:39], a[56:59], v[16:19], v[36:39]
  v_bitop3_b32 v117, v16, v20, v117 bitop3:0x80
  v_mfma_f32_16x16x32_bf16 v[40:43], a[48:51], v[20:23], v[40:43]
  v_mfma_f32_16x16x32_bf16 v[44:47], a[56:59], v[20:23], v[44:47]
  s_waitcnt lgkmcnt(4)
  v_mfma_f32_16x16x32_bf16 v[32:35], a[52:55], v[24:27], v[32:35]
  ds_read_b128 v[16:19], v103 offset:16384
  ds_read_b128 v[20:23], v103 offset:20480
  v_mfma_f32_16x16x32_bf16 v[36:39], a[60:63], v[24:27], v[36:39]
  v_bitop3_b32 v117, v24, v28, v117 bitop3:0x80
  v_mfma_f32_16x16x32_bf16 v[40:43], a[52:55], v[28:31], v[40:43]
  v_mfma_f32_16x16x32_bf16 v[44:47], a[60:63], v[28:31], v[44:47]
  s_waitcnt lgkmcnt(4)
  v_mfma_f32_16x16x32_bf16 v[32:35], a[64:67], v[0:3], v[32:35]
  ds_read_b128 v[24:27], v104 offset:16384
  ds_read_b128 v[28:31], v104 offset:20480
  v_mfma_f32_16x16x32_bf16 v[36:39], a[72:75], v[0:3], v[36:39]
  v_bitop3_b32 v117, v0, v4, v117 bitop3:0x80
  v_mfma_f32_16x16x32_bf16 v[40:43], a[64:67], v[4:7], v[40:43]
  v_mfma_f32_16x16x32_bf16 v[44:47], a[72:75], v[4:7], v[44:47]
  s_waitcnt lgkmcnt(4)
  v_mfma_f32_16x16x32_bf16 v[32:35], a[68:71], v[8:11], v[32:35]
  ds_read_b128 v[0:3], v101 offset:24576
  ds_read_b128 v[4:7], v101 offset:28672
  v_mfma_f32_16x16x32_bf16 v[36:39], a[76:79], v[8:11], v[36:39]
  v_bitop3_b32 v117, v8, v12, v117 bitop3:0x80
  v_mfma_f32_16x16x32_bf16 v[40:43], a[68:71], v[12:15], v[40:43]
  v_mfma_f32_16x16x32_bf16 v[44:47], a[76:79], v[12:15], v[44:47]
  s_waitcnt lgkmcnt(4)
  v_mfma_f32_16x16x32_bf16 v[32:35], a[80:83], v[16:19], v[32:35]
  ds_read_b128 v[8:11], v102 offset:24576
  ds_read_b128 v[12:15], v102 offset:28672
  s_waitcnt vmcnt(0)
  v_mfma_f32_16x16x32_bf16 v[36:39], a[88:91], v[16:19], v[36:39]
  v_bitop3_b32 v117, v16, v20, v117 bitop3:0x80
  v_mfma_f32_16x16x32_bf16 v[40:43], a[80:83], v[20:23], v[40:43]
  s_mov_b64 exec, 1
  buffer_store_dword v109, off, s[32:35], s86 sc1
  s_mov_b64 exec, -1
  v_mfma_f32_16x16x32_bf16 v[44:47], a[88:91], v[20:23], v[44:47]
  s_waitcnt lgkmcnt(4)
  v_mfma_f32_16x16x32_bf16 v[32:35], a[84:87], v[24:27], v[32:35]
  ds_read_b128 v[16:19], v103 offset:24576
  ds_read_b128 v[20:23], v103 offset:28672
  v_mfma_f32_16x16x32_bf16 v[36:39], a[92:95], v[24:27], v[36:39]
  v_bitop3_b32 v117, v24, v28, v117 bitop3:0x80
  v_mfma_f32_16x16x32_bf16 v[40:43], a[84:87], v[28:31], v[40:43]
  v_mfma_f32_16x16x32_bf16 v[44:47], a[92:95], v[28:31], v[44:47]
  s_waitcnt lgkmcnt(4)
  v_mfma_f32_16x16x32_bf16 v[32:35], a[96:99], v[0:3], v[32:35]
  ds_read_b128 v[24:27], v104 offset:24576
  ds_read_b128 v[28:31], v104 offset:28672
  v_mfma_f32_16x16x32_bf16 v[36:39], a[104:107], v[0:3], v[36:39]
  v_bitop3_b32 v117, v0, v4, v117 bitop3:0x80
  v_mfma_f32_16x16x32_bf16 v[40:43], a[96:99], v[4:7], v[40:43]
  v_mfma_f32_16x16x32_bf16 v[44:47], a[104:107], v[4:7], v[44:47]
  s_waitcnt lgkmcnt(4)
  v_mfma_f32_16x16x32_bf16 v[32:35], a[100:103], v[8:11], v[32:35]
  ds_read_b128 v[0:3], v101 offset:0
  ds_read_b128 v[4:7], v101 offset:4096
  v_mfma_f32_16x16x32_bf16 v[36:39], a[108:111], v[8:11], v[36:39]
  v_bitop3_b32 v117, v8, v12, v117 bitop3:0x80
  v_mfma_f32_16x16x32_bf16 v[40:43], a[100:103], v[12:15], v[40:43]
  v_mfma_f32_16x16x32_bf16 v[44:47], a[108:111], v[12:15], v[44:47]
  s_waitcnt lgkmcnt(4)
  v_mfma_f32_16x16x32_bf16 v[32:35], a[112:115], v[16:19], v[32:35]
  ds_read_b128 v[8:11], v102 offset:0
  ds_read_b128 v[12:15], v102 offset:4096
  v_mfma_f32_16x16x32_bf16 v[36:39], a[120:123], v[16:19], v[36:39]
  v_bitop3_b32 v117, v16, v20, v117 bitop3:0x80
  v_mfma_f32_16x16x32_bf16 v[40:43], a[112:115], v[20:23], v[40:43]
  v_mfma_f32_16x16x32_bf16 v[44:47], a[120:123], v[20:23], v[44:47]
  s_waitcnt lgkmcnt(4)
  v_mfma_f32_16x16x32_bf16 v[32:35], a[116:119], v[24:27], v[32:35]
  ds_read_b128 v[16:19], v103 offset:0
  ds_read_b128 v[20:23], v103 offset:4096
  v_mfma_f32_16x16x32_bf16 v[36:39], a[124:127], v[24:27], v[36:39]
  v_bitop3_b32 v117, v24, v28, v117 bitop3:0x80
  v_mfma_f32_16x16x32_bf16 v[40:43], a[116:119], v[28:31], v[40:43]
  v_cmp_eq_u32 vcc, 0, v117
  v_mfma_f32_16x16x32_bf16 v[44:47], a[124:127], v[28:31], v[44:47]
  s_waitcnt lgkmcnt(4)
  v_mfma_f32_16x16x32_bf16 v[48:51], v[0:3], a[128:131], 0
  ds_read_b128 v[24:27], v104 offset:0
  ds_read_b128 v[28:31], v104 offset:4096
  v_mfma_f32_16x16x32_bf16 v[56:59], v[0:3], a[136:139], 0
  s_cbranch_vccnz LH_redo
  v_mfma_f32_16x16x32_bf16 v[52:55], v[4:7], a[128:131], 0
  v_mul_f32 v32, s57, v32
  v_mul_f32 v33, s57, v33
  v_mfma_f32_16x16x32_bf16 v[60:63], v[4:7], a[136:139], 0
  s_waitcnt lgkmcnt(4)
  v_mul_f32 v34, s57, v34
  v_mul_f32 v35, s57, v35
  v_mfma_f32_16x16x32_bf16 v[48:51], v[8:11], a[132:135], v[48:51]
  ds_read_b128 v[0:3], v101 offset:8192
  ds_read_b128 v[4:7], v101 offset:12288
  v_mul_f32 v36, s57, v36
  v_mfma_f32_16x16x32_bf16 v[56:59], v[8:11], a[140:143], v[56:59]
  v_mul_f32 v37, s57, v37
  v_mul_f32 v38, s57, v38
  v_mfma_f32_16x16x32_bf16 v[52:55], v[12:15], a[132:135], v[52:55]
  v_mul_f32 v39, s57, v39
  v_cvt_pk_bf16_f32 v36, v32, v36
  v_mfma_f32_16x16x32_bf16 v[60:63], v[12:15], a[140:143], v[60:63]
  s_waitcnt lgkmcnt(4)
  v_cvt_pk_bf16_f32 v33, v33, v37
  v_cvt_pk_bf16_f32 v34, v34, v38
  v_mfma_f32_16x16x32_bf16 v[48:51], v[16:19], a[144:147], v[48:51]
  ds_read_b128 v[8:11], v102 offset:8192
  ds_read_b128 v[12:15], v102 offset:12288
  v_cvt_pk_bf16_f32 v35, v35, v39
  v_mfma_f32_16x16x32_bf16 v[56:59], v[16:19], a[152:155], v[56:59]
  v_bfi_b32 v32, 1, s65, v36
  v_mfma_f32_16x16x32_bf16 v[52:55], v[20:23], a[144:147], v[52:55]
  buffer_store_dwordx4 v[32:35], v100, s[32:35], s91 offen offset:0 sc1
  v_mfma_f32_16x16x32_bf16 v[60:63], v[20:23], a[152:155], v[60:63]
  s_waitcnt lgkmcnt(4)
  v_mul_f32 v40, s57, v40
  v_mul_f32 v41, s57, v41
  v_mfma_f32_16x16x32_bf16 v[48:51], v[24:27], a[148:151], v[48:51]
  ds_read_b128 v[16:19], v103 offset:8192
  ds_read_b128 v[20:23], v103 offset:12288
  v_mul_f32 v42, s57, v42
  v_mfma_f32_16x16x32_bf16 v[56:59], v[24:27], a[156:159], v[56:59]
  v_mul_f32 v43, s57, v43
  v_mul_f32 v44, s57, v44
  v_mfma_f32_16x16x32_bf16 v[52:55], v[28:31], a[148:151], v[52:55]
  v_mul_f32 v45, s57, v45
  v_mul_f32 v46, s57, v46
  v_mfma_f32_16x16x32_bf16 v[60:63], v[28:31], a[156:159], v[60:63]
  s_waitcnt lgkmcnt(4)
  v_mul_f32 v47, s57, v47
  v_cvt_pk_bf16_f32 v44, v40, v44
  v_mfma_f32_16x16x32_bf16 v[48:51], v[0:3], a[160:163], v[48:51]
  ds_read_b128 v[24:27], v104 offset:8192
  ds_read_b128 v[28:31], v104 offset:12288
  v_cvt_pk_bf16_f32 v41, v41, v45
  v_mfma_f32_16x16x32_bf16 v[56:59], v[0:3], a[168:171], v[56:59]
  v_cvt_pk_bf16_f32 v42, v42, v46
  v_cvt_pk_bf16_f32 v43, v43, v47
  v_mfma_f32_16x16x32_bf16 v[52:55], v[4:7], a[160:163], v[52:55]
  v_bfi_b32 v40, 1, s65, v44
  v_mfma_f32_16x16x32_bf16 v[60:63], v[4:7], a[168:171], v[60:63]
  s_waitcnt lgkmcnt(4)
  buffer_store_dwordx4 v[40:43], v100, s[32:35], s91 offen offset:1024 sc1
  v_mfma_f32_16x16x32_bf16 v[48:51], v[8:11], a[164:167], v[48:51]
  ds_read_b128 v[0:3], v101 offset:16384
  ds_read_b128 v[4:7], v101 offset:20480
  v_mov_b32 v32, v36
  v_mfma_f32_16x16x32_bf16 v[56:59], v[8:11], a[172:175], v[56:59]
  v_mov_b32 v40, v44
  v_mfma_f32_16x16x32_bf16 v[52:55], v[12:15], a[164:167], v[52:55]
  ds_write_b128 v106, v[32:35] offset:8192
  v_mfma_f32_16x16x32_bf16 v[60:63], v[12:15], a[172:175], v[60:63]
  s_waitcnt lgkmcnt(5)
  v_mfma_f32_16x16x32_bf16 v[48:51], v[16:19], a[176:179], v[48:51]
  ds_read_b128 v[8:11], v102 offset:16384
  ds_read_b128 v[12:15], v102 offset:20480
  v_mfma_f32_16x16x32_bf16 v[56:59], v[16:19], a[184:187], v[56:59]
  v_mfma_f32_16x16x32_bf16 v[52:55], v[20:23], a[176:179], v[52:55]
  ds_write_b128 v106, v[40:43] offset:12288
  v_mfma_f32_16x16x32_bf16 v[60:63], v[20:23], a[184:187], v[60:63]
  s_waitcnt lgkmcnt(6)
  v_mfma_f32_16x16x32_bf16 v[48:51], v[24:27], a[180:183], v[48:51]
  ds_read_b128 v[16:19], v103 offset:16384
  ds_read_b128 v[20:23], v103 offset:20480
  v_add_u32 v115, s53, v100
  v_mfma_f32_16x16x32_bf16 v[56:59], v[24:27], a[188:191], v[56:59]
  s_and_b32 s55, s26, 1
  s_lshl_b32 s55, s55, 12
  v_add_u32 v114, s55, v115
  v_mfma_f32_16x16x32_bf16 v[52:55], v[28:31], a[180:183], v[52:55]
  v_mov_b32 v117, 0xff7fffff
  ds_read_b128 v[32:35], v114 offset:0
  v_mfma_f32_16x16x32_bf16 v[60:63], v[28:31], a[188:191], v[60:63]
  s_waitcnt lgkmcnt(7)
  ds_read_b128 v[36:39], v115 offset:8192
  v_mfma_f32_16x16x32_bf16 v[48:51], v[0:3], a[192:195], v[48:51]
  ds_read_b128 v[24:27], v104 offset:16384
  ds_read_b128 v[28:31], v104 offset:20480
  ds_read_b128 v[40:43], v115 offset:12288
  v_mfma_f32_16x16x32_bf16 v[56:59], v[0:3], a[200:203], v[56:59]
  ds_read_b128 v[80:83], v114 offset:1024
  v_mfma_f32_16x16x32_bf16 v[52:55], v[4:7], a[192:195], v[52:55]
  ds_read_b128 v[84:87], v115 offset:9216
  v_mfma_f32_16x16x32_bf16 v[60:63], v[4:7], a[200:203], v[60:63]
  s_waitcnt lgkmcnt(10)
  ds_read_b128 v[88:91], v115 offset:13312
  v_mfma_f32_16x16x32_bf16 v[48:51], v[8:11], a[196:199], v[48:51]
  ds_read_b128 v[0:3], v101 offset:24576
  ds_read_b128 v[4:7], v101 offset:28672
  v_mfma_f32_16x16x32_bf16 v[56:59], v[8:11], a[204:207], v[56:59]
  v_mfma_f32_16x16x32_bf16 v[52:55], v[12:15], a[196:199], v[52:55]
  v_mfma_f32_16x16x32_bf16 v[60:63], v[12:15], a[204:207], v[60:63]
  s_waitcnt lgkmcnt(10)
  s_waitcnt lgkmcnt(5)
  v_mfma_f32_16x16x32_bf16 v[92:95], v[36:39], v[32:35], 0
  v_mfma_f32_16x16x32_bf16 v[96:99], v[40:43], v[32:35], 0
  ds_read_b128 v[32:35], v114 offset:2048
  ds_read_b128 v[36:39], v115 offset:10240
  ds_read_b128 v[40:43], v115 offset:14336
  v_mfma_f32_16x16x32_bf16 v[48:51], v[16:19], a[208:211], v[48:51]
  ds_read_b128 v[8:11], v102 offset:24576
  ds_read_b128 v[12:15], v102 offset:28672
  v_mfma_f32_16x16x32_bf16 v[56:59], v[16:19], a[216:219], v[56:59]
  s_waitcnt lgkmcnt(7)
  v_mfma_f32_16x16x32_bf16 v[92:95], v[84:87], v[80:83], v[92:95]
  v_mfma_f32_16x16x32_bf16 v[96:99], v[88:91], v[80:83], v[96:99]
  ds_read_b128 v[80:83], v114 offset:3072
  ds_read_b128 v[84:87], v115 offset:11264
  ds_read_b128 v[88:91], v115 offset:15360
  v_mfma_f32_16x16x32_bf16 v[52:55], v[20:23], a[208:211], v[52:55]
  v_mfma_f32_16x16x32_bf16 v[60:63], v[20:23], a[216:219], v[60:63]
  v_mfma_f32_16x16x32_bf16 v[48:51], v[24:27], a[212:215], v[48:51]
  ds_read_b128 v[16:19], v103 offset:24576
  ds_read_b128 v[20:23], v103 offset:28672
  v_mfma_f32_16x16x32_bf16 v[56:59], v[24:27], a[220:223], v[56:59]
  v_mfma_f32_16x16x32_bf16 v[52:55], v[28:31], a[212:215], v[52:55]
  s_waitcnt lgkmcnt(7)
  v_mfma_f32_16x16x32_bf16 v[92:95], v[36:39], v[32:35], v[92:95]
  v_mfma_f32_16x16x32_bf16 v[96:99], v[40:43], v[32:35], v[96:99]
  v_mfma_f32_16x16x32_bf16 v[60:63], v[28:31], a[220:223], v[60:63]
  v_mfma_f32_16x16x32_bf16 v[48:51], v[0:3], a[224:227], v[48:51]
  ds_read_b128 v[24:27], v104 offset:24576
  ds_read_b128 v[28:31], v104 offset:28672
  s_waitcnt lgkmcnt(4)
  v_mfma_f32_16x16x32_bf16 v[56:59], v[0:3], a[232:235], v[56:59]
  v_mfma_f32_16x16x32_bf16 v[92:95], v[84:87], v[80:83], v[92:95]
  v_mfma_f32_16x16x32_bf16 v[96:99], v[88:91], v[80:83], v[96:99]
  s_lshr_b32 s55, s26, 1
  s_lshl_b32 s55, s55, 12
  v_add_u32 v115, s55, v115
  v_mfma_f32_16x16x32_bf16 v[52:55], v[4:7], a[224:227], v[52:55]
  v_mov_b32 v36, 0x3f803f80
  v_mov_b32 v37, 0x3f803f80
  v_mfma_f32_16x16x32_bf16 v[60:63], v[4:7], a[232:235], v[60:63]
  v_mov_b32 v38, 0x3f803f80
  v_mov_b32 v39, 0x3f803f80
  v_mfma_f32_16x16x32_bf16 v[48:51], v[8:11], a[228:231], v[48:51]
  ds_read_b128 v[0:3], v101 offset:0
  ds_read_b128 v[4:7], v101 offset:4096
  ds_read_b128 v[40:43], v115 offset:16384
  v_mfma_f32_16x16x32_bf16 v[56:59], v[8:11], a[236:239], v[56:59]
  ds_read_b128 v[44:47], v115 offset:17408
  v_cndmask_b32 v92, v117, v92, s[66:67]
  v_cndmask_b32 v93, v117, v93, s[68:69]
  v_mfma_f32_16x16x32_bf16 v[52:55], v[12:15], a[228:231], v[52:55]
  v_cndmask_b32 v94, v117, v94, s[70:71]
  v_cndmask_b32 v95, v117, v95, s[72:73]
  v_mfma_f32_16x16x32_bf16 v[60:63], v[12:15], a[236:239], v[60:63]
  s_waitcnt lgkmcnt(6)
  v_cndmask_b32 v96, v117, v96, s[74:75]
  v_cndmask_b32 v97, v117, v97, s[76:77]
  v_mfma_f32_16x16x32_bf16 v[48:51], v[16:19], a[240:243], v[48:51]
  ds_read_b128 v[8:11], v102 offset:0
  ds_read_b128 v[12:15], v102 offset:4096
  v_cndmask_b32 v98, v117, v98, s[78:79]
  v_mfma_f32_16x16x32_bf16 v[56:59], v[16:19], a[248:251], v[56:59]
  v_cndmask_b32 v99, v117, v99, s[80:81]
  v_max3_f32 v113, v92, v93, v94
  v_mfma_f32_16x16x32_bf16 v[52:55], v[20:23], a[240:243], v[52:55]
  buffer_load_dwordx4 v[120:123], v100, s[32:35], s87 offen offset:0 sc1
  v_max3_f32 v113, v113, v95, v96
  v_mfma_f32_16x16x32_bf16 v[60:63], v[20:23], a[248:251], v[60:63]
  s_waitcnt lgkmcnt(6)
  v_max3_f32 v113, v113, v97, v98
  v_max_f32 v113, v113, v99
  v_mfma_f32_16x16x32_bf16 v[48:51], v[24:27], a[244:247], v[48:51]
  ds_read_b128 v[16:19], v103 offset:0
  ds_read_b128 v[20:23], v103 offset:4096
  v_mov_b32 v114, v113
  v_mfma_f32_16x16x32_bf16 v[56:59], v[24:27], a[252:255], v[56:59]
  buffer_load_dwordx4 v[124:127], v100, s[32:35], s87 offen offset:1024 sc1
  v_permlane16_swap_b32 v113, v114
  v_mfma_f32_16x16x32_bf16 v[52:55], v[28:31], a[244:247], v[52:55]
  v_max_f32 v113, v113, v114
  v_mov_b32 v114, v113
  v_mfma_f32_16x16x32_bf16 v[60:63], v[28:31], a[252:255], v[60:63]
  s_waitcnt lgkmcnt(6)
  v_permlane32_swap_b32 v113, v114
  v_max_f32 v113, v113, v114
  v_mfma_f32_16x16x32_bf16 v[64:67], v[128:131], v[0:3], 0
  ds_read_b128 v[24:27], v104 offset:0
  ds_read_b128 v[28:31], v104 offset:4096
  v_sub_f32 v92, v92, v113
  v_mfma_f32_16x16x32_bf16 v[68:71], v[136:139], v[0:3], 0
  v_sub_f32 v93, v93, v113
  v_sub_f32 v94, v94, v113
  v_mfma_f32_16x16x32_bf16 v[72:75], v[128:131], v[4:7], 0
  v_cvt_pk_bf16_f32 v48, v48, v49
  v_cvt_pk_bf16_f32 v50, v50, v51
  v_mfma_f32_16x16x32_bf16 v[76:79], v[136:139], v[4:7], 0
  s_waitcnt lgkmcnt(4)
  v_cvt_pk_bf16_f32 v49, v52, v53
  v_cvt_pk_bf16_f32 v51, v54, v55
  v_mfma_f32_16x16x32_bf16 v[64:67], v[132:135], v[8:11], v[64:67]
  ds_read_b128 v[0:3], v101 offset:8192
  ds_read_b128 v[4:7], v101 offset:12288
  v_mov_b64 v[52:53], v[48:49]
  v_mfma_f32_16x16x32_bf16 v[68:71], v[140:143], v[8:11], v[68:71]
  v_mov_b64 v[54:55], v[50:51]
  v_permlane16_swap_b32 v48, v50
  v_mfma_f32_16x16x32_bf16 v[72:75], v[132:135], v[12:15], v[72:75]
  v_permlane16_swap_b32 v49, v51
  v_permlane32_swap_b32 v48, v50
  v_mfma_f32_16x16x32_bf16 v[76:79], v[140:143], v[12:15], v[76:79]
  s_waitcnt lgkmcnt(4)
  v_permlane32_swap_b32 v49, v51
  v_bfi_b32 v48, 1, s65, v48
  v_mfma_f32_16x16x32_bf16 v[64:67], v[144:147], v[16:19], v[64:67]
  ds_read_b128 v[8:11], v102 offset:8192
  ds_read_b128 v[12:15], v102 offset:12288
  v_sub_f32 v95, v95, v113
  v_mfma_f32_16x16x32_bf16 v[68:71], v[152:155], v[16:19], v[68:71]
  buffer_store_dwordx4 v[48:51], v100, s[32:35], s91 offen offset:2048 sc1
  v_mfma_f32_16x16x32_bf16 v[72:75], v[144:147], v[20:23], v[72:75]
  v_cvt_pk_bf16_f32 v56, v56, v57
  v_cvt_pk_bf16_f32 v58, v58, v59
  v_mfma_f32_16x16x32_bf16 v[76:79], v[152:155], v[20:23], v[76:79]
  s_waitcnt lgkmcnt(4)
  v_cvt_pk_bf16_f32 v57, v60, v61
  v_cvt_pk_bf16_f32 v59, v62, v63
  v_mfma_f32_16x16x32_bf16 v[64:67], v[148:151], v[24:27], v[64:67]
  ds_read_b128 v[16:19], v103 offset:8192
  ds_read_b128 v[20:23], v103 offset:12288
  v_mov_b64 v[60:61], v[56:57]
  v_mfma_f32_16x16x32_bf16 v[68:71], v[156:159], v[24:27], v[68:71]
  v_mov_b64 v[62:63], v[58:59]
  v_permlane16_swap_b32 v56, v58
  v_mfma_f32_16x16x32_bf16 v[72:75], v[148:151], v[28:31], v[72:75]
  v_permlane16_swap_b32 v57, v59
  v_permlane32_swap_b32 v56, v58
  v_mfma_f32_16x16x32_bf16 v[76:79], v[156:159], v[28:31], v[76:79]
  s_waitcnt lgkmcnt(4)
  v_permlane32_swap_b32 v57, v59
  v_bfi_b32 v56, 1, s65, v56
  v_mfma_f32_16x16x32_bf16 v[64:67], v[160:163], v[0:3], v[64:67]
  ds_read_b128 v[24:27], v104 offset:8192
  ds_read_b128 v[28:31], v104 offset:12288
  v_sub_f32 v96, v96, v113
  v_mfma_f32_16x16x32_bf16 v[68:71], v[168:171], v[0:3], v[68:71]
  buffer_store_dwordx4 v[56:59], v100, s[32:35], s91 offen offset:3072 sc1
  v_mfma_f32_16x16x32_bf16 v[72:75], v[160:163], v[4:7], v[72:75]
  v_sub_f32 v97, v97, v113
  v_sub_f32 v98, v98, v113
  v_mfma_f32_16x16x32_bf16 v[76:79], v[168:171], v[4:7], v[76:79]
  s_waitcnt lgkmcnt(4)
  v_sub_f32 v99, v99, v113
  v_mfma_f32_16x16x32_bf16 v[64:67], v[164:167], v[8:11], v[64:67]
  ds_read_b128 v[0:3], v101 offset:16384
  ds_read_b128 v[4:7], v101 offset:20480
  v_mfma_f32_16x16x32_bf16 v[68:71], v[172:175], v[8:11], v[68:71]
  v_exp_f32 v92, v92
  v_mfma_f32_16x16x32_bf16 v[72:75], v[164:167], v[12:15], v[72:75]
  ds_write_b128 v107, v[52:55] offset:16384
  v_mfma_f32_16x16x32_bf16 v[76:79], v[172:175], v[12:15], v[76:79]
  s_waitcnt lgkmcnt(5)
  v_exp_f32 v93, v93
  v_mfma_f32_16x16x32_bf16 v[64:67], v[176:179], v[16:19], v[64:67]
  ds_read_b128 v[8:11], v102 offset:16384
  ds_read_b128 v[12:15], v102 offset:20480
  v_mfma_f32_16x16x32_bf16 v[68:71], v[184:187], v[16:19], v[68:71]
  v_exp_f32 v94, v94
  v_mfma_f32_16x16x32_bf16 v[72:75], v[176:179], v[20:23], v[72:75]
  ds_write_b128 v107, v[60:63] offset:17408
  v_mfma_f32_16x16x32_bf16 v[76:79], v[184:187], v[20:23], v[76:79]
  s_waitcnt lgkmcnt(6)
  v_exp_f32 v95, v95
  v_mfma_f32_16x16x32_bf16 v[64:67], v[180:183], v[24:27], v[64:67]
  ds_read_b128 v[16:19], v103 offset:16384
  ds_read_b128 v[20:23], v103 offset:20480
  v_mfma_f32_16x16x32_bf16 v[68:71], v[188:191], v[24:27], v[68:71]
  v_exp_f32 v96, v96
  v_mfma_f32_16x16x32_bf16 v[72:75], v[180:183], v[28:31], v[72:75]
  v_exp_f32 v97, v97
  v_mfma_f32_16x16x32_bf16 v[76:79], v[188:191], v[28:31], v[76:79]
  s_waitcnt lgkmcnt(6)
  v_exp_f32 v98, v98
  v_mfma_f32_16x16x32_bf16 v[64:67], v[192:195], v[0:3], v[64:67]
  ds_read_b128 v[24:27], v104 offset:16384
  ds_read_b128 v[28:31], v104 offset:20480
  v_mfma_f32_16x16x32_bf16 v[68:71], v[200:203], v[0:3], v[68:71]
  v_exp_f32 v99, v99
  v_mfma_f32_16x16x32_bf16 v[72:75], v[192:195], v[4:7], v[72:75]
  v_cvt_pk_bf16_f32 v32, v92, v93
  v_cvt_pk_bf16_f32 v33, v96, v97
  v_mfma_f32_16x16x32_bf16 v[76:79], v[200:203], v[4:7], v[76:79]
  s_waitcnt lgkmcnt(5)
  v_cvt_pk_bf16_f32 v34, v94, v95
  v_cvt_pk_bf16_f32 v35, v98, v99
  v_mfma_f32_16x16x32_bf16 v[64:67], v[196:199], v[8:11], v[64:67]
  ds_read_b128 v[0:3], v101 offset:24576
  ds_read_b128 v[4:7], v101 offset:28672
  s_nop 0
  v_mfma_f32_16x16x32_bf16 v[68:71], v[204:207], v[8:11], v[68:71]
  buffer_load_dword v117, v116, s[32:35], s84 offen sc1
  v_mfma_f32_16x16x32_bf16 v[80:83], v[40:43], v[32:35], 0
  ds_read_b128 v[40:43], v115 offset:18432
  v_mfma_f32_16x16x32_bf16 v[84:87], v[44:47], v[32:35], 0
  ds_read_b128 v[44:47], v115 offset:19456
  v_mfma_f32_16x16x32_bf16 v[96:99], v[36:39], v[32:35], 0
  v_mfma_f32_16x16x32_bf16 v[72:75], v[196:199], v[12:15], v[72:75]
  s_waitcnt lgkmcnt(0)
  v_mfma_f32_16x16x32_bf16 v[88:91], v[40:43], v[32:35], 0
  v_mfma_f32_16x16x32_bf16 v[92:95], v[44:47], v[32:35], 0
  v_mfma_f32_16x16x32_bf16 v[76:79], v[204:207], v[12:15], v[76:79]
  v_mfma_f32_16x16x32_bf16 v[64:67], v[208:211], v[16:19], v[64:67]
  ds_read_b128 v[8:11], v102 offset:24576
  ds_read_b128 v[12:15], v102 offset:28672
  v_mfma_f32_16x16x32_bf16 v[68:71], v[216:219], v[16:19], v[68:71]
  v_mfma_f32_16x16x32_bf16 v[72:75], v[208:211], v[20:23], v[72:75]
  v_mfma_f32_16x16x32_bf16 v[76:79], v[216:219], v[20:23], v[76:79]
  s_add_u32 s50, s50, 2
  s_xor_b32 s52, s52, 32768
  s_add_u32 s91, s91, 32768
  v_mfma_f32_16x16x32_bf16 v[64:67], v[212:215], v[24:27], v[64:67]
  ds_read_b128 v[16:19], v103 offset:24576
  ds_read_b128 v[20:23], v103 offset:28672
  v_mfma_f32_16x16x32_bf16 v[68:71], v[220:223], v[24:27], v[68:71]
  s_cmp_eq_u32 s91, s61
  s_cselect_b32 s91, s60, s91
  s_addc_u32 s65, s65, 0
  v_mfma_f32_16x16x32_bf16 v[72:75], v[212:215], v[28:31], v[72:75]
  s_and_b32 s55, s26, 1
  s_lshl_b32 s55, s55, 12
  s_add_u32 s55, s55, s53
  v_mfma_f32_16x16x32_bf16 v[76:79], v[220:223], v[28:31], v[76:79]
  v_add_u32 v107, s55, v100
  v_add_u32 v115, 135424, v100
  v_mfma_f32_16x16x32_bf16 v[64:67], v[224:227], v[0:3], v[64:67]
  ds_read_b128 v[24:27], v104 offset:24576
  ds_read_b128 v[28:31], v104 offset:28672
  v_xor_b32 v101, 32768, v101
  v_xor_b32 v102, 32768, v102
  v_xor_b32 v103, 32768, v103
  v_xor_b32 v104, 32768, v104
  s_cmp_lt_u32 s50, 4
  s_cbranch_scc1 LH_again
LH_att:
  s_waitcnt vmcnt(3)
LH_kmw:
  v_and_b32 v114, v120, v122
  v_bitop3_b32 v114, v114, v124, v126 bitop3:0x80
  v_and_b32 v114, 1, v114
  v_cmp_eq_u32 vcc, 0, v114
  s_cbranch_vccz LH_kmok
  s_sleep 1
  buffer_load_dwordx4 v[120:123], v100, s[32:35], s87 offen offset:0 sc1
  buffer_load_dwordx4 v[124:127], v100, s[32:35], s87 offen offset:1024 sc1
  s_waitcnt vmcnt(0)
  s_add_u32 s56, s56, 1
  s_cmp_lt_u32 s56, 65536
  s_cbranch_scc1 LH_kmw
  s_branch L_abort
LH_kmok:
  s_waitcnt lgkmcnt(0)
  v_mfma_f32_16x16x32_bf16 v[68:71], v[232:235], v[0:3], v[68:71]
  ds_write_b128 v118, v[120:123]
  v_mfma_f32_16x16x32_bf16 v[72:75], v[224:227], v[4:7], v[72:75]
  ds_write_b128 v118, v[124:127] offset:1024
  v_mfma_f32_16x16x32_bf16 v[76:79], v[232:235], v[4:7], v[76:79]
  s_lshl_b32 s54, s51, 18
  s_add_u32 s54, s54, s63
  s_lshl_b32 s86, s51, 11
  v_mfma_f32_16x16x32_bf16 v[64:67], v[228:231], v[8:11], v[64:67]
  s_add_u32 s86, s86, s64
  s_add_u32 s51, s51, 2
  s_xor_b32 s53, s53, 32768
  v_mfma_f32_16x16x32_bf16 v[68:71], v[236:239], v[8:11], v[68:71]
  buffer_load_dword v117, v116, s[32:35], s84 offen sc1
  v_mfma_f32_16x16x32_bf16 v[72:75], v[228:231], v[12:15], v[72:75]
  s_waitcnt lgkmcnt(0)
  v_mfma_f32_16x16x32_bf16 v[76:79], v[236:239], v[12:15], v[76:79]
  s_barrier
  v_mfma_f32_16x16x32_bf16 v[64:67], v[240:243], v[16:19], v[64:67]
  ds_read_b128 v[32:35], v115 offset:0
  ds_read_b128 v[36:39], v115 offset:1024
  v_mfma_f32_16x16x32_bf16 v[68:71], v[248:251], v[16:19], v[68:71]
  ds_read_b128 v[40:43], v115 offset:2048
  ds_read_b128 v[44:47], v115 offset:3072
  v_mfma_f32_16x16x32_bf16 v[72:75], v[240:243], v[20:23], v[72:75]
  ds_read_b128 v[48:51], v115 offset:4096
  v_mov_b64 v[0:1], 0
  v_mov_b64 v[2:3], 0
  v_mfma_f32_16x16x32_bf16 v[76:79], v[248:251], v[20:23], v[76:79]
  ds_read_b128 v[52:55], v115 offset:5120
  v_mov_b64 v[4:5], 0
  v_mov_b64 v[6:7], 0
  v_mfma_f32_16x16x32_bf16 v[64:67], v[244:247], v[24:27], v[64:67]
  ds_read_b128 v[56:59], v115 offset:6144
  v_mov_b64 v[8:9], 0
  v_mov_b64 v[10:11], 0
  v_mfma_f32_16x16x32_bf16 v[68:71], v[252:255], v[24:27], v[68:71]
  ds_read_b128 v[60:63], v115 offset:7168
  v_mov_b64 v[12:13], 0
  v_mov_b64 v[14:15], 0
  v_mfma_f32_16x16x32_bf16 v[72:75], v[244:247], v[28:31], v[72:75]
  v_mfma_f32_16x16x32_bf16 v[76:79], v[252:255], v[28:31], v[76:79]
  s_waitcnt lgkmcnt(4)
  v_smfmac_f32_16x16x64_bf16 v[0:3], v[32:35], a[0:7], v119
  v_smfmac_f32_16x16x64_bf16 v[4:7], v[32:35], a[8:15], v119
  v_cvt_pk_bf16_f32 v64, v64, v68
  v_smfmac_f32_16x16x64_bf16 v[0:3], v[36:39], a[16:23], v119
  v_cvt_pk_bf16_f32 v65, v65, v69
  v_smfmac_f32_16x16x64_bf16 v[4:7], v[36:39], a[24:31], v119
  s_waitcnt lgkmcnt(0)
  v_cvt_pk_bf16_f32 v66, v66, v70
  v_smfmac_f32_16x16x64_bf16 v[0:3], v[40:43], a[32:39], v119
  v_cvt_pk_bf16_f32 v67, v67, v71
  v_smfmac_f32_16x16x64_bf16 v[4:7], v[40:43], a[40:47], v119
  ds_write_b128 v106, v[64:67] offset:0
  v_smfmac_f32_16x16x64_bf16 v[0:3], v[44:47], a[48:55], v119
  v_cvt_pk_bf16_f32 v72, v72, v76
  v_smfmac_f32_16x16x64_bf16 v[4:7], v[44:47], a[56:63], v119
  v_cvt_pk_bf16_f32 v73, v73, v77
  v_smfmac_f32_16x16x64_bf16 v[0:3], v[48:51], a[64:71], v119
  v_cvt_pk_bf16_f32 v74, v74, v78
  v_smfmac_f32_16x16x64_bf16 v[4:7], v[48:51], a[72:79], v119
  v_cvt_pk_bf16_f32 v75, v75, v79
  v_smfmac_f32_16x16x64_bf16 v[0:3], v[52:55], a[80:87], v119
  ds_write_b128 v106, v[72:75] offset:4096
  v_smfmac_f32_16x16x64_bf16 v[4:7], v[52:55], a[88:95], v119
  v_smfmac_f32_16x16x64_bf16 v[0:3], v[56:59], a[96:103], v119
  ds_read_b128 v[64:67], v107 offset:0
  v_smfmac_f32_16x16x64_bf16 v[4:7], v[56:59], a[104:111], v119
  ds_read_b128 v[68:71], v107 offset:1024
  v_smfmac_f32_16x16x64_bf16 v[0:3], v[60:63], a[112:119], v119
  ds_read_b128 v[72:75], v107 offset:2048
  ds_read_b128 v[76:79], v107 offset:3072
  v_smfmac_f32_16x16x64_bf16 v[4:7], v[60:63], a[120:127], v119
  s_waitcnt vmcnt(0)
  v_cmp_eq_u32 vcc, 0, v117
  s_cbranch_vccnz LH_x_w
LH_x:
  s_add_u32 m0, s90, 0
  v_smfmac_f32_16x16x64_bf16 v[8:11], v[32:35], a[128:135], v119
  buffer_load_dwordx4 v105, s[32:35], s88 offen offset:0 sc1 lds
  s_add_u32 m0, s90, 1024
  v_add_f32 v0, v0, v2
  v_add_f32 v1, v1, v3
  v_smfmac_f32_16x16x64_bf16 v[12:15], v[32:35], a[136:143], v119
  v_add_f32 v4, v4, v6
  v_add_f32 v5, v5, v7
  v_smfmac_f32_16x16x64_bf16 v[8:11], v[36:39], a[144:151], v119
  buffer_load_dwordx4 v105, s[32:35], s89 offen offset:0 sc1 lds
  s_add_u32 m0, s90, 7936
  v_cvt_pk_bf16_f32 v120, v0, v4
  v_cvt_pk_bf16_f32 v121, v1, v5
  v_smfmac_f32_16x16x64_bf16 v[12:15], v[36:39], a[152:159], v119
  ds_write2_b32 v108, v120, v121 offset0:0 offset1:68
  v_smfmac_f32_16x16x64_bf16 v[8:11], v[40:43], a[160:167], v119
  buffer_load_dwordx4 v105, s[32:35], s88 offen offset:256 sc1 lds
  s_add_u32 m0, s90, 8960
  v_mov_b32 v0, 0x3f803f80
  v_smfmac_f32_16x16x64_bf16 v[12:15], v[40:43], a[168:175], v119
  buffer_load_dwordx4 v105, s[32:35], s89 offen offset:256 sc1 lds
  s_add_u32 m0, s90, 15872
  v_mov_b32 v1, 0x3f803f80
  v_smfmac_f32_16x16x64_bf16 v[8:11], v[44:47], a[176:183], v119
  s_waitcnt lgkmcnt(0)
  s_barrier
  v_smfmac_f32_16x16x64_bf16 v[12:15], v[44:47], a[184:191], v119
  ds_read_b128 v[16:19], v109
  ds_read_b128 v[20:23], v109 offset:64
  v_smfmac_f32_16x16x64_bf16 v[8:11], v[48:51], a[192:199], v119
  ds_read_b128 v[24:27], v109 offset:128
  ds_read_b128 v[28:31], v109 offset:192
  v_smfmac_f32_16x16x64_bf16 v[12:15], v[48:51], a[200:207], v119
  buffer_load_dwordx4 v105, s[32:35], s88 offen offset:512 sc1 lds
  s_add_u32 m0, s90, 16896
  v_mov_b32 v5, 0
  v_smfmac_f32_16x16x64_bf16 v[8:11], v[52:55], a[208:215], v119
  v_mov_b32 v6, 0
  v_smfmac_f32_16x16x64_bf16 v[12:15], v[52:55], a[216:223], v119
  buffer_load_dwordx4 v105, s[32:35], s89 offen offset:512 sc1 lds
  s_add_u32 m0, s90, 23808
  v_mov_b32 v2, v113
  v_smfmac_f32_16x16x64_bf16 v[8:11], v[56:59], a[224:231], v119
  s_waitcnt lgkmcnt(0)
  v_mfma_f32_16x16x32_bf16 v[124:127], v[16:19], v[64:67], 0
  v_mfma_f32_16x16x32_bf16 v[124:127], v[20:23], v[68:71], v[124:127]
  v_mfma_f32_16x16x32_bf16 v[124:127], v[24:27], v[72:75], v[124:127]
  v_mfma_f32_16x16x32_bf16 v[124:127], v[28:31], v[76:79], v[124:127]
  v_smfmac_f32_16x16x64_bf16 v[12:15], v[56:59], a[232:239], v119
  buffer_load_dwordx4 v105, s[32:35], s88 offen offset:768 sc1 lds
  s_add_u32 m0, s90, 24832
  v_smfmac_f32_16x16x64_bf16 v[8:11], v[60:63], a[240:247], v119
  v_mul_f32 v124, s57, v124
  v_smfmac_f32_16x16x64_bf16 v[12:15], v[60:63], a[248:255], v119
  buffer_load_dwordx4 v105, s[32:35], s89 offen offset:768 sc1 lds
  v_mul_f32 v125, s57, v125
  v_max3_f32 v113, v113, v124, v125
  v_mov_b32 v114, v113
  v_add_f32 v8, v8, v10
  v_add_f32 v9, v9, v11
  v_permlane16_swap_b32 v113, v114
  v_max_f32 v113, v113, v114
  v_mov_b32 v114, v113
  v_add_f32 v12, v12, v14
  v_add_f32 v13, v13, v15
  v_cvt_pk_bf16_f32 v122, v8, v9
  v_cvt_pk_bf16_f32 v123, v12, v13
  ds_write_b64 v110, v[122:123]
  v_permlane32_swap_b32 v113, v114
  v_max_f32 v113, v113, v114
  v_sub_f32 v2, v2, v113
  v_sub_f32 v124, v124, v113
  v_sub_f32 v125, v125, v113
  v_exp_f32 v2, v2
  v_exp_f32 v124, v124
  v_exp_f32 v125, v125
  v_mul_f32 v96, v96, v2
  v_cvt_pk_bf16_f32 v4, v124, v125
  v_cvt_pk_bf16_f32 v7, v124, v125
  s_waitcnt lgkmcnt(0)
  v_mfma_f32_16x16x16_bf16 v[96:99], v[0:1], v[4:5], v[96:99]
  s_barrier
  v_pk_mul_f32 v[80:81], v[80:81], v[2:3] op_sel_hi:[1,0]
  ds_read_b64 v[120:121], v111 offset:0
  ds_read_b64 v[122:123], v111 offset:512
  v_pk_mul_f32 v[82:83], v[82:83], v[2:3] op_sel_hi:[1,0]
  v_pk_mul_f32 v[84:85], v[84:85], v[2:3] op_sel_hi:[1,0]
  v_pk_mul_f32 v[86:87], v[86:87], v[2:3] op_sel_hi:[1,0]
  v_pk_mul_f32 v[88:89], v[88:89], v[2:3] op_sel_hi:[1,0]
  v_pk_mul_f32 v[90:91], v[90:91], v[2:3] op_sel_hi:[1,0]
  v_pk_mul_f32 v[92:93], v[92:93], v[2:3] op_sel_hi:[1,0]
  v_pk_mul_f32 v[94:95], v[94:95], v[2:3] op_sel_hi:[1,0]
  v_rcp_f32 v96, v96
  s_waitcnt lgkmcnt(0)
  v_mfma_f32_16x16x16_bf16 v[80:83], v[120:121], v[4:5], v[80:83]
  v_mfma_f32_16x16x16_bf16 v[84:87], v[120:121], v[6:7], v[84:87]
  v_mfma_f32_16x16x16_bf16 v[88:91], v[122:123], v[4:5], v[88:91]
  v_mfma_f32_16x16x16_bf16 v[92:95], v[122:123], v[6:7], v[92:95]
  v_pk_mul_f32 v[80:81], v[80:81], v[96:97] op_sel_hi:[1,0]
  v_pk_mul_f32 v[82:83], v[82:83], v[96:97] op_sel_hi:[1,0]
  v_pk_mul_f32 v[84:85], v[84:85], v[96:97] op_sel_hi:[1,0]
  v_pk_mul_f32 v[86:87], v[86:87], v[96:97] op_sel_hi:[1,0]
  v_cvt_pk_bf16_f32 v80, v80, v84
  v_cvt_pk_bf16_f32 v81, v81, v85
  v_cvt_pk_bf16_f32 v82, v82, v86
  v_cvt_pk_bf16_f32 v83, v83, v87
  buffer_store_dwordx4 v[80:83], v100, s[32:35], s54 offen offset:0 sc1
  v_pk_mul_f32 v[88:89], v[88:89], v[96:97] op_sel_hi:[1,0]
  v_pk_mul_f32 v[90:91], v[90:91], v[96:97] op_sel_hi:[1,0]
  v_pk_mul_f32 v[92:93], v[92:93], v[96:97] op_sel_hi:[1,0]
  v_pk_mul_f32 v[94:95], v[94:95], v[96:97] op_sel_hi:[1,0]
  v_cvt_pk_bf16_f32 v88, v88, v92
  v_cvt_pk_bf16_f32 v89, v89, v93
  v_cvt_pk_bf16_f32 v90, v90, v94
  v_cvt_pk_bf16_f32 v91, v91, v95
  buffer_store_dwordx4 v[88:91], v100, s[32:35], s54 offen offset:1024 sc1
  s_cmp_lt_u32 s50, 64
  s_cbranch_scc1 LH_top
  s_cmp_ge_u32 s51, 64
  s_cbranch_scc1 LH_fin
  v_add_u32 v115, s53, v100
  s_and_b32 s55, s26, 1
  s_lshl_b32 s55, s55, 12
  v_add_u32 v114, s55, v115
  v_mov_b32 v117, 0xff7fffff
  ds_read_b128 v[32:35], v114 offset:0
  ds_read_b128 v[36:39], v115 offset:8192
  ds_read_b128 v[40:43], v115 offset:12288
  ds_read_b128 v[80:83], v114 offset:1024
  ds_read_b128 v[84:87], v115 offset:9216
  ds_read_b128 v[88:91], v115 offset:13312
  s_waitcnt lgkmcnt(3)
  v_mfma_f32_16x16x32_bf16 v[92:95], v[36:39], v[32:35], 0
  v_mfma_f32_16x16x32_bf16 v[96:99], v[40:43], v[32:35], 0
  ds_read_b128 v[32:35], v114 offset:2048
  ds_read_b128 v[36:39], v115 offset:10240
  ds_read_b128 v[40:43], v115 offset:14336
  s_waitcnt lgkmcnt(3)
  v_mfma_f32_16x16x32_bf16 v[92:95], v[84:87], v[80:83], v[92:95]
  v_mfma_f32_16x16x32_bf16 v[96:99], v[88:91], v[80:83], v[96:99]
  ds_read_b128 v[80:83], v114 offset:3072
  ds_read_b128 v[84:87], v115 offset:11264
  ds_read_b128 v[88:91], v115 offset:15360
  s_waitcnt lgkmcnt(3)
  v_mfma_f32_16x16x32_bf16 v[92:95], v[36:39], v[32:35], v[92:95]
  v_mfma_f32_16x16x32_bf16 v[96:99], v[40:43], v[32:35], v[96:99]
  s_waitcnt lgkmcnt(0)
  v_mfma_f32_16x16x32_bf16 v[92:95], v[84:87], v[80:83], v[92:95]
  v_mfma_f32_16x16x32_bf16 v[96:99], v[88:91], v[80:83], v[96:99]
  s_lshr_b32 s55, s26, 1
  s_lshl_b32 s55, s55, 12
  v_add_u32 v115, s55, v115
  v_mov_b32 v36, 0x3f803f80
  v_mov_b32 v37, 0x3f803f80
  v_mov_b32 v38, 0x3f803f80
  v_mov_b32 v39, 0x3f803f80
  ds_read_b128 v[40:43], v115 offset:16384
  ds_read_b128 v[44:47], v115 offset:17408
  v_cndmask_b32 v92, v117, v92, s[66:67]
  v_cndmask_b32 v93, v117, v93, s[68:69]
  v_cndmask_b32 v94, v117, v94, s[70:71]
  v_cndmask_b32 v95, v117, v95, s[72:73]
  v_cndmask_b32 v96, v117, v96, s[74:75]
  v_cndmask_b32 v97, v117, v97, s[76:77]
  v_cndmask_b32 v98, v117, v98, s[78:79]
  v_cndmask_b32 v99, v117, v99, s[80:81]
  v_max3_f32 v113, v92, v93, v94
  v_max3_f32 v113, v113, v95, v96
  v_max3_f32 v113, v113, v97, v98
  v_max_f32 v113, v113, v99
  v_mov_b32 v114, v113
  s_nop 1
  v_permlane16_swap_b32 v113, v114
  v_max_f32 v113, v113, v114
  v_mov_b32 v114, v113
  s_nop 1
  v_permlane32_swap_b32 v113, v114
  v_max_f32 v113, v113, v114
  v_sub_f32 v92, v92, v113
  v_sub_f32 v93, v93, v113
  v_sub_f32 v94, v94, v113
  v_sub_f32 v95, v95, v113
  v_sub_f32 v96, v96, v113
  v_sub_f32 v97, v97, v113
  v_sub_f32 v98, v98, v113
  v_sub_f32 v99, v99, v113
  v_exp_f32 v92, v92
  v_exp_f32 v93, v93
  v_exp_f32 v94, v94
  v_exp_f32 v95, v95
  v_exp_f32 v96, v96
  v_exp_f32 v97, v97
  v_exp_f32 v98, v98
  v_exp_f32 v99, v99
  v_cvt_pk_bf16_f32 v32, v92, v93
  v_cvt_pk_bf16_f32 v33, v96, v97
  v_cvt_pk_bf16_f32 v34, v94, v95
  v_cvt_pk_bf16_f32 v35, v98, v99
  s_waitcnt lgkmcnt(0)
  s_nop 0
  v_mfma_f32_16x16x32_bf16 v[80:83], v[40:43], v[32:35], 0
  ds_read_b128 v[40:43], v115 offset:18432
  v_mfma_f32_16x16x32_bf16 v[84:87], v[44:47], v[32:35], 0
  ds_read_b128 v[44:47], v115 offset:19456
  v_mfma_f32_16x16x32_bf16 v[96:99], v[36:39], v[32:35], 0
  s_waitcnt lgkmcnt(0)
  v_mfma_f32_16x16x32_bf16 v[88:91], v[40:43], v[32:35], 0
  v_mfma_f32_16x16x32_bf16 v[92:95], v[44:47], v[32:35], 0
  s_and_b32 s55, s26, 1
  s_lshl_b32 s55, s55, 12
  s_add_u32 s55, s55, s53
  v_add_u32 v107, s55, v100
  v_add_u32 v115, 135424, v100
  v_xor_b32 v106, 32768, v106
  s_lshl_b32 s87, s51, 13
  s_add_u32 s87, s87, s62
  buffer_load_dwordx4 v[120:123], v100, s[32:35], s87 offen offset:0 sc1
  buffer_load_dwordx4 v[124:127], v100, s[32:35], s87 offen offset:1024 sc1
  s_waitcnt vmcnt(2)
  s_mov_b64 exec, 1
  buffer_store_dword v109, off, s[32:35], s86 sc1
  s_mov_b64 exec, -1
  s_mov_b32 s86, 0x40000000
  s_waitcnt vmcnt(1)
  s_branch LH_att
LH_again:
  s_waitcnt lgkmcnt(0)
  v_mfma_f32_16x16x32_bf16 v[68:71], v[232:235], v[0:3], v[68:71]
  v_mfma_f32_16x16x32_bf16 v[72:75], v[224:227], v[4:7], v[72:75]
  v_mfma_f32_16x16x32_bf16 v[76:79], v[232:235], v[4:7], v[76:79]
  v_mfma_f32_16x16x32_bf16 v[64:67], v[228:231], v[8:11], v[64:67]
  v_mfma_f32_16x16x32_bf16 v[68:71], v[236:239], v[8:11], v[68:71]
  v_mfma_f32_16x16x32_bf16 v[72:75], v[228:231], v[12:15], v[72:75]
  v_mfma_f32_16x16x32_bf16 v[76:79], v[236:239], v[12:15], v[76:79]
  v_mfma_f32_16x16x32_bf16 v[64:67], v[240:243], v[16:19], v[64:67]
  v_mfma_f32_16x16x32_bf16 v[68:71], v[248:251], v[16:19], v[68:71]
  v_mfma_f32_16x16x32_bf16 v[72:75], v[240:243], v[20:23], v[72:75]
  v_mfma_f32_16x16x32_bf16 v[76:79], v[248:251], v[20:23], v[76:79]
  v_mfma_f32_16x16x32_bf16 v[64:67], v[244:247], v[24:27], v[64:67]
  v_mfma_f32_16x16x32_bf16 v[68:71], v[252:255], v[24:27], v[68:71]
  v_mfma_f32_16x16x32_bf16 v[72:75], v[244:247], v[28:31], v[72:75]
  v_mfma_f32_16x16x32_bf16 v[76:79], v[252:255], v[28:31], v[76:79]
  v_cvt_pk_bf16_f32 v64, v64, v68
  v_cvt_pk_bf16_f32 v65, v65, v69
  v_cvt_pk_bf16_f32 v66, v66, v70
  v_cvt_pk_bf16_f32 v67, v67, v71
  ds_write_b128 v106, v[64:67] offset:0
  s_nop 2
  v_cvt_pk_bf16_f32 v72, v72, v76
  v_cvt_pk_bf16_f32 v73, v73, v77
  v_cvt_pk_bf16_f32 v74, v74, v78
  v_cvt_pk_bf16_f32 v75, v75, v79
  ds_write_b128 v106, v[72:75] offset:4096
  s_cmp_eq_u32 s92, 0
  s_cbranch_scc1 LH_more
  s_waitcnt vmcnt(0)
  s_branch LH_top
LH_fin:
  s_waitcnt vmcnt(0)
  s_mov_b64 exec, 1
  buffer_store_dword v109, off, s[32:35], s86 sc1
  s_mov_b64 exec, -1
  s_mov_b32 s86, 0x40000000
  s_branch L_head_done
LH_x_w:
  s_add_u32 s56, s56, 1
  s_cmp_ge_u32 s56, 65536
  s_cbranch_scc1 L_abort
  buffer_load_dword v117, v116, s[32:35], s84 offen sc1
  s_waitcnt vmcnt(0)
  v_cmp_eq_u32 vcc, 0, v117
  s_cbranch_vccz LH_x
  s_sleep 1
  s_branch LH_x_w
L_head_done:
  s_branch L_end
L_post:
  v_and_b32 v1, 63, v0
  v_lshlrev_b32 v96, 4, v1
  s_cmp_eq_u32 s29, 0
  s_cbranch_scc1 L_noln
  v_lshrrev_b32 v2, 8, v96
  v_bfe_u32 v3, v96, 4, 4
  s_and_b32 s63, s28, 7
  v_lshrrev_b32 v108, 2, v96
  v_lshrrev_b32 v4, 1, v3
  v_and_b32 v5, 16, v96
  v_mov_b32 v6, 0x3f80
  v_lshlrev_b32 v6, v5, v6
  v_cmp_eq_u32 vcc, 0, v4
  s_nop 1
  v_cndmask_b32 v112, 0, v6, vcc
  v_cmp_eq_u32 vcc, 1, v4
  s_nop 1
  v_cndmask_b32 v113, 0, v6, vcc
  v_cmp_eq_u32 vcc, 2, v4
  s_nop 1
  v_cndmask_b32 v114, 0, v6, vcc
  v_cmp_eq_u32 vcc, 3, v4
  s_nop 1
  v_cndmask_b32 v115, 0, v6, vcc
  v_cmp_eq_u32 vcc, 4, v4
  s_nop 1
  v_cndmask_b32 v116, 0, v6, vcc
  v_cmp_eq_u32 vcc, 5, v4
  s_nop 1
  v_cndmask_b32 v117, 0, v6, vcc
  v_cmp_eq_u32 vcc, 6, v4
  s_nop 1
  v_cndmask_b32 v118, 0, v6, vcc
  v_cmp_eq_u32 vcc, 7, v4
  s_nop 1
  v_cndmask_b32 v119, 0, v6, vcc
  v_add_u32 v4, 78400, v96
  ds_write_b128 v4, v[112:115]
  ds_write_b128 v4, v[116:119] offset:1024
  v_and_b32 v4, 1, v2
  s_lshl_b32 s51, s63, 1
  v_add_u32 v5, s51, v4
  v_lshrrev_b32 v6, 1, v2
  s_lshl_b32 s51, s26, 8
  v_lshlrev_b32 v7, 10, v5
  v_add_u32 v7, s51, v7
  v_lshl_add_u32 v8, v6, 7, v7
  v_lshl_add_u32 v103, v3, 3, v8
  v_lshrrev_b32 v8, 1, v3
  v_lshl_add_u32 v8, v6, 3, v8
  v_and_b32 v9, 15, v5
  v_xor_b32 v8, v8, v9
  v_lshl_add_u32 v8, v8, 4, v7
  v_and_b32 v9, 1, v3
  v_lshl_add_u32 v104, v9, 3, v8
  v_lshlrev_b32 v8, 6, v4
  v_add_u32 v106, 77824, v8
  s_lshl_b32 s51, s26, 3
  v_add_u32 v105, s51, v106
  v_lshl_add_u32 v105, v6, 2, v105
  s_lshl_b32 s51, s26, 2
  s_add_u32 s51, s51, 78336
  v_mov_b32 v110, s51
  s_mov_b32 s53, 0
  s_mov_b32 s69, 0
  s_waitcnt lgkmcnt(0)
  s_mov_b32 s36, s4
  s_and_b32 s37, s5, 0xffff
  s_mov_b32 s38, 2097152
  s_mov_b32 s39, 0x20000
  s_mov_b32 s61, 18874368
  s_lshl_b32 s62, s63, 7
  s_lshl_b32 s51, s26, 2
  s_add_u32 s62, s62, s51
  s_add_u32 s62, s62, 0
  s_lshr_b32 s92, s28, 3
  s_mov_b32 s93, 1073741824
  s_lshl_b32 s52, s92, 15
  buffer_load_dwordx2 v[56:57], v103, s[36:39], s52 offen sc1
  s_add_u32 s52, s52, 16384
  buffer_load_dwordx2 v[58:59], v103, s[36:39], s52 offen sc1
  s_waitcnt vmcnt(0)
LN_top:
  s_lshl_b32 s84, s92, 15
  s_lshl_b32 s90, s92, 15
  s_add_u32 s90, s90, 16384
  s_waitcnt vmcnt(2)
  v_lshlrev_b32 v36, 16, v56
  v_and_b32 v37, 0xffff0000, v56
  v_lshlrev_b32 v38, 16, v57
  v_and_b32 v39, 0xffff0000, v57
  v_lshlrev_b32 v44, 16, v58
  v_and_b32 v45, 0xffff0000, v58
  v_lshlrev_b32 v46, 16, v59
  v_and_b32 v47, 0xffff0000, v59
  s_add_u32 s50, s92, 4
  s_lshl_b32 s52, s50, 15
  buffer_load_dwordx2 v[56:57], v103, s[36:39], s52 offen sc1
  s_add_u32 s52, s52, 16384
  buffer_load_dwordx2 v[58:59], v103, s[36:39], s52 offen sc1
  v_add_f32 v0, v36, v37
  v_add_f32 v16, v44, v45
  v_mul_f32 v1, v36, v36
  v_mul_f32 v17, v44, v44
  v_add_f32 v2, v38, v39
  v_add_f32 v18, v46, v47
  v_fmac_f32 v1, v37, v37
  v_fmac_f32 v17, v45, v45
  v_add_f32 v0, v0, v2
  v_add_f32 v16, v16, v18
  v_fmac_f32 v1, v38, v38
  v_fmac_f32 v17, v46, v46
  v_fmac_f32 v1, v39, v39
  v_fmac_f32 v17, v47, v47
  v_add_f32_dpp v0, v0, v0 row_ror:8 row_mask:0xf bank_mask:0xf
  v_add_f32_dpp v16, v16, v16 row_ror:8 row_mask:0xf bank_mask:0xf
  v_add_f32_dpp v1, v1, v1 row_ror:8 row_mask:0xf bank_mask:0xf
  v_add_f32_dpp v17, v17, v17 row_ror:8 row_mask:0xf bank_mask:0xf
  v_add_f32_dpp v0, v0, v0 row_ror:4 row_mask:0xf bank_mask:0xf
  v_add_f32_dpp v16, v16, v16 row_ror:4 row_mask:0xf bank_mask:0xf
  v_add_f32_dpp v1, v1, v1 row_ror:4 row_mask:0xf bank_mask:0xf
  v_add_f32_dpp v17, v17, v17 row_ror:4 row_mask:0xf bank_mask:0xf
  v_add_f32_dpp v0, v0, v0 row_ror:2 row_mask:0xf bank_mask:0xf
  v_add_f32_dpp v16, v16, v16 row_ror:2 row_mask:0xf bank_mask:0xf
  v_add_f32_dpp v1, v1, v1 row_ror:2 row_mask:0xf bank_mask:0xf
  v_add_f32_dpp v17, v17, v17 row_ror:2 row_mask:0xf bank_mask:0xf
  v_add_f32_dpp v0, v0, v0 row_ror:1 row_mask:0xf bank_mask:0xf
  v_add_f32_dpp v16, v16, v16 row_ror:1 row_mask:0xf bank_mask:0xf
  v_add_f32_dpp v1, v1, v1 row_ror:1 row_mask:0xf bank_mask:0xf
  v_add_f32_dpp v17, v17, v17 row_ror:1 row_mask:0xf bank_mask:0xf
  s_nop 0
  v_permlane32_swap_b32 v0, v1
  v_permlane32_swap_b32 v16, v17
  v_add_f32 v0, v0, v1
  v_add_f32 v16, v16, v17
  ds_write_b32 v105, v0 offset:0
  ds_write_b32 v105, v16 offset:128
  s_waitcnt lgkmcnt(0)
  s_barrier
  ds_read_b128 v[0:3], v106 offset:0
  ds_read_b128 v[4:7], v106 offset:16
  ds_read_b128 v[16:19], v106 offset:128
  ds_read_b128 v[20:23], v106 offset:144
  s_waitcnt vmcnt(2)
  s_mov_b64 exec, 1
  buffer_store_dword v110, off, s[32:35], s93 sc1
  s_mov_b64 exec, -1
  v_xor_b32 v105, 256, v105
  v_xor_b32 v106, 256, v106
  s_lshl_b32 s93, s92, 11
  s_add_u32 s93, s93, s62
  v_bfe_u32 v68, v96, 4, 1
  v_mul_u32_u24 v68, 16376, v68
  v_add_u32 v68, v68, v104
  s_waitcnt lgkmcnt(2)
  s_waitcnt lgkmcnt(0)
  v_pk_add_f32 v[0:1], v[0:1], v[4:5]
  v_pk_add_f32 v[16:17], v[16:17], v[20:21]
  v_pk_add_f32 v[2:3], v[2:3], v[6:7]
  v_pk_add_f32 v[18:19], v[18:19], v[22:23]
  v_pk_add_f32 v[0:1], v[0:1], v[2:3]
  v_pk_add_f32 v[16:17], v[16:17], v[18:19]
  v_mul_f32 v0, 0x3b000000, v0
  v_mul_f32 v16, 0x3b000000, v16
  v_mul_f32 v1, 0x3b000000, v1
  v_mul_f32 v17, 0x3b000000, v17
  v_fma_f32 v1, -v0, v0, v1
  v_fma_f32 v17, -v16, v16, v17
  v_max_f32 v1, 0, v1
  v_max_f32 v17, 0, v17
  v_add_f32 v1, 0x3727c5ac, v1
  v_add_f32 v17, 0x3727c5ac, v17
  v_rsq_f32 v1, v1
  v_rsq_f32 v17, v17
  s_add_u32 s86, s84, s61
  s_add_u32 s87, s90, s61
  v_mul_f32 v0, v0, v1
  v_mul_f32 v16, v16, v17
  v_fma_f32 v4, v36, v1, -v0
  v_fma_f32 v20, v44, v17, -v16
  v_fma_f32 v5, v37, v1, -v0
  v_fma_f32 v21, v45, v17, -v16
  v_fma_f32 v6, v38, v1, -v0
  v_fma_f32 v22, v46, v17, -v16
  v_fma_f32 v7, v39, v1, -v0
  v_fma_f32 v23, v47, v17, -v16
  v_cvt_pk_bf16_f32 v34, v4, v5
  v_cvt_pk_bf16_f32 v42, v20, v21
  v_cvt_pk_bf16_f32 v35, v6, v7
  v_cvt_pk_bf16_f32 v43, v22, v23
  s_mov_b32 vcc_lo, 0x55555555
  s_mov_b32 vcc_hi, 0x55555555
  v_cndmask_b32_dpp v64, v42, v34, vcc quad_perm:[1,0,3,2] row_mask:0xf bank_mask:0xf
  v_cndmask_b32_dpp v65, v43, v35, vcc quad_perm:[1,0,3,2] row_mask:0xf bank_mask:0xf
  s_not_b64 vcc, vcc
  v_cndmask_b32_dpp v66, v34, v42, vcc quad_perm:[1,0,3,2] row_mask:0xf bank_mask:0xf
  v_cndmask_b32_dpp v67, v35, v43, vcc quad_perm:[1,0,3,2] row_mask:0xf bank_mask:0xf
  v_or_b32 v64, 1, v64
  buffer_store_dwordx4 v[64:67], v68, s[32:35], s86 offen sc1
  s_mov_b32 s92, s50
  s_cmp_lt_u32 s92, 64
  s_cbranch_scc1 LN_top
  s_waitcnt vmcnt(0)
  s_mov_b64 exec, 1
  buffer_store_dword v110, off, s[32:35], s93 sc1
  s_mov_b64 exec, -1
  s_waitcnt vmcnt(0)
L_noln:
  s_cmp_ge_u32 s28, 16
  s_cbranch_scc1 L_ffn
  v_lshrrev_b32 v108, 8, v96
  v_bfe_u32 v109, v96, 4, 4
  s_lshr_b32 s51, s28, 1
  s_lshl_b32 s51, s51, 19
  s_and_b32 s52, s28, 1
  s_lshl_b32 s52, s52, 9
  s_add_u32 s51, s51, s52
  s_lshl_b32 s52, s26, 7
  s_add_u32 s51, s51, s52
  v_lshlrev_b32 v110, 13, v108
  v_lshl_add_u32 v110, v109, 3, v110
  v_add_u32 v110, s51, v110
  s_mov_b32 s36, s14
  s_and_b32 s37, s15, 0xffff
  s_mov_b32 s38, 4194304
  s_mov_b32 s39, 0x20000
  s_mov_b32 s52, 0
  buffer_load_dwordx2 v[0:1], v110, s[36:39], s52 offen
  s_mov_b32 s52, 1024
  buffer_load_dwordx2 v[2:3], v110, s[36:39], s52 offen
  s_mov_b32 s52, 2048
  buffer_load_dwordx2 v[4:5], v110, s[36:39], s52 offen
  s_mov_b32 s52, 3072
  buffer_load_dwordx2 v[6:7], v110, s[36:39], s52 offen
  s_mov_b32 s52, 4096
  buffer_load_dwordx2 v[8:9], v110, s[36:39], s52 offen
  s_mov_b32 s52, 5120
  buffer_load_dwordx2 v[10:11], v110, s[36:39], s52 offen
  s_mov_b32 s52, 6144
  buffer_load_dwordx2 v[12:13], v110, s[36:39], s52 offen
  s_mov_b32 s52, 7168
  buffer_load_dwordx2 v[14:15], v110, s[36:39], s52 offen
  s_mov_b32 s52, 32768
  buffer_load_dwordx2 v[16:17], v110, s[36:39], s52 offen
  s_mov_b32 s52, 33792
  buffer_load_dwordx2 v[18:19], v110, s[36:39], s52 offen
  s_mov_b32 s52, 34816
  buffer_load_dwordx2 v[20:21], v110, s[36:39], s52 offen
  s_mov_b32 s52, 35840
  buffer_load_dwordx2 v[22:23], v110, s[36:39], s52 offen
  s_mov_b32 s52, 36864
  buffer_load_dwordx2 v[24:25], v110, s[36:39], s52 offen
  s_mov_b32 s52, 37888
  buffer_load_dwordx2 v[26:27], v110, s[36:39], s52 offen
  s_mov_b32 s52, 38912
  buffer_load_dwordx2 v[28:29], v110, s[36:39], s52 offen
  s_mov_b32 s52, 39936
  buffer_load_dwordx2 v[30:31], v110, s[36:39], s52 offen
  s_mov_b32 s52, 65536
  buffer_load_dwordx2 v[32:33], v110, s[36:39], s52 offen
  s_mov_b32 s52, 66560
  buffer_load_dwordx2 v[34:35], v110, s[36:39], s52 offen
  s_mov_b32 s52, 67584
  buffer_load_dwordx2 v[36:37], v110, s[36:39], s52 offen
  s_mov_b32 s52, 68608
  buffer_load_dwordx2 v[38:39], v110, s[36:39], s52 offen
  s_mov_b32 s52, 69632
  buffer_load_dwordx2 v[40:41], v110, s[36:39], s52 offen
  s_mov_b32 s52, 70656
  buffer_load_dwordx2 v[42:43], v110, s[36:39], s52 offen
  s_mov_b32 s52, 71680
  buffer_load_dwordx2 v[44:45], v110, s[36:39], s52 offen
  s_mov_b32 s52, 72704
  buffer_load_dwordx2 v[46:47], v110, s[36:39], s52 offen
  s_mov_b32 s52, 98304
  buffer_load_dwordx2 v[48:49], v110, s[36:39], s52 offen
  s_mov_b32 s52, 99328
  buffer_load_dwordx2 v[50:51], v110, s[36:39], s52 offen
  s_mov_b32 s52, 100352
  buffer_load_dwordx2 v[52:53], v110, s[36:39], s52 offen
  s_mov_b32 s52, 101376
  buffer_load_dwordx2 v[54:55], v110, s[36:39], s52 offen
  s_mov_b32 s52, 102400
  buffer_load_dwordx2 v[56:57], v110, s[36:39], s52 offen
  s_mov_b32 s52, 103424
  buffer_load_dwordx2 v[58:59], v110, s[36:39], s52 offen
  s_mov_b32 s52, 104448
  buffer_load_dwordx2 v[60:61], v110, s[36:39], s52 offen
  s_mov_b32 s52, 105472
  buffer_load_dwordx2 v[62:63], v110, s[36:39], s52 offen
  s_mov_b32 s52, 131072
  buffer_load_dwordx2 v[64:65], v110, s[36:39], s52 offen
  s_mov_b32 s52, 132096
  buffer_load_dwordx2 v[66:67], v110, s[36:39], s52 offen
  s_mov_b32 s52, 133120
  buffer_load_dwordx2 v[68:69], v110, s[36:39], s52 offen
  s_mov_b32 s52, 134144
  buffer_load_dwordx2 v[70:71], v110, s[36:39], s52 offen
  s_mov_b32 s52, 135168
  buffer_load_dwordx2 v[72:73], v110, s[36:39], s52 offen
  s_mov_b32 s52, 136192
  buffer_load_dwordx2 v[74:75], v110, s[36:39], s52 offen
  s_mov_b32 s52, 137216
  buffer_load_dwordx2 v[76:77], v110, s[36:39], s52 offen
  s_mov_b32 s52, 138240
  buffer_load_dwordx2 v[78:79], v110, s[36:39], s52 offen
  s_mov_b32 s52, 163840
  buffer_load_dwordx2 v[80:81], v110, s[36:39], s52 offen
  s_mov_b32 s52, 164864
  buffer_load_dwordx2 v[82:83], v110, s[36:39], s52 offen
  s_mov_b32 s52, 165888
  buffer_load_dwordx2 v[84:85], v110, s[36:39], s52 offen
  s_mov_b32 s52, 166912
  buffer_load_dwordx2 v[86:87], v110, s[36:39], s52 offen
  s_mov_b32 s52, 167936
  buffer_load_dwordx2 v[88:89], v110, s[36:39], s52 offen
  s_mov_b32 s52, 168960
  buffer_load_dwordx2 v[90:91], v110, s[36:39], s52 offen
  s_mov_b32 s52, 169984
  buffer_load_dwordx2 v[92:93], v110, s[36:39], s52 offen
  s_mov_b32 s52, 171008
  buffer_load_dwordx2 v[94:95], v110, s[36:39], s52 offen
  s_waitcnt vmcnt(32)
  v_perm_b32 v120, v2, v0, s48
  v_perm_b32 v121, v6, v4, s48
  v_perm_b32 v122, v10, v8, s48
  v_perm_b32 v123, v14, v12, s48
  v_accvgpr_write_b32 a0, v120
  v_accvgpr_write_b32 a1, v121
  v_accvgpr_write_b32 a2, v122
  v_accvgpr_write_b32 a3, v123
  v_perm_b32 v120, v2, v0, s49
  v_perm_b32 v121, v6, v4, s49
  v_perm_b32 v122, v10, v8, s49
  v_perm_b32 v123, v14, v12, s49
  v_accvgpr_write_b32 a4, v120
  v_accvgpr_write_b32 a5, v121
  v_accvgpr_write_b32 a6, v122
  v_accvgpr_write_b32 a7, v123
  v_perm_b32 v120, v3, v1, s48
  v_perm_b32 v121, v7, v5, s48
  v_perm_b32 v122, v11, v9, s48
  v_perm_b32 v123, v15, v13, s48
  v_accvgpr_write_b32 a8, v120
  v_accvgpr_write_b32 a9, v121
  v_accvgpr_write_b32 a10, v122
  v_accvgpr_write_b32 a11, v123
  v_perm_b32 v120, v3, v1, s49
  v_perm_b32 v121, v7, v5, s49
  v_perm_b32 v122, v11, v9, s49
  v_perm_b32 v123, v15, v13, s49
  v_accvgpr_write_b32 a12, v120
  v_accvgpr_write_b32 a13, v121
  v_accvgpr_write_b32 a14, v122
  v_accvgpr_write_b32 a15, v123
  v_perm_b32 v120, v18, v16, s48
  v_perm_b32 v121, v22, v20, s48
  v_perm_b32 v122, v26, v24, s48
  v_perm_b32 v123, v30, v28, s48
  v_accvgpr_write_b32 a16, v120
  v_accvgpr_write_b32 a17, v121
  v_accvgpr_write_b32 a18, v122
  v_accvgpr_write_b32 a19, v123
  v_perm_b32 v120, v18, v16, s49
  v_perm_b32 v121, v22, v20, s49
  v_perm_b32 v122, v26, v24, s49
  v_perm_b32 v123, v30, v28, s49
  v_accvgpr_write_b32 a20, v120
  v_accvgpr_write_b32 a21, v121
  v_accvgpr_write_b32 a22, v122
  v_accvgpr_write_b32 a23, v123
  v_perm_b32 v120, v19, v17, s48
  v_perm_b32 v121, v23, v21, s48
  v_perm_b32 v122, v27, v25, s48
  v_perm_b32 v123, v31, v29, s48
  v_accvgpr_write_b32 a24, v120
  v_accvgpr_write_b32 a25, v121
  v_accvgpr_write_b32 a26, v122
  v_accvgpr_write_b32 a27, v123
  v_perm_b32 v120, v19, v17, s49
  v_perm_b32 v121, v23, v21, s49
  v_perm_b32 v122, v27, v25, s49
  v_perm_b32 v123, v31, v29, s49
  v_accvgpr_write_b32 a28, v120
  v_accvgpr_write_b32 a29, v121
  v_accvgpr_write_b32 a30, v122
  v_accvgpr_write_b32 a31, v123
  s_mov_b32 s52, 196608
  buffer_load_dwordx2 v[0:1], v110, s[36:39], s52 offen
  s_mov_b32 s52, 197632
  buffer_load_dwordx2 v[2:3], v110, s[36:39], s52 offen
  s_mov_b32 s52, 198656
  buffer_load_dwordx2 v[4:5], v110, s[36:39], s52 offen
  s_mov_b32 s52, 199680
  buffer_load_dwordx2 v[6:7], v110, s[36:39], s52 offen
  s_mov_b32 s52, 200704
  buffer_load_dwordx2 v[8:9], v110, s[36:39], s52 offen
  s_mov_b32 s52, 201728
  buffer_load_dwordx2 v[10:11], v110, s[36:39], s52 offen
  s_mov_b32 s52, 202752
  buffer_load_dwordx2 v[12:13], v110, s[36:39], s52 offen
  s_mov_b32 s52, 203776
  buffer_load_dwordx2 v[14:15], v110, s[36:39], s52 offen
  s_mov_b32 s52, 229376
  buffer_load_dwordx2 v[16:17], v110, s[36:39], s52 offen
  s_mov_b32 s52, 230400
  buffer_load_dwordx2 v[18:19], v110, s[36:39], s52 offen
  s_mov_b32 s52, 231424
  buffer_load_dwordx2 v[20:21], v110, s[36:39], s52 offen
  s_mov_b32 s52, 232448
  buffer_load_dwordx2 v[22:23], v110, s[36:39], s52 offen
  s_mov_b32 s52, 233472
  buffer_load_dwordx2 v[24:25], v110, s[36:39], s52 offen
  s_mov_b32 s52, 234496
  buffer_load_dwordx2 v[26:27], v110, s[36:39], s52 offen
  s_mov_b32 s52, 235520
  buffer_load_dwordx2 v[28:29], v110, s[36:39], s52 offen
  s_mov_b32 s52, 236544
  buffer_load_dwordx2 v[30:31], v110, s[36:39], s52 offen
  s_waitcnt vmcnt(32)
  v_perm_b32 v120, v34, v32, s48
  v_perm_b32 v121, v38, v36, s48
  v_perm_b32 v122, v42, v40, s48
  v_perm_b32 v123, v46, v44, s48
  v_accvgpr_write_b32 a32, v120
  v_accvgpr_write_b32 a33, v121
  v_accvgpr_write_b32 a34, v122
  v_accvgpr_write_b32 a35, v123
  v_perm_b32 v120, v34, v32, s49
  v_perm_b32 v121, v38, v36, s49
  v_perm_b32 v122, v42, v40, s49
  v_perm_b32 v123, v46, v44, s49
  v_accvgpr_write_b32 a36, v120
  v_accvgpr_write_b32 a37, v121
  v_accvgpr_write_b32 a38, v122
  v_accvgpr_write_b32 a39, v123
  v_perm_b32 v120, v35, v33, s48
  v_perm_b32 v121, v39, v37, s48
  v_perm_b32 v122, v43, v41, s48
  v_perm_b32 v123, v47, v45, s48
  v_accvgpr_write_b32 a40, v120
  v_accvgpr_write_b32 a41, v121
  v_accvgpr_write_b32 a42, v122
  v_accvgpr_write_b32 a43, v123
  v_perm_b32 v120, v35, v33, s49
  v_perm_b32 v121, v39, v37, s49
  v_perm_b32 v122, v43, v41, s49
  v_perm_b32 v123, v47, v45, s49
  v_accvgpr_write_b32 a44, v120
  v_accvgpr_write_b32 a45, v121
  v_accvgpr_write_b32 a46, v122
  v_accvgpr_write_b32 a47, v123
  v_perm_b32 v120, v50, v48, s48
  v_perm_b32 v121, v54, v52, s48
  v_perm_b32 v122, v58, v56, s48
  v_perm_b32 v123, v62, v60, s48
  v_accvgpr_write_b32 a48, v120
  v_accvgpr_write_b32 a49, v121
  v_accvgpr_write_b32 a50, v122
  v_accvgpr_write_b32 a51, v123
  v_perm_b32 v120, v50, v48, s49
  v_perm_b32 v121, v54, v52, s49
  v_perm_b32 v122, v58, v56, s49
  v_perm_b32 v123, v62, v60, s49
  v_accvgpr_write_b32 a52, v120
  v_accvgpr_write_b32 a53, v121
  v_accvgpr_write_b32 a54, v122
  v_accvgpr_write_b32 a55, v123
  v_perm_b32 v120, v51, v49, s48
  v_perm_b32 v121, v55, v53, s48
  v_perm_b32 v122, v59, v57, s48
  v_perm_b32 v123, v63, v61, s48
  v_accvgpr_write_b32 a56, v120
  v_accvgpr_write_b32 a57, v121
  v_accvgpr_write_b32 a58, v122
  v_accvgpr_write_b32 a59, v123
  v_perm_b32 v120, v51, v49, s49
  v_perm_b32 v121, v55, v53, s49
  v_perm_b32 v122, v59, v57, s49
  v_perm_b32 v123, v63, v61, s49
  v_accvgpr_write_b32 a60, v120
  v_accvgpr_write_b32 a61, v121
  v_accvgpr_write_b32 a62, v122
  v_accvgpr_write_b32 a63, v123
  s_mov_b32 s52, 262144
  buffer_load_dwordx2 v[32:33], v110, s[36:39], s52 offen
  s_mov_b32 s52, 263168
  buffer_load_dwordx2 v[34:35], v110, s[36:39], s52 offen
  s_mov_b32 s52, 264192
  buffer_load_dwordx2 v[36:37], v110, s[36:39], s52 offen
  s_mov_b32 s52, 265216
  buffer_load_dwordx2 v[38:39], v110, s[36:39], s52 offen
  s_mov_b32 s52, 266240
  buffer_load_dwordx2 v[40:41], v110, s[36:39], s52 offen
  s_mov_b32 s52, 267264
  buffer_load_dwordx2 v[42:43], v110, s[36:39], s52 offen
  s_mov_b32 s52, 268288
  buffer_load_dwordx2 v[44:45], v110, s[36:39], s52 offen
  s_mov_b32 s52, 269312
  buffer_load_dwordx2 v[46:47], v110, s[36:39], s52 offen
  s_mov_b32 s52, 294912
  buffer_load_dwordx2 v[48:49], v110, s[36:39], s52 offen
  s_mov_b32 s52, 295936
  buffer_load_dwordx2 v[50:51], v110, s[36:39], s52 offen
  s_mov_b32 s52, 296960
  buffer_load_dwordx2 v[52:53], v110, s[36:39], s52 offen
  s_mov_b32 s52, 297984
  buffer_load_dwordx2 v[54:55], v110, s[36:39], s52 offen
  s_mov_b32 s52, 299008
  buffer_load_dwordx2 v[56:57], v110, s[36:39], s52 offen
  s_mov_b32 s52, 300032
  buffer_load_dwordx2 v[58:59], v110, s[36:39], s52 offen
  s_mov_b32 s52, 301056
  buffer_load_dwordx2 v[60:61], v110, s[36:39], s52 offen
  s_mov_b32 s52, 302080
  buffer_load_dwordx2 v[62:63], v110, s[36:39], s52 offen
  s_waitcnt vmcnt(32)
  v_perm_b32 v120, v66, v64, s48
  v_perm_b32 v121, v70, v68, s48
  v_perm_b32 v122, v74, v72, s48
  v_perm_b32 v123, v78, v76, s48
  v_accvgpr_write_b32 a64, v120
  v_accvgpr_write_b32 a65, v121
  v_accvgpr_write_b32 a66, v122
  v_accvgpr_write_b32 a67, v123
  v_perm_b32 v120, v66, v64, s49
  v_perm_b32 v121, v70, v68, s49
  v_perm_b32 v122, v74, v72, s49
  v_perm_b32 v123, v78, v76, s49
  v_accvgpr_write_b32 a68, v120
  v_accvgpr_write_b32 a69, v121
  v_accvgpr_write_b32 a70, v122
  v_accvgpr_write_b32 a71, v123
  v_perm_b32 v120, v67, v65, s48
  v_perm_b32 v121, v71, v69, s48
  v_perm_b32 v122, v75, v73, s48
  v_perm_b32 v123, v79, v77, s48
  v_accvgpr_write_b32 a72, v120
  v_accvgpr_write_b32 a73, v121
  v_accvgpr_write_b32 a74, v122
  v_accvgpr_write_b32 a75, v123
  v_perm_b32 v120, v67, v65, s49
  v_perm_b32 v121, v71, v69, s49
  v_perm_b32 v122, v75, v73, s49
  v_perm_b32 v123, v79, v77, s49
  v_accvgpr_write_b32 a76, v120
  v_accvgpr_write_b32 a77, v121
  v_accvgpr_write_b32 a78, v122
  v_accvgpr_write_b32 a79, v123
  v_perm_b32 v120, v82, v80, s48
  v_perm_b32 v121, v86, v84, s48
  v_perm_b32 v122, v90, v88, s48
  v_perm_b32 v123, v94, v92, s48
  v_accvgpr_write_b32 a80, v120
  v_accvgpr_write_b32 a81, v121
  v_accvgpr_write_b32 a82, v122
  v_accvgpr_write_b32 a83, v123
  v_perm_b32 v120, v82, v80, s49
  v_perm_b32 v121, v86, v84, s49
  v_perm_b32 v122, v90, v88, s49
  v_perm_b32 v123, v94, v92, s49
  v_accvgpr_write_b32 a84, v120
  v_accvgpr_write_b32 a85, v121
  v_accvgpr_write_b32 a86, v122
  v_accvgpr_write_b32 a87, v123
  v_perm_b32 v120, v83, v81, s48
  v_perm_b32 v121, v87, v85, s48
  v_perm_b32 v122, v91, v89, s48
  v_perm_b32 v123, v95, v93, s48
  v_accvgpr_write_b32 a88, v120
  v_accvgpr_write_b32 a89, v121
  v_accvgpr_write_b32 a90, v122
  v_accvgpr_write_b32 a91, v123
  v_perm_b32 v120, v83, v81, s49
  v_perm_b32 v121, v87, v85, s49
  v_perm_b32 v122, v91, v89, s49
  v_perm_b32 v123, v95, v93, s49
  v_accvgpr_write_b32 a92, v120
  v_accvgpr_write_b32 a93, v121
  v_accvgpr_write_b32 a94, v122
  v_accvgpr_write_b32 a95, v123
  s_mov_b32 s52, 327680
  buffer_load_dwordx2 v[64:65], v110, s[36:39], s52 offen
  s_mov_b32 s52, 328704
  buffer_load_dwordx2 v[66:67], v110, s[36:39], s52 offen
  s_mov_b32 s52, 329728
  buffer_load_dwordx2 v[68:69], v110, s[36:39], s52 offen
  s_mov_b32 s52, 330752
  buffer_load_dwordx2 v[70:71], v110, s[36:39], s52 offen
  s_mov_b32 s52, 331776
  buffer_load_dwordx2 v[72:73], v110, s[36:39], s52 offen
  s_mov_b32 s52, 332800
  buffer_load_dwordx2 v[74:75], v110, s[36:39], s52 offen
  s_mov_b32 s52, 333824
  buffer_load_dwordx2 v[76:77], v110, s[36:39], s52 offen
  s_mov_b32 s52, 334848
  buffer_load_dwordx2 v[78:79], v110, s[36:39], s52 offen
  s_mov_b32 s52, 360448
  buffer_load_dwordx2 v[80:81], v110, s[36:39], s52 offen
  s_mov_b32 s52, 361472
  buffer_load_dwordx2 v[82:83], v110, s[36:39], s52 offen
  s_mov_b32 s52, 362496
  buffer_load_dwordx2 v[84:85], v110, s[36:39], s52 offen
  s_mov_b32 s52, 363520
  buffer_load_dwordx2 v[86:87], v110, s[36:39], s52 offen
  s_mov_b32 s52, 364544
  buffer_load_dwordx2 v[88:89], v110, s[36:39], s52 offen
  s_mov_b32 s52, 365568
  buffer_load_dwordx2 v[90:91], v110, s[36:39], s52 offen
  s_mov_b32 s52, 366592
  buffer_load_dwordx2 v[92:93], v110, s[36:39], s52 offen
  s_mov_b32 s52, 367616
  buffer_load_dwordx2 v[94:95], v110, s[36:39], s52 offen
  s_waitcnt vmcnt(32)
  v_perm_b32 v120, v2, v0, s48
  v_perm_b32 v121, v6, v4, s48
  v_perm_b32 v122, v10, v8, s48
  v_perm_b32 v123, v14, v12, s48
  v_accvgpr_write_b32 a96, v120
  v_accvgpr_write_b32 a97, v121
  v_accvgpr_write_b32 a98, v122
  v_accvgpr_write_b32 a99, v123
  v_perm_b32 v120, v2, v0, s49
  v_perm_b32 v121, v6, v4, s49
  v_perm_b32 v122, v10, v8, s49
  v_perm_b32 v123, v14, v12, s49
  v_accvgpr_write_b32 a100, v120
  v_accvgpr_write_b32 a101, v121
  v_accvgpr_write_b32 a102, v122
  v_accvgpr_write_b32 a103, v123
  v_perm_b32 v120, v3, v1, s48
  v_perm_b32 v121, v7, v5, s48
  v_perm_b32 v122, v11, v9, s48
  v_perm_b32 v123, v15, v13, s48
  v_accvgpr_write_b32 a104, v120
  v_accvgpr_write_b32 a105, v121
  v_accvgpr_write_b32 a106, v122
  v_accvgpr_write_b32 a107, v123
  v_perm_b32 v120, v3, v1, s49
  v_perm_b32 v121, v7, v5, s49
  v_perm_b32 v122, v11, v9, s49
  v_perm_b32 v123, v15, v13, s49
  v_accvgpr_write_b32 a108, v120
  v_accvgpr_write_b32 a109, v121
  v_accvgpr_write_b32 a110, v122
  v_accvgpr_write_b32 a111, v123
  v_perm_b32 v120, v18, v16, s48
  v_perm_b32 v121, v22, v20, s48
  v_perm_b32 v122, v26, v24, s48
  v_perm_b32 v123, v30, v28, s48
  v_accvgpr_write_b32 a112, v120
  v_accvgpr_write_b32 a113, v121
  v_accvgpr_write_b32 a114, v122
  v_accvgpr_write_b32 a115, v123
  v_perm_b32 v120, v18, v16, s49
  v_perm_b32 v121, v22, v20, s49
  v_perm_b32 v122, v26, v24, s49
  v_perm_b32 v123, v30, v28, s49
  v_accvgpr_write_b32 a116, v120
  v_accvgpr_write_b32 a117, v121
  v_accvgpr_write_b32 a118, v122
  v_accvgpr_write_b32 a119, v123
  v_perm_b32 v120, v19, v17, s48
  v_perm_b32 v121, v23, v21, s48
  v_perm_b32 v122, v27, v25, s48
  v_perm_b32 v123, v31, v29, s48
  v_accvgpr_write_b32 a120, v120
  v_accvgpr_write_b32 a121, v121
  v_accvgpr_write_b32 a122, v122
  v_accvgpr_write_b32 a123, v123
  v_perm_b32 v120, v19, v17, s49
  v_perm_b32 v121, v23, v21, s49
  v_perm_b32 v122, v27, v25, s49
  v_perm_b32 v123, v31, v29, s49
  v_accvgpr_write_b32 a124, v120
  v_accvgpr_write_b32 a125, v121
  v_accvgpr_write_b32 a126, v122
  v_accvgpr_write_b32 a127, v123
  s_mov_b32 s52, 393216
  buffer_load_dwordx2 v[0:1], v110, s[36:39], s52 offen
  s_mov_b32 s52, 394240
  buffer_load_dwordx2 v[2:3], v110, s[36:39], s52 offen
  s_mov_b32 s52, 395264
  buffer_load_dwordx2 v[4:5], v110, s[36:39], s52 offen
  s_mov_b32 s52, 396288
  buffer_load_dwordx2 v[6:7], v110, s[36:39], s52 offen
  s_mov_b32 s52, 397312
  buffer_load_dwordx2 v[8:9], v110, s[36:39], s52 offen
  s_mov_b32 s52, 398336
  buffer_load_dwordx2 v[10:11], v110, s[36:39], s52 offen
  s_mov_b32 s52, 399360
  buffer_load_dwordx2 v[12:13], v110, s[36:39], s52 offen
  s_mov_b32 s52, 400384
  buffer_load_dwordx2 v[14:15], v110, s[36:39], s52 offen
  s_mov_b32 s52, 425984
  buffer_load_dwordx2 v[16:17], v110, s[36:39], s52 offen
  s_mov_b32 s52, 427008
  buffer_load_dwordx2 v[18:19], v110, s[36:39], s52 offen
  s_mov_b32 s52, 428032
  buffer_load_dwordx2 v[20:21], v110, s[36:39], s52 offen
  s_mov_b32 s52, 429056
  buffer_load_dwordx2 v[22:23], v110, s[36:39], s52 offen
  s_mov_b32 s52, 430080
  buffer_load_dwordx2 v[24:25], v110, s[36:39], s52 offen
  s_mov_b32 s52, 431104
  buffer_load_dwordx2 v[26:27], v110, s[36:39], s52 offen
  s_mov_b32 s52, 432128
  buffer_load_dwordx2 v[28:29], v110, s[36:39], s52 offen
  s_mov_b32 s52, 433152
  buffer_load_dwordx2 v[30:31], v110, s[36:39], s52 offen
  s_waitcnt vmcnt(32)
  v_perm_b32 v120, v34, v32, s48
  v_perm_b32 v121, v38, v36, s48
  v_perm_b32 v122, v42, v40, s48
  v_perm_b32 v123, v46, v44, s48
  v_accvgpr_write_b32 a128, v120
  v_accvgpr_write_b32 a129, v121
  v_accvgpr_write_b32 a130, v122
  v_accvgpr_write_b32 a131, v123
  v_perm_b32 v120, v34, v32, s49
  v_perm_b32 v121, v38, v36, s49
  v_perm_b32 v122, v42, v40, s49
  v_perm_b32 v123, v46, v44, s49
  v_accvgpr_write_b32 a132, v120
  v_accvgpr_write_b32 a133, v121
  v_accvgpr_write_b32 a134, v122
  v_accvgpr_write_b32 a135, v123
  v_perm_b32 v120, v35, v33, s48
  v_perm_b32 v121, v39, v37, s48
  v_perm_b32 v122, v43, v41, s48
  v_perm_b32 v123, v47, v45, s48
  v_accvgpr_write_b32 a136, v120
  v_accvgpr_write_b32 a137, v121
  v_accvgpr_write_b32 a138, v122
  v_accvgpr_write_b32 a139, v123
  v_perm_b32 v120, v35, v33, s49
  v_perm_b32 v121, v39, v37, s49
  v_perm_b32 v122, v43, v41, s49
  v_perm_b32 v123, v47, v45, s49
  v_accvgpr_write_b32 a140, v120
  v_accvgpr_write_b32 a141, v121
  v_accvgpr_write_b32 a142, v122
  v_accvgpr_write_b32 a143, v123
  v_perm_b32 v120, v50, v48, s48
  v_perm_b32 v121, v54, v52, s48
  v_perm_b32 v122, v58, v56, s48
  v_perm_b32 v123, v62, v60, s48
  v_accvgpr_write_b32 a144, v120
  v_accvgpr_write_b32 a145, v121
  v_accvgpr_write_b32 a146, v122
  v_accvgpr_write_b32 a147, v123
  v_perm_b32 v120, v50, v48, s49
  v_perm_b32 v121, v54, v52, s49
  v_perm_b32 v122, v58, v56, s49
  v_perm_b32 v123, v62, v60, s49
  v_accvgpr_write_b32 a148, v120
  v_accvgpr_write_b32 a149, v121
  v_accvgpr_write_b32 a150, v122
  v_accvgpr_write_b32 a151, v123
  v_perm_b32 v120, v51, v49, s48
  v_perm_b32 v121, v55, v53, s48
  v_perm_b32 v122, v59, v57, s48
  v_perm_b32 v123, v63, v61, s48
  v_accvgpr_write_b32 a152, v120
  v_accvgpr_write_b32 a153, v121
  v_accvgpr_write_b32 a154, v122
  v_accvgpr_write_b32 a155, v123
  v_perm_b32 v120, v51, v49, s49
  v_perm_b32 v121, v55, v53, s49
  v_perm_b32 v122, v59, v57, s49
  v_perm_b32 v123, v63, v61, s49
  v_accvgpr_write_b32 a156, v120
  v_accvgpr_write_b32 a157, v121
  v_accvgpr_write_b32 a158, v122
  v_accvgpr_write_b32 a159, v123
  s_mov_b32 s52, 458752
  buffer_load_dwordx2 v[32:33], v110, s[36:39], s52 offen
  s_mov_b32 s52, 459776
  buffer_load_dwordx2 v[34:35], v110, s[36:39], s52 offen
  s_mov_b32 s52, 460800
  buffer_load_dwordx2 v[36:37], v110, s[36:39], s52 offen
  s_mov_b32 s52, 461824
  buffer_load_dwordx2 v[38:39], v110, s[36:39], s52 offen
  s_mov_b32 s52, 462848
  buffer_load_dwordx2 v[40:41], v110, s[36:39], s52 offen
  s_mov_b32 s52, 463872
  buffer_load_dwordx2 v[42:43], v110, s[36:39], s52 offen
  s_mov_b32 s52, 464896
  buffer_load_dwordx2 v[44:45], v110, s[36:39], s52 offen
  s_mov_b32 s52, 465920
  buffer_load_dwordx2 v[46:47], v110, s[36:39], s52 offen
  s_mov_b32 s52, 491520
  buffer_load_dwordx2 v[48:49], v110, s[36:39], s52 offen
  s_mov_b32 s52, 492544
  buffer_load_dwordx2 v[50:51], v110, s[36:39], s52 offen
  s_mov_b32 s52, 493568
  buffer_load_dwordx2 v[52:53], v110, s[36:39], s52 offen
  s_mov_b32 s52, 494592
  buffer_load_dwordx2 v[54:55], v110, s[36:39], s52 offen
  s_mov_b32 s52, 495616
  buffer_load_dwordx2 v[56:57], v110, s[36:39], s52 offen
  s_mov_b32 s52, 496640
  buffer_load_dwordx2 v[58:59], v110, s[36:39], s52 offen
  s_mov_b32 s52, 497664
  buffer_load_dwordx2 v[60:61], v110, s[36:39], s52 offen
  s_mov_b32 s52, 498688
  buffer_load_dwordx2 v[62:63], v110, s[36:39], s52 offen
  s_waitcnt vmcnt(32)
  v_perm_b32 v120, v66, v64, s48
  v_perm_b32 v121, v70, v68, s48
  v_perm_b32 v122, v74, v72, s48
  v_perm_b32 v123, v78, v76, s48
  v_accvgpr_write_b32 a160, v120
  v_accvgpr_write_b32 a161, v121
  v_accvgpr_write_b32 a162, v122
  v_accvgpr_write_b32 a163, v123
  v_perm_b32 v120, v66, v64, s49
  v_perm_b32 v121, v70, v68, s49
  v_perm_b32 v122, v74, v72, s49
  v_perm_b32 v123, v78, v76, s49
  v_accvgpr_write_b32 a164, v120
  v_accvgpr_write_b32 a165, v121
  v_accvgpr_write_b32 a166, v122
  v_accvgpr_write_b32 a167, v123
  v_perm_b32 v120, v67, v65, s48
  v_perm_b32 v121, v71, v69, s48
  v_perm_b32 v122, v75, v73, s48
  v_perm_b32 v123, v79, v77, s48
  v_accvgpr_write_b32 a168, v120
  v_accvgpr_write_b32 a169, v121
  v_accvgpr_write_b32 a170, v122
  v_accvgpr_write_b32 a171, v123
  v_perm_b32 v120, v67, v65, s49
  v_perm_b32 v121, v71, v69, s49
  v_perm_b32 v122, v75, v73, s49
  v_perm_b32 v123, v79, v77, s49
  v_accvgpr_write_b32 a172, v120
  v_accvgpr_write_b32 a173, v121
  v_accvgpr_write_b32 a174, v122
  v_accvgpr_write_b32 a175, v123
  v_perm_b32 v120, v82, v80, s48
  v_perm_b32 v121, v86, v84, s48
  v_perm_b32 v122, v90, v88, s48
  v_perm_b32 v123, v94, v92, s48
  v_accvgpr_write_b32 a176, v120
  v_accvgpr_write_b32 a177, v121
  v_accvgpr_write_b32 a178, v122
  v_accvgpr_write_b32 a179, v123
  v_perm_b32 v120, v82, v80, s49
  v_perm_b32 v121, v86, v84, s49
  v_perm_b32 v122, v90, v88, s49
  v_perm_b32 v123, v94, v92, s49
  v_accvgpr_write_b32 a180, v120
  v_accvgpr_write_b32 a181, v121
  v_accvgpr_write_b32 a182, v122
  v_accvgpr_write_b32 a183, v123
  v_perm_b32 v120, v83, v81, s48
  v_perm_b32 v121, v87, v85, s48
  v_perm_b32 v122, v91, v89, s48
  v_perm_b32 v123, v95, v93, s48
  v_accvgpr_write_b32 a184, v120
  v_accvgpr_write_b32 a185, v121
  v_accvgpr_write_b32 a186, v122
  v_accvgpr_write_b32 a187, v123
  v_perm_b32 v120, v83, v81, s49
  v_perm_b32 v121, v87, v85, s49
  v_perm_b32 v122, v91, v89, s49
  v_perm_b32 v123, v95, v93, s49
  v_accvgpr_write_b32 a188, v120
  v_accvgpr_write_b32 a189, v121
  v_accvgpr_write_b32 a190, v122
  v_accvgpr_write_b32 a191, v123
  s_waitcnt vmcnt(16)
  v_perm_b32 v120, v2, v0, s48
  v_perm_b32 v121, v6, v4, s48
  v_perm_b32 v122, v10, v8, s48
  v_perm_b32 v123, v14, v12, s48
  v_accvgpr_write_b32 a192, v120
  v_accvgpr_write_b32 a193, v121
  v_accvgpr_write_b32 a194, v122
  v_accvgpr_write_b32 a195, v123
  v_perm_b32 v120, v2, v0, s49
  v_perm_b32 v121, v6, v4, s49
  v_perm_b32 v122, v10, v8, s49
  v_perm_b32 v123, v14, v12, s49
  v_accvgpr_write_b32 a196, v120
  v_accvgpr_write_b32 a197, v121
  v_accvgpr_write_b32 a198, v122
  v_accvgpr_write_b32 a199, v123
  v_perm_b32 v120, v3, v1, s48
  v_perm_b32 v121, v7, v5, s48
  v_perm_b32 v122, v11, v9, s48
  v_perm_b32 v123, v15, v13, s48
  v_accvgpr_write_b32 a200, v120
  v_accvgpr_write_b32 a201, v121
  v_accvgpr_write_b32 a202, v122
  v_accvgpr_write_b32 a203, v123
  v_perm_b32 v120, v3, v1, s49
  v_perm_b32 v121, v7, v5, s49
  v_perm_b32 v122, v11, v9, s49
  v_perm_b32 v123, v15, v13, s49
  v_accvgpr_write_b32 a204, v120
  v_accvgpr_write_b32 a205, v121
  v_accvgpr_write_b32 a206, v122
  v_accvgpr_write_b32 a207, v123
  v_perm_b32 v120, v18, v16, s48
  v_perm_b32 v121, v22, v20, s48
  v_perm_b32 v122, v26, v24, s48
  v_perm_b32 v123, v30, v28, s48
  v_accvgpr_write_b32 a208, v120
  v_accvgpr_write_b32 a209, v121
  v_accvgpr_write_b32 a210, v122
  v_accvgpr_write_b32 a211, v123
  v_perm_b32 v120, v18, v16, s49
  v_perm_b32 v121, v22, v20, s49
  v_perm_b32 v122, v26, v24, s49
  v_perm_b32 v123, v30, v28, s49
  v_accvgpr_write_b32 a212, v120
  v_accvgpr_write_b32 a213, v121
  v_accvgpr_write_b32 a214, v122
  v_accvgpr_write_b32 a215, v123
  v_perm_b32 v120, v19, v17, s48
  v_perm_b32 v121, v23, v21, s48
  v_perm_b32 v122, v27, v25, s48
  v_perm_b32 v123, v31, v29, s48
  v_accvgpr_write_b32 a216, v120
  v_accvgpr_write_b32 a217, v121
  v_accvgpr_write_b32 a218, v122
  v_accvgpr_write_b32 a219, v123
  v_perm_b32 v120, v19, v17, s49
  v_perm_b32 v121, v23, v21, s49
  v_perm_b32 v122, v27, v25, s49
  v_perm_b32 v123, v31, v29, s49
  v_accvgpr_write_b32 a220, v120
  v_accvgpr_write_b32 a221, v121
  v_accvgpr_write_b32 a222, v122
  v_accvgpr_write_b32 a223, v123
  s_waitcnt vmcnt(0)
  v_perm_b32 v120, v34, v32, s48
  v_perm_b32 v121, v38, v36, s48
  v_perm_b32 v122, v42, v40, s48
  v_perm_b32 v123, v46, v44, s48
  v_accvgpr_write_b32 a224, v120
  v_accvgpr_write_b32 a225, v121
  v_accvgpr_write_b32 a226, v122
  v_accvgpr_write_b32 a227, v123
  v_perm_b32 v120, v34, v32, s49
  v_perm_b32 v121, v38, v36, s49
  v_perm_b32 v122, v42, v40, s49
  v_perm_b32 v123, v46, v44, s49
  v_accvgpr_write_b32 a228, v120
  v_accvgpr_write_b32 a229, v121
  v_accvgpr_write_b32 a230, v122
  v_accvgpr_write_b32 a231, v123
  v_perm_b32 v120, v35, v33, s48
  v_perm_b32 v121, v39, v37, s48
  v_perm_b32 v122, v43, v41, s48
  v_perm_b32 v123, v47, v45, s48
  v_accvgpr_write_b32 a232, v120
  v_accvgpr_write_b32 a233, v121
  v_accvgpr_write_b32 a234, v122
  v_accvgpr_write_b32 a235, v123
  v_perm_b32 v120, v35, v33, s49
  v_perm_b32 v121, v39, v37, s49
  v_perm_b32 v122, v43, v41, s49
  v_perm_b32 v123, v47, v45, s49
  v_accvgpr_write_b32 a236, v120
  v_accvgpr_write_b32 a237, v121
  v_accvgpr_write_b32 a238, v122
  v_accvgpr_write_b32 a239, v123
  v_perm_b32 v120, v50, v48, s48
  v_perm_b32 v121, v54, v52, s48
  v_perm_b32 v122, v58, v56, s48
  v_perm_b32 v123, v62, v60, s48
  v_accvgpr_write_b32 a240, v120
  v_accvgpr_write_b32 a241, v121
  v_accvgpr_write_b32 a242, v122
  v_accvgpr_write_b32 a243, v123
  v_perm_b32 v120, v50, v48, s49
  v_perm_b32 v121, v54, v52, s49
  v_perm_b32 v122, v58, v56, s49
  v_perm_b32 v123, v62, v60, s49
  v_accvgpr_write_b32 a244, v120
  v_accvgpr_write_b32 a245, v121
  v_accvgpr_write_b32 a246, v122
  v_accvgpr_write_b32 a247, v123
  v_perm_b32 v120, v51, v49, s48
  v_perm_b32 v121, v55, v53, s48
  v_perm_b32 v122, v59, v57, s48
  v_perm_b32 v123, v63, v61, s48
  v_accvgpr_write_b32 a248, v120
  v_accvgpr_write_b32 a249, v121
  v_accvgpr_write_b32 a250, v122
  v_accvgpr_write_b32 a251, v123
  v_perm_b32 v120, v51, v49, s49
  v_perm_b32 v121, v55, v53, s49
  v_perm_b32 v122, v59, v57, s49
  v_perm_b32 v123, v63, v61, s49
  v_accvgpr_write_b32 a252, v120
  v_accvgpr_write_b32 a253, v121
  v_accvgpr_write_b32 a254, v122
  v_accvgpr_write_b32 a255, v123
  v_lshrrev_b32 v2, 8, v96
  v_bfe_u32 v3, v96, 4, 4
  s_and_b32 s63, s28, 15
  v_lshrrev_b32 v108, 2, v96
  v_lshrrev_b32 v4, 1, v3
  v_and_b32 v5, 16, v96
  v_mov_b32 v6, 0x3f80
  v_lshlrev_b32 v6, v5, v6
  v_cmp_eq_u32 vcc, 0, v4
  s_nop 1
  v_cndmask_b32 v112, 0, v6, vcc
  v_cmp_eq_u32 vcc, 1, v4
  s_nop 1
  v_cndmask_b32 v113, 0, v6, vcc
  v_cmp_eq_u32 vcc, 2, v4
  s_nop 1
  v_cndmask_b32 v114, 0, v6, vcc
  v_cmp_eq_u32 vcc, 3, v4
  s_nop 1
  v_cndmask_b32 v115, 0, v6, vcc
  v_cmp_eq_u32 vcc, 4, v4
  s_nop 1
  v_cndmask_b32 v116, 0, v6, vcc
  v_cmp_eq_u32 vcc, 5, v4
  s_nop 1
  v_cndmask_b32 v117, 0, v6, vcc
  v_cmp_eq_u32 vcc, 6, v4
  s_nop 1
  v_cndmask_b32 v118, 0, v6, vcc
  v_cmp_eq_u32 vcc, 7, v4
  s_nop 1
  v_cndmask_b32 v119, 0, v6, vcc
  v_add_u32 v4, 78400, v96
  ds_write_b128 v4, v[112:115]
  ds_write_b128 v4, v[116:119] offset:1024
  v_and_b32 v4, 1, v2
  s_lshl_b32 s51, s63, 1
  v_add_u32 v5, s51, v4
  v_lshrrev_b32 v6, 1, v2
  s_lshl_b32 s51, s26, 8
  v_lshlrev_b32 v7, 10, v5
  v_add_u32 v7, s51, v7
  v_lshl_add_u32 v8, v6, 7, v7
  v_lshl_add_u32 v103, v3, 3, v8
  v_lshrrev_b32 v8, 1, v3
  v_lshl_add_u32 v8, v6, 3, v8
  v_and_b32 v9, 15, v5
  v_xor_b32 v8, v8, v9
  v_lshl_add_u32 v8, v8, 4, v7
  v_and_b32 v9, 1, v3
  v_lshl_add_u32 v104, v9, 3, v8
  v_lshlrev_b32 v8, 6, v4
  v_add_u32 v106, 77824, v8
  s_lshl_b32 s51, s26, 3
  v_add_u32 v105, s51, v106
  v_lshl_add_u32 v105, v6, 2, v105
  s_lshl_b32 s51, s26, 2
  s_add_u32 s51, s51, 78336
  v_mov_b32 v110, s51
  s_mov_b32 s53, 0
  s_mov_b32 s69, 0
  s_waitcnt lgkmcnt(0)
  v_lshrrev_b32 v2, 8, v96
  v_bfe_u32 v3, v96, 4, 4
  v_mul_u32_u24 v4, 32768, v2
  v_lshl_add_u32 v102, v3, 4, v4
  s_mul_i32 s51, s29, 1048576
  s_add_u32 s51, s51, 1376256
  s_mul_i32 s58, s63, 16384
  s_add_u32 s58, s58, s51
  s_lshl_b32 s52, s26, 12
  s_add_u32 s58, s58, s52
  s_lshl_b32 s62, s63, 4
  s_lshl_b32 s64, s26, 2
  s_add_u32 s62, s62, s64
  s_lshl_b32 s59, s29, 19
  s_add_u32 s59, s59, 15532032
  s_lshl_b32 s64, s63, 12
  s_add_u32 s59, s59, s64
  s_lshl_b32 s64, s26, 10
  s_add_u32 s59, s59, s64
  s_and_b32 s52, s28, 1
  s_lshl_b32 s52, s52, 2
  s_add_u32 s52, s52, s26
  s_lshl_b32 s57, s52, 11
  s_add_u32 s57, s57, s51
  s_lshr_b32 s52, s28, 1
  s_lshl_b32 s51, s52, 8
  s_add_u32 s57, s57, s51
  s_lshl_b32 s55, s29, 9
  s_add_u32 s55, s55, s52
  s_lshl_b32 s55, s55, 15
  s_add_u32 s55, s55, 23068672
  s_lshl_b32 s51, s26, 13
  s_add_u32 s55, s55, s51
  s_lshl_b32 s56, s29, 17
  s_lshl_b32 s51, s52, 8
  s_add_u32 s56, s56, s51
  s_add_u32 s56, s56, 294912
  s_lshl_b32 s64, s26, 6
  s_add_u32 s56, s56, s64
  s_add_u32 s51, s51, s64
  s_sub_u32 s51, 262016, s51
  v_add_u32 v4, s51, v108
  v_and_b32 v108, 12, v108
  v_cmp_lt_u32 vcc, 1, v2
  s_nop 1
  v_cndmask_b32 v108, v108, v4, vcc
  v_mov_b32 v101, v96
  v_mov_b32 v97, v96
  s_lshl_b32 s51, s29, 18
  s_add_u32 s61, s51, 15007744
  v_mov_b32 v4, 1073741824
  v_and_b32 v5, 1, v3
  v_cmp_eq_u32 vcc, 0, v5
  s_nop 1
  v_cndmask_b32 v104, v4, v104, vcc
  s_lshl_b32 s51, s29, 14
  s_add_u32 s62, s62, s51
  s_add_u32 s62, s62, 262144
  s_add_u32 s51, s24, 20971520
  s_addc_u32 s52, s25, 0
  s_cmp_eq_u32 s29, 0
  s_cselect_b32 s36, s4, s51
  s_cselect_b32 s37, s5, s52
  s_and_b32 s37, s37, 0xffff
  s_mov_b32 s38, 2097152
  s_mov_b32 s39, 0x20000
  s_cmp_eq_u32 s30, 0
  s_cbranch_scc1 L_Wslow
  s_mov_b32 s50, 0
  s_lshl_b32 s89, s26, 13
  v_lshlrev_b32 v2, 2, v96
  s_add_u32 s51, s58, 0
  buffer_load_dword v3, v2, s[32:35], s51 offen sc1
  s_add_u32 s51, s58, 262144
  buffer_load_dword v3, v2, s[32:35], s51 offen sc1
  s_add_u32 s51, s58, 524288
  buffer_load_dword v3, v2, s[32:35], s51 offen sc1
  s_add_u32 s51, s58, 786432
  buffer_load_dword v3, v2, s[32:35], s51 offen sc1
  s_add_u32 s90, s50, 0
  s_min_u32 s90, s90, 63
  s_lshl_b32 s91, s90, 11
  s_add_u32 s91, s91, s56
  s_lshl_b32 s90, s90, 18
  s_add_u32 s90, s90, s55
  s_cmp_eq_u32 s50, 63
  s_cselect_b32 s90, 1073741824, s90
  buffer_load_dword v111, v108, s[32:35], s91 offen sc1
  s_waitcnt vmcnt(0)
  v_cmp_eq_u32 vcc, 0, v111
  s_cbranch_vccnz LPWf_f_w
LPWf_f:
  s_add_u32 m0, s89, 0
  s_add_u32 s94, s90, 0
  buffer_load_dwordx4 v101, s[32:35], s94 offen offset:0 sc1 lds
  buffer_load_dwordx4 v101, s[32:35], s94 offen offset:1024 sc1 lds
  buffer_load_dwordx4 v101, s[32:35], s94 offen offset:2048 sc1 lds
  buffer_load_dwordx4 v101, s[32:35], s94 offen offset:3072 sc1 lds
  s_add_u32 m0, s89, 4096
  s_add_u32 s94, s90, 4096
  buffer_load_dwordx4 v101, s[32:35], s94 offen offset:0 sc1 lds
  buffer_load_dwordx4 v101, s[32:35], s94 offen offset:1024 sc1 lds
  buffer_load_dwordx4 v101, s[32:35], s94 offen offset:2048 sc1 lds
  buffer_load_dwordx4 v101, s[32:35], s94 offen offset:3072 sc1 lds
  s_waitcnt vmcnt(4)
  s_barrier
  ds_read_b128 v[0:3], v97 offset:0
  ds_read_b128 v[4:7], v97 offset:1024
  ds_read_b128 v[8:11], v97 offset:2048
  s_waitcnt lgkmcnt(2)
  v_mfma_f32_16x16x32_bf16 v[32:35], v[0:3], a[0:3], 0
  ds_read_b128 v[12:15], v97 offset:3072
  s_and_b32 s65, s50, 3
  s_lshl_b32 s65, s65, 18
  v_mfma_f32_16x16x32_bf16 v[36:39], v[0:3], a[4:7], 0
  s_add_u32 s65, s65, s57
  s_lshr_b32 s54, s50, 2
  s_add_u32 s54, s54, 1
  v_mfma_f32_16x16x32_bf16 v[40:43], v[0:3], a[8:11], 0
  ds_read_b128 v[16:19], v97 offset:8192
  s_add_u32 s90, s50, 1
  s_min_u32 s90, s90, 63
  v_mfma_f32_16x16x32_bf16 v[44:47], v[0:3], a[12:15], 0
  s_waitcnt lgkmcnt(3)
  s_lshl_b32 s91, s90, 11
  s_add_u32 s91, s91, s56
  v_mfma_f32_16x16x32_bf16 v[32:35], v[4:7], a[16:19], v[32:35]
  ds_read_b128 v[20:23], v97 offset:9216
  s_lshl_b32 s90, s90, 18
  s_add_u32 s90, s90, s55
  v_mfma_f32_16x16x32_bf16 v[36:39], v[4:7], a[20:23], v[36:39]
  s_cmp_eq_u32 s50, 63
  s_cselect_b32 s90, 1073741824, s90
  s_xor_b32 s89, s89, 32768
  v_mfma_f32_16x16x32_bf16 v[40:43], v[4:7], a[24:27], v[40:43]
  ds_read_b128 v[24:27], v97 offset:10240
  v_mfma_f32_16x16x32_bf16 v[44:47], v[4:7], a[28:31], v[44:47]
  s_waitcnt lgkmcnt(4)
  v_mfma_f32_16x16x32_bf16 v[32:35], v[8:11], a[32:35], v[32:35]
  ds_read_b128 v[28:31], v97 offset:11264
  v_mfma_f32_16x16x32_bf16 v[36:39], v[8:11], a[36:39], v[36:39]
  v_mfma_f32_16x16x32_bf16 v[40:43], v[8:11], a[40:43], v[40:43]
  v_mfma_f32_16x16x32_bf16 v[44:47], v[8:11], a[44:47], v[44:47]
  s_waitcnt lgkmcnt(4)
  v_mfma_f32_16x16x32_bf16 v[32:35], v[12:15], a[48:51], v[32:35]
  ds_read_b128 v[0:3], v97 offset:16384
  v_mfma_f32_16x16x32_bf16 v[36:39], v[12:15], a[52:55], v[36:39]
  v_mfma_f32_16x16x32_bf16 v[40:43], v[12:15], a[56:59], v[40:43]
  v_mfma_f32_16x16x32_bf16 v[44:47], v[12:15], a[60:63], v[44:47]
  s_waitcnt lgkmcnt(4)
  v_mfma_f32_16x16x32_bf16 v[32:35], v[16:19], a[64:67], v[32:35]
  ds_read_b128 v[4:7], v97 offset:17408
  v_mfma_f32_16x16x32_bf16 v[36:39], v[16:19], a[68:71], v[36:39]
  v_mfma_f32_16x16x32_bf16 v[40:43], v[16:19], a[72:75], v[40:43]
  v_mfma_f32_16x16x32_bf16 v[44:47], v[16:19], a[76:79], v[44:47]
  s_waitcnt lgkmcnt(4)
  v_mfma_f32_16x16x32_bf16 v[32:35], v[20:23], a[80:83], v[32:35]
  ds_read_b128 v[8:11], v97 offset:18432
  v_mfma_f32_16x16x32_bf16 v[36:39], v[20:23], a[84:87], v[36:39]
  v_mfma_f32_16x16x32_bf16 v[40:43], v[20:23], a[88:91], v[40:43]
  v_mfma_f32_16x16x32_bf16 v[44:47], v[20:23], a[92:95], v[44:47]
  s_waitcnt lgkmcnt(4)
  v_mfma_f32_16x16x32_bf16 v[32:35], v[24:27], a[96:99], v[32:35]
  ds_read_b128 v[12:15], v97 offset:19456
  v_mfma_f32_16x16x32_bf16 v[36:39], v[24:27], a[100:103], v[36:39]
  v_mfma_f32_16x16x32_bf16 v[40:43], v[24:27], a[104:107], v[40:43]
  v_mfma_f32_16x16x32_bf16 v[44:47], v[24:27], a[108:111], v[44:47]
  s_waitcnt lgkmcnt(4)
  v_mfma_f32_16x16x32_bf16 v[32:35], v[28:31], a[112:115], v[32:35]
  ds_read_b128 v[16:19], v97 offset:24576
  v_mfma_f32_16x16x32_bf16 v[36:39], v[28:31], a[116:119], v[36:39]
  v_mfma_f32_16x16x32_bf16 v[40:43], v[28:31], a[120:123], v[40:43]
  v_mfma_f32_16x16x32_bf16 v[44:47], v[28:31], a[124:127], v[44:47]
  s_waitcnt lgkmcnt(4)
  v_mfma_f32_16x16x32_bf16 v[32:35], v[0:3], a[128:131], v[32:35]
  ds_read_b128 v[20:23], v97 offset:25600
  v_mfma_f32_16x16x32_bf16 v[36:39], v[0:3], a[132:135], v[36:39]
  v_mfma_f32_16x16x32_bf16 v[40:43], v[0:3], a[136:139], v[40:43]
  v_mfma_f32_16x16x32_bf16 v[44:47], v[0:3], a[140:143], v[44:47]
  s_waitcnt lgkmcnt(4)
  v_mfma_f32_16x16x32_bf16 v[32:35], v[4:7], a[144:147], v[32:35]
  ds_read_b128 v[24:27], v97 offset:26624
  v_mfma_f32_16x16x32_bf16 v[36:39], v[4:7], a[148:151], v[36:39]
  v_mfma_f32_16x16x32_bf16 v[40:43], v[4:7], a[152:155], v[40:43]
  v_mfma_f32_16x16x32_bf16 v[44:47], v[4:7], a[156:159], v[44:47]
  s_waitcnt lgkmcnt(4)
  v_mfma_f32_16x16x32_bf16 v[32:35], v[8:11], a[160:163], v[32:35]
  ds_read_b128 v[28:31], v97 offset:27648
  buffer_load_dword v111, v108, s[32:35], s91 offen sc1
  v_mfma_f32_16x16x32_bf16 v[36:39], v[8:11], a[164:167], v[36:39]
  v_mfma_f32_16x16x32_bf16 v[40:43], v[8:11], a[168:171], v[40:43]
  v_mfma_f32_16x16x32_bf16 v[44:47], v[8:11], a[172:175], v[44:47]
  s_waitcnt lgkmcnt(4)
  v_mfma_f32_16x16x32_bf16 v[32:35], v[12:15], a[176:179], v[32:35]
  s_waitcnt vmcnt(1)
  s_barrier
  ds_read_b128 v[0:3], v97 offset:4096
  v_mfma_f32_16x16x32_bf16 v[36:39], v[12:15], a[180:183], v[36:39]
  v_mfma_f32_16x16x32_bf16 v[40:43], v[12:15], a[184:187], v[40:43]
  v_mfma_f32_16x16x32_bf16 v[44:47], v[12:15], a[188:191], v[44:47]
  s_waitcnt lgkmcnt(4)
  v_mfma_f32_16x16x32_bf16 v[32:35], v[16:19], a[192:195], v[32:35]
  ds_read_b128 v[4:7], v97 offset:5120
  v_mfma_f32_16x16x32_bf16 v[36:39], v[16:19], a[196:199], v[36:39]
  v_mfma_f32_16x16x32_bf16 v[40:43], v[16:19], a[200:203], v[40:43]
  v_mfma_f32_16x16x32_bf16 v[44:47], v[16:19], a[204:207], v[44:47]
  s_waitcnt lgkmcnt(4)
  v_mfma_f32_16x16x32_bf16 v[32:35], v[20:23], a[208:211], v[32:35]
  ds_read_b128 v[8:11], v97 offset:6144
  v_mfma_f32_16x16x32_bf16 v[36:39], v[20:23], a[212:215], v[36:39]
  v_mfma_f32_16x16x32_bf16 v[40:43], v[20:23], a[216:219], v[40:43]
  v_mfma_f32_16x16x32_bf16 v[44:47], v[20:23], a[220:223], v[44:47]
  s_waitcnt lgkmcnt(4)
  v_mfma_f32_16x16x32_bf16 v[32:35], v[24:27], a[224:227], v[32:35]
  ds_read_b128 v[12:15], v97 offset:7168
  v_mfma_f32_16x16x32_bf16 v[36:39], v[24:27], a[228:231], v[36:39]
  v_mfma_f32_16x16x32_bf16 v[40:43], v[24:27], a[232:235], v[40:43]
  v_mfma_f32_16x16x32_bf16 v[44:47], v[24:27], a[236:239], v[44:47]
  s_waitcnt lgkmcnt(4)
  v_mfma_f32_16x16x32_bf16 v[32:35], v[28:31], a[240:243], v[32:35]
  ds_read_b128 v[16:19], v97 offset:12288
  v_mfma_f32_16x16x32_bf16 v[36:39], v[28:31], a[244:247], v[36:39]
  v_mfma_f32_16x16x32_bf16 v[40:43], v[28:31], a[248:251], v[40:43]
  v_mfma_f32_16x16x32_bf16 v[44:47], v[28:31], a[252:255], v[44:47]
  s_waitcnt lgkmcnt(4)
  v_mfma_f32_16x16x32_bf16 v[48:51], v[0:3], a[0:3], 0
  ds_read_b128 v[20:23], v97 offset:13312
  v_mfma_f32_16x16x32_bf16 v[52:55], v[0:3], a[4:7], 0
  v_mfma_f32_16x16x32_bf16 v[56:59], v[0:3], a[8:11], 0
  v_mfma_f32_16x16x32_bf16 v[60:63], v[0:3], a[12:15], 0
  s_waitcnt lgkmcnt(4)
  v_cvt_pk_bf16_f32 v160, v32, v36
  v_cvt_pk_bf16_f32 v161, v40, v44
  v_mfma_f32_16x16x32_bf16 v[48:51], v[4:7], a[16:19], v[48:51]
  ds_read_b128 v[24:27], v97 offset:14336
  v_cvt_pk_bf16_f32 v162, v33, v37
  v_cvt_pk_bf16_f32 v163, v41, v45
  v_mfma_f32_16x16x32_bf16 v[52:55], v[4:7], a[20:23], v[52:55]
  v_bfi_b32 v160, 1, s54, v160
  v_mfma_f32_16x16x32_bf16 v[56:59], v[4:7], a[24:27], v[56:59]
  s_add_u32 s51, s65, 0
  buffer_store_dwordx4 v[160:163], v102, s[32:35], s51 offen offset:0
  v_mfma_f32_16x16x32_bf16 v[60:63], v[4:7], a[28:31], v[60:63]
  s_waitcnt lgkmcnt(4)
  v_mfma_f32_16x16x32_bf16 v[48:51], v[8:11], a[32:35], v[48:51]
  ds_read_b128 v[28:31], v97 offset:15360
  v_cvt_pk_bf16_f32 v164, v34, v38
  v_cvt_pk_bf16_f32 v165, v42, v46
  v_mfma_f32_16x16x32_bf16 v[52:55], v[8:11], a[36:39], v[52:55]
  v_cvt_pk_bf16_f32 v166, v35, v39
  v_cvt_pk_bf16_f32 v167, v43, v47
  v_mfma_f32_16x16x32_bf16 v[56:59], v[8:11], a[40:43], v[56:59]
  v_bfi_b32 v164, 1, s54, v164
  v_mfma_f32_16x16x32_bf16 v[60:63], v[8:11], a[44:47], v[60:63]
  s_waitcnt lgkmcnt(4)
  s_add_u32 s51, s65, 16384
  buffer_store_dwordx4 v[164:167], v102, s[32:35], s51 offen offset:0
  v_mfma_f32_16x16x32_bf16 v[48:51], v[12:15], a[48:51], v[48:51]
  ds_read_b128 v[0:3], v97 offset:20480
  v_mfma_f32_16x16x32_bf16 v[52:55], v[12:15], a[52:55], v[52:55]
  v_mfma_f32_16x16x32_bf16 v[56:59], v[12:15], a[56:59], v[56:59]
  v_mfma_f32_16x16x32_bf16 v[60:63], v[12:15], a[60:63], v[60:63]
  s_waitcnt lgkmcnt(4)
  v_mfma_f32_16x16x32_bf16 v[48:51], v[16:19], a[64:67], v[48:51]
  ds_read_b128 v[4:7], v97 offset:21504
  v_mfma_f32_16x16x32_bf16 v[52:55], v[16:19], a[68:71], v[52:55]
  v_mfma_f32_16x16x32_bf16 v[56:59], v[16:19], a[72:75], v[56:59]
  v_mfma_f32_16x16x32_bf16 v[60:63], v[16:19], a[76:79], v[60:63]
  s_waitcnt lgkmcnt(4)
  v_mfma_f32_16x16x32_bf16 v[48:51], v[20:23], a[80:83], v[48:51]
  ds_read_b128 v[8:11], v97 offset:22528
  v_mfma_f32_16x16x32_bf16 v[52:55], v[20:23], a[84:87], v[52:55]
  v_mfma_f32_16x16x32_bf16 v[56:59], v[20:23], a[88:91], v[56:59]
  v_mfma_f32_16x16x32_bf16 v[60:63], v[20:23], a[92:95], v[60:63]
  s_waitcnt lgkmcnt(4)
  v_mfma_f32_16x16x32_bf16 v[48:51], v[24:27], a[96:99], v[48:51]
  ds_read_b128 v[12:15], v97 offset:23552
  s_waitcnt vmcnt(2)
  v_cmp_eq_u32 vcc, 0, v111
  v_mfma_f32_16x16x32_bf16 v[52:55], v[24:27], a[100:103], v[52:55]
  s_cbranch_vccnz LPWf_ha_w
LPWf_ha:
  v_mfma_f32_16x16x32_bf16 v[56:59], v[24:27], a[104:107], v[56:59]
  s_add_u32 m0, s89, 0
  s_add_u32 s94, s90, 0
  v_mfma_f32_16x16x32_bf16 v[60:63], v[24:27], a[108:111], v[60:63]
  s_waitcnt lgkmcnt(4)
  buffer_load_dwordx4 v101, s[32:35], s94 offen offset:0 sc1 lds
  v_mfma_f32_16x16x32_bf16 v[48:51], v[28:31], a[112:115], v[48:51]
  ds_read_b128 v[16:19], v97 offset:28672
  v_mfma_f32_16x16x32_bf16 v[52:55], v[28:31], a[116:119], v[52:55]
  buffer_load_dwordx4 v101, s[32:35], s94 offen offset:1024 sc1 lds
  v_mfma_f32_16x16x32_bf16 v[56:59], v[28:31], a[120:123], v[56:59]
  v_mfma_f32_16x16x32_bf16 v[60:63], v[28:31], a[124:127], v[60:63]
  s_waitcnt lgkmcnt(4)
  v_mfma_f32_16x16x32_bf16 v[48:51], v[0:3], a[128:131], v[48:51]
  ds_read_b128 v[20:23], v97 offset:29696
  buffer_load_dwordx4 v101, s[32:35], s94 offen offset:2048 sc1 lds
  v_mfma_f32_16x16x32_bf16 v[52:55], v[0:3], a[132:135], v[52:55]
  v_mfma_f32_16x16x32_bf16 v[56:59], v[0:3], a[136:139], v[56:59]
  v_mfma_f32_16x16x32_bf16 v[60:63], v[0:3], a[140:143], v[60:63]
  s_waitcnt lgkmcnt(4)
  buffer_load_dwordx4 v101, s[32:35], s94 offen offset:3072 sc1 lds
  v_mfma_f32_16x16x32_bf16 v[48:51], v[4:7], a[144:147], v[48:51]
  ds_read_b128 v[24:27], v97 offset:30720
  s_lshl_b32 s52, s50, 15
  buffer_load_dwordx2 v[140:141], v103, s[36:39], s52 offen sc1
  v_mfma_f32_16x16x32_bf16 v[52:55], v[4:7], a[148:151], v[52:55]
  s_add_u32 s52, s50, 2
  s_min_u32 s52, s52, 63
  s_lshl_b32 s52, s52, 11
  v_mfma_f32_16x16x32_bf16 v[56:59], v[4:7], a[152:155], v[56:59]
  s_add_u32 s52, s52, s56
  buffer_load_dword v109, v108, s[32:35], s52 offen sc1
  v_mfma_f32_16x16x32_bf16 v[60:63], v[4:7], a[156:159], v[60:63]
  s_waitcnt lgkmcnt(4)
  v_mfma_f32_16x16x32_bf16 v[48:51], v[8:11], a[160:163], v[48:51]
  ds_read_b128 v[28:31], v97 offset:31744
  s_add_u32 m0, s89, 4096
  s_add_u32 s94, s90, 4096
  v_mfma_f32_16x16x32_bf16 v[52:55], v[8:11], a[164:167], v[52:55]
  buffer_load_dwordx4 v101, s[32:35], s94 offen offset:0 sc1 lds
  v_mfma_f32_16x16x32_bf16 v[56:59], v[8:11], a[168:171], v[56:59]
  v_mfma_f32_16x16x32_bf16 v[60:63], v[8:11], a[172:175], v[60:63]
  s_waitcnt lgkmcnt(4)
  buffer_load_dwordx4 v101, s[32:35], s94 offen offset:1024 sc1 lds
  v_mfma_f32_16x16x32_bf16 v[48:51], v[12:15], a[176:179], v[48:51]
  v_mfma_f32_16x16x32_bf16 v[52:55], v[12:15], a[180:183], v[52:55]
  v_mfma_f32_16x16x32_bf16 v[56:59], v[12:15], a[184:187], v[56:59]
  buffer_load_dwordx4 v101, s[32:35], s94 offen offset:2048 sc1 lds
  v_mfma_f32_16x16x32_bf16 v[60:63], v[12:15], a[188:191], v[60:63]
  s_waitcnt lgkmcnt(3)
  v_mfma_f32_16x16x32_bf16 v[48:51], v[16:19], a[192:195], v[48:51]
  v_mfma_f32_16x16x32_bf16 v[52:55], v[16:19], a[196:199], v[52:55]
  buffer_load_dwordx4 v101, s[32:35], s94 offen offset:3072 sc1 lds
  v_mfma_f32_16x16x32_bf16 v[56:59], v[16:19], a[200:203], v[56:59]
  v_mfma_f32_16x16x32_bf16 v[60:63], v[16:19], a[204:207], v[60:63]
  s_waitcnt lgkmcnt(2)
  v_mfma_f32_16x16x32_bf16 v[48:51], v[20:23], a[208:211], v[48:51]
  v_mfma_f32_16x16x32_bf16 v[52:55], v[20:23], a[212:215], v[52:55]
  v_mfma_f32_16x16x32_bf16 v[56:59], v[20:23], a[216:219], v[56:59]
  v_mfma_f32_16x16x32_bf16 v[60:63], v[20:23], a[220:223], v[60:63]
  s_waitcnt lgkmcnt(1)
  v_mfma_f32_16x16x32_bf16 v[48:51], v[24:27], a[224:227], v[48:51]
  v_mfma_f32_16x16x32_bf16 v[52:55], v[24:27], a[228:231], v[52:55]
  v_mfma_f32_16x16x32_bf16 v[56:59], v[24:27], a[232:235], v[56:59]
  v_mfma_f32_16x16x32_bf16 v[60:63], v[24:27], a[236:239], v[60:63]
  s_waitcnt lgkmcnt(0)
  v_mfma_f32_16x16x32_bf16 v[48:51], v[28:31], a[240:243], v[48:51]
  v_mfma_f32_16x16x32_bf16 v[52:55], v[28:31], a[244:247], v[52:55]
  v_mfma_f32_16x16x32_bf16 v[56:59], v[28:31], a[248:251], v[56:59]
  v_mfma_f32_16x16x32_bf16 v[60:63], v[28:31], a[252:255], v[60:63]
  v_xor_b32 v97, 32768, v97
  s_mov_b32 s92, s50
  s_add_u32 s50, s50, 1
  v_cvt_pk_bf16_f32 v168, v48, v52
  s_nop 3
  v_cvt_pk_bf16_f32 v169, v56, v60
  v_cvt_pk_bf16_f32 v170, v49, v53
  v_cvt_pk_bf16_f32 v171, v57, v61
  v_bfi_b32 v168, 1, s54, v168
  s_add_u32 s51, s65, 131072
  buffer_store_dwordx4 v[168:171], v102, s[32:35], s51 offen offset:0
  v_cvt_pk_bf16_f32 v172, v50, v54
  v_cvt_pk_bf16_f32 v173, v58, v62
  v_cvt_pk_bf16_f32 v174, v51, v55
  v_cvt_pk_bf16_f32 v175, v59, v63
  v_bfi_b32 v172, 1, s54, v172
  s_add_u32 s51, s65, 147456
  buffer_store_dwordx4 v[172:175], v102, s[32:35], s51 offen offset:0
  s_waitcnt vmcnt(8)
  s_barrier
  ds_read_b128 v[0:3], v97 offset:0
  ds_read_b128 v[4:7], v97 offset:1024
  ds_read_b128 v[8:11], v97 offset:2048
LPWf_P:
  s_waitcnt lgkmcnt(2)
  v_mfma_f32_16x16x32_bf16 v[32:35], v[0:3], a[0:3], 0
  ds_read_b128 v[12:15], v97 offset:3072
  s_and_b32 s84, s92, 7
  s_lshl_b32 s84, s84, 15
  v_mfma_f32_16x16x32_bf16 v[36:39], v[0:3], a[4:7], 0
  s_and_b32 s86, s92, 3
  s_lshl_b32 s86, s86, 18
  s_add_u32 s86, s86, s58
  v_mfma_f32_16x16x32_bf16 v[40:43], v[0:3], a[8:11], 0
  ds_read_b128 v[16:19], v97 offset:8192
  s_lshr_b32 s85, s92, 2
  s_add_u32 s85, s85, 1
  v_mfma_f32_16x16x32_bf16 v[44:47], v[0:3], a[12:15], 0
  s_waitcnt lgkmcnt(3)
  s_and_b32 s67, s92, 7
  s_lshl_b32 s67, s67, 16
  v_mfma_f32_16x16x32_bf16 v[32:35], v[4:7], a[16:19], v[32:35]
  ds_read_b128 v[20:23], v97 offset:9216
  s_add_u32 s67, s67, s59
  s_lshr_b32 s66, s92, 3
  v_mfma_f32_16x16x32_bf16 v[36:39], v[4:7], a[20:23], v[36:39]
  s_add_u32 s66, s66, 1
  s_and_b32 s65, s50, 3
  s_lshl_b32 s65, s65, 18
  v_mfma_f32_16x16x32_bf16 v[40:43], v[4:7], a[24:27], v[40:43]
  ds_read_b128 v[24:27], v97 offset:10240
  s_add_u32 s65, s65, s57
  s_lshr_b32 s54, s50, 2
  v_mfma_f32_16x16x32_bf16 v[44:47], v[4:7], a[28:31], v[44:47]
  s_waitcnt lgkmcnt(4)
  s_add_u32 s54, s54, 1
  s_add_u32 s90, s50, 1
  v_mfma_f32_16x16x32_bf16 v[32:35], v[8:11], a[32:35], v[32:35]
  ds_read_b128 v[28:31], v97 offset:11264
  s_min_u32 s90, s90, 63
  s_lshl_b32 s91, s90, 11
  v_mfma_f32_16x16x32_bf16 v[36:39], v[8:11], a[36:39], v[36:39]
  s_add_u32 s91, s91, s56
  s_lshl_b32 s90, s90, 18
  s_add_u32 s90, s90, s55
  v_mfma_f32_16x16x32_bf16 v[40:43], v[8:11], a[40:43], v[40:43]
  s_cmp_eq_u32 s50, 63
  s_cselect_b32 s90, 1073741824, s90
  s_xor_b32 s89, s89, 32768
  v_mfma_f32_16x16x32_bf16 v[44:47], v[8:11], a[44:47], v[44:47]
  s_waitcnt lgkmcnt(4)
  v_mfma_f32_16x16x32_bf16 v[32:35], v[12:15], a[48:51], v[32:35]
  ds_read_b128 v[0:3], v97 offset:16384
  v_mfma_f32_16x16x32_bf16 v[36:39], v[12:15], a[52:55], v[36:39]
  v_mfma_f32_16x16x32_bf16 v[40:43], v[12:15], a[56:59], v[40:43]
  v_mfma_f32_16x16x32_bf16 v[44:47], v[12:15], a[60:63], v[44:47]
  s_waitcnt lgkmcnt(4)
  v_mfma_f32_16x16x32_bf16 v[32:35], v[16:19], a[64:67], v[32:35]
  ds_read_b128 v[4:7], v97 offset:17408
  v_mfma_f32_16x16x32_bf16 v[36:39], v[16:19], a[68:71], v[36:39]
  v_mfma_f32_16x16x32_bf16 v[40:43], v[16:19], a[72:75], v[40:43]
  v_mfma_f32_16x16x32_bf16 v[44:47], v[16:19], a[76:79], v[44:47]
  s_waitcnt lgkmcnt(4)
  v_mfma_f32_16x16x32_bf16 v[32:35], v[20:23], a[80:83], v[32:35]
  ds_read_b128 v[8:11], v97 offset:18432
  buffer_load_dwordx4 v[144:147], v96, s[32:35], s86 offen offset:0 sc1
  v_mfma_f32_16x16x32_bf16 v[36:39], v[20:23], a[84:87], v[36:39]
  v_mfma_f32_16x16x32_bf16 v[40:43], v[20:23], a[88:91], v[40:43]
  buffer_load_dwordx4 v[148:151], v96, s[32:35], s86 offen offset:1024 sc1
  v_mfma_f32_16x16x32_bf16 v[44:47], v[20:23], a[92:95], v[44:47]
  s_waitcnt lgkmcnt(4)
  v_mfma_f32_16x16x32_bf16 v[32:35], v[24:27], a[96:99], v[32:35]
  ds_read_b128 v[12:15], v97 offset:19456
  buffer_load_dwordx4 v[152:155], v96, s[32:35], s86 offen offset:2048 sc1
  v_mfma_f32_16x16x32_bf16 v[36:39], v[24:27], a[100:103], v[36:39]
  v_mfma_f32_16x16x32_bf16 v[40:43], v[24:27], a[104:107], v[40:43]
  buffer_load_dwordx4 v[156:159], v96, s[32:35], s86 offen offset:3072 sc1
  v_mfma_f32_16x16x32_bf16 v[44:47], v[24:27], a[108:111], v[44:47]
  s_waitcnt lgkmcnt(4)
  v_mfma_f32_16x16x32_bf16 v[32:35], v[28:31], a[112:115], v[32:35]
  ds_read_b128 v[16:19], v97 offset:24576
  v_mfma_f32_16x16x32_bf16 v[36:39], v[28:31], a[116:119], v[36:39]
  v_mfma_f32_16x16x32_bf16 v[40:43], v[28:31], a[120:123], v[40:43]
  v_mfma_f32_16x16x32_bf16 v[44:47], v[28:31], a[124:127], v[44:47]
  s_waitcnt lgkmcnt(4)
  v_mfma_f32_16x16x32_bf16 v[32:35], v[0:3], a[128:131], v[32:35]
  ds_read_b128 v[20:23], v97 offset:25600
  v_mfma_f32_16x16x32_bf16 v[36:39], v[0:3], a[132:135], v[36:39]
  v_mfma_f32_16x16x32_bf16 v[40:43], v[0:3], a[136:139], v[40:43]
  v_mfma_f32_16x16x32_bf16 v[44:47], v[0:3], a[140:143], v[44:47]
  s_waitcnt lgkmcnt(4)
  v_mfma_f32_16x16x32_bf16 v[32:35], v[4:7], a[144:147], v[32:35]
  ds_read_b128 v[24:27], v97 offset:26624
  v_mfma_f32_16x16x32_bf16 v[36:39], v[4:7], a[148:151], v[36:39]
  v_mfma_f32_16x16x32_bf16 v[40:43], v[4:7], a[152:155], v[40:43]
  v_mfma_f32_16x16x32_bf16 v[44:47], v[4:7], a[156:159], v[44:47]
  s_waitcnt lgkmcnt(4)
  s_waitcnt vmcnt(6)
  v_lshlrev_b32 v132, 16, v140
  v_mfma_f32_16x16x32_bf16 v[32:35], v[8:11], a[160:163], v[32:35]
  ds_read_b128 v[28:31], v97 offset:27648
  v_and_b32 v133, 0xffff0000, v140
  v_lshlrev_b32 v134, 16, v141
  v_mfma_f32_16x16x32_bf16 v[36:39], v[8:11], a[164:167], v[36:39]
  v_and_b32 v135, 0xffff0000, v141
  v_mov_b32 v136, 0
  v_mfma_f32_16x16x32_bf16 v[40:43], v[8:11], a[168:171], v[40:43]
  v_mfma_f32_16x16x32_bf16 v[44:47], v[8:11], a[172:175], v[44:47]
  s_waitcnt lgkmcnt(4)
  v_mfma_f32_16x16x32_bf16 v[32:35], v[12:15], a[176:179], v[32:35]
  s_barrier
  ds_read_b128 v[0:3], v97 offset:4096
  v_mfma_f32_16x16x32_bf16 v[36:39], v[12:15], a[180:183], v[36:39]
  s_waitcnt vmcnt(3)
  v_mfma_f32_16x16x32_bf16 v[132:135], v[112:115], v[144:147], v[132:135]
  v_bitop3_b32 v136, v136, v144, s85 bitop3:246
  s_waitcnt vmcnt(2)
  v_mfma_f32_16x16x32_bf16 v[40:43], v[12:15], a[184:187], v[40:43]
  v_mfma_f32_16x16x32_bf16 v[132:135], v[112:115], v[148:151], v[132:135]
  v_bitop3_b32 v136, v136, v148, s85 bitop3:246
  s_waitcnt vmcnt(1)
  v_mfma_f32_16x16x32_bf16 v[44:47], v[12:15], a[188:191], v[44:47]
  s_waitcnt lgkmcnt(4)
  v_mfma_f32_16x16x32_bf16 v[132:135], v[116:119], v[152:155], v[132:135]
  v_bitop3_b32 v136, v136, v152, s85 bitop3:246
  s_waitcnt vmcnt(0)
  v_mfma_f32_16x16x32_bf16 v[32:35], v[16:19], a[192:195], v[32:35]
  ds_read_b128 v[4:7], v97 offset:5120
  v_mfma_f32_16x16x32_bf16 v[132:135], v[116:119], v[156:159], v[132:135]
  v_bitop3_b32 v136, v136, v156, s85 bitop3:246
  v_and_b32 v136, 1, v136
  v_mfma_f32_16x16x32_bf16 v[36:39], v[16:19], a[196:199], v[36:39]
  v_cmp_ne_u32 vcc, 0, v136
  s_cbranch_vccnz LPWf_gc_r
LPWf_gc:
  v_mfma_f32_16x16x32_bf16 v[40:43], v[16:19], a[200:203], v[40:43]
  v_cmp_eq_u32 vcc, 0, v109
  v_mfma_f32_16x16x32_bf16 v[44:47], v[16:19], a[204:207], v[44:47]
  s_waitcnt lgkmcnt(4)
  s_cbranch_vccz LPWf_E
  v_mfma_f32_16x16x32_bf16 v[32:35], v[20:23], a[208:211], v[32:35]
  ds_read_b128 v[8:11], v97 offset:6144
  v_add_f32 v144, v132, v133
  v_mul_f32 v145, v132, v132
  v_mfma_f32_16x16x32_bf16 v[36:39], v[20:23], a[212:215], v[36:39]
  v_add_f32 v146, v134, v135
  v_fmac_f32 v145, v133, v133
  v_mfma_f32_16x16x32_bf16 v[40:43], v[20:23], a[216:219], v[40:43]
  v_add_f32 v144, v144, v146
  v_fmac_f32 v145, v134, v134
  v_mfma_f32_16x16x32_bf16 v[44:47], v[20:23], a[220:223], v[44:47]
  s_waitcnt lgkmcnt(4)
  v_fmac_f32 v145, v135, v135
  v_add_f32_dpp v144, v144, v144 row_ror:8 row_mask:0xf bank_mask:0xf
  v_mfma_f32_16x16x32_bf16 v[32:35], v[24:27], a[224:227], v[32:35]
  ds_read_b128 v[12:15], v97 offset:7168
  v_add_f32_dpp v145, v145, v145 row_ror:8 row_mask:0xf bank_mask:0xf
  v_add_f32_dpp v144, v144, v144 row_ror:4 row_mask:0xf bank_mask:0xf
  v_mfma_f32_16x16x32_bf16 v[36:39], v[24:27], a[228:231], v[36:39]
  v_add_f32_dpp v145, v145, v145 row_ror:4 row_mask:0xf bank_mask:0xf
  v_add_f32_dpp v144, v144, v144 row_ror:2 row_mask:0xf bank_mask:0xf
  v_mfma_f32_16x16x32_bf16 v[40:43], v[24:27], a[232:235], v[40:43]
  v_add_f32_dpp v145, v145, v145 row_ror:2 row_mask:0xf bank_mask:0xf
  v_add_f32_dpp v144, v144, v144 row_ror:1 row_mask:0xf bank_mask:0xf
  v_mfma_f32_16x16x32_bf16 v[44:47], v[24:27], a[236:239], v[44:47]
  s_waitcnt lgkmcnt(4)
  v_add_f32_dpp v145, v145, v145 row_ror:1 row_mask:0xf bank_mask:0xf
  s_nop 1
  v_permlane32_swap_b32 v144, v145
  v_mfma_f32_16x16x32_bf16 v[32:35], v[28:31], a[240:243], v[32:35]
  ds_read_b128 v[16:19], v97 offset:12288
  v_add_f32 v144, v144, v145
  v_mfma_f32_16x16x32_bf16 v[36:39], v[28:31], a[244:247], v[36:39]
  ds_write_b32 v105, v144 offset:0
  v_bfi_b32 v132, 1, s66, v132
  v_mfma_f32_16x16x32_bf16 v[40:43], v[28:31], a[248:251], v[40:43]
  buffer_store_dwordx4 v[132:135], v96, s[32:35], s67 offen
  v_mfma_f32_16x16x32_bf16 v[44:47], v[28:31], a[252:255], v[44:47]
  s_waitcnt lgkmcnt(5)
  v_mfma_f32_16x16x32_bf16 v[48:51], v[0:3], a[0:3], 0
  ds_read_b128 v[20:23], v97 offset:13312
  v_mfma_f32_16x16x32_bf16 v[52:55], v[0:3], a[4:7], 0
  s_waitcnt lgkmcnt(1)
  v_mfma_f32_16x16x32_bf16 v[56:59], v[0:3], a[8:11], 0
  s_barrier
  ds_read_b128 v[144:147], v106 offset:0
  v_mfma_f32_16x16x32_bf16 v[60:63], v[0:3], a[12:15], 0
  ds_read_b128 v[148:151], v106 offset:16
  buffer_load_dword v111, v108, s[32:35], s91 offen sc1
  v_mfma_f32_16x16x32_bf16 v[48:51], v[4:7], a[16:19], v[48:51]
  ds_read_b128 v[24:27], v97 offset:14336
  v_xor_b32 v105, 256, v105
  v_xor_b32 v106, 256, v106
  v_mfma_f32_16x16x32_bf16 v[52:55], v[4:7], a[20:23], v[52:55]
  s_lshl_b32 s93, s92, 8
  s_add_u32 s93, s93, s62
  s_waitcnt lgkmcnt(1)
  v_mfma_f32_16x16x32_bf16 v[56:59], v[4:7], a[24:27], v[56:59]
  v_add_f32 v144, v144, v148
  v_add_f32 v145, v145, v149
  v_mfma_f32_16x16x32_bf16 v[60:63], v[4:7], a[28:31], v[60:63]
  v_add_f32 v146, v146, v150
  v_add_f32 v147, v147, v151
  v_mfma_f32_16x16x32_bf16 v[48:51], v[8:11], a[32:35], v[48:51]
  ds_read_b128 v[28:31], v97 offset:15360
  v_add_f32 v144, v144, v146
  v_add_f32 v145, v145, v147
  v_mfma_f32_16x16x32_bf16 v[52:55], v[8:11], a[36:39], v[52:55]
  v_mul_f32 v144, 0x3b000000, v144
  v_mul_f32 v145, 0x3b000000, v145
  v_mfma_f32_16x16x32_bf16 v[56:59], v[8:11], a[40:43], v[56:59]
  v_fma_f32 v145, -v144, v144, v145
  v_max_f32 v145, 0, v145
  v_mfma_f32_16x16x32_bf16 v[60:63], v[8:11], a[44:47], v[60:63]
  v_add_f32 v145, 0x3727c5ac, v145
  v_cvt_pk_bf16_f32 v160, v32, v36
  v_mfma_f32_16x16x32_bf16 v[48:51], v[12:15], a[48:51], v[48:51]
  ds_read_b128 v[0:3], v97 offset:20480
  v_rsq_f32 v145, v145
  v_mfma_f32_16x16x32_bf16 v[52:55], v[12:15], a[52:55], v[52:55]
  s_add_u32 s86, s84, s61
  v_mul_f32 v144, v144, v145
  v_fma_f32 v148, v132, v145, -v144
  v_mfma_f32_16x16x32_bf16 v[56:59], v[12:15], a[56:59], v[56:59]
  v_fma_f32 v149, v133, v145, -v144
  v_fma_f32 v150, v134, v145, -v144
  v_mfma_f32_16x16x32_bf16 v[60:63], v[12:15], a[60:63], v[60:63]
  v_fma_f32 v151, v135, v145, -v144
  v_cvt_pk_bf16_f32 v130, v148, v149
  v_mfma_f32_16x16x32_bf16 v[48:51], v[16:19], a[64:67], v[48:51]
  ds_read_b128 v[4:7], v97 offset:21504
  v_cvt_pk_bf16_f32 v131, v150, v151
  v_bfi_b32 v128, 1, s66, v130
  v_mfma_f32_16x16x32_bf16 v[52:55], v[16:19], a[68:71], v[52:55]
  v_mov_b32 v129, v131
  v_mov_b32_dpp v130, v130 quad_perm:[1,0,3,2] row_mask:0xf bank_mask:0xf
  v_mfma_f32_16x16x32_bf16 v[56:59], v[16:19], a[72:75], v[56:59]
  v_mov_b32_dpp v131, v131 quad_perm:[1,0,3,2] row_mask:0xf bank_mask:0xf
  v_cvt_pk_bf16_f32 v161, v40, v44
  v_mfma_f32_16x16x32_bf16 v[60:63], v[16:19], a[76:79], v[60:63]
  buffer_store_dwordx4 v[128:131], v104, s[32:35], s86 offen
  v_mfma_f32_16x16x32_bf16 v[48:51], v[20:23], a[80:83], v[48:51]
  ds_read_b128 v[8:11], v97 offset:22528
  s_mov_b64 exec, 1
  buffer_store_dword v110, off, s[32:35], s93
  s_mov_b64 exec, -1
  v_mfma_f32_16x16x32_bf16 v[52:55], v[20:23], a[84:87], v[52:55]
  v_cvt_pk_bf16_f32 v162, v33, v37
  v_cvt_pk_bf16_f32 v163, v41, v45
  v_mfma_f32_16x16x32_bf16 v[56:59], v[20:23], a[88:91], v[56:59]
  v_bfi_b32 v160, 1, s54, v160
  v_mfma_f32_16x16x32_bf16 v[60:63], v[20:23], a[92:95], v[60:63]
  s_waitcnt lgkmcnt(4)
  s_add_u32 s51, s65, 0
  buffer_store_dwordx4 v[160:163], v102, s[32:35], s51 offen offset:0
  v_mfma_f32_16x16x32_bf16 v[48:51], v[24:27], a[96:99], v[48:51]
  ds_read_b128 v[12:15], v97 offset:23552
  s_waitcnt vmcnt(3)
  v_cmp_eq_u32 vcc, 0, v111
  v_mfma_f32_16x16x32_bf16 v[52:55], v[24:27], a[100:103], v[52:55]
  s_cbranch_vccnz LPWf_ga_w
LPWf_ga:
  v_cvt_pk_bf16_f32 v164, v34, v38
  v_cvt_pk_bf16_f32 v165, v42, v46
  v_mfma_f32_16x16x32_bf16 v[56:59], v[24:27], a[104:107], v[56:59]
  s_add_u32 m0, s89, 0
  s_add_u32 s94, s90, 0
  v_cvt_pk_bf16_f32 v166, v35, v39
  v_mfma_f32_16x16x32_bf16 v[60:63], v[24:27], a[108:111], v[60:63]
  s_waitcnt lgkmcnt(4)
  buffer_load_dwordx4 v101, s[32:35], s94 offen offset:0 sc1 lds
  v_mfma_f32_16x16x32_bf16 v[48:51], v[28:31], a[112:115], v[48:51]
  ds_read_b128 v[16:19], v97 offset:28672
  v_cvt_pk_bf16_f32 v167, v43, v47
  v_bfi_b32 v164, 1, s54, v164
  v_mfma_f32_16x16x32_bf16 v[52:55], v[28:31], a[116:119], v[52:55]
  buffer_load_dwordx4 v101, s[32:35], s94 offen offset:1024 sc1 lds
  v_mfma_f32_16x16x32_bf16 v[56:59], v[28:31], a[120:123], v[56:59]
  s_add_u32 s51, s65, 16384
  buffer_store_dwordx4 v[164:167], v102, s[32:35], s51 offen offset:0
  v_mfma_f32_16x16x32_bf16 v[60:63], v[28:31], a[124:127], v[60:63]
  s_waitcnt lgkmcnt(4)
  v_mfma_f32_16x16x32_bf16 v[48:51], v[0:3], a[128:131], v[48:51]
  ds_read_b128 v[20:23], v97 offset:29696
  buffer_load_dwordx4 v101, s[32:35], s94 offen offset:2048 sc1 lds
  v_mfma_f32_16x16x32_bf16 v[52:55], v[0:3], a[132:135], v[52:55]
  v_mfma_f32_16x16x32_bf16 v[56:59], v[0:3], a[136:139], v[56:59]
  v_mfma_f32_16x16x32_bf16 v[60:63], v[0:3], a[140:143], v[60:63]
  s_waitcnt lgkmcnt(4)
  buffer_load_dwordx4 v101, s[32:35], s94 offen offset:3072 sc1 lds
  v_mfma_f32_16x16x32_bf16 v[48:51], v[4:7], a[144:147], v[48:51]
  ds_read_b128 v[24:27], v97 offset:30720
  s_lshl_b32 s52, s50, 15
  buffer_load_dwordx2 v[140:141], v103, s[36:39], s52 offen sc1
  v_mfma_f32_16x16x32_bf16 v[52:55], v[4:7], a[148:151], v[52:55]
  s_add_u32 s52, s50, 2
  s_min_u32 s52, s52, 63
  s_lshl_b32 s52, s52, 11
  v_mfma_f32_16x16x32_bf16 v[56:59], v[4:7], a[152:155], v[56:59]
  s_add_u32 s52, s52, s56
  buffer_load_dword v109, v108, s[32:35], s52 offen sc1
  v_mfma_f32_16x16x32_bf16 v[60:63], v[4:7], a[156:159], v[60:63]
  s_waitcnt lgkmcnt(4)
  v_mfma_f32_16x16x32_bf16 v[48:51], v[8:11], a[160:163], v[48:51]
  ds_read_b128 v[28:31], v97 offset:31744
  s_add_u32 m0, s89, 4096
  s_add_u32 s94, s90, 4096
  v_mfma_f32_16x16x32_bf16 v[52:55], v[8:11], a[164:167], v[52:55]
  buffer_load_dwordx4 v101, s[32:35], s94 offen offset:0 sc1 lds
  v_mfma_f32_16x16x32_bf16 v[56:59], v[8:11], a[168:171], v[56:59]
  v_mfma_f32_16x16x32_bf16 v[60:63], v[8:11], a[172:175], v[60:63]
  s_waitcnt lgkmcnt(4)
  buffer_load_dwordx4 v101, s[32:35], s94 offen offset:1024 sc1 lds
  v_mfma_f32_16x16x32_bf16 v[48:51], v[12:15], a[176:179], v[48:51]
  v_mfma_f32_16x16x32_bf16 v[52:55], v[12:15], a[180:183], v[52:55]
  v_mfma_f32_16x16x32_bf16 v[56:59], v[12:15], a[184:187], v[56:59]
  buffer_load_dwordx4 v101, s[32:35], s94 offen offset:2048 sc1 lds
  v_mfma_f32_16x16x32_bf16 v[60:63], v[12:15], a[188:191], v[60:63]
  s_waitcnt lgkmcnt(3)
  v_mfma_f32_16x16x32_bf16 v[48:51], v[16:19], a[192:195], v[48:51]
  v_mfma_f32_16x16x32_bf16 v[52:55], v[16:19], a[196:199], v[52:55]
  buffer_load_dwordx4 v101, s[32:35], s94 offen offset:3072 sc1 lds
  v_mfma_f32_16x16x32_bf16 v[56:59], v[16:19], a[200:203], v[56:59]
  v_mfma_f32_16x16x32_bf16 v[60:63], v[16:19], a[204:207], v[60:63]
  s_waitcnt lgkmcnt(2)
  v_mfma_f32_16x16x32_bf16 v[48:51], v[20:23], a[208:211], v[48:51]
  v_mfma_f32_16x16x32_bf16 v[52:55], v[20:23], a[212:215], v[52:55]
  v_mfma_f32_16x16x32_bf16 v[56:59], v[20:23], a[216:219], v[56:59]
  v_mfma_f32_16x16x32_bf16 v[60:63], v[20:23], a[220:223], v[60:63]
  s_waitcnt lgkmcnt(1)
  v_mfma_f32_16x16x32_bf16 v[48:51], v[24:27], a[224:227], v[48:51]
  v_mfma_f32_16x16x32_bf16 v[52:55], v[24:27], a[228:231], v[52:55]
  v_mfma_f32_16x16x32_bf16 v[56:59], v[24:27], a[232:235], v[56:59]
  v_mfma_f32_16x16x32_bf16 v[60:63], v[24:27], a[236:239], v[60:63]
  s_waitcnt lgkmcnt(0)
  v_mfma_f32_16x16x32_bf16 v[48:51], v[28:31], a[240:243], v[48:51]
  v_mfma_f32_16x16x32_bf16 v[52:55], v[28:31], a[244:247], v[52:55]
  v_mfma_f32_16x16x32_bf16 v[56:59], v[28:31], a[248:251], v[56:59]
  v_mfma_f32_16x16x32_bf16 v[60:63], v[28:31], a[252:255], v[60:63]
  v_xor_b32 v97, 32768, v97
  s_mov_b32 s92, s50
  s_add_u32 s50, s50, 1
  v_cvt_pk_bf16_f32 v168, v48, v52
  s_nop 3
  v_cvt_pk_bf16_f32 v169, v56, v60
  v_cvt_pk_bf16_f32 v170, v49, v53
  v_cvt_pk_bf16_f32 v171, v57, v61
  v_bfi_b32 v168, 1, s54, v168
  s_add_u32 s51, s65, 131072
  buffer_store_dwordx4 v[168:171], v102, s[32:35], s51 offen offset:0
  v_cvt_pk_bf16_f32 v172, v50, v54
  v_cvt_pk_bf16_f32 v173, v58, v62
  v_cvt_pk_bf16_f32 v174, v51, v55
  v_cvt_pk_bf16_f32 v175, v59, v63
  v_bfi_b32 v172, 1, s54, v172
  s_add_u32 s51, s65, 147456
  buffer_store_dwordx4 v[172:175], v102, s[32:35], s51 offen offset:0
  s_waitcnt vmcnt(8)
  s_barrier
  ds_read_b128 v[0:3], v97 offset:0
  ds_read_b128 v[4:7], v97 offset:1024
  ds_read_b128 v[8:11], v97 offset:2048
LPWf_J:
  s_cmp_lt_u32 s50, 64
  s_cbranch_scc1 LPWf_P
LPWf_N:
  s_and_b32 s84, s92, 7
  s_lshl_b32 s84, s84, 15
  s_and_b32 s86, s92, 3
  s_lshl_b32 s86, s86, 18
  s_add_u32 s86, s86, s58
  s_lshr_b32 s85, s92, 2
  s_add_u32 s85, s85, 1
  s_and_b32 s67, s92, 7
  s_lshl_b32 s67, s67, 16
  s_add_u32 s67, s67, s59
  s_lshr_b32 s66, s92, 3
  s_add_u32 s66, s66, 1
  s_waitcnt vmcnt(0)
  buffer_load_dwordx4 v[144:147], v96, s[32:35], s86 offen offset:0 sc1
  buffer_load_dwordx4 v[148:151], v96, s[32:35], s86 offen offset:1024 sc1
  buffer_load_dwordx4 v[152:155], v96, s[32:35], s86 offen offset:2048 sc1
  buffer_load_dwordx4 v[156:159], v96, s[32:35], s86 offen offset:3072 sc1
  v_lshlrev_b32 v132, 16, v140
  v_and_b32 v133, 0xffff0000, v140
  v_lshlrev_b32 v134, 16, v141
  v_and_b32 v135, 0xffff0000, v141
  v_mov_b32 v136, 0
  s_waitcnt vmcnt(3)
  v_mfma_f32_16x16x32_bf16 v[132:135], v[112:115], v[144:147], v[132:135]
  v_bitop3_b32 v136, v136, v144, s85 bitop3:246
  s_waitcnt vmcnt(2)
  v_mfma_f32_16x16x32_bf16 v[132:135], v[112:115], v[148:151], v[132:135]
  v_bitop3_b32 v136, v136, v148, s85 bitop3:246
  s_waitcnt vmcnt(1)
  v_mfma_f32_16x16x32_bf16 v[132:135], v[116:119], v[152:155], v[132:135]
  v_bitop3_b32 v136, v136, v152, s85 bitop3:246
  s_waitcnt vmcnt(0)
  v_mfma_f32_16x16x32_bf16 v[132:135], v[116:119], v[156:159], v[132:135]
  v_bitop3_b32 v136, v136, v156, s85 bitop3:246
  v_and_b32 v136, 1, v136
  v_cmp_ne_u32 vcc, 0, v136
  s_cbranch_vccnz LPWf_nc_r
LPWf_nc:
  s_nop 3
  v_add_f32 v144, v132, v133
  v_mul_f32 v145, v132, v132
  v_add_f32 v146, v134, v135
  v_fmac_f32 v145, v133, v133
  v_add_f32 v144, v144, v146
  v_fmac_f32 v145, v134, v134
  v_fmac_f32 v145, v135, v135
  v_add_f32_dpp v144, v144, v144 row_ror:8 row_mask:0xf bank_mask:0xf
  s_nop 0
  v_add_f32_dpp v145, v145, v145 row_ror:8 row_mask:0xf bank_mask:0xf
  v_add_f32_dpp v144, v144, v144 row_ror:4 row_mask:0xf bank_mask:0xf
  s_nop 0
  v_add_f32_dpp v145, v145, v145 row_ror:4 row_mask:0xf bank_mask:0xf
  v_add_f32_dpp v144, v144, v144 row_ror:2 row_mask:0xf bank_mask:0xf
  s_nop 0
  v_add_f32_dpp v145, v145, v145 row_ror:2 row_mask:0xf bank_mask:0xf
  v_add_f32_dpp v144, v144, v144 row_ror:1 row_mask:0xf bank_mask:0xf
  s_nop 0
  v_add_f32_dpp v145, v145, v145 row_ror:1 row_mask:0xf bank_mask:0xf
  s_nop 1
  v_permlane32_swap_b32 v144, v145
  v_add_f32 v144, v144, v145
  ds_write_b32 v105, v144 offset:0
  s_waitcnt lgkmcnt(0)
  s_barrier
  ds_read_b128 v[144:147], v106 offset:0
  ds_read_b128 v[148:151], v106 offset:16
  v_xor_b32 v105, 256, v105
  v_xor_b32 v106, 256, v106
  s_lshl_b32 s93, s92, 8
  s_add_u32 s93, s93, s62
  s_waitcnt lgkmcnt(0)
  v_pk_add_f32 v[144:145], v[144:145], v[148:149]
  v_pk_add_f32 v[146:147], v[146:147], v[150:151]
  v_pk_add_f32 v[144:145], v[144:145], v[146:147]
  v_mul_f32 v144, 0x3b000000, v144
  v_mul_f32 v145, 0x3b000000, v145
  v_fma_f32 v145, -v144, v144, v145
  v_max_f32 v145, 0, v145
  v_add_f32 v145, 0x3727c5ac, v145
  v_rsq_f32 v145, v145
  s_add_u32 s86, s84, s61
  v_mul_f32 v144, v144, v145
  v_fma_f32 v148, v132, v145, -v144
  v_fma_f32 v149, v133, v145, -v144
  v_fma_f32 v150, v134, v145, -v144
  v_fma_f32 v151, v135, v145, -v144
  v_cvt_pk_bf16_f32 v130, v148, v149
  v_cvt_pk_bf16_f32 v131, v150, v151
  v_bfi_b32 v128, 1, s66, v130
  v_mov_b32 v129, v131
  v_mov_b32_dpp v130, v130 quad_perm:[1,0,3,2] row_mask:0xf bank_mask:0xf
  v_mov_b32_dpp v131, v131 quad_perm:[1,0,3,2] row_mask:0xf bank_mask:0xf
  buffer_store_dwordx4 v[128:131], v104, s[32:35], s86 offen
  s_mov_b64 exec, 1
  buffer_store_dword v110, off, s[32:35], s93
  s_mov_b64 exec, -1
  v_bfi_b32 v132, 1, s66, v132
  buffer_store_dwordx4 v[132:135], v96, s[32:35], s67 offen
  s_branch L_post_done
LPWf_E:
  v_mfma_f32_16x16x32_bf16 v[32:35], v[20:23], a[208:211], v[32:35]
  ds_read_b128 v[8:11], v97 offset:6144
  v_add_f32 v144, v132, v133
  v_mul_f32 v145, v132, v132
  v_mfma_f32_16x16x32_bf16 v[36:39], v[20:23], a[212:215], v[36:39]
  s_add_u32 m0, s89, 0
  s_add_u32 s94, s90, 0
  v_add_f32 v146, v134, v135
  v_mfma_f32_16x16x32_bf16 v[40:43], v[20:23], a[216:219], v[40:43]
  buffer_load_dwordx4 v101, s[32:35], s94 offen offset:0 sc1 lds
  v_fmac_f32 v145, v133, v133
  v_mfma_f32_16x16x32_bf16 v[44:47], v[20:23], a[220:223], v[44:47]
  s_waitcnt lgkmcnt(4)
  v_add_f32 v144, v144, v146
  v_fmac_f32 v145, v134, v134
  v_mfma_f32_16x16x32_bf16 v[32:35], v[24:27], a[224:227], v[32:35]
  ds_read_b128 v[12:15], v97 offset:7168
  v_fmac_f32 v145, v135, v135
  v_add_f32_dpp v144, v144, v144 row_ror:8 row_mask:0xf bank_mask:0xf
  v_mfma_f32_16x16x32_bf16 v[36:39], v[24:27], a[228:231], v[36:39]
  buffer_load_dwordx4 v101, s[32:35], s94 offen offset:1024 sc1 lds
  v_add_f32_dpp v145, v145, v145 row_ror:8 row_mask:0xf bank_mask:0xf
  v_mfma_f32_16x16x32_bf16 v[40:43], v[24:27], a[232:235], v[40:43]
  v_add_f32_dpp v144, v144, v144 row_ror:4 row_mask:0xf bank_mask:0xf
  v_add_f32_dpp v145, v145, v145 row_ror:4 row_mask:0xf bank_mask:0xf
  v_mfma_f32_16x16x32_bf16 v[44:47], v[24:27], a[236:239], v[44:47]
  s_waitcnt lgkmcnt(4)
  v_add_f32_dpp v144, v144, v144 row_ror:2 row_mask:0xf bank_mask:0xf
  v_add_f32_dpp v145, v145, v145 row_ror:2 row_mask:0xf bank_mask:0xf
  v_mfma_f32_16x16x32_bf16 v[32:35], v[28:31], a[240:243], v[32:35]
  ds_read_b128 v[16:19], v97 offset:12288
  v_add_f32_dpp v144, v144, v144 row_ror:1 row_mask:0xf bank_mask:0xf
  v_add_f32_dpp v145, v145, v145 row_ror:1 row_mask:0xf bank_mask:0xf
  v_mfma_f32_16x16x32_bf16 v[36:39], v[28:31], a[244:247], v[36:39]
  buffer_load_dwordx4 v101, s[32:35], s94 offen offset:2048 sc1 lds
  v_permlane32_swap_b32 v144, v145
  v_mfma_f32_16x16x32_bf16 v[40:43], v[28:31], a[248:251], v[40:43]
  v_add_f32 v144, v144, v145
  v_mfma_f32_16x16x32_bf16 v[44:47], v[28:31], a[252:255], v[44:47]
  s_waitcnt lgkmcnt(4)
  ds_write_b32 v105, v144 offset:0
  v_mfma_f32_16x16x32_bf16 v[48:51], v[0:3], a[0:3], 0
  ds_read_b128 v[20:23], v97 offset:13312
  v_bfi_b32 v132, 1, s66, v132
  v_mfma_f32_16x16x32_bf16 v[52:55], v[0:3], a[4:7], 0
  buffer_load_dwordx4 v101, s[32:35], s94 offen offset:3072 sc1 lds
  v_mfma_f32_16x16x32_bf16 v[56:59], v[0:3], a[8:11], 0
  buffer_store_dwordx4 v[132:135], v96, s[32:35], s67 offen
  v_mfma_f32_16x16x32_bf16 v[60:63], v[0:3], a[12:15], 0
  s_waitcnt lgkmcnt(5)
  s_waitcnt lgkmcnt(1)
  v_mfma_f32_16x16x32_bf16 v[48:51], v[4:7], a[16:19], v[48:51]
  ds_read_b128 v[24:27], v97 offset:14336
  s_barrier
  v_mfma_f32_16x16x32_bf16 v[52:55], v[4:7], a[20:23], v[52:55]
  s_add_u32 m0, s89, 4096
  s_add_u32 s94, s90, 4096
  ds_read_b128 v[144:147], v106 offset:0
  v_mfma_f32_16x16x32_bf16 v[56:59], v[4:7], a[24:27], v[56:59]
  buffer_load_dwordx4 v101, s[32:35], s94 offen offset:0 sc1 lds
  ds_read_b128 v[148:151], v106 offset:16
  v_mfma_f32_16x16x32_bf16 v[60:63], v[4:7], a[28:31], v[60:63]
  v_xor_b32 v105, 256, v105
  v_xor_b32 v106, 256, v106
  v_mfma_f32_16x16x32_bf16 v[48:51], v[8:11], a[32:35], v[48:51]
  ds_read_b128 v[28:31], v97 offset:15360
  s_lshl_b32 s93, s92, 8
  s_add_u32 s93, s93, s62
  v_mfma_f32_16x16x32_bf16 v[52:55], v[8:11], a[36:39], v[52:55]
  buffer_load_dwordx4 v101, s[32:35], s94 offen offset:1024 sc1 lds
  s_waitcnt lgkmcnt(1)
  v_mfma_f32_16x16x32_bf16 v[56:59], v[8:11], a[40:43], v[56:59]
  v_add_f32 v144, v144, v148
  v_add_f32 v145, v145, v149
  v_mfma_f32_16x16x32_bf16 v[60:63], v[8:11], a[44:47], v[60:63]
  v_add_f32 v146, v146, v150
  v_add_f32 v147, v147, v151
  v_mfma_f32_16x16x32_bf16 v[48:51], v[12:15], a[48:51], v[48:51]
  ds_read_b128 v[0:3], v97 offset:20480
  v_add_f32 v144, v144, v146
  v_add_f32 v145, v145, v147
  v_mfma_f32_16x16x32_bf16 v[52:55], v[12:15], a[52:55], v[52:55]
  buffer_load_dwordx4 v101, s[32:35], s94 offen offset:2048 sc1 lds
  v_mul_f32 v144, 0x3b000000, v144
  v_mfma_f32_16x16x32_bf16 v[56:59], v[12:15], a[56:59], v[56:59]
  v_mul_f32 v145, 0x3b000000, v145
  v_fma_f32 v145, -v144, v144, v145
  v_mfma_f32_16x16x32_bf16 v[60:63], v[12:15], a[60:63], v[60:63]
  v_max_f32 v145, 0, v145
  v_add_f32 v145, 0x3727c5ac, v145
  v_mfma_f32_16x16x32_bf16 v[48:51], v[16:19], a[64:67], v[48:51]
  ds_read_b128 v[4:7], v97 offset:21504
  v_rsq_f32 v145, v145
  v_mfma_f32_16x16x32_bf16 v[52:55], v[16:19], a[68:71], v[52:55]
  buffer_load_dwordx4 v101, s[32:35], s94 offen offset:3072 sc1 lds
  s_add_u32 s86, s84, s61
  v_mfma_f32_16x16x32_bf16 v[56:59], v[16:19], a[72:75], v[56:59]
  v_mul_f32 v144, v144, v145
  v_fma_f32 v148, v132, v145, -v144
  v_mfma_f32_16x16x32_bf16 v[60:63], v[16:19], a[76:79], v[60:63]
  v_fma_f32 v149, v133, v145, -v144
  v_fma_f32 v150, v134, v145, -v144
  v_mfma_f32_16x16x32_bf16 v[48:51], v[20:23], a[80:83], v[48:51]
  ds_read_b128 v[8:11], v97 offset:22528
  v_fma_f32 v151, v135, v145, -v144
  v_cvt_pk_bf16_f32 v130, v148, v149
  v_mfma_f32_16x16x32_bf16 v[52:55], v[20:23], a[84:87], v[52:55]
  s_lshl_b32 s52, s50, 15
  buffer_load_dwordx2 v[140:141], v103, s[36:39], s52 offen sc1
  v_mfma_f32_16x16x32_bf16 v[56:59], v[20:23], a[88:91], v[56:59]
  v_cvt_pk_bf16_f32 v131, v150, v151
  v_bfi_b32 v128, 1, s66, v130
  v_mfma_f32_16x16x32_bf16 v[60:63], v[20:23], a[92:95], v[60:63]
  v_mov_b32 v129, v131
  v_mov_b32_dpp v130, v130 quad_perm:[1,0,3,2] row_mask:0xf bank_mask:0xf
  v_mfma_f32_16x16x32_bf16 v[48:51], v[24:27], a[96:99], v[48:51]
  ds_read_b128 v[12:15], v97 offset:23552
  v_mov_b32_dpp v131, v131 quad_perm:[1,0,3,2] row_mask:0xf bank_mask:0xf
  v_mfma_f32_16x16x32_bf16 v[52:55], v[24:27], a[100:103], v[52:55]
  buffer_store_dwordx4 v[128:131], v104, s[32:35], s86 offen
  v_mfma_f32_16x16x32_bf16 v[56:59], v[24:27], a[104:107], v[56:59]
  s_mov_b64 exec, 1
  buffer_store_dword v110, off, s[32:35], s93
  s_mov_b64 exec, -1
  v_mfma_f32_16x16x32_bf16 v[60:63], v[24:27], a[108:111], v[60:63]
  s_waitcnt lgkmcnt(4)
  v_cvt_pk_bf16_f32 v160, v32, v36
  v_cvt_pk_bf16_f32 v161, v40, v44
  v_mfma_f32_16x16x32_bf16 v[48:51], v[28:31], a[112:115], v[48:51]
  ds_read_b128 v[16:19], v97 offset:28672
  v_cvt_pk_bf16_f32 v162, v33, v37
  v_cvt_pk_bf16_f32 v163, v41, v45
  v_mfma_f32_16x16x32_bf16 v[52:55], v[28:31], a[116:119], v[52:55]
  v_bfi_b32 v160, 1, s54, v160
  v_mfma_f32_16x16x32_bf16 v[56:59], v[28:31], a[120:123], v[56:59]
  s_add_u32 s51, s65, 0
  buffer_store_dwordx4 v[160:163], v102, s[32:35], s51 offen offset:0
  v_mfma_f32_16x16x32_bf16 v[60:63], v[28:31], a[124:127], v[60:63]
  s_waitcnt lgkmcnt(4)
  v_cvt_pk_bf16_f32 v164, v34, v38
  v_cvt_pk_bf16_f32 v165, v42, v46
  v_mfma_f32_16x16x32_bf16 v[48:51], v[0:3], a[128:131], v[48:51]
  ds_read_b128 v[20:23], v97 offset:29696
  v_cvt_pk_bf16_f32 v166, v35, v39
  v_cvt_pk_bf16_f32 v167, v43, v47
  v_mfma_f32_16x16x32_bf16 v[52:55], v[0:3], a[132:135], v[52:55]
  v_bfi_b32 v164, 1, s54, v164
  v_mfma_f32_16x16x32_bf16 v[56:59], v[0:3], a[136:139], v[56:59]
  s_add_u32 s51, s65, 16384
  buffer_store_dwordx4 v[164:167], v102, s[32:35], s51 offen offset:0
  v_mfma_f32_16x16x32_bf16 v[60:63], v[0:3], a[140:143], v[60:63]
  s_waitcnt lgkmcnt(4)
  v_mfma_f32_16x16x32_bf16 v[48:51], v[4:7], a[144:147], v[48:51]
  ds_read_b128 v[24:27], v97 offset:30720
  v_mfma_f32_16x16x32_bf16 v[52:55], v[4:7], a[148:151], v[52:55]
  v_mfma_f32_16x16x32_bf16 v[56:59], v[4:7], a[152:155], v[56:59]
  v_mfma_f32_16x16x32_bf16 v[60:63], v[4:7], a[156:159], v[60:63]
  s_waitcnt lgkmcnt(4)
  v_mfma_f32_16x16x32_bf16 v[48:51], v[8:11], a[160:163], v[48:51]
  ds_read_b128 v[28:31], v97 offset:31744
  v_mfma_f32_16x16x32_bf16 v[52:55], v[8:11], a[164:167], v[52:55]
  v_mfma_f32_16x16x32_bf16 v[56:59], v[8:11], a[168:171], v[56:59]
  v_mfma_f32_16x16x32_bf16 v[60:63], v[8:11], a[172:175], v[60:63]
  s_waitcnt lgkmcnt(4)
  v_mfma_f32_16x16x32_bf16 v[48:51], v[12:15], a[176:179], v[48:51]
  v_mfma_f32_16x16x32_bf16 v[52:55], v[12:15], a[180:183], v[52:55]
  v_mfma_f32_16x16x32_bf16 v[56:59], v[12:15], a[184:187], v[56:59]
  v_mfma_f32_16x16x32_bf16 v[60:63], v[12:15], a[188:191], v[60:63]
  s_waitcnt lgkmcnt(3)
  v_mfma_f32_16x16x32_bf16 v[48:51], v[16:19], a[192:195], v[48:51]
  s_add_u32 s52, s50, 2
  s_min_u32 s52, s52, 63
  s_lshl_b32 s52, s52, 11
  v_mfma_f32_16x16x32_bf16 v[52:55], v[16:19], a[196:199], v[52:55]
  s_add_u32 s52, s52, s56
  buffer_load_dword v109, v108, s[32:35], s52 offen sc1
  v_mfma_f32_16x16x32_bf16 v[56:59], v[16:19], a[200:203], v[56:59]
  v_mfma_f32_16x16x32_bf16 v[60:63], v[16:19], a[204:207], v[60:63]
  s_waitcnt lgkmcnt(2)
  v_mfma_f32_16x16x32_bf16 v[48:51], v[20:23], a[208:211], v[48:51]
  v_mfma_f32_16x16x32_bf16 v[52:55], v[20:23], a[212:215], v[52:55]
  v_mfma_f32_16x16x32_bf16 v[56:59], v[20:23], a[216:219], v[56:59]
  v_mfma_f32_16x16x32_bf16 v[60:63], v[20:23], a[220:223], v[60:63]
  s_waitcnt lgkmcnt(1)
  v_mfma_f32_16x16x32_bf16 v[48:51], v[24:27], a[224:227], v[48:51]
  v_xor_b32 v97, 32768, v97
  s_mov_b32 s92, s50
  v_mfma_f32_16x16x32_bf16 v[52:55], v[24:27], a[228:231], v[52:55]
  s_add_u32 s50, s50, 1
  s_waitcnt vmcnt(11)
  v_mfma_f32_16x16x32_bf16 v[56:59], v[24:27], a[232:235], v[56:59]
  s_barrier
  ds_read_b128 v[0:3], v97 offset:0
  v_mfma_f32_16x16x32_bf16 v[60:63], v[24:27], a[236:239], v[60:63]
  s_waitcnt lgkmcnt(1)
  ds_read_b128 v[4:7], v97 offset:1024
  ds_read_b128 v[8:11], v97 offset:2048
  v_mfma_f32_16x16x32_bf16 v[48:51], v[28:31], a[240:243], v[48:51]
  v_mfma_f32_16x16x32_bf16 v[52:55], v[28:31], a[244:247], v[52:55]
  v_mfma_f32_16x16x32_bf16 v[56:59], v[28:31], a[248:251], v[56:59]
  v_mfma_f32_16x16x32_bf16 v[60:63], v[28:31], a[252:255], v[60:63]
  v_cvt_pk_bf16_f32 v168, v48, v52
  s_nop 6
  v_cvt_pk_bf16_f32 v169, v56, v60
  v_cvt_pk_bf16_f32 v170, v49, v53
  v_cvt_pk_bf16_f32 v171, v57, v61
  v_bfi_b32 v168, 1, s54, v168
  s_add_u32 s51, s65, 131072
  buffer_store_dwordx4 v[168:171], v102, s[32:35], s51 offen offset:0
  v_cvt_pk_bf16_f32 v172, v50, v54
  v_cvt_pk_bf16_f32 v173, v58, v62
  v_cvt_pk_bf16_f32 v174, v51, v55
  v_cvt_pk_bf16_f32 v175, v59, v63
  v_bfi_b32 v172, 1, s54, v172
  s_add_u32 s51, s65, 147456
  buffer_store_dwordx4 v[172:175], v102, s[32:35], s51 offen offset:0
  s_branch LPWf_J
LPWf_f_w:
  s_add_u32 s53, s53, 1
  s_cmp_ge_u32 s53, 65536
  s_cbranch_scc1 L_abort
  buffer_load_dword v111, v108, s[32:35], s91 offen sc1
  s_waitcnt vmcnt(0)
  v_cmp_eq_u32 vcc, 0, v111
  s_cbranch_vccz LPWf_f
  s_sleep 1
  s_branch LPWf_f_w
LPWf_ha_w:
  s_add_u32 s53, s53, 1
  s_cmp_ge_u32 s53, 65536
  s_cbranch_scc1 L_abort
  buffer_load_dword v111, v108, s[32:35], s91 offen sc1
  s_waitcnt vmcnt(0)
  v_cmp_eq_u32 vcc, 0, v111
  s_cbranch_vccz LPWf_ha
  s_sleep 1
  s_branch LPWf_ha_w
LPWf_ga_w:
  s_add_u32 s53, s53, 1
  s_cmp_ge_u32 s53, 65536
  s_cbranch_scc1 L_abort
  buffer_load_dword v111, v108, s[32:35], s91 offen sc1
  s_waitcnt vmcnt(0)
  v_cmp_eq_u32 vcc, 0, v111
  s_cbranch_vccz LPWf_ga
  s_sleep 1
  s_branch LPWf_ga_w
LPWf_gc_r:
  s_add_u32 s69, s69, 1
  s_cmp_ge_u32 s69, 65536
  s_cbranch_scc1 L_abort
  s_nop 4
  buffer_load_dwordx4 v[144:147], v96, s[32:35], s86 offen offset:0 sc1
  buffer_load_dwordx4 v[148:151], v96, s[32:35], s86 offen offset:1024 sc1
  buffer_load_dwordx4 v[152:155], v96, s[32:35], s86 offen offset:2048 sc1
  buffer_load_dwordx4 v[156:159], v96, s[32:35], s86 offen offset:3072 sc1
  v_lshlrev_b32 v132, 16, v140
  v_and_b32 v133, 0xffff0000, v140
  v_lshlrev_b32 v134, 16, v141
  v_and_b32 v135, 0xffff0000, v141
  v_mov_b32 v136, 0
  s_waitcnt vmcnt(3)
  v_mfma_f32_16x16x32_bf16 v[132:135], v[112:115], v[144:147], v[132:135]
  v_bitop3_b32 v136, v136, v144, s85 bitop3:246
  s_waitcnt vmcnt(2)
  v_mfma_f32_16x16x32_bf16 v[132:135], v[112:115], v[148:151], v[132:135]
  v_bitop3_b32 v136, v136, v148, s85 bitop3:246
  s_waitcnt vmcnt(1)
  v_mfma_f32_16x16x32_bf16 v[132:135], v[116:119], v[152:155], v[132:135]
  v_bitop3_b32 v136, v136, v152, s85 bitop3:246
  s_waitcnt vmcnt(0)
  v_mfma_f32_16x16x32_bf16 v[132:135], v[116:119], v[156:159], v[132:135]
  v_bitop3_b32 v136, v136, v156, s85 bitop3:246
  v_and_b32 v136, 1, v136
  v_cmp_ne_u32 vcc, 0, v136
  s_cbranch_vccnz LPWf_gc_r
  s_nop 4
  s_branch LPWf_gc
LPWf_nc_r:
  s_add_u32 s69, s69, 1
  s_cmp_ge_u32 s69, 65536
  s_cbranch_scc1 L_abort
  s_nop 4
  buffer_load_dwordx4 v[144:147], v96, s[32:35], s86 offen offset:0 sc1
  buffer_load_dwordx4 v[148:151], v96, s[32:35], s86 offen offset:1024 sc1
  buffer_load_dwordx4 v[152:155], v96, s[32:35], s86 offen offset:2048 sc1
  buffer_load_dwordx4 v[156:159], v96, s[32:35], s86 offen offset:3072 sc1
  v_lshlrev_b32 v132, 16, v140
  v_and_b32 v133, 0xffff0000, v140
  v_lshlrev_b32 v134, 16, v141
  v_and_b32 v135, 0xffff0000, v141
  v_mov_b32 v136, 0
  s_waitcnt vmcnt(3)
  v_mfma_f32_16x16x32_bf16 v[132:135], v[112:115], v[144:147], v[132:135]
  v_bitop3_b32 v136, v136, v144, s85 bitop3:246
  s_waitcnt vmcnt(2)
  v_mfma_f32_16x16x32_bf16 v[132:135], v[112:115], v[148:151], v[132:135]
  v_bitop3_b32 v136, v136, v148, s85 bitop3:246
  s_waitcnt vmcnt(1)
  v_mfma_f32_16x16x32_bf16 v[132:135], v[116:119], v[152:155], v[132:135]
  v_bitop3_b32 v136, v136, v152, s85 bitop3:246
  s_waitcnt vmcnt(0)
  v_mfma_f32_16x16x32_bf16 v[132:135], v[116:119], v[156:159], v[132:135]
  v_bitop3_b32 v136, v136, v156, s85 bitop3:246
  v_and_b32 v136, 1, v136
  v_cmp_ne_u32 vcc, 0, v136
  s_cbranch_vccnz LPWf_nc_r
  s_nop 4
  s_branch LPWf_nc
L_Wslow:
  s_mov_b32 s50, 0
  s_lshl_b32 s89, s26, 13
  v_lshlrev_b32 v2, 2, v96
  s_add_u32 s51, s58, 0
  buffer_load_dword v3, v2, s[32:35], s51 offen sc1
  s_add_u32 s51, s58, 262144
  buffer_load_dword v3, v2, s[32:35], s51 offen sc1
  s_add_u32 s51, s58, 524288
  buffer_load_dword v3, v2, s[32:35], s51 offen sc1
  s_add_u32 s51, s58, 786432
  buffer_load_dword v3, v2, s[32:35], s51 offen sc1
  s_add_u32 s90, s50, 0
  s_min_u32 s90, s90, 63
  s_lshl_b32 s91, s90, 11
  s_add_u32 s91, s91, s56
  s_lshl_b32 s90, s90, 18
  s_add_u32 s90, s90, s55
  s_cmp_eq_u32 s50, 63
  s_cselect_b32 s90, 1073741824, s90
  buffer_load_dword v111, v108, s[32:35], s91 offen sc1
  s_waitcnt vmcnt(0)
  v_cmp_eq_u32 vcc, 0, v111
  s_cbranch_vccnz LPWs_f_w
LPWs_f:
  s_add_u32 m0, s89, 0
  s_add_u32 s94, s90, 0
  buffer_load_dwordx4 v101, s[32:35], s94 offen offset:0 sc1 lds
  buffer_load_dwordx4 v101, s[32:35], s94 offen offset:1024 sc1 lds
  buffer_load_dwordx4 v101, s[32:35], s94 offen offset:2048 sc1 lds
  buffer_load_dwordx4 v101, s[32:35], s94 offen offset:3072 sc1 lds
  s_add_u32 m0, s89, 4096
  s_add_u32 s94, s90, 4096
  buffer_load_dwordx4 v101, s[32:35], s94 offen offset:0 sc1 lds
  buffer_load_dwordx4 v101, s[32:35], s94 offen offset:1024 sc1 lds
  buffer_load_dwordx4 v101, s[32:35], s94 offen offset:2048 sc1 lds
  buffer_load_dwordx4 v101, s[32:35], s94 offen offset:3072 sc1 lds
  s_waitcnt vmcnt(4)
  s_barrier
  ds_read_b128 v[0:3], v97 offset:0
  ds_read_b128 v[4:7], v97 offset:1024
  ds_read_b128 v[8:11], v97 offset:2048
  s_waitcnt lgkmcnt(2)
  v_mfma_f32_16x16x32_bf16 v[32:35], v[0:3], a[0:3], 0
  ds_read_b128 v[12:15], v97 offset:3072
  s_and_b32 s65, s50, 3
  s_lshl_b32 s65, s65, 18
  v_mfma_f32_16x16x32_bf16 v[36:39], v[0:3], a[4:7], 0
  s_add_u32 s65, s65, s57
  s_lshr_b32 s54, s50, 2
  s_add_u32 s54, s54, 1
  v_mfma_f32_16x16x32_bf16 v[40:43], v[0:3], a[8:11], 0
  ds_read_b128 v[16:19], v97 offset:8192
  s_add_u32 s90, s50, 1
  s_min_u32 s90, s90, 63
  v_mfma_f32_16x16x32_bf16 v[44:47], v[0:3], a[12:15], 0
  s_waitcnt lgkmcnt(3)
  s_lshl_b32 s91, s90, 11
  s_add_u32 s91, s91, s56
  v_mfma_f32_16x16x32_bf16 v[32:35], v[4:7], a[16:19], v[32:35]
  ds_read_b128 v[20:23], v97 offset:9216
  s_lshl_b32 s90, s90, 18
  s_add_u32 s90, s90, s55
  v_mfma_f32_16x16x32_bf16 v[36:39], v[4:7], a[20:23], v[36:39]
  s_cmp_eq_u32 s50, 63
  s_cselect_b32 s90, 1073741824, s90
  s_xor_b32 s89, s89, 32768
  v_mfma_f32_16x16x32_bf16 v[40:43], v[4:7], a[24:27], v[40:43]
  ds_read_b128 v[24:27], v97 offset:10240
  v_mfma_f32_16x16x32_bf16 v[44:47], v[4:7], a[28:31], v[44:47]
  s_waitcnt lgkmcnt(4)
  v_mfma_f32_16x16x32_bf16 v[32:35], v[8:11], a[32:35], v[32:35]
  ds_read_b128 v[28:31], v97 offset:11264
  v_mfma_f32_16x16x32_bf16 v[36:39], v[8:11], a[36:39], v[36:39]
  v_mfma_f32_16x16x32_bf16 v[40:43], v[8:11], a[40:43], v[40:43]
  v_mfma_f32_16x16x32_bf16 v[44:47], v[8:11], a[44:47], v[44:47]
  s_waitcnt lgkmcnt(4)
  v_mfma_f32_16x16x32_bf16 v[32:35], v[12:15], a[48:51], v[32:35]
  ds_read_b128 v[0:3], v97 offset:16384
  v_mfma_f32_16x16x32_bf16 v[36:39], v[12:15], a[52:55], v[36:39]
  v_mfma_f32_16x16x32_bf16 v[40:43], v[12:15], a[56:59], v[40:43]
  v_mfma_f32_16x16x32_bf16 v[44:47], v[12:15], a[60:63], v[44:47]
  s_waitcnt lgkmcnt(4)
  v_mfma_f32_16x16x32_bf16 v[32:35], v[16:19], a[64:67], v[32:35]
  ds_read_b128 v[4:7], v97 offset:17408
  v_mfma_f32_16x16x32_bf16 v[36:39], v[16:19], a[68:71], v[36:39]
  v_mfma_f32_16x16x32_bf16 v[40:43], v[16:19], a[72:75], v[40:43]
  v_mfma_f32_16x16x32_bf16 v[44:47], v[16:19], a[76:79], v[44:47]
  s_waitcnt lgkmcnt(4)
  v_mfma_f32_16x16x32_bf16 v[32:35], v[20:23], a[80:83], v[32:35]
  ds_read_b128 v[8:11], v97 offset:18432
  v_mfma_f32_16x16x32_bf16 v[36:39], v[20:23], a[84:87], v[36:39]
  v_mfma_f32_16x16x32_bf16 v[40:43], v[20:23], a[88:91], v[40:43]
  v_mfma_f32_16x16x32_bf16 v[44:47], v[20:23], a[92:95], v[44:47]
  s_waitcnt lgkmcnt(4)
  v_mfma_f32_16x16x32_bf16 v[32:35], v[24:27], a[96:99], v[32:35]
  ds_read_b128 v[12:15], v97 offset:19456
  v_mfma_f32_16x16x32_bf16 v[36:39], v[24:27], a[100:103], v[36:39]
  v_mfma_f32_16x16x32_bf16 v[40:43], v[24:27], a[104:107], v[40:43]
  v_mfma_f32_16x16x32_bf16 v[44:47], v[24:27], a[108:111], v[44:47]
  s_waitcnt lgkmcnt(4)
  v_mfma_f32_16x16x32_bf16 v[32:35], v[28:31], a[112:115], v[32:35]
  ds_read_b128 v[16:19], v97 offset:24576
  v_mfma_f32_16x16x32_bf16 v[36:39], v[28:31], a[116:119], v[36:39]
  v_mfma_f32_16x16x32_bf16 v[40:43], v[28:31], a[120:123], v[40:43]
  v_mfma_f32_16x16x32_bf16 v[44:47], v[28:31], a[124:127], v[44:47]
  s_waitcnt lgkmcnt(4)
  v_mfma_f32_16x16x32_bf16 v[32:35], v[0:3], a[128:131], v[32:35]
  ds_read_b128 v[20:23], v97 offset:25600
  v_mfma_f32_16x16x32_bf16 v[36:39], v[0:3], a[132:135], v[36:39]
  v_mfma_f32_16x16x32_bf16 v[40:43], v[0:3], a[136:139], v[40:43]
  v_mfma_f32_16x16x32_bf16 v[44:47], v[0:3], a[140:143], v[44:47]
  s_waitcnt lgkmcnt(4)
  v_mfma_f32_16x16x32_bf16 v[32:35], v[4:7], a[144:147], v[32:35]
  ds_read_b128 v[24:27], v97 offset:26624
  v_mfma_f32_16x16x32_bf16 v[36:39], v[4:7], a[148:151], v[36:39]
  v_mfma_f32_16x16x32_bf16 v[40:43], v[4:7], a[152:155], v[40:43]
  v_mfma_f32_16x16x32_bf16 v[44:47], v[4:7], a[156:159], v[44:47]
  s_waitcnt lgkmcnt(4)
  v_mfma_f32_16x16x32_bf16 v[32:35], v[8:11], a[160:163], v[32:35]
  ds_read_b128 v[28:31], v97 offset:27648
  buffer_load_dword v111, v108, s[32:35], s91 offen sc1
  v_mfma_f32_16x16x32_bf16 v[36:39], v[8:11], a[164:167], v[36:39]
  v_mfma_f32_16x16x32_bf16 v[40:43], v[8:11], a[168:171], v[40:43]
  v_mfma_f32_16x16x32_bf16 v[44:47], v[8:11], a[172:175], v[44:47]
  s_waitcnt lgkmcnt(4)
  v_mfma_f32_16x16x32_bf16 v[32:35], v[12:15], a[176:179], v[32:35]
  s_waitcnt vmcnt(1)
  s_barrier
  ds_read_b128 v[0:3], v97 offset:4096
  v_mfma_f32_16x16x32_bf16 v[36:39], v[12:15], a[180:183], v[36:39]
  v_mfma_f32_16x16x32_bf16 v[40:43], v[12:15], a[184:187], v[40:43]
  v_mfma_f32_16x16x32_bf16 v[44:47], v[12:15], a[188:191], v[44:47]
  s_waitcnt lgkmcnt(4)
  v_mfma_f32_16x16x32_bf16 v[32:35], v[16:19], a[192:195], v[32:35]
  ds_read_b128 v[4:7], v97 offset:5120
  v_mfma_f32_16x16x32_bf16 v[36:39], v[16:19], a[196:199], v[36:39]
  v_mfma_f32_16x16x32_bf16 v[40:43], v[16:19], a[200:203], v[40:43]
  v_mfma_f32_16x16x32_bf16 v[44:47], v[16:19], a[204:207], v[44:47]
  s_waitcnt lgkmcnt(4)
  v_mfma_f32_16x16x32_bf16 v[32:35], v[20:23], a[208:211], v[32:35]
  ds_read_b128 v[8:11], v97 offset:6144
  v_mfma_f32_16x16x32_bf16 v[36:39], v[20:23], a[212:215], v[36:39]
  v_mfma_f32_16x16x32_bf16 v[40:43], v[20:23], a[216:219], v[40:43]
  v_mfma_f32_16x16x32_bf16 v[44:47], v[20:23], a[220:223], v[44:47]
  s_waitcnt lgkmcnt(4)
  v_mfma_f32_16x16x32_bf16 v[32:35], v[24:27], a[224:227], v[32:35]
  ds_read_b128 v[12:15], v97 offset:7168
  v_mfma_f32_16x16x32_bf16 v[36:39], v[24:27], a[228:231], v[36:39]
  v_mfma_f32_16x16x32_bf16 v[40:43], v[24:27], a[232:235], v[40:43]
  v_mfma_f32_16x16x32_bf16 v[44:47], v[24:27], a[236:239], v[44:47]
  s_waitcnt lgkmcnt(4)
  v_mfma_f32_16x16x32_bf16 v[32:35], v[28:31], a[240:243], v[32:35]
  ds_read_b128 v[16:19], v97 offset:12288
  v_mfma_f32_16x16x32_bf16 v[36:39], v[28:31], a[244:247], v[36:39]
  v_mfma_f32_16x16x32_bf16 v[40:43], v[28:31], a[248:251], v[40:43]
  v_mfma_f32_16x16x32_bf16 v[44:47], v[28:31], a[252:255], v[44:47]
  s_waitcnt lgkmcnt(4)
  v_mfma_f32_16x16x32_bf16 v[48:51], v[0:3], a[0:3], 0
  ds_read_b128 v[20:23], v97 offset:13312
  v_mfma_f32_16x16x32_bf16 v[52:55], v[0:3], a[4:7], 0
  v_mfma_f32_16x16x32_bf16 v[56:59], v[0:3], a[8:11], 0
  v_mfma_f32_16x16x32_bf16 v[60:63], v[0:3], a[12:15], 0
  s_waitcnt lgkmcnt(4)
  v_cvt_pk_bf16_f32 v160, v32, v36
  v_cvt_pk_bf16_f32 v161, v40, v44
  v_mfma_f32_16x16x32_bf16 v[48:51], v[4:7], a[16:19], v[48:51]
  ds_read_b128 v[24:27], v97 offset:14336
  v_cvt_pk_bf16_f32 v162, v33, v37
  v_cvt_pk_bf16_f32 v163, v41, v45
  v_mfma_f32_16x16x32_bf16 v[52:55], v[4:7], a[20:23], v[52:55]
  v_bfi_b32 v160, 1, s54, v160
  v_mfma_f32_16x16x32_bf16 v[56:59], v[4:7], a[24:27], v[56:59]
  s_add_u32 s51, s65, 0
  buffer_store_dwordx4 v[160:163], v102, s[32:35], s51 offen offset:0 sc1
  v_mfma_f32_16x16x32_bf16 v[60:63], v[4:7], a[28:31], v[60:63]
  s_waitcnt lgkmcnt(4)
  v_mfma_f32_16x16x32_bf16 v[48:51], v[8:11], a[32:35], v[48:51]
  ds_read_b128 v[28:31], v97 offset:15360
  v_cvt_pk_bf16_f32 v164, v34, v38
  v_cvt_pk_bf16_f32 v165, v42, v46
  v_mfma_f32_16x16x32_bf16 v[52:55], v[8:11], a[36:39], v[52:55]
  v_cvt_pk_bf16_f32 v166, v35, v39
  v_cvt_pk_bf16_f32 v167, v43, v47
  v_mfma_f32_16x16x32_bf16 v[56:59], v[8:11], a[40:43], v[56:59]
  v_bfi_b32 v164, 1, s54, v164
  v_mfma_f32_16x16x32_bf16 v[60:63], v[8:11], a[44:47], v[60:63]
  s_waitcnt lgkmcnt(4)
  s_add_u32 s51, s65, 16384
  buffer_store_dwordx4 v[164:167], v102, s[32:35], s51 offen offset:0 sc1
  v_mfma_f32_16x16x32_bf16 v[48:51], v[12:15], a[48:51], v[48:51]
  ds_read_b128 v[0:3], v97 offset:20480
  v_mfma_f32_16x16x32_bf16 v[52:55], v[12:15], a[52:55], v[52:55]
  v_mfma_f32_16x16x32_bf16 v[56:59], v[12:15], a[56:59], v[56:59]
  v_mfma_f32_16x16x32_bf16 v[60:63], v[12:15], a[60:63], v[60:63]
  s_waitcnt lgkmcnt(4)
  v_mfma_f32_16x16x32_bf16 v[48:51], v[16:19], a[64:67], v[48:51]
  ds_read_b128 v[4:7], v97 offset:21504
  v_mfma_f32_16x16x32_bf16 v[52:55], v[16:19], a[68:71], v[52:55]
  v_mfma_f32_16x16x32_bf16 v[56:59], v[16:19], a[72:75], v[56:59]
  v_mfma_f32_16x16x32_bf16 v[60:63], v[16:19], a[76:79], v[60:63]
  s_waitcnt lgkmcnt(4)
  v_mfma_f32_16x16x32_bf16 v[48:51], v[20:23], a[80:83], v[48:51]
  ds_read_b128 v[8:11], v97 offset:22528
  v_mfma_f32_16x16x32_bf16 v[52:55], v[20:23], a[84:87], v[52:55]
  v_mfma_f32_16x16x32_bf16 v[56:59], v[20:23], a[88:91], v[56:59]
  v_mfma_f32_16x16x32_bf16 v[60:63], v[20:23], a[92:95], v[60:63]
  s_waitcnt lgkmcnt(4)
  v_mfma_f32_16x16x32_bf16 v[48:51], v[24:27], a[96:99], v[48:51]
  ds_read_b128 v[12:15], v97 offset:23552
  s_waitcnt vmcnt(2)
  v_cmp_eq_u32 vcc, 0, v111
  v_mfma_f32_16x16x32_bf16 v[52:55], v[24:27], a[100:103], v[52:55]
  s_cbranch_vccnz LPWs_ha_w
LPWs_ha:
  v_mfma_f32_16x16x32_bf16 v[56:59], v[24:27], a[104:107], v[56:59]
  s_add_u32 m0, s89, 0
  s_add_u32 s94, s90, 0
  v_mfma_f32_16x16x32_bf16 v[60:63], v[24:27], a[108:111], v[60:63]
  s_waitcnt lgkmcnt(4)
  buffer_load_dwordx4 v101, s[32:35], s94 offen offset:0 sc1 lds
  v_mfma_f32_16x16x32_bf16 v[48:51], v[28:31], a[112:115], v[48:51]
  ds_read_b128 v[16:19], v97 offset:28672
  v_mfma_f32_16x16x32_bf16 v[52:55], v[28:31], a[116:119], v[52:55]
  buffer_load_dwordx4 v101, s[32:35], s94 offen offset:1024 sc1 lds
  v_mfma_f32_16x16x32_bf16 v[56:59], v[28:31], a[120:123], v[56:59]
  v_mfma_f32_16x16x32_bf16 v[60:63], v[28:31], a[124:127], v[60:63]
  s_waitcnt lgkmcnt(4)
  v_mfma_f32_16x16x32_bf16 v[48:51], v[0:3], a[128:131], v[48:51]
  ds_read_b128 v[20:23], v97 offset:29696
  buffer_load_dwordx4 v101, s[32:35], s94 offen offset:2048 sc1 lds
  v_mfma_f32_16x16x32_bf16 v[52:55], v[0:3], a[132:135], v[52:55]
  v_mfma_f32_16x16x32_bf16 v[56:59], v[0:3], a[136:139], v[56:59]
  v_mfma_f32_16x16x32_bf16 v[60:63], v[0:3], a[140:143], v[60:63]
  s_waitcnt lgkmcnt(4)
  buffer_load_dwordx4 v101, s[32:35], s94 offen offset:3072 sc1 lds
  v_mfma_f32_16x16x32_bf16 v[48:51], v[4:7], a[144:147], v[48:51]
  ds_read_b128 v[24:27], v97 offset:30720
  s_lshl_b32 s52, s50, 15
  buffer_load_dwordx2 v[140:141], v103, s[36:39], s52 offen sc1
  v_mfma_f32_16x16x32_bf16 v[52:55], v[4:7], a[148:151], v[52:55]
  s_add_u32 s52, s50, 2
  s_min_u32 s52, s52, 63
  s_lshl_b32 s52, s52, 11
  v_mfma_f32_16x16x32_bf16 v[56:59], v[4:7], a[152:155], v[56:59]
  s_add_u32 s52, s52, s56
  buffer_load_dword v109, v108, s[32:35], s52 offen sc1
  v_mfma_f32_16x16x32_bf16 v[60:63], v[4:7], a[156:159], v[60:63]
  s_waitcnt lgkmcnt(4)
  v_mfma_f32_16x16x32_bf16 v[48:51], v[8:11], a[160:163], v[48:51]
  ds_read_b128 v[28:31], v97 offset:31744
  s_add_u32 m0, s89, 4096
  s_add_u32 s94, s90, 4096
  v_mfma_f32_16x16x32_bf16 v[52:55], v[8:11], a[164:167], v[52:55]
  buffer_load_dwordx4 v101, s[32:35], s94 offen offset:0 sc1 lds
  v_mfma_f32_16x16x32_bf16 v[56:59], v[8:11], a[168:171], v[56:59]
  v_mfma_f32_16x16x32_bf16 v[60:63], v[8:11], a[172:175], v[60:63]
  s_waitcnt lgkmcnt(4)
  buffer_load_dwordx4 v101, s[32:35], s94 offen offset:1024 sc1 lds
  v_mfma_f32_16x16x32_bf16 v[48:51], v[12:15], a[176:179], v[48:51]
  v_mfma_f32_16x16x32_bf16 v[52:55], v[12:15], a[180:183], v[52:55]
  v_mfma_f32_16x16x32_bf16 v[56:59], v[12:15], a[184:187], v[56:59]
  buffer_load_dwordx4 v101, s[32:35], s94 offen offset:2048 sc1 lds
  v_mfma_f32_16x16x32_bf16 v[60:63], v[12:15], a[188:191], v[60:63]
  s_waitcnt lgkmcnt(3)
  v_mfma_f32_16x16x32_bf16 v[48:51], v[16:19], a[192:195], v[48:51]
  v_mfma_f32_16x16x32_bf16 v[52:55], v[16:19], a[196:199], v[52:55]
  buffer_load_dwordx4 v101, s[32:35], s94 offen offset:3072 sc1 lds
  v_mfma_f32_16x16x32_bf16 v[56:59], v[16:19], a[200:203], v[56:59]
  v_mfma_f32_16x16x32_bf16 v[60:63], v[16:19], a[204:207], v[60:63]
  s_waitcnt lgkmcnt(2)
  v_mfma_f32_16x16x32_bf16 v[48:51], v[20:23], a[208:211], v[48:51]
  v_mfma_f32_16x16x32_bf16 v[52:55], v[20:23], a[212:215], v[52:55]
  v_mfma_f32_16x16x32_bf16 v[56:59], v[20:23], a[216:219], v[56:59]
  v_mfma_f32_16x16x32_bf16 v[60:63], v[20:23], a[220:223], v[60:63]
  s_waitcnt lgkmcnt(1)
  v_mfma_f32_16x16x32_bf16 v[48:51], v[24:27], a[224:227], v[48:51]
  v_mfma_f32_16x16x32_bf16 v[52:55], v[24:27], a[228:231], v[52:55]
  v_mfma_f32_16x16x32_bf16 v[56:59], v[24:27], a[232:235], v[56:59]
  v_mfma_f32_16x16x32_bf16 v[60:63], v[24:27], a[236:239], v[60:63]
  s_waitcnt lgkmcnt(0)
  v_mfma_f32_16x16x32_bf16 v[48:51], v[28:31], a[240:243], v[48:51]
  v_mfma_f32_16x16x32_bf16 v[52:55], v[28:31], a[244:247], v[52:55]
  v_mfma_f32_16x16x32_bf16 v[56:59], v[28:31], a[248:251], v[56:59]
  v_mfma_f32_16x16x32_bf16 v[60:63], v[28:31], a[252:255], v[60:63]
  v_xor_b32 v97, 32768, v97
  s_mov_b32 s92, s50
  s_add_u32 s50, s50, 1
  v_cvt_pk_bf16_f32 v168, v48, v52
  s_nop 3
  v_cvt_pk_bf16_f32 v169, v56, v60
  v_cvt_pk_bf16_f32 v170, v49, v53
  v_cvt_pk_bf16_f32 v171, v57, v61
  v_bfi_b32 v168, 1, s54, v168
  s_add_u32 s51, s65, 131072
  buffer_store_dwordx4 v[168:171], v102, s[32:35], s51 offen offset:0 sc1
  v_cvt_pk_bf16_f32 v172, v50, v54
  v_cvt_pk_bf16_f32 v173, v58, v62
  v_cvt_pk_bf16_f32 v174, v51, v55
  v_cvt_pk_bf16_f32 v175, v59, v63
  v_bfi_b32 v172, 1, s54, v172
  s_add_u32 s51, s65, 147456
  buffer_store_dwordx4 v[172:175], v102, s[32:35], s51 offen offset:0 sc1
  s_waitcnt vmcnt(8)
  s_barrier
  ds_read_b128 v[0:3], v97 offset:0
  ds_read_b128 v[4:7], v97 offset:1024
  ds_read_b128 v[8:11], v97 offset:2048
LPWs_P:
  s_waitcnt lgkmcnt(2)
  v_mfma_f32_16x16x32_bf16 v[32:35], v[0:3], a[0:3], 0
  ds_read_b128 v[12:15], v97 offset:3072
  s_and_b32 s84, s92, 7
  s_lshl_b32 s84, s84, 15
  v_mfma_f32_16x16x32_bf16 v[36:39], v[0:3], a[4:7], 0
  s_and_b32 s86, s92, 3
  s_lshl_b32 s86, s86, 18
  s_add_u32 s86, s86, s58
  v_mfma_f32_16x16x32_bf16 v[40:43], v[0:3], a[8:11], 0
  ds_read_b128 v[16:19], v97 offset:8192
  s_lshr_b32 s85, s92, 2
  s_add_u32 s85, s85, 1
  v_mfma_f32_16x16x32_bf16 v[44:47], v[0:3], a[12:15], 0
  s_waitcnt lgkmcnt(3)
  s_and_b32 s67, s92, 7
  s_lshl_b32 s67, s67, 16
  v_mfma_f32_16x16x32_bf16 v[32:35], v[4:7], a[16:19], v[32:35]
  ds_read_b128 v[20:23], v97 offset:9216
  s_add_u32 s67, s67, s59
  s_lshr_b32 s66, s92, 3
  v_mfma_f32_16x16x32_bf16 v[36:39], v[4:7], a[20:23], v[36:39]
  s_add_u32 s66, s66, 1
  s_and_b32 s65, s50, 3
  s_lshl_b32 s65, s65, 18
  v_mfma_f32_16x16x32_bf16 v[40:43], v[4:7], a[24:27], v[40:43]
  ds_read_b128 v[24:27], v97 offset:10240
  s_add_u32 s65, s65, s57
  s_lshr_b32 s54, s50, 2
  v_mfma_f32_16x16x32_bf16 v[44:47], v[4:7], a[28:31], v[44:47]
  s_waitcnt lgkmcnt(4)
  s_add_u32 s54, s54, 1
  s_add_u32 s90, s50, 1
  v_mfma_f32_16x16x32_bf16 v[32:35], v[8:11], a[32:35], v[32:35]
  ds_read_b128 v[28:31], v97 offset:11264
  s_min_u32 s90, s90, 63
  s_lshl_b32 s91, s90, 11
  v_mfma_f32_16x16x32_bf16 v[36:39], v[8:11], a[36:39], v[36:39]
  s_add_u32 s91, s91, s56
  s_lshl_b32 s90, s90, 18
  s_add_u32 s90, s90, s55
  v_mfma_f32_16x16x32_bf16 v[40:43], v[8:11], a[40:43], v[40:43]
  s_cmp_eq_u32 s50, 63
  s_cselect_b32 s90, 1073741824, s90
  s_xor_b32 s89, s89, 32768
  v_mfma_f32_16x16x32_bf16 v[44:47], v[8:11], a[44:47], v[44:47]
  s_waitcnt lgkmcnt(4)
  v_mfma_f32_16x16x32_bf16 v[32:35], v[12:15], a[48:51], v[32:35]
  ds_read_b128 v[0:3], v97 offset:16384
  v_mfma_f32_16x16x32_bf16 v[36:39], v[12:15], a[52:55], v[36:39]
  v_mfma_f32_16x16x32_bf16 v[40:43], v[12:15], a[56:59], v[40:43]
  v_mfma_f32_16x16x32_bf16 v[44:47], v[12:15], a[60:63], v[44:47]
  s_waitcnt lgkmcnt(4)
  v_mfma_f32_16x16x32_bf16 v[32:35], v[16:19], a[64:67], v[32:35]
  ds_read_b128 v[4:7], v97 offset:17408
  v_mfma_f32_16x16x32_bf16 v[36:39], v[16:19], a[68:71], v[36:39]
  v_mfma_f32_16x16x32_bf16 v[40:43], v[16:19], a[72:75], v[40:43]
  v_mfma_f32_16x16x32_bf16 v[44:47], v[16:19], a[76:79], v[44:47]
  s_waitcnt lgkmcnt(4)
  v_mfma_f32_16x16x32_bf16 v[32:35], v[20:23], a[80:83], v[32:35]
  ds_read_b128 v[8:11], v97 offset:18432
  buffer_load_dwordx4 v[144:147], v96, s[32:35], s86 offen offset:0 sc1
  v_mfma_f32_16x16x32_bf16 v[36:39], v[20:23], a[84:87], v[36:39]
  v_mfma_f32_16x16x32_bf16 v[40:43], v[20:23], a[88:91], v[40:43]
  buffer_load_dwordx4 v[148:151], v96, s[32:35], s86 offen offset:1024 sc1
  v_mfma_f32_16x16x32_bf16 v[44:47], v[20:23], a[92:95], v[44:47]
  s_waitcnt lgkmcnt(4)
  v_mfma_f32_16x16x32_bf16 v[32:35], v[24:27], a[96:99], v[32:35]
  ds_read_b128 v[12:15], v97 offset:19456
  buffer_load_dwordx4 v[152:155], v96, s[32:35], s86 offen offset:2048 sc1
  v_mfma_f32_16x16x32_bf16 v[36:39], v[24:27], a[100:103], v[36:39]
  v_mfma_f32_16x16x32_bf16 v[40:43], v[24:27], a[104:107], v[40:43]
  buffer_load_dwordx4 v[156:159], v96, s[32:35], s86 offen offset:3072 sc1
  v_mfma_f32_16x16x32_bf16 v[44:47], v[24:27], a[108:111], v[44:47]
  s_waitcnt lgkmcnt(4)
  v_mfma_f32_16x16x32_bf16 v[32:35], v[28:31], a[112:115], v[32:35]
  ds_read_b128 v[16:19], v97 offset:24576
  v_mfma_f32_16x16x32_bf16 v[36:39], v[28:31], a[116:119], v[36:39]
  v_mfma_f32_16x16x32_bf16 v[40:43], v[28:31], a[120:123], v[40:43]
  v_mfma_f32_16x16x32_bf16 v[44:47], v[28:31], a[124:127], v[44:47]
  s_waitcnt lgkmcnt(4)
  v_mfma_f32_16x16x32_bf16 v[32:35], v[0:3], a[128:131], v[32:35]
  ds_read_b128 v[20:23], v97 offset:25600
  v_mfma_f32_16x16x32_bf16 v[36:39], v[0:3], a[132:135], v[36:39]
  v_mfma_f32_16x16x32_bf16 v[40:43], v[0:3], a[136:139], v[40:43]
  v_mfma_f32_16x16x32_bf16 v[44:47], v[0:3], a[140:143], v[44:47]
  s_waitcnt lgkmcnt(4)
  v_mfma_f32_16x16x32_bf16 v[32:35], v[4:7], a[144:147], v[32:35]
  ds_read_b128 v[24:27], v97 offset:26624
  v_mfma_f32_16x16x32_bf16 v[36:39], v[4:7], a[148:151], v[36:39]
  v_mfma_f32_16x16x32_bf16 v[40:43], v[4:7], a[152:155], v[40:43]
  v_mfma_f32_16x16x32_bf16 v[44:47], v[4:7], a[156:159], v[44:47]
  s_waitcnt lgkmcnt(4)
  s_waitcnt vmcnt(6)
  v_lshlrev_b32 v132, 16, v140
  v_mfma_f32_16x16x32_bf16 v[32:35], v[8:11], a[160:163], v[32:35]
  ds_read_b128 v[28:31], v97 offset:27648
  v_and_b32 v133, 0xffff0000, v140
  v_lshlrev_b32 v134, 16, v141
  v_mfma_f32_16x16x32_bf16 v[36:39], v[8:11], a[164:167], v[36:39]
  v_and_b32 v135, 0xffff0000, v141
  v_mov_b32 v136, 0
  v_mfma_f32_16x16x32_bf16 v[40:43], v[8:11], a[168:171], v[40:43]
  v_mfma_f32_16x16x32_bf16 v[44:47], v[8:11], a[172:175], v[44:47]
  s_waitcnt lgkmcnt(4)
  v_mfma_f32_16x16x32_bf16 v[32:35], v[12:15], a[176:179], v[32:35]
  s_barrier
  ds_read_b128 v[0:3], v97 offset:4096
  v_mfma_f32_16x16x32_bf16 v[36:39], v[12:15], a[180:183], v[36:39]
  s_waitcnt vmcnt(3)
  v_mfma_f32_16x16x32_bf16 v[132:135], v[112:115], v[144:147], v[132:135]
  v_bitop3_b32 v136, v136, v144, s85 bitop3:246
  s_waitcnt vmcnt(2)
  v_mfma_f32_16x16x32_bf16 v[40:43], v[12:15], a[184:187], v[40:43]
  v_mfma_f32_16x16x32_bf16 v[132:135], v[112:115], v[148:151], v[132:135]
  v_bitop3_b32 v136, v136, v148, s85 bitop3:246
  s_waitcnt vmcnt(1)
  v_mfma_f32_16x16x32_bf16 v[44:47], v[12:15], a[188:191], v[44:47]
  s_waitcnt lgkmcnt(4)
  v_mfma_f32_16x16x32_bf16 v[132:135], v[116:119], v[152:155], v[132:135]
  v_bitop3_b32 v136, v136, v152, s85 bitop3:246
  s_waitcnt vmcnt(0)
  v_mfma_f32_16x16x32_bf16 v[32:35], v[16:19], a[192:195], v[32:35]
  ds_read_b128 v[4:7], v97 offset:5120
  v_mfma_f32_16x16x32_bf16 v[132:135], v[116:119], v[156:159], v[132:135]
  v_bitop3_b32 v136, v136, v156, s85 bitop3:246
  v_and_b32 v136, 1, v136
  v_mfma_f32_16x16x32_bf16 v[36:39], v[16:19], a[196:199], v[36:39]
  v_cmp_ne_u32 vcc, 0, v136
  s_cbranch_vccnz LPWs_gc_r
LPWs_gc:
  v_mfma_f32_16x16x32_bf16 v[40:43], v[16:19], a[200:203], v[40:43]
  v_cmp_eq_u32 vcc, 0, v109
  v_mfma_f32_16x16x32_bf16 v[44:47], v[16:19], a[204:207], v[44:47]
  s_waitcnt lgkmcnt(4)
  s_cbranch_vccz LPWs_E
  v_mfma_f32_16x16x32_bf16 v[32:35], v[20:23], a[208:211], v[32:35]
  ds_read_b128 v[8:11], v97 offset:6144
  v_add_f32 v144, v132, v133
  v_mul_f32 v145, v132, v132
  v_mfma_f32_16x16x32_bf16 v[36:39], v[20:23], a[212:215], v[36:39]
  v_add_f32 v146, v134, v135
  v_fmac_f32 v145, v133, v133
  v_mfma_f32_16x16x32_bf16 v[40:43], v[20:23], a[216:219], v[40:43]
  v_add_f32 v144, v144, v146
  v_fmac_f32 v145, v134, v134
  v_mfma_f32_16x16x32_bf16 v[44:47], v[20:23], a[220:223], v[44:47]
  s_waitcnt lgkmcnt(4)
  v_fmac_f32 v145, v135, v135
  v_add_f32_dpp v144, v144, v144 row_ror:8 row_mask:0xf bank_mask:0xf
  v_mfma_f32_16x16x32_bf16 v[32:35], v[24:27], a[224:227], v[32:35]
  ds_read_b128 v[12:15], v97 offset:7168
  v_add_f32_dpp v145, v145, v145 row_ror:8 row_mask:0xf bank_mask:0xf
  v_add_f32_dpp v144, v144, v144 row_ror:4 row_mask:0xf bank_mask:0xf
  v_mfma_f32_16x16x32_bf16 v[36:39], v[24:27], a[228:231], v[36:39]
  v_add_f32_dpp v145, v145, v145 row_ror:4 row_mask:0xf bank_mask:0xf
  v_add_f32_dpp v144, v144, v144 row_ror:2 row_mask:0xf bank_mask:0xf
  v_mfma_f32_16x16x32_bf16 v[40:43], v[24:27], a[232:235], v[40:43]
  v_add_f32_dpp v145, v145, v145 row_ror:2 row_mask:0xf bank_mask:0xf
  v_add_f32_dpp v144, v144, v144 row_ror:1 row_mask:0xf bank_mask:0xf
  v_mfma_f32_16x16x32_bf16 v[44:47], v[24:27], a[236:239], v[44:47]
  s_waitcnt lgkmcnt(4)
  v_add_f32_dpp v145, v145, v145 row_ror:1 row_mask:0xf bank_mask:0xf
  s_nop 1
  v_permlane32_swap_b32 v144, v145
  v_mfma_f32_16x16x32_bf16 v[32:35], v[28:31], a[240:243], v[32:35]
  ds_read_b128 v[16:19], v97 offset:12288
  v_add_f32 v144, v144, v145
  v_mfma_f32_16x16x32_bf16 v[36:39], v[28:31], a[244:247], v[36:39]
  ds_write_b32 v105, v144 offset:0
  v_bfi_b32 v132, 1, s66, v132
  v_mfma_f32_16x16x32_bf16 v[40:43], v[28:31], a[248:251], v[40:43]
  buffer_store_dwordx4 v[132:135], v96, s[32:35], s67 offen sc1
  v_mfma_f32_16x16x32_bf16 v[44:47], v[28:31], a[252:255], v[44:47]
  s_waitcnt lgkmcnt(5)
  v_mfma_f32_16x16x32_bf16 v[48:51], v[0:3], a[0:3], 0
  ds_read_b128 v[20:23], v97 offset:13312
  v_mfma_f32_16x16x32_bf16 v[52:55], v[0:3], a[4:7], 0
  s_waitcnt lgkmcnt(1)
  v_mfma_f32_16x16x32_bf16 v[56:59], v[0:3], a[8:11], 0
  s_barrier
  ds_read_b128 v[144:147], v106 offset:0
  v_mfma_f32_16x16x32_bf16 v[60:63], v[0:3], a[12:15], 0
  ds_read_b128 v[148:151], v106 offset:16
  buffer_load_dword v111, v108, s[32:35], s91 offen sc1
  v_mfma_f32_16x16x32_bf16 v[48:51], v[4:7], a[16:19], v[48:51]
  ds_read_b128 v[24:27], v97 offset:14336
  v_xor_b32 v105, 256, v105
  v_xor_b32 v106, 256, v106
  v_mfma_f32_16x16x32_bf16 v[52:55], v[4:7], a[20:23], v[52:55]
  s_lshl_b32 s93, s92, 8
  s_add_u32 s93, s93, s62
  s_waitcnt lgkmcnt(1)
  v_mfma_f32_16x16x32_bf16 v[56:59], v[4:7], a[24:27], v[56:59]
  v_add_f32 v144, v144, v148
  v_add_f32 v145, v145, v149
  v_mfma_f32_16x16x32_bf16 v[60:63], v[4:7], a[28:31], v[60:63]
  v_add_f32 v146, v146, v150
  v_add_f32 v147, v147, v151
  v_mfma_f32_16x16x32_bf16 v[48:51], v[8:11], a[32:35], v[48:51]
  ds_read_b128 v[28:31], v97 offset:15360
  v_add_f32 v144, v144, v146
  v_add_f32 v145, v145, v147
  v_mfma_f32_16x16x32_bf16 v[52:55], v[8:11], a[36:39], v[52:55]
  v_mul_f32 v144, 0x3b000000, v144
  v_mul_f32 v145, 0x3b000000, v145
  v_mfma_f32_16x16x32_bf16 v[56:59], v[8:11], a[40:43], v[56:59]
  v_fma_f32 v145, -v144, v144, v145
  v_max_f32 v145, 0, v145
  v_mfma_f32_16x16x32_bf16 v[60:63], v[8:11], a[44:47], v[60:63]
  v_add_f32 v145, 0x3727c5ac, v145
  v_cvt_pk_bf16_f32 v160, v32, v36
  v_mfma_f32_16x16x32_bf16 v[48:51], v[12:15], a[48:51], v[48:51]
  ds_read_b128 v[0:3], v97 offset:20480
  v_rsq_f32 v145, v145
  v_mfma_f32_16x16x32_bf16 v[52:55], v[12:15], a[52:55], v[52:55]
  s_add_u32 s86, s84, s61
  v_mul_f32 v144, v144, v145
  v_fma_f32 v148, v132, v145, -v144
  v_mfma_f32_16x16x32_bf16 v[56:59], v[12:15], a[56:59], v[56:59]
  v_fma_f32 v149, v133, v145, -v144
  v_fma_f32 v150, v134, v145, -v144
  v_mfma_f32_16x16x32_bf16 v[60:63], v[12:15], a[60:63], v[60:63]
  v_fma_f32 v151, v135, v145, -v144
  v_cvt_pk_bf16_f32 v130, v148, v149
  v_mfma_f32_16x16x32_bf16 v[48:51], v[16:19], a[64:67], v[48:51]
  ds_read_b128 v[4:7], v97 offset:21504
  v_cvt_pk_bf16_f32 v131, v150, v151
  v_bfi_b32 v128, 1, s66, v130
  v_mfma_f32_16x16x32_bf16 v[52:55], v[16:19], a[68:71], v[52:55]
  v_mov_b32 v129, v131
  v_mov_b32_dpp v130, v130 quad_perm:[1,0,3,2] row_mask:0xf bank_mask:0xf
  v_mfma_f32_16x16x32_bf16 v[56:59], v[16:19], a[72:75], v[56:59]
  v_mov_b32_dpp v131, v131 quad_perm:[1,0,3,2] row_mask:0xf bank_mask:0xf
  v_cvt_pk_bf16_f32 v161, v40, v44
  v_mfma_f32_16x16x32_bf16 v[60:63], v[16:19], a[76:79], v[60:63]
  buffer_store_dwordx4 v[128:131], v104, s[32:35], s86 offen sc1
  v_mfma_f32_16x16x32_bf16 v[48:51], v[20:23], a[80:83], v[48:51]
  ds_read_b128 v[8:11], v97 offset:22528
  s_mov_b64 exec, 1
  buffer_store_dword v110, off, s[32:35], s93 sc1
  s_mov_b64 exec, -1
  v_mfma_f32_16x16x32_bf16 v[52:55], v[20:23], a[84:87], v[52:55]
  v_cvt_pk_bf16_f32 v162, v33, v37
  v_cvt_pk_bf16_f32 v163, v41, v45
  v_mfma_f32_16x16x32_bf16 v[56:59], v[20:23], a[88:91], v[56:59]
  v_bfi_b32 v160, 1, s54, v160
  v_mfma_f32_16x16x32_bf16 v[60:63], v[20:23], a[92:95], v[60:63]
  s_waitcnt lgkmcnt(4)
  s_add_u32 s51, s65, 0
  buffer_store_dwordx4 v[160:163], v102, s[32:35], s51 offen offset:0 sc1
  v_mfma_f32_16x16x32_bf16 v[48:51], v[24:27], a[96:99], v[48:51]
  ds_read_b128 v[12:15], v97 offset:23552
  s_waitcnt vmcnt(3)
  v_cmp_eq_u32 vcc, 0, v111
  v_mfma_f32_16x16x32_bf16 v[52:55], v[24:27], a[100:103], v[52:55]
  s_cbranch_vccnz LPWs_ga_w
LPWs_ga:
  v_cvt_pk_bf16_f32 v164, v34, v38
  v_cvt_pk_bf16_f32 v165, v42, v46
  v_mfma_f32_16x16x32_bf16 v[56:59], v[24:27], a[104:107], v[56:59]
  s_add_u32 m0, s89, 0
  s_add_u32 s94, s90, 0
  v_cvt_pk_bf16_f32 v166, v35, v39
  v_mfma_f32_16x16x32_bf16 v[60:63], v[24:27], a[108:111], v[60:63]
  s_waitcnt lgkmcnt(4)
  buffer_load_dwordx4 v101, s[32:35], s94 offen offset:0 sc1 lds
  v_mfma_f32_16x16x32_bf16 v[48:51], v[28:31], a[112:115], v[48:51]
  ds_read_b128 v[16:19], v97 offset:28672
  v_cvt_pk_bf16_f32 v167, v43, v47
  v_bfi_b32 v164, 1, s54, v164
  v_mfma_f32_16x16x32_bf16 v[52:55], v[28:31], a[116:119], v[52:55]
  buffer_load_dwordx4 v101, s[32:35], s94 offen offset:1024 sc1 lds
  v_mfma_f32_16x16x32_bf16 v[56:59], v[28:31], a[120:123], v[56:59]
  s_add_u32 s51, s65, 16384
  buffer_store_dwordx4 v[164:167], v102, s[32:35], s51 offen offset:0 sc1
  v_mfma_f32_16x16x32_bf16 v[60:63], v[28:31], a[124:127], v[60:63]
  s_waitcnt lgkmcnt(4)
  v_mfma_f32_16x16x32_bf16 v[48:51], v[0:3], a[128:131], v[48:51]
  ds_read_b128 v[20:23], v97 offset:29696
  buffer_load_dwordx4 v101, s[32:35], s94 offen offset:2048 sc1 lds
  v_mfma_f32_16x16x32_bf16 v[52:55], v[0:3], a[132:135], v[52:55]
  v_mfma_f32_16x16x32_bf16 v[56:59], v[0:3], a[136:139], v[56:59]
  v_mfma_f32_16x16x32_bf16 v[60:63], v[0:3], a[140:143], v[60:63]
  s_waitcnt lgkmcnt(4)
  buffer_load_dwordx4 v101, s[32:35], s94 offen offset:3072 sc1 lds
  v_mfma_f32_16x16x32_bf16 v[48:51], v[4:7], a[144:147], v[48:51]
  ds_read_b128 v[24:27], v97 offset:30720
  s_lshl_b32 s52, s50, 15
  buffer_load_dwordx2 v[140:141], v103, s[36:39], s52 offen sc1
  v_mfma_f32_16x16x32_bf16 v[52:55], v[4:7], a[148:151], v[52:55]
  s_add_u32 s52, s50, 2
  s_min_u32 s52, s52, 63
  s_lshl_b32 s52, s52, 11
  v_mfma_f32_16x16x32_bf16 v[56:59], v[4:7], a[152:155], v[56:59]
  s_add_u32 s52, s52, s56
  buffer_load_dword v109, v108, s[32:35], s52 offen sc1
  v_mfma_f32_16x16x32_bf16 v[60:63], v[4:7], a[156:159], v[60:63]
  s_waitcnt lgkmcnt(4)
  v_mfma_f32_16x16x32_bf16 v[48:51], v[8:11], a[160:163], v[48:51]
  ds_read_b128 v[28:31], v97 offset:31744
  s_add_u32 m0, s89, 4096
  s_add_u32 s94, s90, 4096
  v_mfma_f32_16x16x32_bf16 v[52:55], v[8:11], a[164:167], v[52:55]
  buffer_load_dwordx4 v101, s[32:35], s94 offen offset:0 sc1 lds
  v_mfma_f32_16x16x32_bf16 v[56:59], v[8:11], a[168:171], v[56:59]
  v_mfma_f32_16x16x32_bf16 v[60:63], v[8:11], a[172:175], v[60:63]
  s_waitcnt lgkmcnt(4)
  buffer_load_dwordx4 v101, s[32:35], s94 offen offset:1024 sc1 lds
  v_mfma_f32_16x16x32_bf16 v[48:51], v[12:15], a[176:179], v[48:51]
  v_mfma_f32_16x16x32_bf16 v[52:55], v[12:15], a[180:183], v[52:55]
  v_mfma_f32_16x16x32_bf16 v[56:59], v[12:15], a[184:187], v[56:59]
  buffer_load_dwordx4 v101, s[32:35], s94 offen offset:2048 sc1 lds
  v_mfma_f32_16x16x32_bf16 v[60:63], v[12:15], a[188:191], v[60:63]
  s_waitcnt lgkmcnt(3)
  v_mfma_f32_16x16x32_bf16 v[48:51], v[16:19], a[192:195], v[48:51]
  v_mfma_f32_16x16x32_bf16 v[52:55], v[16:19], a[196:199], v[52:55]
  buffer_load_dwordx4 v101, s[32:35], s94 offen offset:3072 sc1 lds
  v_mfma_f32_16x16x32_bf16 v[56:59], v[16:19], a[200:203], v[56:59]
  v_mfma_f32_16x16x32_bf16 v[60:63], v[16:19], a[204:207], v[60:63]
  s_waitcnt lgkmcnt(2)
  v_mfma_f32_16x16x32_bf16 v[48:51], v[20:23], a[208:211], v[48:51]
  v_mfma_f32_16x16x32_bf16 v[52:55], v[20:23], a[212:215], v[52:55]
  v_mfma_f32_16x16x32_bf16 v[56:59], v[20:23], a[216:219], v[56:59]
  v_mfma_f32_16x16x32_bf16 v[60:63], v[20:23], a[220:223], v[60:63]
  s_waitcnt lgkmcnt(1)
  v_mfma_f32_16x16x32_bf16 v[48:51], v[24:27], a[224:227], v[48:51]
  v_mfma_f32_16x16x32_bf16 v[52:55], v[24:27], a[228:231], v[52:55]
  v_mfma_f32_16x16x32_bf16 v[56:59], v[24:27], a[232:235], v[56:59]
  v_mfma_f32_16x16x32_bf16 v[60:63], v[24:27], a[236:239], v[60:63]
  s_waitcnt lgkmcnt(0)
  v_mfma_f32_16x16x32_bf16 v[48:51], v[28:31], a[240:243], v[48:51]
  v_mfma_f32_16x16x32_bf16 v[52:55], v[28:31], a[244:247], v[52:55]
  v_mfma_f32_16x16x32_bf16 v[56:59], v[28:31], a[248:251], v[56:59]
  v_mfma_f32_16x16x32_bf16 v[60:63], v[28:31], a[252:255], v[60:63]
  v_xor_b32 v97, 32768, v97
  s_mov_b32 s92, s50
  s_add_u32 s50, s50, 1
  v_cvt_pk_bf16_f32 v168, v48, v52
  s_nop 3
  v_cvt_pk_bf16_f32 v169, v56, v60
  v_cvt_pk_bf16_f32 v170, v49, v53
  v_cvt_pk_bf16_f32 v171, v57, v61
  v_bfi_b32 v168, 1, s54, v168
  s_add_u32 s51, s65, 131072
  buffer_store_dwordx4 v[168:171], v102, s[32:35], s51 offen offset:0 sc1
  v_cvt_pk_bf16_f32 v172, v50, v54
  v_cvt_pk_bf16_f32 v173, v58, v62
  v_cvt_pk_bf16_f32 v174, v51, v55
  v_cvt_pk_bf16_f32 v175, v59, v63
  v_bfi_b32 v172, 1, s54, v172
  s_add_u32 s51, s65, 147456
  buffer_store_dwordx4 v[172:175], v102, s[32:35], s51 offen offset:0 sc1
  s_waitcnt vmcnt(8)
  s_barrier
  ds_read_b128 v[0:3], v97 offset:0
  ds_read_b128 v[4:7], v97 offset:1024
  ds_read_b128 v[8:11], v97 offset:2048
LPWs_J:
  s_cmp_lt_u32 s50, 64
  s_cbranch_scc1 LPWs_P
LPWs_N:
  s_and_b32 s84, s92, 7
  s_lshl_b32 s84, s84, 15
  s_and_b32 s86, s92, 3
  s_lshl_b32 s86, s86, 18
  s_add_u32 s86, s86, s58
  s_lshr_b32 s85, s92, 2
  s_add_u32 s85, s85, 1
  s_and_b32 s67, s92, 7
  s_lshl_b32 s67, s67, 16
  s_add_u32 s67, s67, s59
  s_lshr_b32 s66, s92, 3
  s_add_u32 s66, s66, 1
  s_waitcnt vmcnt(0)
  buffer_load_dwordx4 v[144:147], v96, s[32:35], s86 offen offset:0 sc1
  buffer_load_dwordx4 v[148:151], v96, s[32:35], s86 offen offset:1024 sc1
  buffer_load_dwordx4 v[152:155], v96, s[32:35], s86 offen offset:2048 sc1
  buffer_load_dwordx4 v[156:159], v96, s[32:35], s86 offen offset:3072 sc1
  v_lshlrev_b32 v132, 16, v140
  v_and_b32 v133, 0xffff0000, v140
  v_lshlrev_b32 v134, 16, v141
  v_and_b32 v135, 0xffff0000, v141
  v_mov_b32 v136, 0
  s_waitcnt vmcnt(3)
  v_mfma_f32_16x16x32_bf16 v[132:135], v[112:115], v[144:147], v[132:135]
  v_bitop3_b32 v136, v136, v144, s85 bitop3:246
  s_waitcnt vmcnt(2)
  v_mfma_f32_16x16x32_bf16 v[132:135], v[112:115], v[148:151], v[132:135]
  v_bitop3_b32 v136, v136, v148, s85 bitop3:246
  s_waitcnt vmcnt(1)
  v_mfma_f32_16x16x32_bf16 v[132:135], v[116:119], v[152:155], v[132:135]
  v_bitop3_b32 v136, v136, v152, s85 bitop3:246
  s_waitcnt vmcnt(0)
  v_mfma_f32_16x16x32_bf16 v[132:135], v[116:119], v[156:159], v[132:135]
  v_bitop3_b32 v136, v136, v156, s85 bitop3:246
  v_and_b32 v136, 1, v136
  v_cmp_ne_u32 vcc, 0, v136
  s_cbranch_vccnz LPWs_nc_r
LPWs_nc:
  s_nop 3
  v_add_f32 v144, v132, v133
  v_mul_f32 v145, v132, v132
  v_add_f32 v146, v134, v135
  v_fmac_f32 v145, v133, v133
  v_add_f32 v144, v144, v146
  v_fmac_f32 v145, v134, v134
  v_fmac_f32 v145, v135, v135
  v_add_f32_dpp v144, v144, v144 row_ror:8 row_mask:0xf bank_mask:0xf
  s_nop 0
  v_add_f32_dpp v145, v145, v145 row_ror:8 row_mask:0xf bank_mask:0xf
  v_add_f32_dpp v144, v144, v144 row_ror:4 row_mask:0xf bank_mask:0xf
  s_nop 0
  v_add_f32_dpp v145, v145, v145 row_ror:4 row_mask:0xf bank_mask:0xf
  v_add_f32_dpp v144, v144, v144 row_ror:2 row_mask:0xf bank_mask:0xf
  s_nop 0
  v_add_f32_dpp v145, v145, v145 row_ror:2 row_mask:0xf bank_mask:0xf
  v_add_f32_dpp v144, v144, v144 row_ror:1 row_mask:0xf bank_mask:0xf
  s_nop 0
  v_add_f32_dpp v145, v145, v145 row_ror:1 row_mask:0xf bank_mask:0xf
  s_nop 1
  v_permlane32_swap_b32 v144, v145
  v_add_f32 v144, v144, v145
  ds_write_b32 v105, v144 offset:0
  s_waitcnt lgkmcnt(0)
  s_barrier
  ds_read_b128 v[144:147], v106 offset:0
  ds_read_b128 v[148:151], v106 offset:16
  v_xor_b32 v105, 256, v105
  v_xor_b32 v106, 256, v106
  s_lshl_b32 s93, s92, 8
  s_add_u32 s93, s93, s62
  s_waitcnt lgkmcnt(0)
  v_pk_add_f32 v[144:145], v[144:145], v[148:149]
  v_pk_add_f32 v[146:147], v[146:147], v[150:151]
  v_pk_add_f32 v[144:145], v[144:145], v[146:147]
  v_mul_f32 v144, 0x3b000000, v144
  v_mul_f32 v145, 0x3b000000, v145
  v_fma_f32 v145, -v144, v144, v145
  v_max_f32 v145, 0, v145
  v_add_f32 v145, 0x3727c5ac, v145
  v_rsq_f32 v145, v145
  s_add_u32 s86, s84, s61
  v_mul_f32 v144, v144, v145
  v_fma_f32 v148, v132, v145, -v144
  v_fma_f32 v149, v133, v145, -v144
  v_fma_f32 v150, v134, v145, -v144
  v_fma_f32 v151, v135, v145, -v144
  v_cvt_pk_bf16_f32 v130, v148, v149
  v_cvt_pk_bf16_f32 v131, v150, v151
  v_bfi_b32 v128, 1, s66, v130
  v_mov_b32 v129, v131
  v_mov_b32_dpp v130, v130 quad_perm:[1,0,3,2] row_mask:0xf bank_mask:0xf
  v_mov_b32_dpp v131, v131 quad_perm:[1,0,3,2] row_mask:0xf bank_mask:0xf
  buffer_store_dwordx4 v[128:131], v104, s[32:35], s86 offen sc1
  s_mov_b64 exec, 1
  buffer_store_dword v110, off, s[32:35], s93 sc1
  s_mov_b64 exec, -1
  v_bfi_b32 v132, 1, s66, v132
  buffer_store_dwordx4 v[132:135], v96, s[32:35], s67 offen sc1
  s_branch L_post_done
LPWs_E:
  v_mfma_f32_16x16x32_bf16 v[32:35], v[20:23], a[208:211], v[32:35]
  ds_read_b128 v[8:11], v97 offset:6144
  v_add_f32 v144, v132, v133
  v_mul_f32 v145, v132, v132
  v_mfma_f32_16x16x32_bf16 v[36:39], v[20:23], a[212:215], v[36:39]
  s_add_u32 m0, s89, 0
  s_add_u32 s94, s90, 0
  v_add_f32 v146, v134, v135
  v_mfma_f32_16x16x32_bf16 v[40:43], v[20:23], a[216:219], v[40:43]
  buffer_load_dwordx4 v101, s[32:35], s94 offen offset:0 sc1 lds
  v_fmac_f32 v145, v133, v133
  v_mfma_f32_16x16x32_bf16 v[44:47], v[20:23], a[220:223], v[44:47]
  s_waitcnt lgkmcnt(4)
  v_add_f32 v144, v144, v146
  v_fmac_f32 v145, v134, v134
  v_mfma_f32_16x16x32_bf16 v[32:35], v[24:27], a[224:227], v[32:35]
  ds_read_b128 v[12:15], v97 offset:7168
  v_fmac_f32 v145, v135, v135
  v_add_f32_dpp v144, v144, v144 row_ror:8 row_mask:0xf bank_mask:0xf
  v_mfma_f32_16x16x32_bf16 v[36:39], v[24:27], a[228:231], v[36:39]
  buffer_load_dwordx4 v101, s[32:35], s94 offen offset:1024 sc1 lds
  v_add_f32_dpp v145, v145, v145 row_ror:8 row_mask:0xf bank_mask:0xf
  v_mfma_f32_16x16x32_bf16 v[40:43], v[24:27], a[232:235], v[40:43]
  v_add_f32_dpp v144, v144, v144 row_ror:4 row_mask:0xf bank_mask:0xf
  v_add_f32_dpp v145, v145, v145 row_ror:4 row_mask:0xf bank_mask:0xf
  v_mfma_f32_16x16x32_bf16 v[44:47], v[24:27], a[236:239], v[44:47]
  s_waitcnt lgkmcnt(4)
  v_add_f32_dpp v144, v144, v144 row_ror:2 row_mask:0xf bank_mask:0xf
  v_add_f32_dpp v145, v145, v145 row_ror:2 row_mask:0xf bank_mask:0xf
  v_mfma_f32_16x16x32_bf16 v[32:35], v[28:31], a[240:243], v[32:35]
  ds_read_b128 v[16:19], v97 offset:12288
  v_add_f32_dpp v144, v144, v144 row_ror:1 row_mask:0xf bank_mask:0xf
  v_add_f32_dpp v145, v145, v145 row_ror:1 row_mask:0xf bank_mask:0xf
  v_mfma_f32_16x16x32_bf16 v[36:39], v[28:31], a[244:247], v[36:39]
  buffer_load_dwordx4 v101, s[32:35], s94 offen offset:2048 sc1 lds
  v_permlane32_swap_b32 v144, v145
  v_mfma_f32_16x16x32_bf16 v[40:43], v[28:31], a[248:251], v[40:43]
  v_add_f32 v144, v144, v145
  v_mfma_f32_16x16x32_bf16 v[44:47], v[28:31], a[252:255], v[44:47]
  s_waitcnt lgkmcnt(4)
  ds_write_b32 v105, v144 offset:0
  v_mfma_f32_16x16x32_bf16 v[48:51], v[0:3], a[0:3], 0
  ds_read_b128 v[20:23], v97 offset:13312
  v_bfi_b32 v132, 1, s66, v132
  v_mfma_f32_16x16x32_bf16 v[52:55], v[0:3], a[4:7], 0
  buffer_load_dwordx4 v101, s[32:35], s94 offen offset:3072 sc1 lds
  v_mfma_f32_16x16x32_bf16 v[56:59], v[0:3], a[8:11], 0
  buffer_store_dwordx4 v[132:135], v96, s[32:35], s67 offen sc1
  v_mfma_f32_16x16x32_bf16 v[60:63], v[0:3], a[12:15], 0
  s_waitcnt lgkmcnt(5)
  s_waitcnt lgkmcnt(1)
  v_mfma_f32_16x16x32_bf16 v[48:51], v[4:7], a[16:19], v[48:51]
  ds_read_b128 v[24:27], v97 offset:14336
  s_barrier
  v_mfma_f32_16x16x32_bf16 v[52:55], v[4:7], a[20:23], v[52:55]
  s_add_u32 m0, s89, 4096
  s_add_u32 s94, s90, 4096
  ds_read_b128 v[144:147], v106 offset:0
  v_mfma_f32_16x16x32_bf16 v[56:59], v[4:7], a[24:27], v[56:59]
  buffer_load_dwordx4 v101, s[32:35], s94 offen offset:0 sc1 lds
  ds_read_b128 v[148:151], v106 offset:16
  v_mfma_f32_16x16x32_bf16 v[60:63], v[4:7], a[28:31], v[60:63]
  v_xor_b32 v105, 256, v105
  v_xor_b32 v106, 256, v106
  v_mfma_f32_16x16x32_bf16 v[48:51], v[8:11], a[32:35], v[48:51]
  ds_read_b128 v[28:31], v97 offset:15360
  s_lshl_b32 s93, s92, 8
  s_add_u32 s93, s93, s62
  v_mfma_f32_16x16x32_bf16 v[52:55], v[8:11], a[36:39], v[52:55]
  buffer_load_dwordx4 v101, s[32:35], s94 offen offset:1024 sc1 lds
  s_waitcnt lgkmcnt(1)
  v_mfma_f32_16x16x32_bf16 v[56:59], v[8:11], a[40:43], v[56:59]
  v_add_f32 v144, v144, v148
  v_add_f32 v145, v145, v149
  v_mfma_f32_16x16x32_bf16 v[60:63], v[8:11], a[44:47], v[60:63]
  v_add_f32 v146, v146, v150
  v_add_f32 v147, v147, v151
  v_mfma_f32_16x16x32_bf16 v[48:51], v[12:15], a[48:51], v[48:51]
  ds_read_b128 v[0:3], v97 offset:20480
  v_add_f32 v144, v144, v146
  v_add_f32 v145, v145, v147
  v_mfma_f32_16x16x32_bf16 v[52:55], v[12:15], a[52:55], v[52:55]
  buffer_load_dwordx4 v101, s[32:35], s94 offen offset:2048 sc1 lds
  v_mul_f32 v144, 0x3b000000, v144
  v_mfma_f32_16x16x32_bf16 v[56:59], v[12:15], a[56:59], v[56:59]
  v_mul_f32 v145, 0x3b000000, v145
  v_fma_f32 v145, -v144, v144, v145
  v_mfma_f32_16x16x32_bf16 v[60:63], v[12:15], a[60:63], v[60:63]
  v_max_f32 v145, 0, v145
  v_add_f32 v145, 0x3727c5ac, v145
  v_mfma_f32_16x16x32_bf16 v[48:51], v[16:19], a[64:67], v[48:51]
  ds_read_b128 v[4:7], v97 offset:21504
  v_rsq_f32 v145, v145
  v_mfma_f32_16x16x32_bf16 v[52:55], v[16:19], a[68:71], v[52:55]
  buffer_load_dwordx4 v101, s[32:35], s94 offen offset:3072 sc1 lds
  s_add_u32 s86, s84, s61
  v_mfma_f32_16x16x32_bf16 v[56:59], v[16:19], a[72:75], v[56:59]
  v_mul_f32 v144, v144, v145
  v_fma_f32 v148, v132, v145, -v144
  v_mfma_f32_16x16x32_bf16 v[60:63], v[16:19], a[76:79], v[60:63]
  v_fma_f32 v149, v133, v145, -v144
  v_fma_f32 v150, v134, v145, -v144
  v_mfma_f32_16x16x32_bf16 v[48:51], v[20:23], a[80:83], v[48:51]
  ds_read_b128 v[8:11], v97 offset:22528
  v_fma_f32 v151, v135, v145, -v144
  v_cvt_pk_bf16_f32 v130, v148, v149
  v_mfma_f32_16x16x32_bf16 v[52:55], v[20:23], a[84:87], v[52:55]
  s_lshl_b32 s52, s50, 15
  buffer_load_dwordx2 v[140:141], v103, s[36:39], s52 offen sc1
  v_mfma_f32_16x16x32_bf16 v[56:59], v[20:23], a[88:91], v[56:59]
  v_cvt_pk_bf16_f32 v131, v150, v151
  v_bfi_b32 v128, 1, s66, v130
  v_mfma_f32_16x16x32_bf16 v[60:63], v[20:23], a[92:95], v[60:63]
  v_mov_b32 v129, v131
  v_mov_b32_dpp v130, v130 quad_perm:[1,0,3,2] row_mask:0xf bank_mask:0xf
  v_mfma_f32_16x16x32_bf16 v[48:51], v[24:27], a[96:99], v[48:51]
  ds_read_b128 v[12:15], v97 offset:23552
  v_mov_b32_dpp v131, v131 quad_perm:[1,0,3,2] row_mask:0xf bank_mask:0xf
  v_mfma_f32_16x16x32_bf16 v[52:55], v[24:27], a[100:103], v[52:55]
  buffer_store_dwordx4 v[128:131], v104, s[32:35], s86 offen sc1
  v_mfma_f32_16x16x32_bf16 v[56:59], v[24:27], a[104:107], v[56:59]
  s_mov_b64 exec, 1
  buffer_store_dword v110, off, s[32:35], s93 sc1
  s_mov_b64 exec, -1
  v_mfma_f32_16x16x32_bf16 v[60:63], v[24:27], a[108:111], v[60:63]
  s_waitcnt lgkmcnt(4)
  v_cvt_pk_bf16_f32 v160, v32, v36
  v_cvt_pk_bf16_f32 v161, v40, v44
  v_mfma_f32_16x16x32_bf16 v[48:51], v[28:31], a[112:115], v[48:51]
  ds_read_b128 v[16:19], v97 offset:28672
  v_cvt_pk_bf16_f32 v162, v33, v37
  v_cvt_pk_bf16_f32 v163, v41, v45
  v_mfma_f32_16x16x32_bf16 v[52:55], v[28:31], a[116:119], v[52:55]
  v_bfi_b32 v160, 1, s54, v160
  v_mfma_f32_16x16x32_bf16 v[56:59], v[28:31], a[120:123], v[56:59]
  s_add_u32 s51, s65, 0
  buffer_store_dwordx4 v[160:163], v102, s[32:35], s51 offen offset:0 sc1
  v_mfma_f32_16x16x32_bf16 v[60:63], v[28:31], a[124:127], v[60:63]
  s_waitcnt lgkmcnt(4)
  v_cvt_pk_bf16_f32 v164, v34, v38
  v_cvt_pk_bf16_f32 v165, v42, v46
  v_mfma_f32_16x16x32_bf16 v[48:51], v[0:3], a[128:131], v[48:51]
  ds_read_b128 v[20:23], v97 offset:29696
  v_cvt_pk_bf16_f32 v166, v35, v39
  v_cvt_pk_bf16_f32 v167, v43, v47
  v_mfma_f32_16x16x32_bf16 v[52:55], v[0:3], a[132:135], v[52:55]
  v_bfi_b32 v164, 1, s54, v164
  v_mfma_f32_16x16x32_bf16 v[56:59], v[0:3], a[136:139], v[56:59]
  s_add_u32 s51, s65, 16384
  buffer_store_dwordx4 v[164:167], v102, s[32:35], s51 offen offset:0 sc1
  v_mfma_f32_16x16x32_bf16 v[60:63], v[0:3], a[140:143], v[60:63]
  s_waitcnt lgkmcnt(4)
  v_mfma_f32_16x16x32_bf16 v[48:51], v[4:7], a[144:147], v[48:51]
  ds_read_b128 v[24:27], v97 offset:30720
  v_mfma_f32_16x16x32_bf16 v[52:55], v[4:7], a[148:151], v[52:55]
  v_mfma_f32_16x16x32_bf16 v[56:59], v[4:7], a[152:155], v[56:59]
  v_mfma_f32_16x16x32_bf16 v[60:63], v[4:7], a[156:159], v[60:63]
  s_waitcnt lgkmcnt(4)
  v_mfma_f32_16x16x32_bf16 v[48:51], v[8:11], a[160:163], v[48:51]
  ds_read_b128 v[28:31], v97 offset:31744
  v_mfma_f32_16x16x32_bf16 v[52:55], v[8:11], a[164:167], v[52:55]
  v_mfma_f32_16x16x32_bf16 v[56:59], v[8:11], a[168:171], v[56:59]
  v_mfma_f32_16x16x32_bf16 v[60:63], v[8:11], a[172:175], v[60:63]
  s_waitcnt lgkmcnt(4)
  v_mfma_f32_16x16x32_bf16 v[48:51], v[12:15], a[176:179], v[48:51]
  v_mfma_f32_16x16x32_bf16 v[52:55], v[12:15], a[180:183], v[52:55]
  v_mfma_f32_16x16x32_bf16 v[56:59], v[12:15], a[184:187], v[56:59]
  v_mfma_f32_16x16x32_bf16 v[60:63], v[12:15], a[188:191], v[60:63]
  s_waitcnt lgkmcnt(3)
  v_mfma_f32_16x16x32_bf16 v[48:51], v[16:19], a[192:195], v[48:51]
  s_add_u32 s52, s50, 2
  s_min_u32 s52, s52, 63
  s_lshl_b32 s52, s52, 11
  v_mfma_f32_16x16x32_bf16 v[52:55], v[16:19], a[196:199], v[52:55]
  s_add_u32 s52, s52, s56
  buffer_load_dword v109, v108, s[32:35], s52 offen sc1
  v_mfma_f32_16x16x32_bf16 v[56:59], v[16:19], a[200:203], v[56:59]
  v_mfma_f32_16x16x32_bf16 v[60:63], v[16:19], a[204:207], v[60:63]
  s_waitcnt lgkmcnt(2)
  v_mfma_f32_16x16x32_bf16 v[48:51], v[20:23], a[208:211], v[48:51]
  v_mfma_f32_16x16x32_bf16 v[52:55], v[20:23], a[212:215], v[52:55]
  v_mfma_f32_16x16x32_bf16 v[56:59], v[20:23], a[216:219], v[56:59]
  v_mfma_f32_16x16x32_bf16 v[60:63], v[20:23], a[220:223], v[60:63]
  s_waitcnt lgkmcnt(1)
  v_mfma_f32_16x16x32_bf16 v[48:51], v[24:27], a[224:227], v[48:51]
  v_xor_b32 v97, 32768, v97
  s_mov_b32 s92, s50
  v_mfma_f32_16x16x32_bf16 v[52:55], v[24:27], a[228:231], v[52:55]
  s_add_u32 s50, s50, 1
  s_waitcnt vmcnt(11)
  v_mfma_f32_16x16x32_bf16 v[56:59], v[24:27], a[232:235], v[56:59]
  s_barrier
  ds_read_b128 v[0:3], v97 offset:0
  v_mfma_f32_16x16x32_bf16 v[60:63], v[24:27], a[236:239], v[60:63]
  s_waitcnt lgkmcnt(1)
  ds_read_b128 v[4:7], v97 offset:1024
  ds_read_b128 v[8:11], v97 offset:2048
  v_mfma_f32_16x16x32_bf16 v[48:51], v[28:31], a[240:243], v[48:51]
  v_mfma_f32_16x16x32_bf16 v[52:55], v[28:31], a[244:247], v[52:55]
  v_mfma_f32_16x16x32_bf16 v[56:59], v[28:31], a[248:251], v[56:59]
  v_mfma_f32_16x16x32_bf16 v[60:63], v[28:31], a[252:255], v[60:63]
  v_cvt_pk_bf16_f32 v168, v48, v52
  s_nop 6
  v_cvt_pk_bf16_f32 v169, v56, v60
  v_cvt_pk_bf16_f32 v170, v49, v53
  v_cvt_pk_bf16_f32 v171, v57, v61
  v_bfi_b32 v168, 1, s54, v168
  s_add_u32 s51, s65, 131072
  buffer_store_dwordx4 v[168:171], v102, s[32:35], s51 offen offset:0 sc1
  v_cvt_pk_bf16_f32 v172, v50, v54
  v_cvt_pk_bf16_f32 v173, v58, v62
  v_cvt_pk_bf16_f32 v174, v51, v55
  v_cvt_pk_bf16_f32 v175, v59, v63
  v_bfi_b32 v172, 1, s54, v172
  s_add_u32 s51, s65, 147456
  buffer_store_dwordx4 v[172:175], v102, s[32:35], s51 offen offset:0 sc1
  s_branch LPWs_J
LPWs_f_w:
  s_add_u32 s53, s53, 1
  s_cmp_ge_u32 s53, 65536
  s_cbranch_scc1 L_abort
  buffer_load_dword v111, v108, s[32:35], s91 offen sc1
  s_waitcnt vmcnt(0)
  v_cmp_eq_u32 vcc, 0, v111
  s_cbranch_vccz LPWs_f
  s_sleep 1
  s_branch LPWs_f_w
LPWs_ha_w:
  s_add_u32 s53, s53, 1
  s_cmp_ge_u32 s53, 65536
  s_cbranch_scc1 L_abort
  buffer_load_dword v111, v108, s[32:35], s91 offen sc1
  s_waitcnt vmcnt(0)
  v_cmp_eq_u32 vcc, 0, v111
  s_cbranch_vccz LPWs_ha
  s_sleep 1
  s_branch LPWs_ha_w
LPWs_ga_w:
  s_add_u32 s53, s53, 1
  s_cmp_ge_u32 s53, 65536
  s_cbranch_scc1 L_abort
  buffer_load_dword v111, v108, s[32:35], s91 offen sc1
  s_waitcnt vmcnt(0)
  v_cmp_eq_u32 vcc, 0, v111
  s_cbranch_vccz LPWs_ga
  s_sleep 1
  s_branch LPWs_ga_w
LPWs_gc_r:
  s_add_u32 s69, s69, 1
  s_cmp_ge_u32 s69, 65536
  s_cbranch_scc1 L_abort
  s_nop 4
  buffer_load_dwordx4 v[144:147], v96, s[32:35], s86 offen offset:0 sc1
  buffer_load_dwordx4 v[148:151], v96, s[32:35], s86 offen offset:1024 sc1
  buffer_load_dwordx4 v[152:155], v96, s[32:35], s86 offen offset:2048 sc1
  buffer_load_dwordx4 v[156:159], v96, s[32:35], s86 offen offset:3072 sc1
  v_lshlrev_b32 v132, 16, v140
  v_and_b32 v133, 0xffff0000, v140
  v_lshlrev_b32 v134, 16, v141
  v_and_b32 v135, 0xffff0000, v141
  v_mov_b32 v136, 0
  s_waitcnt vmcnt(3)
  v_mfma_f32_16x16x32_bf16 v[132:135], v[112:115], v[144:147], v[132:135]
  v_bitop3_b32 v136, v136, v144, s85 bitop3:246
  s_waitcnt vmcnt(2)
  v_mfma_f32_16x16x32_bf16 v[132:135], v[112:115], v[148:151], v[132:135]
  v_bitop3_b32 v136, v136, v148, s85 bitop3:246
  s_waitcnt vmcnt(1)
  v_mfma_f32_16x16x32_bf16 v[132:135], v[116:119], v[152:155], v[132:135]
  v_bitop3_b32 v136, v136, v152, s85 bitop3:246
  s_waitcnt vmcnt(0)
  v_mfma_f32_16x16x32_bf16 v[132:135], v[116:119], v[156:159], v[132:135]
  v_bitop3_b32 v136, v136, v156, s85 bitop3:246
  v_and_b32 v136, 1, v136
  v_cmp_ne_u32 vcc, 0, v136
  s_cbranch_vccnz LPWs_gc_r
  s_nop 4
  s_branch LPWs_gc
LPWs_nc_r:
  s_add_u32 s69, s69, 1
  s_cmp_ge_u32 s69, 65536
  s_cbranch_scc1 L_abort
  s_nop 4
  buffer_load_dwordx4 v[144:147], v96, s[32:35], s86 offen offset:0 sc1
  buffer_load_dwordx4 v[148:151], v96, s[32:35], s86 offen offset:1024 sc1
  buffer_load_dwordx4 v[152:155], v96, s[32:35], s86 offen offset:2048 sc1
  buffer_load_dwordx4 v[156:159], v96, s[32:35], s86 offen offset:3072 sc1
  v_lshlrev_b32 v132, 16, v140
  v_and_b32 v133, 0xffff0000, v140
  v_lshlrev_b32 v134, 16, v141
  v_and_b32 v135, 0xffff0000, v141
  v_mov_b32 v136, 0
  s_waitcnt vmcnt(3)
  v_mfma_f32_16x16x32_bf16 v[132:135], v[112:115], v[144:147], v[132:135]
  v_bitop3_b32 v136, v136, v144, s85 bitop3:246
  s_waitcnt vmcnt(2)
  v_mfma_f32_16x16x32_bf16 v[132:135], v[112:115], v[148:151], v[132:135]
  v_bitop3_b32 v136, v136, v148, s85 bitop3:246
  s_waitcnt vmcnt(1)
  v_mfma_f32_16x16x32_bf16 v[132:135], v[116:119], v[152:155], v[132:135]
  v_bitop3_b32 v136, v136, v152, s85 bitop3:246
  s_waitcnt vmcnt(0)
  v_mfma_f32_16x16x32_bf16 v[132:135], v[116:119], v[156:159], v[132:135]
  v_bitop3_b32 v136, v136, v156, s85 bitop3:246
  v_and_b32 v136, 1, v136
  v_cmp_ne_u32 vcc, 0, v136
  s_cbranch_vccnz LPWs_nc_r
  s_nop 4
  s_branch LPWs_nc
L_ffn:
  v_lshrrev_b32 v108, 8, v96
  v_bfe_u32 v109, v96, 4, 4
  s_and_b32 s63, s28, 7
  s_mul_i32 s51, s63, 344
  s_lshr_b32 s52, s26, 1
  s_mul_i32 s52, s52, 192
  s_add_u32 s51, s51, s52
  v_mul_u32_u24 v111, 22016, v108
  v_lshl_add_u32 v111, v109, 2, v111
  v_add_u32 v111, s51, v111
  s_and_b32 s52, s26, 1
  s_lshl_b32 s51, s52, 7
  v_add_u32 v110, s51, v111
  v_add_u32 v111, 64, v111
  s_cmp_eq_u32 s52, 0
  s_cselect_b32 s68, s48, s49
  s_cmp_eq_u32 s26, 3
  s_cselect_b32 s51, 6, 16
  v_mov_b32 v107, 1073741824
  v_cmp_gt_u32 vcc, s51, v109
  s_nop 1
  v_cndmask_b32 v110, v107, v110, vcc
  s_mov_b32 s36, s16
  s_and_b32 s37, s17, 0xffff
  s_mov_b32 s38, 1409024
  s_mov_b32 s39, 0x20000
  s_mov_b32 s52, 0
  buffer_load_dword v0, v110, s[36:39], s52 offen
  buffer_load_dword v8, v111, s[36:39], s52 offen
  s_mov_b32 s52, 2752
  buffer_load_dword v1, v110, s[36:39], s52 offen
  buffer_load_dword v9, v111, s[36:39], s52 offen
  s_mov_b32 s52, 5504
  buffer_load_dword v2, v110, s[36:39], s52 offen
  buffer_load_dword v10, v111, s[36:39], s52 offen
  s_mov_b32 s52, 8256
  buffer_load_dword v3, v110, s[36:39], s52 offen
  buffer_load_dword v11, v111, s[36:39], s52 offen
  s_mov_b32 s52, 11008
  buffer_load_dword v4, v110, s[36:39], s52 offen
  buffer_load_dword v12, v111, s[36:39], s52 offen
  s_mov_b32 s52, 13760
  buffer_load_dword v5, v110, s[36:39], s52 offen
  buffer_load_dword v13, v111, s[36:39], s52 offen
  s_mov_b32 s52, 16512
  buffer_load_dword v6, v110, s[36:39], s52 offen
  buffer_load_dword v14, v111, s[36:39], s52 offen
  s_mov_b32 s52, 19264
  buffer_load_dword v7, v110, s[36:39], s52 offen
  buffer_load_dword v15, v111, s[36:39], s52 offen
  s_mov_b32 s52, 88064
  buffer_load_dword v32, v110, s[36:39], s52 offen
  buffer_load_dword v40, v111, s[36:39], s52 offen
  s_mov_b32 s52, 90816
  buffer_load_dword v33, v110, s[36:39], s52 offen
  buffer_load_dword v41, v111, s[36:39], s52 offen
  s_mov_b32 s52, 93568
  buffer_load_dword v34, v110, s[36:39], s52 offen
  buffer_load_dword v42, v111, s[36:39], s52 offen
  s_mov_b32 s52, 96320
  buffer_load_dword v35, v110, s[36:39], s52 offen
  buffer_load_dword v43, v111, s[36:39], s52 offen
  s_mov_b32 s52, 99072
  buffer_load_dword v36, v110, s[36:39], s52 offen
  buffer_load_dword v44, v111, s[36:39], s52 offen
  s_mov_b32 s52, 101824
  buffer_load_dword v37, v110, s[36:39], s52 offen
  buffer_load_dword v45, v111, s[36:39], s52 offen
  s_mov_b32 s52, 104576
  buffer_load_dword v38, v110, s[36:39], s52 offen
  buffer_load_dword v46, v111, s[36:39], s52 offen
  s_mov_b32 s52, 107328
  buffer_load_dword v39, v110, s[36:39], s52 offen
  buffer_load_dword v47, v111, s[36:39], s52 offen
  s_mov_b32 s52, 176128
  buffer_load_dword v64, v110, s[36:39], s52 offen
  buffer_load_dword v72, v111, s[36:39], s52 offen
  s_mov_b32 s52, 178880
  buffer_load_dword v65, v110, s[36:39], s52 offen
  buffer_load_dword v73, v111, s[36:39], s52 offen
  s_mov_b32 s52, 181632
  buffer_load_dword v66, v110, s[36:39], s52 offen
  buffer_load_dword v74, v111, s[36:39], s52 offen
  s_mov_b32 s52, 184384
  buffer_load_dword v67, v110, s[36:39], s52 offen
  buffer_load_dword v75, v111, s[36:39], s52 offen
  s_mov_b32 s52, 187136
  buffer_load_dword v68, v110, s[36:39], s52 offen
  buffer_load_dword v76, v111, s[36:39], s52 offen
  s_mov_b32 s52, 189888
  buffer_load_dword v69, v110, s[36:39], s52 offen
  buffer_load_dword v77, v111, s[36:39], s52 offen
  s_mov_b32 s52, 192640
  buffer_load_dword v70, v110, s[36:39], s52 offen
  buffer_load_dword v78, v111, s[36:39], s52 offen
  s_mov_b32 s52, 195392
  buffer_load_dword v71, v110, s[36:39], s52 offen
  buffer_load_dword v79, v111, s[36:39], s52 offen
  s_waitcnt vmcnt(32)
  v_perm_b32 v120, v1, v0, s48
  v_perm_b32 v121, v3, v2, s48
  v_perm_b32 v122, v5, v4, s48
  v_perm_b32 v123, v7, v6, s48
  v_accvgpr_write_b32 a0, v120
  v_accvgpr_write_b32 a1, v121
  v_accvgpr_write_b32 a2, v122
  v_accvgpr_write_b32 a3, v123
  v_perm_b32 v120, v1, v0, s49
  v_perm_b32 v121, v3, v2, s49
  v_perm_b32 v122, v5, v4, s49
  v_perm_b32 v123, v7, v6, s49
  v_accvgpr_write_b32 a4, v120
  v_accvgpr_write_b32 a5, v121
  v_accvgpr_write_b32 a6, v122
  v_accvgpr_write_b32 a7, v123
  v_perm_b32 v120, v9, v8, s68
  v_perm_b32 v121, v11, v10, s68
  v_perm_b32 v122, v13, v12, s68
  v_perm_b32 v123, v15, v14, s68
  v_accvgpr_write_b32 a8, v120
  v_accvgpr_write_b32 a9, v121
  v_accvgpr_write_b32 a10, v122
  v_accvgpr_write_b32 a11, v123
  s_mov_b32 s52, 264192
  buffer_load_dword v0, v110, s[36:39], s52 offen
  buffer_load_dword v8, v111, s[36:39], s52 offen
  s_mov_b32 s52, 266944
  buffer_load_dword v1, v110, s[36:39], s52 offen
  buffer_load_dword v9, v111, s[36:39], s52 offen
  s_mov_b32 s52, 269696
  buffer_load_dword v2, v110, s[36:39], s52 offen
  buffer_load_dword v10, v111, s[36:39], s52 offen
  s_mov_b32 s52, 272448
  buffer_load_dword v3, v110, s[36:39], s52 offen
  buffer_load_dword v11, v111, s[36:39], s52 offen
  s_mov_b32 s52, 275200
  buffer_load_dword v4, v110, s[36:39], s52 offen
  buffer_load_dword v12, v111, s[36:39], s52 offen
  s_mov_b32 s52, 277952
  buffer_load_dword v5, v110, s[36:39], s52 offen
  buffer_load_dword v13, v111, s[36:39], s52 offen
  s_mov_b32 s52, 280704
  buffer_load_dword v6, v110, s[36:39], s52 offen
  buffer_load_dword v14, v111, s[36:39], s52 offen
  s_mov_b32 s52, 283456
  buffer_load_dword v7, v110, s[36:39], s52 offen
  buffer_load_dword v15, v111, s[36:39], s52 offen
  s_waitcnt vmcnt(32)
  v_perm_b32 v120, v33, v32, s48
  v_perm_b32 v121, v35, v34, s48
  v_perm_b32 v122, v37, v36, s48
  v_perm_b32 v123, v39, v38, s48
  v_accvgpr_write_b32 a12, v120
  v_accvgpr_write_b32 a13, v121
  v_accvgpr_write_b32 a14, v122
  v_accvgpr_write_b32 a15, v123
  v_perm_b32 v120, v33, v32, s49
  v_perm_b32 v121, v35, v34, s49
  v_perm_b32 v122, v37, v36, s49
  v_perm_b32 v123, v39, v38, s49
  v_accvgpr_write_b32 a16, v120
  v_accvgpr_write_b32 a17, v121
  v_accvgpr_write_b32 a18, v122
  v_accvgpr_write_b32 a19, v123
  v_perm_b32 v120, v41, v40, s68
  v_perm_b32 v121, v43, v42, s68
  v_perm_b32 v122, v45, v44, s68
  v_perm_b32 v123, v47, v46, s68
  v_accvgpr_write_b32 a20, v120
  v_accvgpr_write_b32 a21, v121
  v_accvgpr_write_b32 a22, v122
  v_accvgpr_write_b32 a23, v123
  s_mov_b32 s52, 352256
  buffer_load_dword v32, v110, s[36:39], s52 offen
  buffer_load_dword v40, v111, s[36:39], s52 offen
  s_mov_b32 s52, 355008
  buffer_load_dword v33, v110, s[36:39], s52 offen
  buffer_load_dword v41, v111, s[36:39], s52 offen
  s_mov_b32 s52, 357760
  buffer_load_dword v34, v110, s[36:39], s52 offen
  buffer_load_dword v42, v111, s[36:39], s52 offen
  s_mov_b32 s52, 360512
  buffer_load_dword v35, v110, s[36:39], s52 offen
  buffer_load_dword v43, v111, s[36:39], s52 offen
  s_mov_b32 s52, 363264
  buffer_load_dword v36, v110, s[36:39], s52 offen
  buffer_load_dword v44, v111, s[36:39], s52 offen
  s_mov_b32 s52, 366016
  buffer_load_dword v37, v110, s[36:39], s52 offen
  buffer_load_dword v45, v111, s[36:39], s52 offen
  s_mov_b32 s52, 368768
  buffer_load_dword v38, v110, s[36:39], s52 offen
  buffer_load_dword v46, v111, s[36:39], s52 offen
  s_mov_b32 s52, 371520
  buffer_load_dword v39, v110, s[36:39], s52 offen
  buffer_load_dword v47, v111, s[36:39], s52 offen
  s_waitcnt vmcnt(32)
  v_perm_b32 v120, v65, v64, s48
  v_perm_b32 v121, v67, v66, s48
  v_perm_b32 v122, v69, v68, s48
  v_perm_b32 v123, v71, v70, s48
  v_accvgpr_write_b32 a24, v120
  v_accvgpr_write_b32 a25, v121
  v_accvgpr_write_b32 a26, v122
  v_accvgpr_write_b32 a27, v123
  v_perm_b32 v120, v65, v64, s49
  v_perm_b32 v121, v67, v66, s49
  v_perm_b32 v122, v69, v68, s49
  v_perm_b32 v123, v71, v70, s49
  v_accvgpr_write_b32 a28, v120
  v_accvgpr_write_b32 a29, v121
  v_accvgpr_write_b32 a30, v122
  v_accvgpr_write_b32 a31, v123
  v_perm_b32 v120, v73, v72, s68
  v_perm_b32 v121, v75, v74, s68
  v_perm_b32 v122, v77, v76, s68
  v_perm_b32 v123, v79, v78, s68
  v_accvgpr_write_b32 a32, v120
  v_accvgpr_write_b32 a33, v121
  v_accvgpr_write_b32 a34, v122
  v_accvgpr_write_b32 a35, v123
  s_mov_b32 s52, 440320
  buffer_load_dword v64, v110, s[36:39], s52 offen
  buffer_load_dword v72, v111, s[36:39], s52 offen
  s_mov_b32 s52, 443072
  buffer_load_dword v65, v110, s[36:39], s52 offen
  buffer_load_dword v73, v111, s[36:39], s52 offen
  s_mov_b32 s52, 445824
  buffer_load_dword v66, v110, s[36:39], s52 offen
  buffer_load_dword v74, v111, s[36:39], s52 offen
  s_mov_b32 s52, 448576
  buffer_load_dword v67, v110, s[36:39], s52 offen
  buffer_load_dword v75, v111, s[36:39], s52 offen
  s_mov_b32 s52, 451328
  buffer_load_dword v68, v110, s[36:39], s52 offen
  buffer_load_dword v76, v111, s[36:39], s52 offen
  s_mov_b32 s52, 454080
  buffer_load_dword v69, v110, s[36:39], s52 offen
  buffer_load_dword v77, v111, s[36:39], s52 offen
  s_mov_b32 s52, 456832
  buffer_load_dword v70, v110, s[36:39], s52 offen
  buffer_load_dword v78, v111, s[36:39], s52 offen
  s_mov_b32 s52, 459584
  buffer_load_dword v71, v110, s[36:39], s52 offen
  buffer_load_dword v79, v111, s[36:39], s52 offen
  s_waitcnt vmcnt(32)
  v_perm_b32 v120, v1, v0, s48
  v_perm_b32 v121, v3, v2, s48
  v_perm_b32 v122, v5, v4, s48
  v_perm_b32 v123, v7, v6, s48
  v_accvgpr_write_b32 a36, v120
  v_accvgpr_write_b32 a37, v121
  v_accvgpr_write_b32 a38, v122
  v_accvgpr_write_b32 a39, v123
  v_perm_b32 v120, v1, v0, s49
  v_perm_b32 v121, v3, v2, s49
  v_perm_b32 v122, v5, v4, s49
  v_perm_b32 v123, v7, v6, s49
  v_accvgpr_write_b32 a40, v120
  v_accvgpr_write_b32 a41, v121
  v_accvgpr_write_b32 a42, v122
  v_accvgpr_write_b32 a43, v123
  v_perm_b32 v120, v9, v8, s68
  v_perm_b32 v121, v11, v10, s68
  v_perm_b32 v122, v13, v12, s68
  v_perm_b32 v123, v15, v14, s68
  v_accvgpr_write_b32 a44, v120
  v_accvgpr_write_b32 a45, v121
  v_accvgpr_write_b32 a46, v122
  v_accvgpr_write_b32 a47, v123
  s_mov_b32 s52, 528384
  buffer_load_dword v0, v110, s[36:39], s52 offen
  buffer_load_dword v8, v111, s[36:39], s52 offen
  s_mov_b32 s52, 531136
  buffer_load_dword v1, v110, s[36:39], s52 offen
  buffer_load_dword v9, v111, s[36:39], s52 offen
  s_mov_b32 s52, 533888
  buffer_load_dword v2, v110, s[36:39], s52 offen
  buffer_load_dword v10, v111, s[36:39], s52 offen
  s_mov_b32 s52, 536640
  buffer_load_dword v3, v110, s[36:39], s52 offen
  buffer_load_dword v11, v111, s[36:39], s52 offen
  s_mov_b32 s52, 539392
  buffer_load_dword v4, v110, s[36:39], s52 offen
  buffer_load_dword v12, v111, s[36:39], s52 offen
  s_mov_b32 s52, 542144
  buffer_load_dword v5, v110, s[36:39], s52 offen
  buffer_load_dword v13, v111, s[36:39], s52 offen
  s_mov_b32 s52, 544896
  buffer_load_dword v6, v110, s[36:39], s52 offen
  buffer_load_dword v14, v111, s[36:39], s52 offen
  s_mov_b32 s52, 547648
  buffer_load_dword v7, v110, s[36:39], s52 offen
  buffer_load_dword v15, v111, s[36:39], s52 offen
  s_waitcnt vmcnt(32)
  v_perm_b32 v120, v33, v32, s48
  v_perm_b32 v121, v35, v34, s48
  v_perm_b32 v122, v37, v36, s48
  v_perm_b32 v123, v39, v38, s48
  v_accvgpr_write_b32 a48, v120
  v_accvgpr_write_b32 a49, v121
  v_accvgpr_write_b32 a50, v122
  v_accvgpr_write_b32 a51, v123
  v_perm_b32 v120, v33, v32, s49
  v_perm_b32 v121, v35, v34, s49
  v_perm_b32 v122, v37, v36, s49
  v_perm_b32 v123, v39, v38, s49
  v_accvgpr_write_b32 a52, v120
  v_accvgpr_write_b32 a53, v121
  v_accvgpr_write_b32 a54, v122
  v_accvgpr_write_b32 a55, v123
  v_perm_b32 v120, v41, v40, s68
  v_perm_b32 v121, v43, v42, s68
  v_perm_b32 v122, v45, v44, s68
  v_perm_b32 v123, v47, v46, s68
  v_accvgpr_write_b32 a56, v120
  v_accvgpr_write_b32 a57, v121
  v_accvgpr_write_b32 a58, v122
  v_accvgpr_write_b32 a59, v123
  s_mov_b32 s52, 616448
  buffer_load_dword v32, v110, s[36:39], s52 offen
  buffer_load_dword v40, v111, s[36:39], s52 offen
  s_mov_b32 s52, 619200
  buffer_load_dword v33, v110, s[36:39], s52 offen
  buffer_load_dword v41, v111, s[36:39], s52 offen
  s_mov_b32 s52, 621952
  buffer_load_dword v34, v110, s[36:39], s52 offen
  buffer_load_dword v42, v111, s[36:39], s52 offen
  s_mov_b32 s52, 624704
  buffer_load_dword v35, v110, s[36:39], s52 offen
  buffer_load_dword v43, v111, s[36:39], s52 offen
  s_mov_b32 s52, 627456
  buffer_load_dword v36, v110, s[36:39], s52 offen
  buffer_load_dword v44, v111, s[36:39], s52 offen
  s_mov_b32 s52, 630208
  buffer_load_dword v37, v110, s[36:39], s52 offen
  buffer_load_dword v45, v111, s[36:39], s52 offen
  s_mov_b32 s52, 632960
  buffer_load_dword v38, v110, s[36:39], s52 offen
  buffer_load_dword v46, v111, s[36:39], s52 offen
  s_mov_b32 s52, 635712
  buffer_load_dword v39, v110, s[36:39], s52 offen
  buffer_load_dword v47, v111, s[36:39], s52 offen
  s_waitcnt vmcnt(32)
  v_perm_b32 v120, v65, v64, s48
  v_perm_b32 v121, v67, v66, s48
  v_perm_b32 v122, v69, v68, s48
  v_perm_b32 v123, v71, v70, s48
  v_accvgpr_write_b32 a60, v120
  v_accvgpr_write_b32 a61, v121
  v_accvgpr_write_b32 a62, v122
  v_accvgpr_write_b32 a63, v123
  v_perm_b32 v120, v65, v64, s49
  v_perm_b32 v121, v67, v66, s49
  v_perm_b32 v122, v69, v68, s49
  v_perm_b32 v123, v71, v70, s49
  v_accvgpr_write_b32 a64, v120
  v_accvgpr_write_b32 a65, v121
  v_accvgpr_write_b32 a66, v122
  v_accvgpr_write_b32 a67, v123
  v_perm_b32 v120, v73, v72, s68
  v_perm_b32 v121, v75, v74, s68
  v_perm_b32 v122, v77, v76, s68
  v_perm_b32 v123, v79, v78, s68
  v_accvgpr_write_b32 a68, v120
  v_accvgpr_write_b32 a69, v121
  v_accvgpr_write_b32 a70, v122
  v_accvgpr_write_b32 a71, v123
  s_mov_b32 s52, 704512
  buffer_load_dword v64, v110, s[36:39], s52 offen
  buffer_load_dword v72, v111, s[36:39], s52 offen
  s_mov_b32 s52, 707264
  buffer_load_dword v65, v110, s[36:39], s52 offen
  buffer_load_dword v73, v111, s[36:39], s52 offen
  s_mov_b32 s52, 710016
  buffer_load_dword v66, v110, s[36:39], s52 offen
  buffer_load_dword v74, v111, s[36:39], s52 offen
  s_mov_b32 s52, 712768
  buffer_load_dword v67, v110, s[36:39], s52 offen
  buffer_load_dword v75, v111, s[36:39], s52 offen
  s_mov_b32 s52, 715520
  buffer_load_dword v68, v110, s[36:39], s52 offen
  buffer_load_dword v76, v111, s[36:39], s52 offen
  s_mov_b32 s52, 718272
  buffer_load_dword v69, v110, s[36:39], s52 offen
  buffer_load_dword v77, v111, s[36:39], s52 offen
  s_mov_b32 s52, 721024
  buffer_load_dword v70, v110, s[36:39], s52 offen
  buffer_load_dword v78, v111, s[36:39], s52 offen
  s_mov_b32 s52, 723776
  buffer_load_dword v71, v110, s[36:39], s52 offen
  buffer_load_dword v79, v111, s[36:39], s52 offen
  s_waitcnt vmcnt(32)
  v_perm_b32 v120, v1, v0, s48
  v_perm_b32 v121, v3, v2, s48
  v_perm_b32 v122, v5, v4, s48
  v_perm_b32 v123, v7, v6, s48
  v_accvgpr_write_b32 a72, v120
  v_accvgpr_write_b32 a73, v121
  v_accvgpr_write_b32 a74, v122
  v_accvgpr_write_b32 a75, v123
  v_perm_b32 v120, v1, v0, s49
  v_perm_b32 v121, v3, v2, s49
  v_perm_b32 v122, v5, v4, s49
  v_perm_b32 v123, v7, v6, s49
  v_accvgpr_write_b32 a76, v120
  v_accvgpr_write_b32 a77, v121
  v_accvgpr_write_b32 a78, v122
  v_accvgpr_write_b32 a79, v123
  v_perm_b32 v120, v9, v8, s68
  v_perm_b32 v121, v11, v10, s68
  v_perm_b32 v122, v13, v12, s68
  v_perm_b32 v123, v15, v14, s68
  v_accvgpr_write_b32 a80, v120
  v_accvgpr_write_b32 a81, v121
  v_accvgpr_write_b32 a82, v122
  v_accvgpr_write_b32 a83, v123
  s_mov_b32 s52, 792576
  buffer_load_dword v0, v110, s[36:39], s52 offen
  buffer_load_dword v8, v111, s[36:39], s52 offen
  s_mov_b32 s52, 795328
  buffer_load_dword v1, v110, s[36:39], s52 offen
  buffer_load_dword v9, v111, s[36:39], s52 offen
  s_mov_b32 s52, 798080
  buffer_load_dword v2, v110, s[36:39], s52 offen
  buffer_load_dword v10, v111, s[36:39], s52 offen
  s_mov_b32 s52, 800832
  buffer_load_dword v3, v110, s[36:39], s52 offen
  buffer_load_dword v11, v111, s[36:39], s52 offen
  s_mov_b32 s52, 803584
  buffer_load_dword v4, v110, s[36:39], s52 offen
  buffer_load_dword v12, v111, s[36:39], s52 offen
  s_mov_b32 s52, 806336
  buffer_load_dword v5, v110, s[36:39], s52 offen
  buffer_load_dword v13, v111, s[36:39], s52 offen
  s_mov_b32 s52, 809088
  buffer_load_dword v6, v110, s[36:39], s52 offen
  buffer_load_dword v14, v111, s[36:39], s52 offen
  s_mov_b32 s52, 811840
  buffer_load_dword v7, v110, s[36:39], s52 offen
  buffer_load_dword v15, v111, s[36:39], s52 offen
  s_waitcnt vmcnt(32)
  v_perm_b32 v120, v33, v32, s48
  v_perm_b32 v121, v35, v34, s48
  v_perm_b32 v122, v37, v36, s48
  v_perm_b32 v123, v39, v38, s48
  v_accvgpr_write_b32 a84, v120
  v_accvgpr_write_b32 a85, v121
  v_accvgpr_write_b32 a86, v122
  v_accvgpr_write_b32 a87, v123
  v_perm_b32 v120, v33, v32, s49
  v_perm_b32 v121, v35, v34, s49
  v_perm_b32 v122, v37, v36, s49
  v_perm_b32 v123, v39, v38, s49
  v_accvgpr_write_b32 a88, v120
  v_accvgpr_write_b32 a89, v121
  v_accvgpr_write_b32 a90, v122
  v_accvgpr_write_b32 a91, v123
  v_perm_b32 v120, v41, v40, s68
  v_perm_b32 v121, v43, v42, s68
  v_perm_b32 v122, v45, v44, s68
  v_perm_b32 v123, v47, v46, s68
  v_accvgpr_write_b32 a92, v120
  v_accvgpr_write_b32 a93, v121
  v_accvgpr_write_b32 a94, v122
  v_accvgpr_write_b32 a95, v123
  s_mov_b32 s52, 880640
  buffer_load_dword v32, v110, s[36:39], s52 offen
  buffer_load_dword v40, v111, s[36:39], s52 offen
  s_mov_b32 s52, 883392
  buffer_load_dword v33, v110, s[36:39], s52 offen
  buffer_load_dword v41, v111, s[36:39], s52 offen
  s_mov_b32 s52, 886144
  buffer_load_dword v34, v110, s[36:39], s52 offen
  buffer_load_dword v42, v111, s[36:39], s52 offen
  s_mov_b32 s52, 888896
  buffer_load_dword v35, v110, s[36:39], s52 offen
  buffer_load_dword v43, v111, s[36:39], s52 offen
  s_mov_b32 s52, 891648
  buffer_load_dword v36, v110, s[36:39], s52 offen
  buffer_load_dword v44, v111, s[36:39], s52 offen
  s_mov_b32 s52, 894400
  buffer_load_dword v37, v110, s[36:39], s52 offen
  buffer_load_dword v45, v111, s[36:39], s52 offen
  s_mov_b32 s52, 897152
  buffer_load_dword v38, v110, s[36:39], s52 offen
  buffer_load_dword v46, v111, s[36:39], s52 offen
  s_mov_b32 s52, 899904
  buffer_load_dword v39, v110, s[36:39], s52 offen
  buffer_load_dword v47, v111, s[36:39], s52 offen
  s_waitcnt vmcnt(32)
  v_perm_b32 v120, v65, v64, s48
  v_perm_b32 v121, v67, v66, s48
  v_perm_b32 v122, v69, v68, s48
  v_perm_b32 v123, v71, v70, s48
  v_accvgpr_write_b32 a96, v120
  v_accvgpr_write_b32 a97, v121
  v_accvgpr_write_b32 a98, v122
  v_accvgpr_write_b32 a99, v123
  v_perm_b32 v120, v65, v64, s49
  v_perm_b32 v121, v67, v66, s49
  v_perm_b32 v122, v69, v68, s49
  v_perm_b32 v123, v71, v70, s49
  v_accvgpr_write_b32 a100, v120
  v_accvgpr_write_b32 a101, v121
  v_accvgpr_write_b32 a102, v122
  v_accvgpr_write_b32 a103, v123
  v_perm_b32 v120, v73, v72, s68
  v_perm_b32 v121, v75, v74, s68
  v_perm_b32 v122, v77, v76, s68
  v_perm_b32 v123, v79, v78, s68
  v_accvgpr_write_b32 a104, v120
  v_accvgpr_write_b32 a105, v121
  v_accvgpr_write_b32 a106, v122
  v_accvgpr_write_b32 a107, v123
  s_mov_b32 s52, 968704
  buffer_load_dword v64, v110, s[36:39], s52 offen
  buffer_load_dword v72, v111, s[36:39], s52 offen
  s_mov_b32 s52, 971456
  buffer_load_dword v65, v110, s[36:39], s52 offen
  buffer_load_dword v73, v111, s[36:39], s52 offen
  s_mov_b32 s52, 974208
  buffer_load_dword v66, v110, s[36:39], s52 offen
  buffer_load_dword v74, v111, s[36:39], s52 offen
  s_mov_b32 s52, 976960
  buffer_load_dword v67, v110, s[36:39], s52 offen
  buffer_load_dword v75, v111, s[36:39], s52 offen
  s_mov_b32 s52, 979712
  buffer_load_dword v68, v110, s[36:39], s52 offen
  buffer_load_dword v76, v111, s[36:39], s52 offen
  s_mov_b32 s52, 982464
  buffer_load_dword v69, v110, s[36:39], s52 offen
  buffer_load_dword v77, v111, s[36:39], s52 offen
  s_mov_b32 s52, 985216
  buffer_load_dword v70, v110, s[36:39], s52 offen
  buffer_load_dword v78, v111, s[36:39], s52 offen
  s_mov_b32 s52, 987968
  buffer_load_dword v71, v110, s[36:39], s52 offen
  buffer_load_dword v79, v111, s[36:39], s52 offen
  s_waitcnt vmcnt(32)
  v_perm_b32 v120, v1, v0, s48
  v_perm_b32 v121, v3, v2, s48
  v_perm_b32 v122, v5, v4, s48
  v_perm_b32 v123, v7, v6, s48
  v_accvgpr_write_b32 a108, v120
  v_accvgpr_write_b32 a109, v121
  v_accvgpr_write_b32 a110, v122
  v_accvgpr_write_b32 a111, v123
  v_perm_b32 v120, v1, v0, s49
  v_perm_b32 v121, v3, v2, s49
  v_perm_b32 v122, v5, v4, s49
  v_perm_b32 v123, v7, v6, s49
  v_accvgpr_write_b32 a112, v120
  v_accvgpr_write_b32 a113, v121
  v_accvgpr_write_b32 a114, v122
  v_accvgpr_write_b32 a115, v123
  v_perm_b32 v120, v9, v8, s68
  v_perm_b32 v121, v11, v10, s68
  v_perm_b32 v122, v13, v12, s68
  v_perm_b32 v123, v15, v14, s68
  v_accvgpr_write_b32 a116, v120
  v_accvgpr_write_b32 a117, v121
  v_accvgpr_write_b32 a118, v122
  v_accvgpr_write_b32 a119, v123
  s_mov_b32 s52, 1056768
  buffer_load_dword v0, v110, s[36:39], s52 offen
  buffer_load_dword v8, v111, s[36:39], s52 offen
  s_mov_b32 s52, 1059520
  buffer_load_dword v1, v110, s[36:39], s52 offen
  buffer_load_dword v9, v111, s[36:39], s52 offen
  s_mov_b32 s52, 1062272
  buffer_load_dword v2, v110, s[36:39], s52 offen
  buffer_load_dword v10, v111, s[36:39], s52 offen
  s_mov_b32 s52, 1065024
  buffer_load_dword v3, v110, s[36:39], s52 offen
  buffer_load_dword v11, v111, s[36:39], s52 offen
  s_mov_b32 s52, 1067776
  buffer_load_dword v4, v110, s[36:39], s52 offen
  buffer_load_dword v12, v111, s[36:39], s52 offen
  s_mov_b32 s52, 1070528
  buffer_load_dword v5, v110, s[36:39], s52 offen
  buffer_load_dword v13, v111, s[36:39], s52 offen
  s_mov_b32 s52, 1073280
  buffer_load_dword v6, v110, s[36:39], s52 offen
  buffer_load_dword v14, v111, s[36:39], s52 offen
  s_mov_b32 s52, 1076032
  buffer_load_dword v7, v110, s[36:39], s52 offen
  buffer_load_dword v15, v111, s[36:39], s52 offen
  s_waitcnt vmcnt(32)
  v_perm_b32 v120, v33, v32, s48
  v_perm_b32 v121, v35, v34, s48
  v_perm_b32 v122, v37, v36, s48
  v_perm_b32 v123, v39, v38, s48
  v_accvgpr_write_b32 a120, v120
  v_accvgpr_write_b32 a121, v121
  v_accvgpr_write_b32 a122, v122
  v_accvgpr_write_b32 a123, v123
  v_perm_b32 v120, v33, v32, s49
  v_perm_b32 v121, v35, v34, s49
  v_perm_b32 v122, v37, v36, s49
  v_perm_b32 v123, v39, v38, s49
  v_accvgpr_write_b32 a124, v120
  v_accvgpr_write_b32 a125, v121
  v_accvgpr_write_b32 a126, v122
  v_accvgpr_write_b32 a127, v123
  v_perm_b32 v120, v41, v40, s68
  v_perm_b32 v121, v43, v42, s68
  v_perm_b32 v122, v45, v44, s68
  v_perm_b32 v123, v47, v46, s68
  v_accvgpr_write_b32 a128, v120
  v_accvgpr_write_b32 a129, v121
  v_accvgpr_write_b32 a130, v122
  v_accvgpr_write_b32 a131, v123
  s_mov_b32 s52, 1144832
  buffer_load_dword v32, v110, s[36:39], s52 offen
  buffer_load_dword v40, v111, s[36:39], s52 offen
  s_mov_b32 s52, 1147584
  buffer_load_dword v33, v110, s[36:39], s52 offen
  buffer_load_dword v41, v111, s[36:39], s52 offen
  s_mov_b32 s52, 1150336
  buffer_load_dword v34, v110, s[36:39], s52 offen
  buffer_load_dword v42, v111, s[36:39], s52 offen
  s_mov_b32 s52, 1153088
  buffer_load_dword v35, v110, s[36:39], s52 offen
  buffer_load_dword v43, v111, s[36:39], s52 offen
  s_mov_b32 s52, 1155840
  buffer_load_dword v36, v110, s[36:39], s52 offen
  buffer_load_dword v44, v111, s[36:39], s52 offen
  s_mov_b32 s52, 1158592
  buffer_load_dword v37, v110, s[36:39], s52 offen
  buffer_load_dword v45, v111, s[36:39], s52 offen
  s_mov_b32 s52, 1161344
  buffer_load_dword v38, v110, s[36:39], s52 offen
  buffer_load_dword v46, v111, s[36:39], s52 offen
  s_mov_b32 s52, 1164096
  buffer_load_dword v39, v110, s[36:39], s52 offen
  buffer_load_dword v47, v111, s[36:39], s52 offen
  s_waitcnt vmcnt(32)
  v_perm_b32 v120, v65, v64, s48
  v_perm_b32 v121, v67, v66, s48
  v_perm_b32 v122, v69, v68, s48
  v_perm_b32 v123, v71, v70, s48
  v_accvgpr_write_b32 a132, v120
  v_accvgpr_write_b32 a133, v121
  v_accvgpr_write_b32 a134, v122
  v_accvgpr_write_b32 a135, v123
  v_perm_b32 v120, v65, v64, s49
  v_perm_b32 v121, v67, v66, s49
  v_perm_b32 v122, v69, v68, s49
  v_perm_b32 v123, v71, v70, s49
  v_accvgpr_write_b32 a136, v120
  v_accvgpr_write_b32 a137, v121
  v_accvgpr_write_b32 a138, v122
  v_accvgpr_write_b32 a139, v123
  v_perm_b32 v120, v73, v72, s68
  v_perm_b32 v121, v75, v74, s68
  v_perm_b32 v122, v77, v76, s68
  v_perm_b32 v123, v79, v78, s68
  v_accvgpr_write_b32 a140, v120
  v_accvgpr_write_b32 a141, v121
  v_accvgpr_write_b32 a142, v122
  v_accvgpr_write_b32 a143, v123
  s_mov_b32 s52, 1232896
  buffer_load_dword v64, v110, s[36:39], s52 offen
  buffer_load_dword v72, v111, s[36:39], s52 offen
  s_mov_b32 s52, 1235648
  buffer_load_dword v65, v110, s[36:39], s52 offen
  buffer_load_dword v73, v111, s[36:39], s52 offen
  s_mov_b32 s52, 1238400
  buffer_load_dword v66, v110, s[36:39], s52 offen
  buffer_load_dword v74, v111, s[36:39], s52 offen
  s_mov_b32 s52, 1241152
  buffer_load_dword v67, v110, s[36:39], s52 offen
  buffer_load_dword v75, v111, s[36:39], s52 offen
  s_mov_b32 s52, 1243904
  buffer_load_dword v68, v110, s[36:39], s52 offen
  buffer_load_dword v76, v111, s[36:39], s52 offen
  s_mov_b32 s52, 1246656
  buffer_load_dword v69, v110, s[36:39], s52 offen
  buffer_load_dword v77, v111, s[36:39], s52 offen
  s_mov_b32 s52, 1249408
  buffer_load_dword v70, v110, s[36:39], s52 offen
  buffer_load_dword v78, v111, s[36:39], s52 offen
  s_mov_b32 s52, 1252160
  buffer_load_dword v71, v110, s[36:39], s52 offen
  buffer_load_dword v79, v111, s[36:39], s52 offen
  s_waitcnt vmcnt(32)
  v_perm_b32 v120, v1, v0, s48
  v_perm_b32 v121, v3, v2, s48
  v_perm_b32 v122, v5, v4, s48
  v_perm_b32 v123, v7, v6, s48
  v_accvgpr_write_b32 a144, v120
  v_accvgpr_write_b32 a145, v121
  v_accvgpr_write_b32 a146, v122
  v_accvgpr_write_b32 a147, v123
  v_perm_b32 v120, v1, v0, s49
  v_perm_b32 v121, v3, v2, s49
  v_perm_b32 v122, v5, v4, s49
  v_perm_b32 v123, v7, v6, s49
  v_accvgpr_write_b32 a148, v120
  v_accvgpr_write_b32 a149, v121
  v_accvgpr_write_b32 a150, v122
  v_accvgpr_write_b32 a151, v123
  v_perm_b32 v120, v9, v8, s68
  v_perm_b32 v121, v11, v10, s68
  v_perm_b32 v122, v13, v12, s68
  v_perm_b32 v123, v15, v14, s68
  v_accvgpr_write_b32 a152, v120
  v_accvgpr_write_b32 a153, v121
  v_accvgpr_write_b32 a154, v122
  v_accvgpr_write_b32 a155, v123
  s_mov_b32 s52, 1320960
  buffer_load_dword v0, v110, s[36:39], s52 offen
  buffer_load_dword v8, v111, s[36:39], s52 offen
  s_mov_b32 s52, 1323712
  buffer_load_dword v1, v110, s[36:39], s52 offen
  buffer_load_dword v9, v111, s[36:39], s52 offen
  s_mov_b32 s52, 1326464
  buffer_load_dword v2, v110, s[36:39], s52 offen
  buffer_load_dword v10, v111, s[36:39], s52 offen
  s_mov_b32 s52, 1329216
  buffer_load_dword v3, v110, s[36:39], s52 offen
  buffer_load_dword v11, v111, s[36:39], s52 offen
  s_mov_b32 s52, 1331968
  buffer_load_dword v4, v110, s[36:39], s52 offen
  buffer_load_dword v12, v111, s[36:39], s52 offen
  s_mov_b32 s52, 1334720
  buffer_load_dword v5, v110, s[36:39], s52 offen
  buffer_load_dword v13, v111, s[36:39], s52 offen
  s_mov_b32 s52, 1337472
  buffer_load_dword v6, v110, s[36:39], s52 offen
  buffer_load_dword v14, v111, s[36:39], s52 offen
  s_mov_b32 s52, 1340224
  buffer_load_dword v7, v110, s[36:39], s52 offen
  buffer_load_dword v15, v111, s[36:39], s52 offen
  s_waitcnt vmcnt(32)
  v_perm_b32 v120, v33, v32, s48
  v_perm_b32 v121, v35, v34, s48
  v_perm_b32 v122, v37, v36, s48
  v_perm_b32 v123, v39, v38, s48
  v_accvgpr_write_b32 a156, v120
  v_accvgpr_write_b32 a157, v121
  v_accvgpr_write_b32 a158, v122
  v_accvgpr_write_b32 a159, v123
  v_perm_b32 v120, v33, v32, s49
  v_perm_b32 v121, v35, v34, s49
  v_perm_b32 v122, v37, v36, s49
  v_perm_b32 v123, v39, v38, s49
  v_accvgpr_write_b32 a160, v120
  v_accvgpr_write_b32 a161, v121
  v_accvgpr_write_b32 a162, v122
  v_accvgpr_write_b32 a163, v123
  v_perm_b32 v120, v41, v40, s68
  v_perm_b32 v121, v43, v42, s68
  v_perm_b32 v122, v45, v44, s68
  v_perm_b32 v123, v47, v46, s68
  v_accvgpr_write_b32 a164, v120
  v_accvgpr_write_b32 a165, v121
  v_accvgpr_write_b32 a166, v122
  v_accvgpr_write_b32 a167, v123
  s_waitcnt vmcnt(16)
  v_perm_b32 v120, v65, v64, s48
  v_perm_b32 v121, v67, v66, s48
  v_perm_b32 v122, v69, v68, s48
  v_perm_b32 v123, v71, v70, s48
  v_accvgpr_write_b32 a168, v120
  v_accvgpr_write_b32 a169, v121
  v_accvgpr_write_b32 a170, v122
  v_accvgpr_write_b32 a171, v123
  v_perm_b32 v120, v65, v64, s49
  v_perm_b32 v121, v67, v66, s49
  v_perm_b32 v122, v69, v68, s49
  v_perm_b32 v123, v71, v70, s49
  v_accvgpr_write_b32 a172, v120
  v_accvgpr_write_b32 a173, v121
  v_accvgpr_write_b32 a174, v122
  v_accvgpr_write_b32 a175, v123
  v_perm_b32 v120, v73, v72, s68
  v_perm_b32 v121, v75, v74, s68
  v_perm_b32 v122, v77, v76, s68
  v_perm_b32 v123, v79, v78, s68
  v_accvgpr_write_b32 a176, v120
  v_accvgpr_write_b32 a177, v121
  v_accvgpr_write_b32 a178, v122
  v_accvgpr_write_b32 a179, v123
  s_waitcnt vmcnt(0)
  v_perm_b32 v120, v1, v0, s48
  v_perm_b32 v121, v3, v2, s48
  v_perm_b32 v122, v5, v4, s48
  v_perm_b32 v123, v7, v6, s48
  v_accvgpr_write_b32 a180, v120
  v_accvgpr_write_b32 a181, v121
  v_accvgpr_write_b32 a182, v122
  v_accvgpr_write_b32 a183, v123
  v_perm_b32 v120, v1, v0, s49
  v_perm_b32 v121, v3, v2, s49
  v_perm_b32 v122, v5, v4, s49
  v_perm_b32 v123, v7, v6, s49
  v_accvgpr_write_b32 a184, v120
  v_accvgpr_write_b32 a185, v121
  v_accvgpr_write_b32 a186, v122
  v_accvgpr_write_b32 a187, v123
  v_perm_b32 v120, v9, v8, s68
  v_perm_b32 v121, v11, v10, s68
  v_perm_b32 v122, v13, v12, s68
  v_perm_b32 v123, v15, v14, s68
  v_accvgpr_write_b32 a188, v120
  v_accvgpr_write_b32 a189, v121
  v_accvgpr_write_b32 a190, v122
  v_accvgpr_write_b32 a191, v123
  s_mul_i32 s51, s63, 176128
  s_lshl_b32 s52, s26, 8
  s_add_u32 s51, s51, s52
  v_lshlrev_b32 v110, 13, v108
  v_lshl_add_u32 v110, v109, 3, v110
  v_add_u32 v110, s51, v110
  v_cmp_gt_u32 vcc, 2, v108
  s_nop 1
  v_cndmask_b32 v111, v107, v110, vcc
  v_cmp_gt_u32 vcc, 1, v108
  s_nop 1
  v_cndmask_b32 v106, v107, v110, vcc
  s_mov_b32 s40, s18
  s_and_b32 s41, s19, 0xffff
  s_mov_b32 s42, 1409024
  s_mov_b32 s43, 0x20000
  s_mov_b32 s52, 0
  buffer_load_dwordx2 v[0:1], v110, s[40:43], s52 offen
  s_mov_b32 s52, 2048
  buffer_load_dwordx2 v[2:3], v110, s[40:43], s52 offen
  s_mov_b32 s52, 4096
  buffer_load_dwordx2 v[4:5], v110, s[40:43], s52 offen
  s_mov_b32 s52, 6144
  buffer_load_dwordx2 v[6:7], v110, s[40:43], s52 offen
  s_mov_b32 s52, 1024
  buffer_load_dwordx2 v[8:9], v110, s[40:43], s52 offen
  s_mov_b32 s52, 3072
  buffer_load_dwordx2 v[10:11], v110, s[40:43], s52 offen
  s_mov_b32 s52, 5120
  buffer_load_dwordx2 v[12:13], v110, s[40:43], s52 offen
  s_mov_b32 s52, 7168
  buffer_load_dwordx2 v[14:15], v110, s[40:43], s52 offen
  s_mov_b32 s52, 128
  buffer_load_dwordx2 v[16:17], v110, s[40:43], s52 offen
  s_mov_b32 s52, 2176
  buffer_load_dwordx2 v[18:19], v110, s[40:43], s52 offen
  s_mov_b32 s52, 4224
  buffer_load_dwordx2 v[20:21], v110, s[40:43], s52 offen
  s_mov_b32 s52, 6272
  buffer_load_dwordx2 v[22:23], v110, s[40:43], s52 offen
  s_mov_b32 s52, 1152
  buffer_load_dwordx2 v[24:25], v110, s[40:43], s52 offen
  s_mov_b32 s52, 3200
  buffer_load_dwordx2 v[26:27], v110, s[40:43], s52 offen
  s_mov_b32 s52, 5248
  buffer_load_dwordx2 v[28:29], v110, s[40:43], s52 offen
  s_mov_b32 s52, 7296
  buffer_load_dwordx2 v[30:31], v110, s[40:43], s52 offen
  s_mov_b32 s52, 32768
  buffer_load_dwordx2 v[32:33], v110, s[40:43], s52 offen
  s_mov_b32 s52, 34816
  buffer_load_dwordx2 v[34:35], v110, s[40:43], s52 offen
  s_mov_b32 s52, 36864
  buffer_load_dwordx2 v[36:37], v110, s[40:43], s52 offen
  s_mov_b32 s52, 38912
  buffer_load_dwordx2 v[38:39], v110, s[40:43], s52 offen
  s_mov_b32 s52, 33792
  buffer_load_dwordx2 v[40:41], v110, s[40:43], s52 offen
  s_mov_b32 s52, 35840
  buffer_load_dwordx2 v[42:43], v110, s[40:43], s52 offen
  s_mov_b32 s52, 37888
  buffer_load_dwordx2 v[44:45], v110, s[40:43], s52 offen
  s_mov_b32 s52, 39936
  buffer_load_dwordx2 v[46:47], v110, s[40:43], s52 offen
  s_mov_b32 s52, 32896
  buffer_load_dwordx2 v[48:49], v110, s[40:43], s52 offen
  s_mov_b32 s52, 34944
  buffer_load_dwordx2 v[50:51], v110, s[40:43], s52 offen
  s_mov_b32 s52, 36992
  buffer_load_dwordx2 v[52:53], v110, s[40:43], s52 offen
  s_mov_b32 s52, 39040
  buffer_load_dwordx2 v[54:55], v110, s[40:43], s52 offen
  s_mov_b32 s52, 33920
  buffer_load_dwordx2 v[56:57], v110, s[40:43], s52 offen
  s_mov_b32 s52, 35968
  buffer_load_dwordx2 v[58:59], v110, s[40:43], s52 offen
  s_mov_b32 s52, 38016
  buffer_load_dwordx2 v[60:61], v110, s[40:43], s52 offen
  s_mov_b32 s52, 40064
  buffer_load_dwordx2 v[62:63], v110, s[40:43], s52 offen
  s_mov_b32 s52, 65536
  buffer_load_dwordx2 v[64:65], v110, s[40:43], s52 offen
  s_mov_b32 s52, 67584
  buffer_load_dwordx2 v[66:67], v110, s[40:43], s52 offen
  s_mov_b32 s52, 69632
  buffer_load_dwordx2 v[68:69], v110, s[40:43], s52 offen
  s_mov_b32 s52, 71680
  buffer_load_dwordx2 v[70:71], v110, s[40:43], s52 offen
  s_mov_b32 s52, 66560
  buffer_load_dwordx2 v[72:73], v110, s[40:43], s52 offen
  s_mov_b32 s52, 68608
  buffer_load_dwordx2 v[74:75], v110, s[40:43], s52 offen
  s_mov_b32 s52, 70656
  buffer_load_dwordx2 v[76:77], v110, s[40:43], s52 offen
  s_mov_b32 s52, 72704
  buffer_load_dwordx2 v[78:79], v110, s[40:43], s52 offen
  s_mov_b32 s52, 65664
  buffer_load_dwordx2 v[80:81], v110, s[40:43], s52 offen
  s_mov_b32 s52, 67712
  buffer_load_dwordx2 v[82:83], v110, s[40:43], s52 offen
  s_mov_b32 s52, 69760
  buffer_load_dwordx2 v[84:85], v110, s[40:43], s52 offen
  s_mov_b32 s52, 71808
  buffer_load_dwordx2 v[86:87], v110, s[40:43], s52 offen
  s_mov_b32 s52, 66688
  buffer_load_dwordx2 v[88:89], v110, s[40:43], s52 offen
  s_mov_b32 s52, 68736
  buffer_load_dwordx2 v[90:91], v110, s[40:43], s52 offen
  s_mov_b32 s52, 70784
  buffer_load_dwordx2 v[92:93], v110, s[40:43], s52 offen
  s_mov_b32 s52, 72832
  buffer_load_dwordx2 v[94:95], v110, s[40:43], s52 offen
  s_waitcnt vmcnt(32)
  v_perm_b32 v120, v2, v0, s48
  v_perm_b32 v121, v6, v4, s48
  v_perm_b32 v122, v10, v8, s48
  v_perm_b32 v123, v14, v12, s48
  v_accvgpr_write_b32 a192, v120
  v_accvgpr_write_b32 a193, v121
  v_accvgpr_write_b32 a194, v122
  v_accvgpr_write_b32 a195, v123
  v_perm_b32 v120, v2, v0, s49
  v_perm_b32 v121, v6, v4, s49
  v_perm_b32 v122, v10, v8, s49
  v_perm_b32 v123, v14, v12, s49
  v_accvgpr_write_b32 a196, v120
  v_accvgpr_write_b32 a197, v121
  v_accvgpr_write_b32 a198, v122
  v_accvgpr_write_b32 a199, v123
  v_perm_b32 v120, v3, v1, s48
  v_perm_b32 v121, v7, v5, s48
  v_perm_b32 v122, v11, v9, s48
  v_perm_b32 v123, v15, v13, s48
  v_accvgpr_write_b32 a200, v120
  v_accvgpr_write_b32 a201, v121
  v_accvgpr_write_b32 a202, v122
  v_accvgpr_write_b32 a203, v123
  v_perm_b32 v120, v3, v1, s49
  v_perm_b32 v121, v7, v5, s49
  v_perm_b32 v122, v11, v9, s49
  v_perm_b32 v123, v15, v13, s49
  v_accvgpr_write_b32 a204, v120
  v_accvgpr_write_b32 a205, v121
  v_accvgpr_write_b32 a206, v122
  v_accvgpr_write_b32 a207, v123
  v_perm_b32 v160, v18, v16, s48
  v_perm_b32 v161, v22, v20, s48
  v_perm_b32 v162, v26, v24, s48
  v_perm_b32 v163, v30, v28, s48
  v_perm_b32 v164, v18, v16, s49
  v_perm_b32 v165, v22, v20, s49
  v_perm_b32 v166, v26, v24, s49
  v_perm_b32 v167, v30, v28, s49
  v_perm_b32 v168, v19, v17, s48
  v_perm_b32 v169, v23, v21, s48
  v_perm_b32 v170, v27, v25, s48
  v_perm_b32 v171, v31, v29, s48
  v_perm_b32 v172, v19, v17, s49
  v_perm_b32 v173, v23, v21, s49
  v_perm_b32 v174, v27, v25, s49
  v_perm_b32 v175, v31, v29, s49
  s_mov_b32 s52, 98304
  buffer_load_dwordx2 v[0:1], v110, s[40:43], s52 offen
  s_mov_b32 s52, 100352
  buffer_load_dwordx2 v[2:3], v110, s[40:43], s52 offen
  s_mov_b32 s52, 102400
  buffer_load_dwordx2 v[4:5], v110, s[40:43], s52 offen
  s_mov_b32 s52, 104448
  buffer_load_dwordx2 v[6:7], v110, s[40:43], s52 offen
  s_mov_b32 s52, 99328
  buffer_load_dwordx2 v[8:9], v110, s[40:43], s52 offen
  s_mov_b32 s52, 101376
  buffer_load_dwordx2 v[10:11], v110, s[40:43], s52 offen
  s_mov_b32 s52, 103424
  buffer_load_dwordx2 v[12:13], v110, s[40:43], s52 offen
  s_mov_b32 s52, 105472
  buffer_load_dwordx2 v[14:15], v110, s[40:43], s52 offen
  s_mov_b32 s52, 98432
  buffer_load_dwordx2 v[16:17], v110, s[40:43], s52 offen
  s_mov_b32 s52, 100480
  buffer_load_dwordx2 v[18:19], v110, s[40:43], s52 offen
  s_mov_b32 s52, 102528
  buffer_load_dwordx2 v[20:21], v110, s[40:43], s52 offen
  s_mov_b32 s52, 104576
  buffer_load_dwordx2 v[22:23], v110, s[40:43], s52 offen
  s_mov_b32 s52, 99456
  buffer_load_dwordx2 v[24:25], v110, s[40:43], s52 offen
  s_mov_b32 s52, 101504
  buffer_load_dwordx2 v[26:27], v110, s[40:43], s52 offen
  s_mov_b32 s52, 103552
  buffer_load_dwordx2 v[28:29], v110, s[40:43], s52 offen
  s_mov_b32 s52, 105600
  buffer_load_dwordx2 v[30:31], v110, s[40:43], s52 offen
  s_waitcnt vmcnt(32)
  v_perm_b32 v120, v34, v32, s48
  v_perm_b32 v121, v38, v36, s48
  v_perm_b32 v122, v42, v40, s48
  v_perm_b32 v123, v46, v44, s48
  v_accvgpr_write_b32 a208, v120
  v_accvgpr_write_b32 a209, v121
  v_accvgpr_write_b32 a210, v122
  v_accvgpr_write_b32 a211, v123
  v_perm_b32 v120, v34, v32, s49
  v_perm_b32 v121, v38, v36, s49
  v_perm_b32 v122, v42, v40, s49
  v_perm_b32 v123, v46, v44, s49
  v_accvgpr_write_b32 a212, v120
  v_accvgpr_write_b32 a213, v121
  v_accvgpr_write_b32 a214, v122
  v_accvgpr_write_b32 a215, v123
  v_perm_b32 v120, v35, v33, s48
  v_perm_b32 v121, v39, v37, s48
  v_perm_b32 v122, v43, v41, s48
  v_perm_b32 v123, v47, v45, s48
  v_accvgpr_write_b32 a216, v120
  v_accvgpr_write_b32 a217, v121
  v_accvgpr_write_b32 a218, v122
  v_accvgpr_write_b32 a219, v123
  v_perm_b32 v120, v35, v33, s49
  v_perm_b32 v121, v39, v37, s49
  v_perm_b32 v122, v43, v41, s49
  v_perm_b32 v123, v47, v45, s49
  v_accvgpr_write_b32 a220, v120
  v_accvgpr_write_b32 a221, v121
  v_accvgpr_write_b32 a222, v122
  v_accvgpr_write_b32 a223, v123
  v_perm_b32 v176, v50, v48, s48
  v_perm_b32 v177, v54, v52, s48
  v_perm_b32 v178, v58, v56, s48
  v_perm_b32 v179, v62, v60, s48
  v_perm_b32 v180, v50, v48, s49
  v_perm_b32 v181, v54, v52, s49
  v_perm_b32 v182, v58, v56, s49
  v_perm_b32 v183, v62, v60, s49
  v_perm_b32 v184, v51, v49, s48
  v_perm_b32 v185, v55, v53, s48
  v_perm_b32 v186, v59, v57, s48
  v_perm_b32 v187, v63, v61, s48
  v_perm_b32 v188, v51, v49, s49
  v_perm_b32 v189, v55, v53, s49
  v_perm_b32 v190, v59, v57, s49
  v_perm_b32 v191, v63, v61, s49
  s_mov_b32 s52, 131072
  buffer_load_dwordx2 v[32:33], v110, s[40:43], s52 offen
  s_mov_b32 s52, 133120
  buffer_load_dwordx2 v[34:35], v110, s[40:43], s52 offen
  s_mov_b32 s52, 135168
  buffer_load_dwordx2 v[36:37], v110, s[40:43], s52 offen
  s_mov_b32 s52, 137216
  buffer_load_dwordx2 v[38:39], v110, s[40:43], s52 offen
  s_mov_b32 s52, 132096
  buffer_load_dwordx2 v[40:41], v110, s[40:43], s52 offen
  s_mov_b32 s52, 134144
  buffer_load_dwordx2 v[42:43], v110, s[40:43], s52 offen
  s_mov_b32 s52, 136192
  buffer_load_dwordx2 v[44:45], v110, s[40:43], s52 offen
  s_mov_b32 s52, 138240
  buffer_load_dwordx2 v[46:47], v110, s[40:43], s52 offen
  s_mov_b32 s52, 131200
  buffer_load_dwordx2 v[48:49], v110, s[40:43], s52 offen
  s_mov_b32 s52, 133248
  buffer_load_dwordx2 v[50:51], v110, s[40:43], s52 offen
  s_mov_b32 s52, 135296
  buffer_load_dwordx2 v[52:53], v110, s[40:43], s52 offen
  s_mov_b32 s52, 137344
  buffer_load_dwordx2 v[54:55], v110, s[40:43], s52 offen
  s_mov_b32 s52, 132224
  buffer_load_dwordx2 v[56:57], v110, s[40:43], s52 offen
  s_mov_b32 s52, 134272
  buffer_load_dwordx2 v[58:59], v110, s[40:43], s52 offen
  s_mov_b32 s52, 136320
  buffer_load_dwordx2 v[60:61], v110, s[40:43], s52 offen
  s_mov_b32 s52, 138368
  buffer_load_dwordx2 v[62:63], v110, s[40:43], s52 offen
  s_waitcnt vmcnt(32)
  v_perm_b32 v120, v66, v64, s48
  v_perm_b32 v121, v70, v68, s48
  v_perm_b32 v122, v74, v72, s48
  v_perm_b32 v123, v78, v76, s48
  v_accvgpr_write_b32 a224, v120
  v_accvgpr_write_b32 a225, v121
  v_accvgpr_write_b32 a226, v122
  v_accvgpr_write_b32 a227, v123
  v_perm_b32 v120, v66, v64, s49
  v_perm_b32 v121, v70, v68, s49
  v_perm_b32 v122, v74, v72, s49
  v_perm_b32 v123, v78, v76, s49
  v_accvgpr_write_b32 a228, v120
  v_accvgpr_write_b32 a229, v121
  v_accvgpr_write_b32 a230, v122
  v_accvgpr_write_b32 a231, v123
  v_perm_b32 v120, v67, v65, s48
  v_perm_b32 v121, v71, v69, s48
  v_perm_b32 v122, v75, v73, s48
  v_perm_b32 v123, v79, v77, s48
  v_accvgpr_write_b32 a232, v120
  v_accvgpr_write_b32 a233, v121
  v_accvgpr_write_b32 a234, v122
  v_accvgpr_write_b32 a235, v123
  v_perm_b32 v120, v67, v65, s49
  v_perm_b32 v121, v71, v69, s49
  v_perm_b32 v122, v75, v73, s49
  v_perm_b32 v123, v79, v77, s49
  v_accvgpr_write_b32 a236, v120
  v_accvgpr_write_b32 a237, v121
  v_accvgpr_write_b32 a238, v122
  v_accvgpr_write_b32 a239, v123
  v_perm_b32 v192, v82, v80, s48
  v_perm_b32 v193, v86, v84, s48
  v_perm_b32 v194, v90, v88, s48
  v_perm_b32 v195, v94, v92, s48
  v_perm_b32 v196, v82, v80, s49
  v_perm_b32 v197, v86, v84, s49
  v_perm_b32 v198, v90, v88, s49
  v_perm_b32 v199, v94, v92, s49
  v_perm_b32 v200, v83, v81, s48
  v_perm_b32 v201, v87, v85, s48
  v_perm_b32 v202, v91, v89, s48
  v_perm_b32 v203, v95, v93, s48
  v_perm_b32 v204, v83, v81, s49
  v_perm_b32 v205, v87, v85, s49
  v_perm_b32 v206, v91, v89, s49
  v_perm_b32 v207, v95, v93, s49
  s_mov_b32 s52, 163840
  buffer_load_dwordx2 v[64:65], v111, s[40:43], s52 offen
  s_mov_b32 s52, 165888
  buffer_load_dwordx2 v[66:67], v111, s[40:43], s52 offen
  s_mov_b32 s52, 167936
  buffer_load_dwordx2 v[68:69], v106, s[40:43], s52 offen
  s_mov_b32 s52, 169984
  buffer_load_dwordx2 v[70:71], v106, s[40:43], s52 offen
  s_mov_b32 s52, 164864
  buffer_load_dwordx2 v[72:73], v111, s[40:43], s52 offen
  s_mov_b32 s52, 166912
  buffer_load_dwordx2 v[74:75], v111, s[40:43], s52 offen
  s_mov_b32 s52, 168960
  buffer_load_dwordx2 v[76:77], v106, s[40:43], s52 offen
  s_mov_b32 s52, 171008
  buffer_load_dwordx2 v[78:79], v106, s[40:43], s52 offen
  s_mov_b32 s52, 163968
  buffer_load_dwordx2 v[80:81], v111, s[40:43], s52 offen
  s_mov_b32 s52, 166016
  buffer_load_dwordx2 v[82:83], v111, s[40:43], s52 offen
  s_mov_b32 s52, 168064
  buffer_load_dwordx2 v[84:85], v106, s[40:43], s52 offen
  s_mov_b32 s52, 170112
  buffer_load_dwordx2 v[86:87], v106, s[40:43], s52 offen
  s_mov_b32 s52, 164992
  buffer_load_dwordx2 v[88:89], v111, s[40:43], s52 offen
  s_mov_b32 s52, 167040
  buffer_load_dwordx2 v[90:91], v111, s[40:43], s52 offen
  s_mov_b32 s52, 169088
  buffer_load_dwordx2 v[92:93], v106, s[40:43], s52 offen
  s_mov_b32 s52, 171136
  buffer_load_dwordx2 v[94:95], v106, s[40:43], s52 offen
  s_waitcnt vmcnt(32)
  v_perm_b32 v120, v2, v0, s48
  v_perm_b32 v121, v6, v4, s48
  v_perm_b32 v122, v10, v8, s48
  v_perm_b32 v123, v14, v12, s48
  v_accvgpr_write_b32 a240, v120
  v_accvgpr_write_b32 a241, v121
  v_accvgpr_write_b32 a242, v122
  v_accvgpr_write_b32 a243, v123
  v_perm_b32 v120, v2, v0, s49
  v_perm_b32 v121, v6, v4, s49
  v_perm_b32 v122, v10, v8, s49
  v_perm_b32 v123, v14, v12, s49
  v_accvgpr_write_b32 a244, v120
  v_accvgpr_write_b32 a245, v121
  v_accvgpr_write_b32 a246, v122
  v_accvgpr_write_b32 a247, v123
  v_perm_b32 v120, v3, v1, s48
  v_perm_b32 v121, v7, v5, s48
  v_perm_b32 v122, v11, v9, s48
  v_perm_b32 v123, v15, v13, s48
  v_accvgpr_write_b32 a248, v120
  v_accvgpr_write_b32 a249, v121
  v_accvgpr_write_b32 a250, v122
  v_accvgpr_write_b32 a251, v123
  v_perm_b32 v120, v3, v1, s49
  v_perm_b32 v121, v7, v5, s49
  v_perm_b32 v122, v11, v9, s49
  v_perm_b32 v123, v15, v13, s49
  v_accvgpr_write_b32 a252, v120
  v_accvgpr_write_b32 a253, v121
  v_accvgpr_write_b32 a254, v122
  v_accvgpr_write_b32 a255, v123
  v_perm_b32 v208, v18, v16, s48
  v_perm_b32 v209, v22, v20, s48
  v_perm_b32 v210, v26, v24, s48
  v_perm_b32 v211, v30, v28, s48
  v_perm_b32 v212, v18, v16, s49
  v_perm_b32 v213, v22, v20, s49
  v_perm_b32 v214, v26, v24, s49
  v_perm_b32 v215, v30, v28, s49
  v_perm_b32 v216, v19, v17, s48
  v_perm_b32 v217, v23, v21, s48
  v_perm_b32 v218, v27, v25, s48
  v_perm_b32 v219, v31, v29, s48
  v_perm_b32 v220, v19, v17, s49
  v_perm_b32 v221, v23, v21, s49
  v_perm_b32 v222, v27, v25, s49
  v_perm_b32 v223, v31, v29, s49
  s_waitcnt vmcnt(16)
  v_perm_b32 v128, v34, v32, s48
  v_perm_b32 v129, v38, v36, s48
  v_perm_b32 v130, v42, v40, s48
  v_perm_b32 v131, v46, v44, s48
  v_perm_b32 v132, v34, v32, s49
  v_perm_b32 v133, v38, v36, s49
  v_perm_b32 v134, v42, v40, s49
  v_perm_b32 v135, v46, v44, s49
  v_perm_b32 v136, v35, v33, s48
  v_perm_b32 v137, v39, v37, s48
  v_perm_b32 v138, v43, v41, s48
  v_perm_b32 v139, v47, v45, s48
  v_perm_b32 v140, v35, v33, s49
  v_perm_b32 v141, v39, v37, s49
  v_perm_b32 v142, v43, v41, s49
  v_perm_b32 v143, v47, v45, s49
  v_perm_b32 v224, v50, v48, s48
  v_perm_b32 v225, v54, v52, s48
  v_perm_b32 v226, v58, v56, s48
  v_perm_b32 v227, v62, v60, s48
  v_perm_b32 v228, v50, v48, s49
  v_perm_b32 v229, v54, v52, s49
  v_perm_b32 v230, v58, v56, s49
  v_perm_b32 v231, v62, v60, s49
  v_perm_b32 v232, v51, v49, s48
  v_perm_b32 v233, v55, v53, s48
  v_perm_b32 v234, v59, v57, s48
  v_perm_b32 v235, v63, v61, s48
  v_perm_b32 v236, v51, v49, s49
  v_perm_b32 v237, v55, v53, s49
  v_perm_b32 v238, v59, v57, s49
  v_perm_b32 v239, v63, v61, s49
  s_waitcnt vmcnt(0)
  v_perm_b32 v144, v66, v64, s48
  v_perm_b32 v145, v70, v68, s48
  v_perm_b32 v146, v74, v72, s48
  v_perm_b32 v147, v78, v76, s48
  v_perm_b32 v148, v66, v64, s49
  v_perm_b32 v149, v70, v68, s49
  v_perm_b32 v150, v74, v72, s49
  v_perm_b32 v151, v78, v76, s49
  v_perm_b32 v152, v67, v65, s48
  v_perm_b32 v153, v71, v69, s48
  v_perm_b32 v154, v75, v73, s48
  v_perm_b32 v155, v79, v77, s48
  v_perm_b32 v156, v67, v65, s49
  v_perm_b32 v157, v71, v69, s49
  v_perm_b32 v158, v75, v73, s49
  v_perm_b32 v159, v79, v77, s49
  v_perm_b32 v240, v82, v80, s48
  v_perm_b32 v241, v86, v84, s48
  v_perm_b32 v242, v90, v88, s48
  v_perm_b32 v243, v94, v92, s48
  v_perm_b32 v244, v82, v80, s49
  v_perm_b32 v245, v86, v84, s49
  v_perm_b32 v246, v90, v88, s49
  v_perm_b32 v247, v94, v92, s49
  v_perm_b32 v248, v83, v81, s48
  v_perm_b32 v249, v87, v85, s48
  v_perm_b32 v250, v91, v89, s48
  v_perm_b32 v251, v95, v93, s48
  v_perm_b32 v252, v83, v81, s49
  v_perm_b32 v253, v87, v85, s49
  v_perm_b32 v254, v91, v89, s49
  v_perm_b32 v255, v95, v93, s49
  v_lshrrev_b32 v2, 8, v96
  v_bfe_u32 v3, v96, 4, 4
  s_and_b32 s63, s28, 7
  v_lshrrev_b32 v108, 2, v96
  v_lshrrev_b32 v4, 1, v3
  v_and_b32 v5, 16, v96
  v_mov_b32 v6, 0x3f80
  v_lshlrev_b32 v6, v5, v6
  v_cmp_eq_u32 vcc, 0, v4
  s_nop 1
  v_cndmask_b32 v112, 0, v6, vcc
  v_cmp_eq_u32 vcc, 1, v4
  s_nop 1
  v_cndmask_b32 v113, 0, v6, vcc
  v_cmp_eq_u32 vcc, 2, v4
  s_nop 1
  v_cndmask_b32 v114, 0, v6, vcc
  v_cmp_eq_u32 vcc, 3, v4
  s_nop 1
  v_cndmask_b32 v115, 0, v6, vcc
  v_cmp_eq_u32 vcc, 4, v4
  s_nop 1
  v_cndmask_b32 v116, 0, v6, vcc
  v_cmp_eq_u32 vcc, 5, v4
  s_nop 1
  v_cndmask_b32 v117, 0, v6, vcc
  v_cmp_eq_u32 vcc, 6, v4
  s_nop 1
  v_cndmask_b32 v118, 0, v6, vcc
  v_cmp_eq_u32 vcc, 7, v4
  s_nop 1
  v_cndmask_b32 v119, 0, v6, vcc
  v_add_u32 v4, 78400, v96
  ds_write_b128 v4, v[112:115]
  ds_write_b128 v4, v[116:119] offset:1024
  v_and_b32 v4, 1, v2
  s_lshl_b32 s51, s63, 1
  v_add_u32 v5, s51, v4
  v_lshrrev_b32 v6, 1, v2
  s_lshl_b32 s51, s26, 8
  v_lshlrev_b32 v7, 10, v5
  v_add_u32 v7, s51, v7
  v_lshl_add_u32 v8, v6, 7, v7
  v_lshl_add_u32 v103, v3, 3, v8
  v_lshrrev_b32 v8, 1, v3
  v_lshl_add_u32 v8, v6, 3, v8
  v_and_b32 v9, 15, v5
  v_xor_b32 v8, v8, v9
  v_lshl_add_u32 v8, v8, 4, v7
  v_and_b32 v9, 1, v3
  v_lshl_add_u32 v104, v9, 3, v8
  v_lshlrev_b32 v8, 6, v4
  v_add_u32 v106, 77824, v8
  s_lshl_b32 s51, s26, 3
  v_add_u32 v105, s51, v106
  v_lshl_add_u32 v105, v6, 2, v105
  s_lshl_b32 s51, s26, 2
  s_add_u32 s51, s51, 78336
  v_mov_b32 v110, s51
  s_mov_b32 s53, 0
  s_mov_b32 s69, 0
  s_waitcnt lgkmcnt(0)
  v_lshrrev_b32 v2, 8, v96
  v_bfe_u32 v3, v96, 4, 4
  v_mul_u32_u24 v4, 32768, v2
  v_lshl_add_u32 v102, v3, 4, v4
  s_mul_i32 s51, s29, 1048576
  s_add_u32 s51, s51, 3473408
  s_mul_i32 s58, s63, 16384
  s_add_u32 s58, s58, s51
  s_lshl_b32 s52, s26, 12
  s_add_u32 s58, s58, s52
  s_lshl_b32 s62, s63, 7
  s_lshl_b32 s64, s26, 2
  s_add_u32 s62, s62, s64
  s_lshl_b32 s59, s29, 19
  s_add_u32 s59, s59, 15532032
  s_lshl_b32 s64, s63, 12
  s_add_u32 s59, s59, s64
  s_lshl_b32 s64, s26, 10
  s_add_u32 s59, s59, s64
  v_add_u32 v4, 0, v2
  v_xor_b32 v4, v4, v3
  v_lshlrev_b32 v4, 4, v4
  v_lshl_add_u32 v97, v3, 8, v4
  v_add_u32 v4, 4, v2
  v_xor_b32 v4, v4, v3
  v_lshlrev_b32 v4, 4, v4
  v_lshl_add_u32 v98, v3, 8, v4
  v_add_u32 v4, 8, v2
  v_xor_b32 v4, v4, v3
  v_lshlrev_b32 v4, 4, v4
  v_lshl_add_u32 v99, v3, 8, v4
  v_add_u32 v4, 12, v2
  v_xor_b32 v4, v4, v3
  v_lshlrev_b32 v4, 4, v4
  v_lshl_add_u32 v100, v3, 8, v4
  v_lshlrev_b32 v4, 10, v2
  v_lshl_add_u32 v101, v3, 4, v4
  s_add_u32 s57, s51, s52
  s_lshl_b32 s52, s63, 8
  s_add_u32 s57, s57, s52
  s_lshr_b32 s52, s26, 1
  s_mul_i32 s52, s52, 3072
  s_add_u32 s52, s52, 65536
  v_add_u32 v107, s52, v96
  s_and_b32 s52, s26, 1
  s_lshl_b32 s64, s52, 3
  v_add_u32 v109, s64, v107
  s_lshl_b32 s52, s52, 11
  v_add_u32 v107, s52, v107
  s_lshl_b32 s51, s29, 18
  s_add_u32 s55, s51, 15007744
  s_lshl_b32 s52, s26, 12
  s_add_u32 s55, s55, s52
  s_lshl_b32 s56, s29, 14
  s_add_u32 s56, s56, 262144
  s_add_u32 s62, s62, 131072
  s_cmp_eq_u32 s29, 0
  s_cselect_b32 s61, 12910592, 1073741824
  s_cselect_b32 s62, s62, 1073741824
  s_mov_b32 s36, s20
  s_and_b32 s37, s21, 0xffff
  s_mov_b32 s38, 2097152
  s_mov_b32 s39, 0x20000
  s_cmp_eq_u32 s29, 0
  s_cselect_b32 s38, 0, s38
  s_cselect_b32 s60, 20971520, 1073741824
  s_cmp_eq_u32 s30, 0
  s_cbranch_scc1 L_Fslow
  s_bfe_u32 s50, s28, 0x10003
  s_lshl_b32 s89, s26, 10
  s_mov_b32 s93, 1073741824
  v_add_u32 v110, 65536, v96
  s_lshl_b32 s51, s63, 2
  s_add_u32 s51, s51, s26
  s_lshl_b32 s95, s51, 10
  s_lshl_b32 s52, s29, 18
  s_add_u32 s95, s95, s52
  s_add_u32 s95, s95, 15007744
  s_lshl_b32 s88, s51, 2
  s_lshl_b32 s52, s29, 17
  s_add_u32 s88, s88, s52
  s_add_u32 s88, s88, 557056
  s_lshl_b32 s52, s50, 11
  s_add_u32 s88, s88, s52
  s_mov_b64 exec, 1
  buffer_store_dword v110, off, s[32:35], s88
  s_mov_b64 exec, -1
  s_add_u32 s88, s88, 4096
  s_cmp_ge_u32 s50, 56
  s_cselect_b32 s88, 1073741824, s88
  s_mov_b64 exec, 1
  buffer_store_dword v110, off, s[32:35], s88
  s_mov_b64 exec, -1
  s_add_u32 s88, s88, 4096
  s_cmp_ge_u32 s50, 56
  s_cselect_b32 s88, 1073741824, s88
  s_mov_b64 exec, 1
  buffer_store_dword v110, off, s[32:35], s88
  s_mov_b64 exec, -1
  s_add_u32 s88, s88, 4096
  s_cmp_ge_u32 s50, 56
  s_cselect_b32 s88, 1073741824, s88
  v_lshlrev_b32 v2, 2, v96
  s_add_u32 s51, s58, 0
  buffer_load_dword v3, v2, s[32:35], s51 offen sc1
  s_add_u32 s51, s58, 131072
  buffer_load_dword v3, v2, s[32:35], s51 offen sc1
  s_add_u32 s51, s58, 262144
  buffer_load_dword v3, v2, s[32:35], s51 offen sc1
  s_add_u32 s51, s58, 393216
  buffer_load_dword v3, v2, s[32:35], s51 offen sc1
  s_add_u32 s51, s58, 524288
  buffer_load_dword v3, v2, s[32:35], s51 offen sc1
  s_add_u32 s51, s58, 655360
  buffer_load_dword v3, v2, s[32:35], s51 offen sc1
  s_add_u32 s51, s58, 786432
  buffer_load_dword v3, v2, s[32:35], s51 offen sc1
  s_add_u32 s51, s58, 917504
  buffer_load_dword v3, v2, s[32:35], s51 offen sc1
  s_add_u32 s51, s59, 0
  buffer_load_dword v3, v96, s[32:35], s51 offen sc1
  s_add_u32 s51, s59, 32768
  buffer_load_dword v3, v96, s[32:35], s51 offen sc1
  s_add_u32 s51, s59, 65536
  buffer_load_dword v3, v96, s[32:35], s51 offen sc1
  s_add_u32 s51, s59, 98304
  buffer_load_dword v3, v96, s[32:35], s51 offen sc1
  s_add_u32 s51, s59, 131072
  buffer_load_dword v3, v96, s[32:35], s51 offen sc1
  s_add_u32 s51, s59, 163840
  buffer_load_dword v3, v96, s[32:35], s51 offen sc1
  s_add_u32 s51, s59, 196608
  buffer_load_dword v3, v96, s[32:35], s51 offen sc1
  s_add_u32 s51, s59, 229376
  buffer_load_dword v3, v96, s[32:35], s51 offen sc1
  s_add_u32 s51, s59, 262144
  buffer_load_dword v3, v96, s[32:35], s51 offen sc1
  s_add_u32 s51, s59, 294912
  buffer_load_dword v3, v96, s[32:35], s51 offen sc1
  s_add_u32 s51, s59, 327680
  buffer_load_dword v3, v96, s[32:35], s51 offen sc1
  s_add_u32 s51, s59, 360448
  buffer_load_dword v3, v96, s[32:35], s51 offen sc1
  s_add_u32 s51, s59, 393216
  buffer_load_dword v3, v96, s[32:35], s51 offen sc1
  s_add_u32 s51, s59, 425984
  buffer_load_dword v3, v96, s[32:35], s51 offen sc1
  s_add_u32 s51, s59, 458752
  buffer_load_dword v3, v96, s[32:35], s51 offen sc1
  s_add_u32 s51, s59, 491520
  buffer_load_dword v3, v96, s[32:35], s51 offen sc1
  v_lshlrev_b32 v122, 3, v96
  v_and_b32 v122, 0x380, v122
  s_add_u32 s51, s50, 0
  s_and_b32 s51, s51, 7
  s_lshl_b32 s51, s51, 15
  s_add_u32 s51, s51, s95
  buffer_load_dword v111, v122, s[32:35], s51 offen sc1
  v_lshlrev_b32 v122, 3, v96
  v_and_b32 v122, 0x380, v122
  s_add_u32 s51, s50, 2
  s_and_b32 s51, s51, 7
  s_lshl_b32 s51, s51, 15
  s_add_u32 s51, s51, s95
  buffer_load_dword v111, v122, s[32:35], s51 offen sc1
  v_lshlrev_b32 v122, 3, v96
  v_and_b32 v122, 0x380, v122
  s_add_u32 s51, s50, 4
  s_and_b32 s51, s51, 7
  s_lshl_b32 s51, s51, 15
  s_add_u32 s51, s51, s95
  buffer_load_dword v111, v122, s[32:35], s51 offen sc1
  v_lshlrev_b32 v122, 3, v96
  v_and_b32 v122, 0x380, v122
  s_add_u32 s51, s50, 6
  s_and_b32 s51, s51, 7
  s_lshl_b32 s51, s51, 15
  s_add_u32 s51, s51, s95
  buffer_load_dword v111, v122, s[32:35], s51 offen sc1
  s_waitcnt vmcnt(0)
  s_lshl_b32 s91, s50, 8
  s_add_u32 s91, s91, s56
  s_and_b32 s90, s50, 7
  s_lshl_b32 s90, s90, 15
  s_add_u32 s90, s90, s55
  s_branch LPFf_poll
LPFf_chk:
  v_cmp_eq_u32 vcc, 0, v111
  s_cbranch_vccnz LPFf_again
  s_add_u32 m0, s89, 0
  s_add_u32 s94, s90, 16384
  buffer_load_dwordx4 v101, s[32:35], s90 offen offset:0 sc1 lds
  s_add_u32 m0, s89, 7936
  s_nop 0
  buffer_load_dwordx4 v101, s[32:35], s90 offen offset:256 sc1 lds
  s_add_u32 m0, s89, 15872
  s_nop 0
  buffer_load_dwordx4 v101, s[32:35], s90 offen offset:512 sc1 lds
  s_add_u32 m0, s89, 23808
  s_nop 0
  buffer_load_dwordx4 v101, s[32:35], s90 offen offset:768 sc1 lds
  s_add_u32 m0, s89, 4096
  s_nop 0
  buffer_load_dwordx4 v101, s[32:35], s94 offen offset:0 sc1 lds
  s_add_u32 m0, s89, 12032
  s_nop 0
  buffer_load_dwordx4 v101, s[32:35], s94 offen offset:256 sc1 lds
  s_add_u32 m0, s89, 19968
  s_nop 0
  buffer_load_dwordx4 v101, s[32:35], s94 offen offset:512 sc1 lds
  s_add_u32 m0, s89, 27904
  s_nop 0
  buffer_load_dwordx4 v101, s[32:35], s94 offen offset:768 sc1 lds
  s_lshr_b32 s66, s50, 3
  s_add_u32 s66, s66, 1
  s_waitcnt vmcnt(4)
  s_barrier
  ds_read_b128 v[0:3], v97 offset:0
  ds_read_b128 v[4:7], v98 offset:0
  ds_read_b128 v[8:11], v99 offset:0
  s_waitcnt lgkmcnt(2)
  v_mfma_f32_16x16x32_bf16 v[40:43], a[0:3], v[0:3], 0
  ds_read_b128 v[12:15], v100 offset:0
  v_mfma_f32_16x16x32_bf16 v[44:47], a[4:7], v[0:3], 0
  v_xor_b32 v120, s66, v0
  v_mfma_f32_16x16x32_bf16 v[48:51], a[8:11], v[0:3], 0
  s_waitcnt lgkmcnt(2)
  s_and_b32 s65, s50, 3
  s_lshl_b32 s65, s65, 18
  v_mfma_f32_16x16x32_bf16 v[40:43], a[12:15], v[4:7], v[40:43]
  ds_read_b128 v[0:3], v97 offset:8192
  s_add_u32 s65, s65, s57
  s_lshr_b32 s54, s50, 2
  v_mfma_f32_16x16x32_bf16 v[44:47], a[16:19], v[4:7], v[44:47]
  v_bitop3_b32 v120, v120, v4, s66 bitop3:246
  s_add_u32 s54, s54, 1
  v_mfma_f32_16x16x32_bf16 v[48:51], a[20:23], v[4:7], v[48:51]
  s_waitcnt lgkmcnt(2)
  v_mfma_f32_16x16x32_bf16 v[40:43], a[24:27], v[8:11], v[40:43]
  ds_read_b128 v[4:7], v98 offset:8192
  v_mfma_f32_16x16x32_bf16 v[44:47], a[28:31], v[8:11], v[44:47]
  v_bitop3_b32 v120, v120, v8, s66 bitop3:246
  v_mfma_f32_16x16x32_bf16 v[48:51], a[32:35], v[8:11], v[48:51]
  s_waitcnt lgkmcnt(2)
  v_mfma_f32_16x16x32_bf16 v[40:43], a[36:39], v[12:15], v[40:43]
  ds_read_b128 v[8:11], v99 offset:8192
  v_mfma_f32_16x16x32_bf16 v[44:47], a[40:43], v[12:15], v[44:47]
  v_bitop3_b32 v120, v120, v12, s66 bitop3:246
  v_mfma_f32_16x16x32_bf16 v[48:51], a[44:47], v[12:15], v[48:51]
  s_waitcnt lgkmcnt(2)
  v_mfma_f32_16x16x32_bf16 v[40:43], a[48:51], v[0:3], v[40:43]
  ds_read_b128 v[12:15], v100 offset:8192
  v_mfma_f32_16x16x32_bf16 v[44:47], a[52:55], v[0:3], v[44:47]
  v_bitop3_b32 v120, v120, v0, s66 bitop3:246
  v_mfma_f32_16x16x32_bf16 v[48:51], a[56:59], v[0:3], v[48:51]
  s_waitcnt lgkmcnt(2)
  v_mfma_f32_16x16x32_bf16 v[40:43], a[60:63], v[4:7], v[40:43]
  ds_read_b128 v[0:3], v97 offset:16384
  v_mfma_f32_16x16x32_bf16 v[44:47], a[64:67], v[4:7], v[44:47]
  v_bitop3_b32 v120, v120, v4, s66 bitop3:246
  v_mfma_f32_16x16x32_bf16 v[48:51], a[68:71], v[4:7], v[48:51]
  s_waitcnt lgkmcnt(2)
  v_mfma_f32_16x16x32_bf16 v[40:43], a[72:75], v[8:11], v[40:43]
  ds_read_b128 v[4:7], v98 offset:16384
  v_mfma_f32_16x16x32_bf16 v[44:47], a[76:79], v[8:11], v[44:47]
  v_bitop3_b32 v120, v120, v8, s66 bitop3:246
  v_mfma_f32_16x16x32_bf16 v[48:51], a[80:83], v[8:11], v[48:51]
  s_waitcnt lgkmcnt(2)
  v_mfma_f32_16x16x32_bf16 v[40:43], a[84:87], v[12:15], v[40:43]
  ds_read_b128 v[8:11], v99 offset:16384
  v_mfma_f32_16x16x32_bf16 v[44:47], a[88:91], v[12:15], v[44:47]
  v_bitop3_b32 v120, v120, v12, s66 bitop3:246
  v_mfma_f32_16x16x32_bf16 v[48:51], a[92:95], v[12:15], v[48:51]
  s_waitcnt lgkmcnt(2)
  v_mfma_f32_16x16x32_bf16 v[40:43], a[96:99], v[0:3], v[40:43]
  ds_read_b128 v[12:15], v100 offset:16384
  v_mfma_f32_16x16x32_bf16 v[44:47], a[100:103], v[0:3], v[44:47]
  v_bitop3_b32 v120, v120, v0, s66 bitop3:246
  v_mfma_f32_16x16x32_bf16 v[48:51], a[104:107], v[0:3], v[48:51]
  s_waitcnt lgkmcnt(2)
  v_mfma_f32_16x16x32_bf16 v[40:43], a[108:111], v[4:7], v[40:43]
  ds_read_b128 v[0:3], v97 offset:24576
  v_mfma_f32_16x16x32_bf16 v[44:47], a[112:115], v[4:7], v[44:47]
  v_bitop3_b32 v120, v120, v4, s66 bitop3:246
  v_mfma_f32_16x16x32_bf16 v[48:51], a[116:119], v[4:7], v[48:51]
  s_waitcnt lgkmcnt(2)
  v_mfma_f32_16x16x32_bf16 v[40:43], a[120:123], v[8:11], v[40:43]
  s_waitcnt vmcnt(0)
  s_barrier
  ds_read_b128 v[4:7], v98 offset:24576
  v_mfma_f32_16x16x32_bf16 v[44:47], a[124:127], v[8:11], v[44:47]
  v_bitop3_b32 v120, v120, v8, s66 bitop3:246
  v_mfma_f32_16x16x32_bf16 v[48:51], a[128:131], v[8:11], v[48:51]
  s_waitcnt lgkmcnt(2)
  s_branch LPFf_join
LPFf_go:
  s_lshr_b32 s66, s50, 3
  s_add_u32 s66, s66, 1
  s_waitcnt vmcnt(4)
  s_barrier
  ds_read_b128 v[0:3], v97 offset:0
  ds_read_b128 v[4:7], v98 offset:0
  ds_read_b128 v[8:11], v99 offset:0
  s_waitcnt lgkmcnt(2)
  v_mfma_f32_16x16x32_bf16 v[40:43], a[0:3], v[0:3], 0
  ds_read_b128 v[12:15], v100 offset:0
  v_mfma_f32_16x16x32_bf16 v[44:47], a[4:7], v[0:3], 0
  v_xor_b32 v120, s66, v0
  v_mfma_f32_16x16x32_bf16 v[48:51], a[8:11], v[0:3], 0
  s_waitcnt lgkmcnt(2)
  buffer_store_dwordx4 v[124:127], v123, s[32:35], s86 offen sc1
  v_mfma_f32_16x16x32_bf16 v[40:43], a[12:15], v[4:7], v[40:43]
  ds_read_b128 v[0:3], v97 offset:8192
  v_mfma_f32_16x16x32_bf16 v[44:47], a[16:19], v[4:7], v[44:47]
  v_bitop3_b32 v120, v120, v4, s66 bitop3:246
  v_mfma_f32_16x16x32_bf16 v[48:51], a[20:23], v[4:7], v[48:51]
  s_waitcnt lgkmcnt(2)
  s_mov_b64 exec, 1
  buffer_store_dword v110, off, s[32:35], s93 sc1
  s_mov_b64 exec, -1
  v_mfma_f32_16x16x32_bf16 v[40:43], a[24:27], v[8:11], v[40:43]
  ds_read_b128 v[4:7], v98 offset:8192
  v_mfma_f32_16x16x32_bf16 v[44:47], a[28:31], v[8:11], v[44:47]
  v_bitop3_b32 v120, v120, v8, s66 bitop3:246
  v_mfma_f32_16x16x32_bf16 v[48:51], a[32:35], v[8:11], v[48:51]
  s_waitcnt lgkmcnt(2)
  buffer_store_dwordx2 v[116:117], v103, s[36:39], s64 offen
  v_mfma_f32_16x16x32_bf16 v[40:43], a[36:39], v[12:15], v[40:43]
  ds_read_b128 v[8:11], v99 offset:8192
  v_mfma_f32_16x16x32_bf16 v[44:47], a[40:43], v[12:15], v[44:47]
  v_bitop3_b32 v120, v120, v12, s66 bitop3:246
  s_add_u32 s87, s64, s60
  v_mfma_f32_16x16x32_bf16 v[48:51], a[44:47], v[12:15], v[48:51]
  s_waitcnt lgkmcnt(2)
  v_mfma_f32_16x16x32_bf16 v[40:43], a[48:51], v[0:3], v[40:43]
  ds_read_b128 v[12:15], v100 offset:8192
  v_mfma_f32_16x16x32_bf16 v[44:47], a[52:55], v[0:3], v[44:47]
  v_bitop3_b32 v120, v120, v0, s66 bitop3:246
  v_mfma_f32_16x16x32_bf16 v[48:51], a[56:59], v[0:3], v[48:51]
  s_waitcnt lgkmcnt(2)
  buffer_store_dwordx2 v[116:117], v103, s[32:35], s87 offen sc1
  v_mfma_f32_16x16x32_bf16 v[40:43], a[60:63], v[4:7], v[40:43]
  ds_read_b128 v[0:3], v97 offset:16384
  v_mfma_f32_16x16x32_bf16 v[44:47], a[64:67], v[4:7], v[44:47]
  v_bitop3_b32 v120, v120, v4, s66 bitop3:246
  v_mfma_f32_16x16x32_bf16 v[48:51], a[68:71], v[4:7], v[48:51]
  s_waitcnt lgkmcnt(2)
  buffer_store_dwordx2 v[112:113], v103, s[36:39], s84 offen
  v_mfma_f32_16x16x32_bf16 v[40:43], a[72:75], v[8:11], v[40:43]
  ds_read_b128 v[4:7], v98 offset:16384
  v_mfma_f32_16x16x32_bf16 v[44:47], a[76:79], v[8:11], v[44:47]
  v_bitop3_b32 v120, v120, v8, s66 bitop3:246
  s_add_u32 s86, s84, s60
  v_mfma_f32_16x16x32_bf16 v[48:51], a[80:83], v[8:11], v[48:51]
  s_waitcnt lgkmcnt(2)
  v_mfma_f32_16x16x32_bf16 v[40:43], a[84:87], v[12:15], v[40:43]
  ds_read_b128 v[8:11], v99 offset:16384
  v_mfma_f32_16x16x32_bf16 v[44:47], a[88:91], v[12:15], v[44:47]
  v_bitop3_b32 v120, v120, v12, s66 bitop3:246
  v_mfma_f32_16x16x32_bf16 v[48:51], a[92:95], v[12:15], v[48:51]
  s_waitcnt lgkmcnt(2)
  buffer_store_dwordx2 v[112:113], v103, s[32:35], s86 offen sc1
  v_mfma_f32_16x16x32_bf16 v[40:43], a[96:99], v[0:3], v[40:43]
  ds_read_b128 v[12:15], v100 offset:16384
  s_and_b32 s65, s50, 3
  s_lshl_b32 s65, s65, 18
  v_mfma_f32_16x16x32_bf16 v[44:47], a[100:103], v[0:3], v[44:47]
  v_bitop3_b32 v120, v120, v0, s66 bitop3:246
  s_add_u32 s65, s65, s57
  v_mfma_f32_16x16x32_bf16 v[48:51], a[104:107], v[0:3], v[48:51]
  s_waitcnt lgkmcnt(2)
  s_lshr_b32 s54, s50, 2
  s_add_u32 s54, s54, 1
  v_mfma_f32_16x16x32_bf16 v[40:43], a[108:111], v[4:7], v[40:43]
  ds_read_b128 v[0:3], v97 offset:24576
  v_mfma_f32_16x16x32_bf16 v[44:47], a[112:115], v[4:7], v[44:47]
  v_bitop3_b32 v120, v120, v4, s66 bitop3:246
  v_mfma_f32_16x16x32_bf16 v[48:51], a[116:119], v[4:7], v[48:51]
  s_waitcnt lgkmcnt(2)
  v_mfma_f32_16x16x32_bf16 v[40:43], a[120:123], v[8:11], v[40:43]
  s_waitcnt vmcnt(6)
  s_barrier
  ds_read_b128 v[4:7], v98 offset:24576
  v_mfma_f32_16x16x32_bf16 v[44:47], a[124:127], v[8:11], v[44:47]
  v_bitop3_b32 v120, v120, v8, s66 bitop3:246
  v_mfma_f32_16x16x32_bf16 v[48:51], a[128:131], v[8:11], v[48:51]
  s_waitcnt lgkmcnt(2)
LPFf_join:
  v_mfma_f32_16x16x32_bf16 v[40:43], a[132:135], v[12:15], v[40:43]
  ds_read_b128 v[8:11], v99 offset:24576
  v_mfma_f32_16x16x32_bf16 v[44:47], a[136:139], v[12:15], v[44:47]
  v_bitop3_b32 v120, v120, v12, s66 bitop3:246
  v_mfma_f32_16x16x32_bf16 v[48:51], a[140:143], v[12:15], v[48:51]
  s_waitcnt lgkmcnt(2)
  s_mov_b64 exec, 1
  buffer_store_dword v110, off, s[32:35], s88
  s_mov_b64 exec, -1
  v_mfma_f32_16x16x32_bf16 v[40:43], a[144:147], v[0:3], v[40:43]
  ds_read_b128 v[12:15], v100 offset:24576
  s_add_u32 s88, s88, 4096
  s_cmp_ge_u32 s50, 56
  s_cselect_b32 s88, 1073741824, s88
  v_mfma_f32_16x16x32_bf16 v[44:47], a[148:151], v[0:3], v[44:47]
  v_bitop3_b32 v120, v120, v0, s66 bitop3:246
  v_lshlrev_b32 v122, 3, v96
  v_mfma_f32_16x16x32_bf16 v[48:51], a[152:155], v[0:3], v[48:51]
  s_waitcnt lgkmcnt(2)
  v_and_b32 v122, 0x380, v122
  s_add_u32 s51, s50, 2
  v_mfma_f32_16x16x32_bf16 v[40:43], a[156:159], v[4:7], v[40:43]
  ds_read_b128 v[0:3], v97 offset:4096
  s_and_b32 s51, s51, 7
  s_lshl_b32 s51, s51, 15
  v_mfma_f32_16x16x32_bf16 v[44:47], a[160:163], v[4:7], v[44:47]
  v_bitop3_b32 v120, v120, v4, s66 bitop3:246
  s_add_u32 s51, s51, s95
  v_mfma_f32_16x16x32_bf16 v[48:51], a[164:167], v[4:7], v[48:51]
  s_waitcnt lgkmcnt(2)
  buffer_load_dword v111, v122, s[32:35], s51 offen sc1
  v_mfma_f32_16x16x32_bf16 v[40:43], a[168:171], v[8:11], v[40:43]
  ds_read_b128 v[4:7], v98 offset:4096
  buffer_load_dword v111, v108, s[32:35], s91 offen offset:512 sc1
  v_mfma_f32_16x16x32_bf16 v[44:47], a[172:175], v[8:11], v[44:47]
  v_bitop3_b32 v120, v120, v8, s66 bitop3:246
  v_mfma_f32_16x16x32_bf16 v[48:51], a[176:179], v[8:11], v[48:51]
  s_waitcnt lgkmcnt(2)
  v_mfma_f32_16x16x32_bf16 v[40:43], a[180:183], v[12:15], v[40:43]
  ds_read_b128 v[8:11], v99 offset:4096
  v_mfma_f32_16x16x32_bf16 v[44:47], a[184:187], v[12:15], v[44:47]
  v_bitop3_b32 v120, v120, v12, s66 bitop3:246
  v_mfma_f32_16x16x32_bf16 v[48:51], a[188:191], v[12:15], v[48:51]
  s_waitcnt lgkmcnt(2)
  v_mfma_f32_16x16x32_bf16 v[52:55], a[0:3], v[0:3], 0
  ds_read_b128 v[12:15], v100 offset:4096
  v_mfma_f32_16x16x32_bf16 v[56:59], a[4:7], v[0:3], 0
  v_bitop3_b32 v120, v120, v0, s66 bitop3:246
  v_mfma_f32_16x16x32_bf16 v[60:63], a[8:11], v[0:3], 0
  s_waitcnt lgkmcnt(2)
  v_max_f32 v40, 0, v40
  v_max_f32 v41, 0, v41
  v_mfma_f32_16x16x32_bf16 v[52:55], a[12:15], v[4:7], v[52:55]
  ds_read_b128 v[0:3], v97 offset:12288
  v_max_f32 v42, 0, v42
  v_max_f32 v43, 0, v43
  v_mfma_f32_16x16x32_bf16 v[56:59], a[16:19], v[4:7], v[56:59]
  v_bitop3_b32 v120, v120, v4, s66 bitop3:246
  v_max_f32 v44, 0, v44
  v_mfma_f32_16x16x32_bf16 v[60:63], a[20:23], v[4:7], v[60:63]
  s_waitcnt lgkmcnt(2)
  v_max_f32 v45, 0, v45
  v_max_f32 v46, 0, v46
  v_mfma_f32_16x16x32_bf16 v[52:55], a[24:27], v[8:11], v[52:55]
  ds_read_b128 v[4:7], v98 offset:12288
  v_max_f32 v47, 0, v47
  v_cvt_pk_bf16_f32 v112, v40, v41
  v_mfma_f32_16x16x32_bf16 v[56:59], a[28:31], v[8:11], v[56:59]
  v_bitop3_b32 v120, v120, v8, s66 bitop3:246
  v_cvt_pk_bf16_f32 v113, v42, v43
  v_mfma_f32_16x16x32_bf16 v[60:63], a[32:35], v[8:11], v[60:63]
  s_waitcnt lgkmcnt(2)
  v_cvt_pk_bf16_f32 v114, v44, v45
  v_cvt_pk_bf16_f32 v115, v46, v47
  v_mfma_f32_16x16x32_bf16 v[52:55], a[36:39], v[12:15], v[52:55]
  ds_read_b128 v[8:11], v99 offset:12288
  ds_write_b128 v107, v[112:115] offset:0
  v_mfma_f32_16x16x32_bf16 v[56:59], a[40:43], v[12:15], v[56:59]
  v_bitop3_b32 v120, v120, v12, s66 bitop3:246
  v_max_f32 v48, 0, v48
  v_mfma_f32_16x16x32_bf16 v[60:63], a[44:47], v[12:15], v[60:63]
  s_waitcnt lgkmcnt(3)
  v_max_f32 v49, 0, v49
  v_max_f32 v50, 0, v50
  v_mfma_f32_16x16x32_bf16 v[52:55], a[48:51], v[0:3], v[52:55]
  ds_read_b128 v[12:15], v100 offset:12288
  v_max_f32 v51, 0, v51
  v_cvt_pk_bf16_f32 v116, v48, v49
  v_mfma_f32_16x16x32_bf16 v[56:59], a[52:55], v[0:3], v[56:59]
  v_bitop3_b32 v120, v120, v0, s66 bitop3:246
  v_cvt_pk_bf16_f32 v117, v50, v51
  v_mfma_f32_16x16x32_bf16 v[60:63], a[56:59], v[0:3], v[60:63]
  s_waitcnt lgkmcnt(3)
  ds_write_b64 v109, v[116:117] offset:1024
  v_mfma_f32_16x16x32_bf16 v[52:55], a[60:63], v[4:7], v[52:55]
  ds_read_b128 v[0:3], v97 offset:20480
  v_mfma_f32_16x16x32_bf16 v[56:59], a[64:67], v[4:7], v[56:59]
  v_bitop3_b32 v120, v120, v4, s66 bitop3:246
  v_mfma_f32_16x16x32_bf16 v[60:63], a[68:71], v[4:7], v[60:63]
  s_waitcnt lgkmcnt(4)
  v_mfma_f32_16x16x32_bf16 v[52:55], a[72:75], v[8:11], v[52:55]
  ds_read_b128 v[4:7], v98 offset:20480
  v_mfma_f32_16x16x32_bf16 v[56:59], a[76:79], v[8:11], v[56:59]
  v_bitop3_b32 v120, v120, v8, s66 bitop3:246
  v_mfma_f32_16x16x32_bf16 v[60:63], a[80:83], v[8:11], v[60:63]
  s_waitcnt lgkmcnt(3)
  s_waitcnt lgkmcnt(2)
  v_mfma_f32_16x16x32_bf16 v[52:55], a[84:87], v[12:15], v[52:55]
  ds_read_b128 v[8:11], v99 offset:20480
  s_barrier
  v_mfma_f32_16x16x32_bf16 v[56:59], a[88:91], v[12:15], v[56:59]
  v_bitop3_b32 v120, v120, v12, s66 bitop3:246
  v_mfma_f32_16x16x32_bf16 v[60:63], a[92:95], v[12:15], v[60:63]
  s_waitcnt lgkmcnt(2)
  ds_read_b128 v[16:19], v110 offset:0
  v_mfma_f32_16x16x32_bf16 v[52:55], a[96:99], v[0:3], v[52:55]
  ds_read_b128 v[12:15], v100 offset:20480
  v_mfma_f32_16x16x32_bf16 v[56:59], a[100:103], v[0:3], v[56:59]
  v_bitop3_b32 v120, v120, v0, s66 bitop3:246
  ds_read_b128 v[20:23], v110 offset:1024
  v_mfma_f32_16x16x32_bf16 v[60:63], a[104:107], v[0:3], v[60:63]
  s_waitcnt lgkmcnt(4)
  v_mfma_f32_16x16x32_bf16 v[52:55], a[108:111], v[4:7], v[52:55]
  ds_read_b128 v[0:3], v97 offset:28672
  ds_read_b128 v[24:27], v110 offset:2048
  v_mfma_f32_16x16x32_bf16 v[56:59], a[112:115], v[4:7], v[56:59]
  v_bitop3_b32 v120, v120, v4, s66 bitop3:246
  v_mfma_f32_16x16x32_bf16 v[60:63], a[116:119], v[4:7], v[60:63]
  s_waitcnt lgkmcnt(5)
  ds_read_b128 v[28:31], v110 offset:3072
  v_mfma_f32_16x16x32_bf16 v[52:55], a[120:123], v[8:11], v[52:55]
  ds_read_b128 v[4:7], v98 offset:28672
  v_mfma_f32_16x16x32_bf16 v[56:59], a[124:127], v[8:11], v[56:59]
  v_bitop3_b32 v120, v120, v8, s66 bitop3:246
  ds_read_b128 v[32:35], v110 offset:4096
  v_mfma_f32_16x16x32_bf16 v[60:63], a[128:131], v[8:11], v[60:63]
  s_waitcnt lgkmcnt(6)
  v_mfma_f32_16x16x32_bf16 v[52:55], a[132:135], v[12:15], v[52:55]
  ds_read_b128 v[8:11], v99 offset:28672
  ds_read_b128 v[36:39], v110 offset:5120
  v_mfma_f32_16x16x32_bf16 v[56:59], a[136:139], v[12:15], v[56:59]
  v_bitop3_b32 v120, v120, v12, s66 bitop3:246
  v_mfma_f32_16x16x32_bf16 v[60:63], a[140:143], v[12:15], v[60:63]
  s_waitcnt lgkmcnt(6)
  v_mfma_f32_16x16x32_bf16 v[52:55], a[144:147], v[0:3], v[52:55]
  ds_read_b128 v[12:15], v100 offset:28672
  v_mfma_f32_16x16x32_bf16 v[56:59], a[148:151], v[0:3], v[56:59]
  v_bitop3_b32 v120, v120, v0, s66 bitop3:246
  v_mfma_f32_16x16x32_bf16 v[60:63], a[152:155], v[0:3], v[60:63]
  s_waitcnt lgkmcnt(4)
  v_mfma_f32_16x16x32_bf16 v[52:55], a[156:159], v[4:7], v[52:55]
  v_mfma_f32_16x16x32_bf16 v[56:59], a[160:163], v[4:7], v[56:59]
  v_bitop3_b32 v120, v120, v4, s66 bitop3:246
  v_mfma_f32_16x16x32_bf16 v[60:63], a[164:167], v[4:7], v[60:63]
  s_waitcnt lgkmcnt(2)
  v_mfma_f32_16x16x32_bf16 v[52:55], a[168:171], v[8:11], v[52:55]
  v_mfma_f32_16x16x32_bf16 v[56:59], a[172:175], v[8:11], v[56:59]
  v_bitop3_b32 v120, v120, v8, s66 bitop3:246
  v_mfma_f32_16x16x32_bf16 v[60:63], a[176:179], v[8:11], v[60:63]
  s_waitcnt lgkmcnt(0)
  v_mfma_f32_16x16x32_bf16 v[52:55], a[180:183], v[12:15], v[52:55]
  v_mfma_f32_16x16x32_bf16 v[56:59], a[184:187], v[12:15], v[56:59]
  v_bitop3_b32 v120, v120, v12, s66 bitop3:246
  v_mfma_f32_16x16x32_bf16 v[60:63], a[188:191], v[12:15], v[60:63]
  v_and_b32 v120, 1, v120
  v_cmp_ne_u32 vcc, 0, v120
  v_mfma_f32_16x16x32_bf16 v[64:67], v[16:19], a[192:195], 0
  s_cbranch_vccnz LPFf_redo
  s_mov_b32 s92, s50
  s_add_u32 s50, s50, 2
  v_mfma_f32_16x16x32_bf16 v[68:71], v[16:19], a[196:199], 0
  s_lshl_b32 s91, s50, 8
  s_add_u32 s91, s91, s56
  s_and_b32 s90, s50, 7
  v_mfma_f32_16x16x32_bf16 v[72:75], v[16:19], a[200:203], 0
  s_lshl_b32 s90, s90, 15
  s_add_u32 s90, s90, s55
  v_mfma_f32_16x16x32_bf16 v[76:79], v[16:19], a[204:207], 0
  buffer_load_dword v111, v108, s[32:35], s91 offen sc1
  v_max_f32 v52, 0, v52
  v_mfma_f32_16x16x32_bf16 v[64:67], v[20:23], a[208:211], v[64:67]
  v_max_f32 v53, 0, v53
  v_max_f32 v54, 0, v54
  v_mfma_f32_16x16x32_bf16 v[68:71], v[20:23], a[212:215], v[68:71]
  v_max_f32 v55, 0, v55
  v_max_f32 v56, 0, v56
  v_mfma_f32_16x16x32_bf16 v[72:75], v[20:23], a[216:219], v[72:75]
  v_max_f32 v57, 0, v57
  v_max_f32 v58, 0, v58
  v_mfma_f32_16x16x32_bf16 v[76:79], v[20:23], a[220:223], v[76:79]
  v_max_f32 v59, 0, v59
  v_cvt_pk_bf16_f32 v112, v52, v53
  v_mfma_f32_16x16x32_bf16 v[64:67], v[24:27], a[224:227], v[64:67]
  v_cvt_pk_bf16_f32 v113, v54, v55
  v_cvt_pk_bf16_f32 v114, v56, v57
  v_mfma_f32_16x16x32_bf16 v[68:71], v[24:27], a[228:231], v[68:71]
  v_cvt_pk_bf16_f32 v115, v58, v59
  v_mfma_f32_16x16x32_bf16 v[72:75], v[24:27], a[232:235], v[72:75]
  ds_write_b128 v107, v[112:115] offset:6144
  v_mfma_f32_16x16x32_bf16 v[76:79], v[24:27], a[236:239], v[76:79]
  v_max_f32 v60, 0, v60
  v_max_f32 v61, 0, v61
  v_mfma_f32_16x16x32_bf16 v[64:67], v[28:31], a[240:243], v[64:67]
  v_max_f32 v62, 0, v62
  v_max_f32 v63, 0, v63
  v_mfma_f32_16x16x32_bf16 v[68:71], v[28:31], a[244:247], v[68:71]
  v_cvt_pk_bf16_f32 v116, v60, v61
  v_cvt_pk_bf16_f32 v117, v62, v63
  v_mfma_f32_16x16x32_bf16 v[72:75], v[28:31], a[248:251], v[72:75]
  ds_write_b64 v109, v[116:117] offset:7168
  s_lshl_b32 s84, s92, 15
  v_mfma_f32_16x16x32_bf16 v[76:79], v[28:31], a[252:255], v[76:79]
  s_and_b32 s86, s92, 3
  s_lshl_b32 s86, s86, 18
  s_add_u32 s86, s86, s58
  v_mfma_f32_16x16x32_bf16 v[64:67], v[32:35], v[128:131], v[64:67]
  s_lshr_b32 s85, s92, 2
  s_add_u32 s85, s85, 1
  s_and_b32 s67, s92, 7
  v_mfma_f32_16x16x32_bf16 v[68:71], v[32:35], v[132:135], v[68:71]
  s_lshl_b32 s67, s67, 16
  s_add_u32 s67, s67, s59
  s_add_u32 s52, s67, 0
  v_mfma_f32_16x16x32_bf16 v[72:75], v[32:35], v[136:139], v[72:75]
  buffer_load_dwordx4 v[44:47], v96, s[32:35], s52 offen sc1
  s_add_u32 s52, s67, 32768
  v_mfma_f32_16x16x32_bf16 v[76:79], v[32:35], v[140:143], v[76:79]
  buffer_load_dwordx4 v[52:55], v96, s[32:35], s52 offen sc1
  v_mfma_f32_16x16x32_bf16 v[64:67], v[36:39], v[144:147], v[64:67]
  s_waitcnt lgkmcnt(0)
  s_barrier
  v_mfma_f32_16x16x32_bf16 v[68:71], v[36:39], v[148:151], v[68:71]
  v_mfma_f32_16x16x32_bf16 v[72:75], v[36:39], v[152:155], v[72:75]
  s_waitcnt vmcnt(2)
  v_cmp_eq_u32 vcc, 0, v111
  v_mfma_f32_16x16x32_bf16 v[76:79], v[36:39], v[156:159], v[76:79]
  v_mfma_f32_16x16x32_bf16 v[80:83], v[16:19], v[160:163], 0
  s_mov_b32 s83, 0
  s_cmp_ge_u32 s50, 64
  s_cselect_b64 vcc, -1, vcc
  v_mfma_f32_16x16x32_bf16 v[84:87], v[16:19], v[164:167], 0
  s_cbranch_vccz LPFf_E
  v_mfma_f32_16x16x32_bf16 v[88:91], v[16:19], v[168:171], 0
  v_mfma_f32_16x16x32_bf16 v[92:95], v[16:19], v[172:175], 0
  ds_read_b128 v[16:19], v110 offset:6144
  v_cvt_pk_bf16_f32 v112, v64, v68
  v_cvt_pk_bf16_f32 v113, v72, v76
  v_mfma_f32_16x16x32_bf16 v[80:83], v[20:23], v[176:179], v[80:83]
  v_cvt_pk_bf16_f32 v114, v65, v69
  v_cvt_pk_bf16_f32 v115, v73, v77
  v_mfma_f32_16x16x32_bf16 v[84:87], v[20:23], v[180:183], v[84:87]
  v_bfi_b32 v112, 1, s54, v112
  v_mfma_f32_16x16x32_bf16 v[88:91], v[20:23], v[184:187], v[88:91]
  s_add_u32 s51, s65, 0
  buffer_store_dwordx4 v[112:115], v102, s[32:35], s51 offen offset:0
  v_mfma_f32_16x16x32_bf16 v[92:95], v[20:23], v[188:191], v[92:95]
  ds_read_b128 v[20:23], v110 offset:7168
  v_mfma_f32_16x16x32_bf16 v[80:83], v[24:27], v[192:195], v[80:83]
  v_cvt_pk_bf16_f32 v116, v66, v70
  v_cvt_pk_bf16_f32 v117, v74, v78
  v_mfma_f32_16x16x32_bf16 v[84:87], v[24:27], v[196:199], v[84:87]
  v_cvt_pk_bf16_f32 v118, v67, v71
  v_cvt_pk_bf16_f32 v119, v75, v79
  v_mfma_f32_16x16x32_bf16 v[88:91], v[24:27], v[200:203], v[88:91]
  v_bfi_b32 v116, 1, s54, v116
  v_mfma_f32_16x16x32_bf16 v[92:95], v[24:27], v[204:207], v[92:95]
  ds_read_b128 v[24:27], v110 offset:8192
  s_add_u32 s51, s65, 16384
  buffer_store_dwordx4 v[116:119], v102, s[32:35], s51 offen offset:0
  v_mfma_f32_16x16x32_bf16 v[80:83], v[28:31], v[208:211], v[80:83]
  v_mfma_f32_16x16x32_bf16 v[84:87], v[28:31], v[212:215], v[84:87]
  s_lshl_b32 s64, s92, 15
  s_add_u32 s64, s64, 16384
  s_and_b32 s87, s92, 3
  v_mfma_f32_16x16x32_bf16 v[88:91], v[28:31], v[216:219], v[88:91]
  s_lshl_b32 s87, s87, 18
  s_add_u32 s87, s87, s58
  s_add_u32 s87, s87, 131072
  v_mfma_f32_16x16x32_bf16 v[92:95], v[28:31], v[220:223], v[92:95]
  ds_read_b128 v[28:31], v110 offset:9216
  v_mfma_f32_16x16x32_bf16 v[80:83], v[32:35], v[224:227], v[80:83]
  v_mfma_f32_16x16x32_bf16 v[84:87], v[32:35], v[228:231], v[84:87]
  v_mfma_f32_16x16x32_bf16 v[88:91], v[32:35], v[232:235], v[88:91]
  v_mfma_f32_16x16x32_bf16 v[92:95], v[32:35], v[236:239], v[92:95]
  ds_read_b128 v[32:35], v110 offset:10240
  v_mfma_f32_16x16x32_bf16 v[80:83], v[36:39], v[240:243], v[80:83]
  v_mfma_f32_16x16x32_bf16 v[84:87], v[36:39], v[244:247], v[84:87]
  v_mfma_f32_16x16x32_bf16 v[88:91], v[36:39], v[248:251], v[88:91]
  v_mfma_f32_16x16x32_bf16 v[92:95], v[36:39], v[252:255], v[92:95]
  ds_read_b128 v[36:39], v110 offset:11264
  s_waitcnt lgkmcnt(5)
  v_mfma_f32_16x16x32_bf16 v[64:67], v[16:19], a[192:195], 0
  v_mfma_f32_16x16x32_bf16 v[68:71], v[16:19], a[196:199], 0
  v_mfma_f32_16x16x32_bf16 v[72:75], v[16:19], a[200:203], 0
  v_mfma_f32_16x16x32_bf16 v[76:79], v[16:19], a[204:207], 0
  s_waitcnt lgkmcnt(4)
  v_cvt_pk_bf16_f32 v112, v80, v84
  v_cvt_pk_bf16_f32 v113, v88, v92
  v_mfma_f32_16x16x32_bf16 v[64:67], v[20:23], a[208:211], v[64:67]
  v_cvt_pk_bf16_f32 v114, v81, v85
  v_cvt_pk_bf16_f32 v115, v89, v93
  v_mfma_f32_16x16x32_bf16 v[68:71], v[20:23], a[212:215], v[68:71]
  v_bfi_b32 v112, 1, s54, v112
  v_mfma_f32_16x16x32_bf16 v[72:75], v[20:23], a[216:219], v[72:75]
  s_add_u32 s51, s65, 0
  buffer_store_dwordx4 v[112:115], v102, s[32:35], s51 offen offset:2048
  v_mfma_f32_16x16x32_bf16 v[76:79], v[20:23], a[220:223], v[76:79]
  s_waitcnt lgkmcnt(3)
  v_cvt_pk_bf16_f32 v116, v82, v86
  v_cvt_pk_bf16_f32 v117, v90, v94
  v_mfma_f32_16x16x32_bf16 v[64:67], v[24:27], a[224:227], v[64:67]
  v_cvt_pk_bf16_f32 v118, v83, v87
  v_cvt_pk_bf16_f32 v119, v91, v95
  v_mfma_f32_16x16x32_bf16 v[68:71], v[24:27], a[228:231], v[68:71]
  v_bfi_b32 v116, 1, s54, v116
  v_mfma_f32_16x16x32_bf16 v[72:75], v[24:27], a[232:235], v[72:75]
  s_add_u32 s51, s65, 16384
  buffer_store_dwordx4 v[116:119], v102, s[32:35], s51 offen offset:2048
  v_mfma_f32_16x16x32_bf16 v[76:79], v[24:27], a[236:239], v[76:79]
  s_waitcnt lgkmcnt(2)
  v_mfma_f32_16x16x32_bf16 v[64:67], v[28:31], a[240:243], v[64:67]
  v_mfma_f32_16x16x32_bf16 v[68:71], v[28:31], a[244:247], v[68:71]
  v_mfma_f32_16x16x32_bf16 v[72:75], v[28:31], a[248:251], v[72:75]
  v_add_u32 v122, 78400, v96
  ds_read_b128 v[56:59], v122
  v_mfma_f32_16x16x32_bf16 v[76:79], v[28:31], a[252:255], v[76:79]
  s_waitcnt lgkmcnt(2)
  ds_read_b128 v[60:63], v122 offset:1024
  v_mfma_f32_16x16x32_bf16 v[64:67], v[32:35], v[128:131], v[64:67]
  v_mfma_f32_16x16x32_bf16 v[68:71], v[32:35], v[132:135], v[68:71]
  v_mfma_f32_16x16x32_bf16 v[72:75], v[32:35], v[136:139], v[72:75]
LPFf_EJ:
  v_mfma_f32_16x16x32_bf16 v[76:79], v[32:35], v[140:143], v[76:79]
  s_waitcnt lgkmcnt(2)
  v_mfma_f32_16x16x32_bf16 v[64:67], v[36:39], v[144:147], v[64:67]
  buffer_load_dwordx4 v[0:3], v96, s[32:35], s86 offen offset:0 sc1
  v_mfma_f32_16x16x32_bf16 v[68:71], v[36:39], v[148:151], v[68:71]
  v_mfma_f32_16x16x32_bf16 v[72:75], v[36:39], v[152:155], v[72:75]
  v_mfma_f32_16x16x32_bf16 v[76:79], v[36:39], v[156:159], v[76:79]
  v_mfma_f32_16x16x32_bf16 v[80:83], v[16:19], v[160:163], 0
  buffer_load_dwordx4 v[4:7], v96, s[32:35], s86 offen offset:1024 sc1
  v_mfma_f32_16x16x32_bf16 v[84:87], v[16:19], v[164:167], 0
  v_mfma_f32_16x16x32_bf16 v[88:91], v[16:19], v[168:171], 0
  v_mfma_f32_16x16x32_bf16 v[92:95], v[16:19], v[172:175], 0
  v_cvt_pk_bf16_f32 v112, v64, v68
  v_cvt_pk_bf16_f32 v113, v72, v76
  v_mfma_f32_16x16x32_bf16 v[80:83], v[20:23], v[176:179], v[80:83]
  v_cvt_pk_bf16_f32 v114, v65, v69
  v_cvt_pk_bf16_f32 v115, v73, v77
  v_mfma_f32_16x16x32_bf16 v[84:87], v[20:23], v[180:183], v[84:87]
  v_bfi_b32 v112, 1, s54, v112
  v_mfma_f32_16x16x32_bf16 v[88:91], v[20:23], v[184:187], v[88:91]
  s_add_u32 s51, s65, 131072
  buffer_store_dwordx4 v[112:115], v102, s[32:35], s51 offen offset:0
  v_mfma_f32_16x16x32_bf16 v[92:95], v[20:23], v[188:191], v[92:95]
  v_cvt_pk_bf16_f32 v116, v66, v70
  v_cvt_pk_bf16_f32 v117, v74, v78
  v_mfma_f32_16x16x32_bf16 v[80:83], v[24:27], v[192:195], v[80:83]
  v_cvt_pk_bf16_f32 v118, v67, v71
  v_cvt_pk_bf16_f32 v119, v75, v79
  v_mfma_f32_16x16x32_bf16 v[84:87], v[24:27], v[196:199], v[84:87]
  v_bfi_b32 v116, 1, s54, v116
  v_mfma_f32_16x16x32_bf16 v[88:91], v[24:27], v[200:203], v[88:91]
  s_add_u32 s51, s65, 147456
  buffer_store_dwordx4 v[116:119], v102, s[32:35], s51 offen offset:0
  v_mfma_f32_16x16x32_bf16 v[92:95], v[24:27], v[204:207], v[92:95]
  v_mfma_f32_16x16x32_bf16 v[80:83], v[28:31], v[208:211], v[80:83]
  v_mfma_f32_16x16x32_bf16 v[84:87], v[28:31], v[212:215], v[84:87]
  v_mfma_f32_16x16x32_bf16 v[88:91], v[28:31], v[216:219], v[88:91]
  buffer_load_dwordx4 v[8:11], v96, s[32:35], s86 offen offset:2048 sc1
  v_mfma_f32_16x16x32_bf16 v[92:95], v[28:31], v[220:223], v[92:95]
  v_mfma_f32_16x16x32_bf16 v[80:83], v[32:35], v[224:227], v[80:83]
  v_mfma_f32_16x16x32_bf16 v[84:87], v[32:35], v[228:231], v[84:87]
  v_mfma_f32_16x16x32_bf16 v[88:91], v[32:35], v[232:235], v[88:91]
  buffer_load_dwordx4 v[12:15], v96, s[32:35], s86 offen offset:3072 sc1
  v_mfma_f32_16x16x32_bf16 v[92:95], v[32:35], v[236:239], v[92:95]
  v_mfma_f32_16x16x32_bf16 v[80:83], v[36:39], v[240:243], v[80:83]
  s_waitcnt vmcnt(11)
  v_xor_b32 v120, s66, v44
  s_waitcnt vmcnt(10)
  v_mfma_f32_16x16x32_bf16 v[84:87], v[36:39], v[244:247], v[84:87]
  v_xor_b32 v121, s66, v52
  v_mfma_f32_16x16x32_bf16 v[88:91], v[36:39], v[248:251], v[88:91]
  v_mfma_f32_16x16x32_bf16 v[92:95], v[36:39], v[252:255], v[92:95]
  s_waitcnt lgkmcnt(0)
  s_waitcnt vmcnt(5)
  v_mfma_f32_16x16x32_bf16 v[44:47], v[56:59], v[0:3], v[44:47]
  v_bitop3_b32 v120, v120, v0, s85 bitop3:246
  s_waitcnt vmcnt(4)
  v_mfma_f32_16x16x32_bf16 v[44:47], v[56:59], v[4:7], v[44:47]
  v_bitop3_b32 v120, v120, v4, s85 bitop3:246
  v_cvt_pk_bf16_f32 v112, v80, v84
  v_cvt_pk_bf16_f32 v113, v88, v92
  v_cvt_pk_bf16_f32 v114, v81, v85
  v_cvt_pk_bf16_f32 v115, v89, v93
  v_bfi_b32 v112, 1, s54, v112
  s_add_u32 s51, s65, 131072
  buffer_store_dwordx4 v[112:115], v102, s[32:35], s51 offen offset:2048
  v_cvt_pk_bf16_f32 v116, v82, v86
  v_cvt_pk_bf16_f32 v117, v90, v94
  v_cvt_pk_bf16_f32 v118, v83, v87
  v_cvt_pk_bf16_f32 v119, v91, v95
  v_bfi_b32 v116, 1, s54, v116
  s_add_u32 s51, s65, 147456
  buffer_store_dwordx4 v[116:119], v102, s[32:35], s51 offen offset:2048
  s_waitcnt vmcnt(3)
  v_mfma_f32_16x16x32_bf16 v[44:47], v[60:63], v[8:11], v[44:47]
  v_bitop3_b32 v120, v120, v8, s85 bitop3:246
  s_waitcnt vmcnt(2)
  v_mfma_f32_16x16x32_bf16 v[44:47], v[60:63], v[12:15], v[44:47]
  v_bitop3_b32 v120, v120, v12, s85 bitop3:246
  v_and_b32 v120, 1, v120
  v_cmp_ne_u32 vcc, 0, v120
  s_cbranch_vccnz LPFf_c_r
LPFf_c:
  s_nop 3
  v_add_f32 v0, v44, v45
  v_mul_f32 v1, v44, v44
  v_add_f32 v2, v46, v47
  v_fmac_f32 v1, v45, v45
  v_add_f32 v0, v0, v2
  v_fmac_f32 v1, v46, v46
  v_fmac_f32 v1, v47, v47
  v_add_f32_dpp v0, v0, v0 row_ror:8 row_mask:0xf bank_mask:0xf
  v_cvt_pk_bf16_f32 v112, v44, v45
  v_add_f32_dpp v1, v1, v1 row_ror:8 row_mask:0xf bank_mask:0xf
  v_add_f32_dpp v0, v0, v0 row_ror:4 row_mask:0xf bank_mask:0xf
  v_cvt_pk_bf16_f32 v113, v46, v47
  v_add_f32_dpp v1, v1, v1 row_ror:4 row_mask:0xf bank_mask:0xf
  v_add_f32_dpp v0, v0, v0 row_ror:2 row_mask:0xf bank_mask:0xf
  s_nop 0
  v_add_f32_dpp v1, v1, v1 row_ror:2 row_mask:0xf bank_mask:0xf
  v_add_f32_dpp v0, v0, v0 row_ror:1 row_mask:0xf bank_mask:0xf
  s_nop 0
  v_add_f32_dpp v1, v1, v1 row_ror:1 row_mask:0xf bank_mask:0xf
  s_nop 1
  v_permlane32_swap_b32 v0, v1
  v_add_f32 v0, v0, v1
  ds_write_b32 v105, v0 offset:0
  s_waitcnt vmcnt(0)
  buffer_load_dwordx4 v[64:67], v96, s[32:35], s87 offen offset:0 sc1
  buffer_load_dwordx4 v[68:71], v96, s[32:35], s87 offen offset:1024 sc1
  buffer_load_dwordx4 v[72:75], v96, s[32:35], s87 offen offset:2048 sc1
  buffer_load_dwordx4 v[76:79], v96, s[32:35], s87 offen offset:3072 sc1
  s_waitcnt lgkmcnt(0)
  s_barrier
  ds_read_b128 v[0:3], v106 offset:0
  ds_read_b128 v[4:7], v106 offset:16
  s_waitcnt lgkmcnt(0)
  v_add_f32 v0, v0, v4
  v_add_f32 v1, v1, v5
  v_add_f32 v2, v2, v6
  v_add_f32 v3, v3, v7
  v_add_f32 v0, v0, v2
  v_add_f32 v1, v1, v3
  v_mul_f32 v0, 0x3b000000, v0
  v_mul_f32 v1, 0x3b000000, v1
  v_fma_f32 v1, -v0, v0, v1
  v_max_f32 v1, 0, v1
  v_add_f32 v1, 0x3727c5ac, v1
  v_rsq_f32 v1, v1
  s_add_u32 s86, s84, s61
  v_mul_f32 v0, v0, v1
  v_fma_f32 v4, v44, v1, -v0
  v_fma_f32 v5, v45, v1, -v0
  v_fma_f32 v6, v46, v1, -v0
  v_fma_f32 v7, v47, v1, -v0
  v_cvt_pk_bf16_f32 v114, v4, v5
  v_cvt_pk_bf16_f32 v115, v6, v7
  v_bfe_u32 v123, v96, 4, 1
  v_mul_u32_u24 v123, 16376, v123
  v_add_u32 v123, v123, v104
  s_waitcnt vmcnt(3)
  v_mfma_f32_16x16x32_bf16 v[52:55], v[56:59], v[64:67], v[52:55]
  v_bitop3_b32 v121, v121, v64, s85 bitop3:246
  s_waitcnt vmcnt(2)
  v_mfma_f32_16x16x32_bf16 v[52:55], v[56:59], v[68:71], v[52:55]
  v_bitop3_b32 v121, v121, v68, s85 bitop3:246
  s_waitcnt vmcnt(1)
  v_mfma_f32_16x16x32_bf16 v[52:55], v[60:63], v[72:75], v[52:55]
  v_bitop3_b32 v121, v121, v72, s85 bitop3:246
  s_waitcnt vmcnt(0)
  v_mfma_f32_16x16x32_bf16 v[52:55], v[60:63], v[76:79], v[52:55]
  v_bitop3_b32 v121, v121, v76, s85 bitop3:246
  v_and_b32 v121, 1, v121
  v_cmp_ne_u32 vcc, 0, v121
  s_cbranch_vccnz LPFf_d_r
LPFf_d:
  buffer_load_dword v111, v108, s[32:35], s91 offen sc1
  s_nop 2
  v_add_f32 v64, v52, v53
  v_mul_f32 v65, v52, v52
  v_add_f32 v66, v54, v55
  v_fmac_f32 v65, v53, v53
  v_add_f32 v64, v64, v66
  v_fmac_f32 v65, v54, v54
  v_fmac_f32 v65, v55, v55
  v_add_f32_dpp v64, v64, v64 row_ror:8 row_mask:0xf bank_mask:0xf
  v_cvt_pk_bf16_f32 v116, v52, v53
  v_add_f32_dpp v65, v65, v65 row_ror:8 row_mask:0xf bank_mask:0xf
  v_add_f32_dpp v64, v64, v64 row_ror:4 row_mask:0xf bank_mask:0xf
  v_cvt_pk_bf16_f32 v117, v54, v55
  v_add_f32_dpp v65, v65, v65 row_ror:4 row_mask:0xf bank_mask:0xf
  v_add_f32_dpp v64, v64, v64 row_ror:2 row_mask:0xf bank_mask:0xf
  s_nop 0
  v_add_f32_dpp v65, v65, v65 row_ror:2 row_mask:0xf bank_mask:0xf
  v_add_f32_dpp v64, v64, v64 row_ror:1 row_mask:0xf bank_mask:0xf
  s_nop 0
  v_add_f32_dpp v65, v65, v65 row_ror:1 row_mask:0xf bank_mask:0xf
  s_nop 1
  v_permlane32_swap_b32 v64, v65
  v_add_f32 v64, v64, v65
  ds_write_b32 v105, v64 offset:128
  v_mfma_f32_32x32x16_bf16 v[80:95], v[56:59], v[56:59], 0
  s_lshl_b32 s93, s92, 11
  s_add_u32 s93, s93, s62
  s_waitcnt lgkmcnt(0)
  v_mfma_f32_32x32x16_bf16 v[16:31], v[56:59], v[56:59], 0
  s_barrier
  ds_read_b128 v[64:67], v106 offset:128
  ds_read_b128 v[68:71], v106 offset:144
  v_xor_b32 v105, 256, v105
  v_xor_b32 v106, 256, v106
  v_mfma_f32_16x16x32_bf16 v[32:35], v[56:59], v[56:59], 0
  s_waitcnt lgkmcnt(0)
  v_pk_add_f32 v[64:65], v[64:65], v[68:69]
  v_pk_add_f32 v[66:67], v[66:67], v[70:71]
  v_pk_add_f32 v[64:65], v[64:65], v[66:67]
  v_mul_f32 v64, 0x3b000000, v64
  v_mul_f32 v65, 0x3b000000, v65
  v_fma_f32 v65, -v64, v64, v65
  v_max_f32 v65, 0, v65
  v_add_f32 v65, 0x3727c5ac, v65
  v_rsq_f32 v65, v65
  s_add_u32 s87, s64, s61
  v_mul_f32 v64, v64, v65
  v_fma_f32 v68, v52, v65, -v64
  v_fma_f32 v69, v53, v65, -v64
  v_fma_f32 v70, v54, v65, -v64
  v_fma_f32 v71, v55, v65, -v64
  v_cvt_pk_bf16_f32 v118, v68, v69
  v_cvt_pk_bf16_f32 v119, v70, v71
  s_mov_b32 vcc_lo, 0x55555555
  s_mov_b32 vcc_hi, 0x55555555
  v_cndmask_b32_dpp v124, v118, v114, vcc quad_perm:[1,0,3,2] row_mask:0xf bank_mask:0xf
  v_cndmask_b32_dpp v125, v119, v115, vcc quad_perm:[1,0,3,2] row_mask:0xf bank_mask:0xf
  s_not_b64 vcc, vcc
  v_cndmask_b32_dpp v126, v114, v118, vcc quad_perm:[1,0,3,2] row_mask:0xf bank_mask:0xf
  v_cndmask_b32_dpp v127, v115, v119, vcc quad_perm:[1,0,3,2] row_mask:0xf bank_mask:0xf
  v_or_b32 v124, 1, v124
  s_cmp_lg_u32 s83, 0
  s_cbranch_scc1 LPFf_pre2
  s_waitcnt vmcnt(0)
  v_cmp_eq_u32 vcc, 0, v111
  s_cmp_ge_u32 s50, 64
  s_cbranch_scc1 LPFf_fin
  s_cbranch_vccz LPFf_pre
  buffer_store_dwordx4 v[124:127], v123, s[32:35], s86 offen sc1
  s_mov_b64 exec, 1
  buffer_store_dword v110, off, s[32:35], s93 sc1
  s_mov_b64 exec, -1
  buffer_store_dwordx2 v[116:117], v103, s[36:39], s64 offen
  s_add_u32 s87, s64, s60
  buffer_store_dwordx2 v[116:117], v103, s[32:35], s87 offen sc1
  buffer_store_dwordx2 v[112:113], v103, s[36:39], s84 offen
  s_add_u32 s86, s84, s60
  buffer_store_dwordx2 v[112:113], v103, s[32:35], s86 offen sc1
  s_branch LPFf_poll
LPFf_fin:
  buffer_store_dwordx2 v[116:117], v103, s[36:39], s64 offen
  buffer_store_dwordx2 v[112:113], v103, s[36:39], s84 offen
  buffer_store_dwordx4 v[124:127], v123, s[32:35], s86 offen sc1
  s_add_u32 s87, s64, s60
  buffer_store_dwordx2 v[116:117], v103, s[32:35], s87 offen sc1
  s_add_u32 s86, s84, s60
  buffer_store_dwordx2 v[112:113], v103, s[32:35], s86 offen sc1
  s_waitcnt vmcnt(0)
  s_mov_b64 exec, 1
  buffer_store_dword v110, off, s[32:35], s93 sc1
  s_mov_b64 exec, -1
  s_branch L_post_done
LPFf_pre:
  s_add_u32 m0, s89, 0
  s_add_u32 s94, s90, 16384
  buffer_load_dwordx4 v101, s[32:35], s90 offen offset:0 sc1 lds
  s_add_u32 m0, s89, 7936
  s_nop 0
  buffer_load_dwordx4 v101, s[32:35], s90 offen offset:256 sc1 lds
  s_add_u32 m0, s89, 15872
  s_nop 0
  buffer_load_dwordx4 v101, s[32:35], s90 offen offset:512 sc1 lds
  s_add_u32 m0, s89, 23808
  s_nop 0
  buffer_load_dwordx4 v101, s[32:35], s90 offen offset:768 sc1 lds
  s_add_u32 m0, s89, 4096
  s_nop 0
  buffer_load_dwordx4 v101, s[32:35], s94 offen offset:0 sc1 lds
  s_add_u32 m0, s89, 12032
  s_nop 0
  buffer_load_dwordx4 v101, s[32:35], s94 offen offset:256 sc1 lds
  s_add_u32 m0, s89, 19968
  s_nop 0
  buffer_load_dwordx4 v101, s[32:35], s94 offen offset:512 sc1 lds
  s_add_u32 m0, s89, 27904
  s_nop 0
  buffer_load_dwordx4 v101, s[32:35], s94 offen offset:768 sc1 lds
LPFf_pre2:
  s_branch LPFf_go
LPFf_E:
  s_mov_b32 s83, 1
  v_mfma_f32_16x16x32_bf16 v[88:91], v[16:19], v[168:171], 0
  s_add_u32 m0, s89, 0
  s_add_u32 s94, s90, 16384
  v_mfma_f32_16x16x32_bf16 v[92:95], v[16:19], v[172:175], 0
  ds_read_b128 v[16:19], v110 offset:6144
  v_cvt_pk_bf16_f32 v112, v64, v68
  v_cvt_pk_bf16_f32 v113, v72, v76
  v_mfma_f32_16x16x32_bf16 v[80:83], v[20:23], v[176:179], v[80:83]
  v_cvt_pk_bf16_f32 v114, v65, v69
  v_cvt_pk_bf16_f32 v115, v73, v77
  v_mfma_f32_16x16x32_bf16 v[84:87], v[20:23], v[180:183], v[84:87]
  v_bfi_b32 v112, 1, s54, v112
  v_mfma_f32_16x16x32_bf16 v[88:91], v[20:23], v[184:187], v[88:91]
  s_add_u32 s51, s65, 0
  buffer_store_dwordx4 v[112:115], v102, s[32:35], s51 offen offset:0
  v_mfma_f32_16x16x32_bf16 v[92:95], v[20:23], v[188:191], v[92:95]
  ds_read_b128 v[20:23], v110 offset:7168
  buffer_load_dwordx4 v101, s[32:35], s90 offen offset:0 sc1 lds
  v_mfma_f32_16x16x32_bf16 v[80:83], v[24:27], v[192:195], v[80:83]
  v_cvt_pk_bf16_f32 v116, v66, v70
  v_cvt_pk_bf16_f32 v117, v74, v78
  v_mfma_f32_16x16x32_bf16 v[84:87], v[24:27], v[196:199], v[84:87]
  v_cvt_pk_bf16_f32 v118, v67, v71
  v_cvt_pk_bf16_f32 v119, v75, v79
  v_mfma_f32_16x16x32_bf16 v[88:91], v[24:27], v[200:203], v[88:91]
  v_bfi_b32 v116, 1, s54, v116
  s_add_u32 m0, s89, 7936
  v_mfma_f32_16x16x32_bf16 v[92:95], v[24:27], v[204:207], v[92:95]
  ds_read_b128 v[24:27], v110 offset:8192
  s_add_u32 s51, s65, 16384
  buffer_store_dwordx4 v[116:119], v102, s[32:35], s51 offen offset:0
  v_mfma_f32_16x16x32_bf16 v[80:83], v[28:31], v[208:211], v[80:83]
  buffer_load_dwordx4 v101, s[32:35], s90 offen offset:256 sc1 lds
  s_add_u32 m0, s89, 15872
  v_mfma_f32_16x16x32_bf16 v[84:87], v[28:31], v[212:215], v[84:87]
  s_lshl_b32 s64, s92, 15
  s_add_u32 s64, s64, 16384
  s_and_b32 s87, s92, 3
  v_mfma_f32_16x16x32_bf16 v[88:91], v[28:31], v[216:219], v[88:91]
  s_lshl_b32 s87, s87, 18
  s_add_u32 s87, s87, s58
  s_add_u32 s87, s87, 131072
  v_mfma_f32_16x16x32_bf16 v[92:95], v[28:31], v[220:223], v[92:95]
  ds_read_b128 v[28:31], v110 offset:9216
  buffer_load_dwordx4 v101, s[32:35], s90 offen offset:512 sc1 lds
  v_mfma_f32_16x16x32_bf16 v[80:83], v[32:35], v[224:227], v[80:83]
  v_mfma_f32_16x16x32_bf16 v[84:87], v[32:35], v[228:231], v[84:87]
  s_add_u32 m0, s89, 23808
  s_nop 0
  buffer_load_dwordx4 v101, s[32:35], s90 offen offset:768 sc1 lds
  v_mfma_f32_16x16x32_bf16 v[88:91], v[32:35], v[232:235], v[88:91]
  v_mfma_f32_16x16x32_bf16 v[92:95], v[32:35], v[236:239], v[92:95]
  ds_read_b128 v[32:35], v110 offset:10240
  v_mfma_f32_16x16x32_bf16 v[80:83], v[36:39], v[240:243], v[80:83]
  v_mfma_f32_16x16x32_bf16 v[84:87], v[36:39], v[244:247], v[84:87]
  v_mfma_f32_16x16x32_bf16 v[88:91], v[36:39], v[248:251], v[88:91]
  s_add_u32 m0, s89, 4096
  s_nop 0
  buffer_load_dwordx4 v101, s[32:35], s94 offen offset:0 sc1 lds
  v_mfma_f32_16x16x32_bf16 v[92:95], v[36:39], v[252:255], v[92:95]
  ds_read_b128 v[36:39], v110 offset:11264
  s_waitcnt lgkmcnt(5)
  v_mfma_f32_16x16x32_bf16 v[64:67], v[16:19], a[192:195], 0
  v_mfma_f32_16x16x32_bf16 v[68:71], v[16:19], a[196:199], 0
  v_mfma_f32_16x16x32_bf16 v[72:75], v[16:19], a[200:203], 0
  v_mfma_f32_16x16x32_bf16 v[76:79], v[16:19], a[204:207], 0
  s_waitcnt lgkmcnt(4)
  v_cvt_pk_bf16_f32 v112, v80, v84
  v_cvt_pk_bf16_f32 v113, v88, v92
  v_mfma_f32_16x16x32_bf16 v[64:67], v[20:23], a[208:211], v[64:67]
  v_cvt_pk_bf16_f32 v114, v81, v85
  v_cvt_pk_bf16_f32 v115, v89, v93
  v_mfma_f32_16x16x32_bf16 v[68:71], v[20:23], a[212:215], v[68:71]
  v_bfi_b32 v112, 1, s54, v112
  s_add_u32 m0, s89, 12032
  v_mfma_f32_16x16x32_bf16 v[72:75], v[20:23], a[216:219], v[72:75]
  s_add_u32 s51, s65, 0
  buffer_store_dwordx4 v[112:115], v102, s[32:35], s51 offen offset:2048
  v_mfma_f32_16x16x32_bf16 v[76:79], v[20:23], a[220:223], v[76:79]
  s_waitcnt lgkmcnt(3)
  v_cvt_pk_bf16_f32 v116, v82, v86
  v_cvt_pk_bf16_f32 v117, v90, v94
  v_mfma_f32_16x16x32_bf16 v[64:67], v[24:27], a[224:227], v[64:67]
  v_cvt_pk_bf16_f32 v118, v83, v87
  v_cvt_pk_bf16_f32 v119, v91, v95
  v_mfma_f32_16x16x32_bf16 v[68:71], v[24:27], a[228:231], v[68:71]
  v_bfi_b32 v116, 1, s54, v116
  v_mfma_f32_16x16x32_bf16 v[72:75], v[24:27], a[232:235], v[72:75]
  s_add_u32 s51, s65, 16384
  buffer_store_dwordx4 v[116:119], v102, s[32:35], s51 offen offset:2048
  v_mfma_f32_16x16x32_bf16 v[76:79], v[24:27], a[236:239], v[76:79]
  s_waitcnt lgkmcnt(2)
  buffer_load_dwordx4 v101, s[32:35], s94 offen offset:256 sc1 lds
  v_mfma_f32_16x16x32_bf16 v[64:67], v[28:31], a[240:243], v[64:67]
  s_add_u32 m0, s89, 19968
  s_nop 0
  buffer_load_dwordx4 v101, s[32:35], s94 offen offset:512 sc1 lds
  v_mfma_f32_16x16x32_bf16 v[68:71], v[28:31], a[244:247], v[68:71]
  s_add_u32 m0, s89, 27904
  s_nop 0
  buffer_load_dwordx4 v101, s[32:35], s94 offen offset:768 sc1 lds
  v_mfma_f32_16x16x32_bf16 v[72:75], v[28:31], a[248:251], v[72:75]
  v_add_u32 v122, 78400, v96
  ds_read_b128 v[56:59], v122
  v_mfma_f32_16x16x32_bf16 v[76:79], v[28:31], a[252:255], v[76:79]
  s_waitcnt lgkmcnt(2)
  ds_read_b128 v[60:63], v122 offset:1024
  v_mfma_f32_16x16x32_bf16 v[64:67], v[32:35], v[128:131], v[64:67]
  v_mfma_f32_16x16x32_bf16 v[68:71], v[32:35], v[132:135], v[68:71]
  v_mfma_f32_16x16x32_bf16 v[72:75], v[32:35], v[136:139], v[72:75]
  s_branch LPFf_EJ
LPFf_redo:
  s_cmp_lt_u32 s88, 1073741824
  s_cselect_b32 s51, 4096, 0
  s_sub_u32 s88, s88, s51
  s_waitcnt lgkmcnt(0)
  s_barrier
LPFf_again:
  s_add_u32 s53, s53, 1
  s_cmp_ge_u32 s53, 65536
  s_cbranch_scc1 L_abort
  s_sleep 1
LPFf_poll:
  buffer_load_dword v111, v108, s[32:35], s91 offen sc1
  s_waitcnt vmcnt(0)
  s_branch LPFf_chk
LPFf_c_r:
  s_add_u32 s69, s69, 1
  s_cmp_ge_u32 s69, 65536
  s_cbranch_scc1 L_abort
  s_nop 4
  s_add_u32 s52, s67, 0
  buffer_load_dwordx4 v[44:47], v96, s[32:35], s52 offen sc1
  buffer_load_dwordx4 v[0:3], v96, s[32:35], s86 offen offset:0 sc1
  buffer_load_dwordx4 v[4:7], v96, s[32:35], s86 offen offset:1024 sc1
  buffer_load_dwordx4 v[8:11], v96, s[32:35], s86 offen offset:2048 sc1
  buffer_load_dwordx4 v[12:15], v96, s[32:35], s86 offen offset:3072 sc1
  s_waitcnt vmcnt(4)
  v_xor_b32 v120, s66, v44
  s_waitcnt vmcnt(3)
  v_mfma_f32_16x16x32_bf16 v[44:47], v[56:59], v[0:3], v[44:47]
  v_bitop3_b32 v120, v120, v0, s85 bitop3:246
  s_waitcnt vmcnt(2)
  v_mfma_f32_16x16x32_bf16 v[44:47], v[56:59], v[4:7], v[44:47]
  v_bitop3_b32 v120, v120, v4, s85 bitop3:246
  s_waitcnt vmcnt(1)
  v_mfma_f32_16x16x32_bf16 v[44:47], v[60:63], v[8:11], v[44:47]
  v_bitop3_b32 v120, v120, v8, s85 bitop3:246
  s_waitcnt vmcnt(0)
  v_mfma_f32_16x16x32_bf16 v[44:47], v[60:63], v[12:15], v[44:47]
  v_bitop3_b32 v120, v120, v12, s85 bitop3:246
  v_and_b32 v120, 1, v120
  v_cmp_ne_u32 vcc, 0, v120
  s_cbranch_vccnz LPFf_c_r
  s_nop 4
  s_branch LPFf_c
LPFf_d_r:
  s_add_u32 s69, s69, 1
  s_cmp_ge_u32 s69, 65536
  s_cbranch_scc1 L_abort
  s_nop 4
  s_add_u32 s52, s67, 32768
  buffer_load_dwordx4 v[52:55], v96, s[32:35], s52 offen sc1
  buffer_load_dwordx4 v[64:67], v96, s[32:35], s87 offen offset:0 sc1
  buffer_load_dwordx4 v[68:71], v96, s[32:35], s87 offen offset:1024 sc1
  buffer_load_dwordx4 v[72:75], v96, s[32:35], s87 offen offset:2048 sc1
  buffer_load_dwordx4 v[76:79], v96, s[32:35], s87 offen offset:3072 sc1
  s_waitcnt vmcnt(4)
  v_xor_b32 v121, s66, v52
  s_waitcnt vmcnt(3)
  v_mfma_f32_16x16x32_bf16 v[52:55], v[56:59], v[64:67], v[52:55]
  v_bitop3_b32 v121, v121, v64, s85 bitop3:246
  s_waitcnt vmcnt(2)
  v_mfma_f32_16x16x32_bf16 v[52:55], v[56:59], v[68:71], v[52:55]
  v_bitop3_b32 v121, v121, v68, s85 bitop3:246
  s_waitcnt vmcnt(1)
  v_mfma_f32_16x16x32_bf16 v[52:55], v[60:63], v[72:75], v[52:55]
  v_bitop3_b32 v121, v121, v72, s85 bitop3:246
  s_waitcnt vmcnt(0)
  v_mfma_f32_16x16x32_bf16 v[52:55], v[60:63], v[76:79], v[52:55]
  v_bitop3_b32 v121, v121, v76, s85 bitop3:246
  v_and_b32 v121, 1, v121
  v_cmp_ne_u32 vcc, 0, v121
  s_cbranch_vccnz LPFf_d_r
  s_nop 4
  s_branch LPFf_d
L_Fslow:
  s_bfe_u32 s50, s28, 0x10003
  s_lshl_b32 s89, s26, 10
  s_mov_b32 s93, 1073741824
  v_add_u32 v110, 65536, v96
  s_lshl_b32 s51, s63, 2
  s_add_u32 s51, s51, s26
  s_lshl_b32 s95, s51, 10
  s_lshl_b32 s52, s29, 18
  s_add_u32 s95, s95, s52
  s_add_u32 s95, s95, 15007744
  s_lshl_b32 s88, s51, 2
  s_lshl_b32 s52, s29, 17
  s_add_u32 s88, s88, s52
  s_add_u32 s88, s88, 557056
  s_lshl_b32 s52, s50, 11
  s_add_u32 s88, s88, s52
  s_mov_b64 exec, 1
  buffer_store_dword v110, off, s[32:35], s88 sc1
  s_mov_b64 exec, -1
  s_add_u32 s88, s88, 4096
  s_cmp_ge_u32 s50, 56
  s_cselect_b32 s88, 1073741824, s88
  s_mov_b64 exec, 1
  buffer_store_dword v110, off, s[32:35], s88 sc1
  s_mov_b64 exec, -1
  s_add_u32 s88, s88, 4096
  s_cmp_ge_u32 s50, 56
  s_cselect_b32 s88, 1073741824, s88
  s_mov_b64 exec, 1
  buffer_store_dword v110, off, s[32:35], s88 sc1
  s_mov_b64 exec, -1
  s_add_u32 s88, s88, 4096
  s_cmp_ge_u32 s50, 56
  s_cselect_b32 s88, 1073741824, s88
  v_lshlrev_b32 v2, 2, v96
  s_add_u32 s51, s58, 0
  buffer_load_dword v3, v2, s[32:35], s51 offen sc1
  s_add_u32 s51, s58, 131072
  buffer_load_dword v3, v2, s[32:35], s51 offen sc1
  s_add_u32 s51, s58, 262144
  buffer_load_dword v3, v2, s[32:35], s51 offen sc1
  s_add_u32 s51, s58, 393216
  buffer_load_dword v3, v2, s[32:35], s51 offen sc1
  s_add_u32 s51, s58, 524288
  buffer_load_dword v3, v2, s[32:35], s51 offen sc1
  s_add_u32 s51, s58, 655360
  buffer_load_dword v3, v2, s[32:35], s51 offen sc1
  s_add_u32 s51, s58, 786432
  buffer_load_dword v3, v2, s[32:35], s51 offen sc1
  s_add_u32 s51, s58, 917504
  buffer_load_dword v3, v2, s[32:35], s51 offen sc1
  s_add_u32 s51, s59, 0
  buffer_load_dword v3, v96, s[32:35], s51 offen sc1
  s_add_u32 s51, s59, 32768
  buffer_load_dword v3, v96, s[32:35], s51 offen sc1
  s_add_u32 s51, s59, 65536
  buffer_load_dword v3, v96, s[32:35], s51 offen sc1
  s_add_u32 s51, s59, 98304
  buffer_load_dword v3, v96, s[32:35], s51 offen sc1
  s_add_u32 s51, s59, 131072
  buffer_load_dword v3, v96, s[32:35], s51 offen sc1
  s_add_u32 s51, s59, 163840
  buffer_load_dword v3, v96, s[32:35], s51 offen sc1
  s_add_u32 s51, s59, 196608
  buffer_load_dword v3, v96, s[32:35], s51 offen sc1
  s_add_u32 s51, s59, 229376
  buffer_load_dword v3, v96, s[32:35], s51 offen sc1
  s_add_u32 s51, s59, 262144
  buffer_load_dword v3, v96, s[32:35], s51 offen sc1
  s_add_u32 s51, s59, 294912
  buffer_load_dword v3, v96, s[32:35], s51 offen sc1
  s_add_u32 s51, s59, 327680
  buffer_load_dword v3, v96, s[32:35], s51 offen sc1
  s_add_u32 s51, s59, 360448
  buffer_load_dword v3, v96, s[32:35], s51 offen sc1
  s_add_u32 s51, s59, 393216
  buffer_load_dword v3, v96, s[32:35], s51 offen sc1
  s_add_u32 s51, s59, 425984
  buffer_load_dword v3, v96, s[32:35], s51 offen sc1
  s_add_u32 s51, s59, 458752
  buffer_load_dword v3, v96, s[32:35], s51 offen sc1
  s_add_u32 s51, s59, 491520
  buffer_load_dword v3, v96, s[32:35], s51 offen sc1
  v_lshlrev_b32 v122, 3, v96
  v_and_b32 v122, 0x380, v122
  s_add_u32 s51, s50, 0
  s_and_b32 s51, s51, 7
  s_lshl_b32 s51, s51, 15
  s_add_u32 s51, s51, s95
  buffer_load_dword v111, v122, s[32:35], s51 offen sc1
  v_lshlrev_b32 v122, 3, v96
  v_and_b32 v122, 0x380, v122
  s_add_u32 s51, s50, 2
  s_and_b32 s51, s51, 7
  s_lshl_b32 s51, s51, 15
  s_add_u32 s51, s51, s95
  buffer_load_dword v111, v122, s[32:35], s51 offen sc1
  v_lshlrev_b32 v122, 3, v96
  v_and_b32 v122, 0x380, v122
  s_add_u32 s51, s50, 4
  s_and_b32 s51, s51, 7
  s_lshl_b32 s51, s51, 15
  s_add_u32 s51, s51, s95
  buffer_load_dword v111, v122, s[32:35], s51 offen sc1
  v_lshlrev_b32 v122, 3, v96
  v_and_b32 v122, 0x380, v122
  s_add_u32 s51, s50, 6
  s_and_b32 s51, s51, 7
  s_lshl_b32 s51, s51, 15
  s_add_u32 s51, s51, s95
  buffer_load_dword v111, v122, s[32:35], s51 offen sc1
  s_waitcnt vmcnt(0)
  s_lshl_b32 s91, s50, 8
  s_add_u32 s91, s91, s56
  s_and_b32 s90, s50, 7
  s_lshl_b32 s90, s90, 15
  s_add_u32 s90, s90, s55
  s_branch LPFs_poll
LPFs_chk:
  v_cmp_eq_u32 vcc, 0, v111
  s_cbranch_vccnz LPFs_again
  s_add_u32 m0, s89, 0
  s_add_u32 s94, s90, 16384
  buffer_load_dwordx4 v101, s[32:35], s90 offen offset:0 sc1 lds
  s_add_u32 m0, s89, 7936
  s_nop 0
  buffer_load_dwordx4 v101, s[32:35], s90 offen offset:256 sc1 lds
  s_add_u32 m0, s89, 15872
  s_nop 0
  buffer_load_dwordx4 v101, s[32:35], s90 offen offset:512 sc1 lds
  s_add_u32 m0, s89, 23808
  s_nop 0
  buffer_load_dwordx4 v101, s[32:35], s90 offen offset:768 sc1 lds
  s_add_u32 m0, s89, 4096
  s_nop 0
  buffer_load_dwordx4 v101, s[32:35], s94 offen offset:0 sc1 lds
  s_add_u32 m0, s89, 12032
  s_nop 0
  buffer_load_dwordx4 v101, s[32:35], s94 offen offset:256 sc1 lds
  s_add_u32 m0, s89, 19968
  s_nop 0
  buffer_load_dwordx4 v101, s[32:35], s94 offen offset:512 sc1 lds
  s_add_u32 m0, s89, 27904
  s_nop 0
  buffer_load_dwordx4 v101, s[32:35], s94 offen offset:768 sc1 lds
  s_lshr_b32 s66, s50, 3
  s_add_u32 s66, s66, 1
  s_waitcnt vmcnt(4)
  s_barrier
  ds_read_b128 v[0:3], v97 offset:0
  ds_read_b128 v[4:7], v98 offset:0
  ds_read_b128 v[8:11], v99 offset:0
  s_waitcnt lgkmcnt(2)
  v_mfma_f32_16x16x32_bf16 v[40:43], a[0:3], v[0:3], 0
  ds_read_b128 v[12:15], v100 offset:0
  v_mfma_f32_16x16x32_bf16 v[44:47], a[4:7], v[0:3], 0
  v_xor_b32 v120, s66, v0
  v_mfma_f32_16x16x32_bf16 v[48:51], a[8:11], v[0:3], 0
  s_waitcnt lgkmcnt(2)
  s_and_b32 s65, s50, 3
  s_lshl_b32 s65, s65, 18
  v_mfma_f32_16x16x32_bf16 v[40:43], a[12:15], v[4:7], v[40:43]
  ds_read_b128 v[0:3], v97 offset:8192
  s_add_u32 s65, s65, s57
  s_lshr_b32 s54, s50, 2
  v_mfma_f32_16x16x32_bf16 v[44:47], a[16:19], v[4:7], v[44:47]
  v_bitop3_b32 v120, v120, v4, s66 bitop3:246
  s_add_u32 s54, s54, 1
  v_mfma_f32_16x16x32_bf16 v[48:51], a[20:23], v[4:7], v[48:51]
  s_waitcnt lgkmcnt(2)
  v_mfma_f32_16x16x32_bf16 v[40:43], a[24:27], v[8:11], v[40:43]
  ds_read_b128 v[4:7], v98 offset:8192
  v_mfma_f32_16x16x32_bf16 v[44:47], a[28:31], v[8:11], v[44:47]
  v_bitop3_b32 v120, v120, v8, s66 bitop3:246
  v_mfma_f32_16x16x32_bf16 v[48:51], a[32:35], v[8:11], v[48:51]
  s_waitcnt lgkmcnt(2)
  v_mfma_f32_16x16x32_bf16 v[40:43], a[36:39], v[12:15], v[40:43]
  ds_read_b128 v[8:11], v99 offset:8192
  v_mfma_f32_16x16x32_bf16 v[44:47], a[40:43], v[12:15], v[44:47]
  v_bitop3_b32 v120, v120, v12, s66 bitop3:246
  v_mfma_f32_16x16x32_bf16 v[48:51], a[44:47], v[12:15], v[48:51]
  s_waitcnt lgkmcnt(2)
  v_mfma_f32_16x16x32_bf16 v[40:43], a[48:51], v[0:3], v[40:43]
  ds_read_b128 v[12:15], v100 offset:8192
  v_mfma_f32_16x16x32_bf16 v[44:47], a[52:55], v[0:3], v[44:47]
  v_bitop3_b32 v120, v120, v0, s66 bitop3:246
  v_mfma_f32_16x16x32_bf16 v[48:51], a[56:59], v[0:3], v[48:51]
  s_waitcnt lgkmcnt(2)
  v_mfma_f32_16x16x32_bf16 v[40:43], a[60:63], v[4:7], v[40:43]
  ds_read_b128 v[0:3], v97 offset:16384
  v_mfma_f32_16x16x32_bf16 v[44:47], a[64:67], v[4:7], v[44:47]
  v_bitop3_b32 v120, v120, v4, s66 bitop3:246
  v_mfma_f32_16x16x32_bf16 v[48:51], a[68:71], v[4:7], v[48:51]
  s_waitcnt lgkmcnt(2)
  v_mfma_f32_16x16x32_bf16 v[40:43], a[72:75], v[8:11], v[40:43]
  ds_read_b128 v[4:7], v98 offset:16384
  v_mfma_f32_16x16x32_bf16 v[44:47], a[76:79], v[8:11], v[44:47]
  v_bitop3_b32 v120, v120, v8, s66 bitop3:246
  v_mfma_f32_16x16x32_bf16 v[48:51], a[80:83], v[8:11], v[48:51]
  s_waitcnt lgkmcnt(2)
  v_mfma_f32_16x16x32_bf16 v[40:43], a[84:87], v[12:15], v[40:43]
  ds_read_b128 v[8:11], v99 offset:16384
  v_mfma_f32_16x16x32_bf16 v[44:47], a[88:91], v[12:15], v[44:47]
  v_bitop3_b32 v120, v120, v12, s66 bitop3:246
  v_mfma_f32_16x16x32_bf16 v[48:51], a[92:95], v[12:15], v[48:51]
  s_waitcnt lgkmcnt(2)
  v_mfma_f32_16x16x32_bf16 v[40:43], a[96:99], v[0:3], v[40:43]
  ds_read_b128 v[12:15], v100 offset:16384
  v_mfma_f32_16x16x32_bf16 v[44:47], a[100:103], v[0:3], v[44:47]
  v_bitop3_b32 v120, v120, v0, s66 bitop3:246
  v_mfma_f32_16x16x32_bf16 v[48:51], a[104:107], v[0:3], v[48:51]
  s_waitcnt lgkmcnt(2)
  v_mfma_f32_16x16x32_bf16 v[40:43], a[108:111], v[4:7], v[40:43]
  ds_read_b128 v[0:3], v97 offset:24576
  v_mfma_f32_16x16x32_bf16 v[44:47], a[112:115], v[4:7], v[44:47]
  v_bitop3_b32 v120, v120, v4, s66 bitop3:246
  v_mfma_f32_16x16x32_bf16 v[48:51], a[116:119], v[4:7], v[48:51]
  s_waitcnt lgkmcnt(2)
  v_mfma_f32_16x16x32_bf16 v[40:43], a[120:123], v[8:11], v[40:43]
  s_waitcnt vmcnt(0)
  s_barrier
  ds_read_b128 v[4:7], v98 offset:24576
  v_mfma_f32_16x16x32_bf16 v[44:47], a[124:127], v[8:11], v[44:47]
  v_bitop3_b32 v120, v120, v8, s66 bitop3:246
  v_mfma_f32_16x16x32_bf16 v[48:51], a[128:131], v[8:11], v[48:51]
  s_waitcnt lgkmcnt(2)
  s_branch LPFs_join
LPFs_go:
  s_lshr_b32 s66, s50, 3
  s_add_u32 s66, s66, 1
  s_waitcnt vmcnt(4)
  s_barrier
  ds_read_b128 v[0:3], v97 offset:0
  ds_read_b128 v[4:7], v98 offset:0
  ds_read_b128 v[8:11], v99 offset:0
  s_waitcnt lgkmcnt(2)
  v_mfma_f32_16x16x32_bf16 v[40:43], a[0:3], v[0:3], 0
  ds_read_b128 v[12:15], v100 offset:0
  v_mfma_f32_16x16x32_bf16 v[44:47], a[4:7], v[0:3], 0
  v_xor_b32 v120, s66, v0
  v_mfma_f32_16x16x32_bf16 v[48:51], a[8:11], v[0:3], 0
  s_waitcnt lgkmcnt(2)
  buffer_store_dwordx4 v[124:127], v123, s[32:35], s86 offen sc1
  v_mfma_f32_16x16x32_bf16 v[40:43], a[12:15], v[4:7], v[40:43]
  ds_read_b128 v[0:3], v97 offset:8192
  v_mfma_f32_16x16x32_bf16 v[44:47], a[16:19], v[4:7], v[44:47]
  v_bitop3_b32 v120, v120, v4, s66 bitop3:246
  v_mfma_f32_16x16x32_bf16 v[48:51], a[20:23], v[4:7], v[48:51]
  s_waitcnt lgkmcnt(2)
  s_mov_b64 exec, 1
  buffer_store_dword v110, off, s[32:35], s93 sc1
  s_mov_b64 exec, -1
  v_mfma_f32_16x16x32_bf16 v[40:43], a[24:27], v[8:11], v[40:43]
  ds_read_b128 v[4:7], v98 offset:8192
  v_mfma_f32_16x16x32_bf16 v[44:47], a[28:31], v[8:11], v[44:47]
  v_bitop3_b32 v120, v120, v8, s66 bitop3:246
  v_mfma_f32_16x16x32_bf16 v[48:51], a[32:35], v[8:11], v[48:51]
  s_waitcnt lgkmcnt(2)
  buffer_store_dwordx2 v[116:117], v103, s[36:39], s64 offen
  v_mfma_f32_16x16x32_bf16 v[40:43], a[36:39], v[12:15], v[40:43]
  ds_read_b128 v[8:11], v99 offset:8192
  v_mfma_f32_16x16x32_bf16 v[44:47], a[40:43], v[12:15], v[44:47]
  v_bitop3_b32 v120, v120, v12, s66 bitop3:246
  s_add_u32 s87, s64, s60
  v_mfma_f32_16x16x32_bf16 v[48:51], a[44:47], v[12:15], v[48:51]
  s_waitcnt lgkmcnt(2)
  v_mfma_f32_16x16x32_bf16 v[40:43], a[48:51], v[0:3], v[40:43]
  ds_read_b128 v[12:15], v100 offset:8192
  v_mfma_f32_16x16x32_bf16 v[44:47], a[52:55], v[0:3], v[44:47]
  v_bitop3_b32 v120, v120, v0, s66 bitop3:246
  v_mfma_f32_16x16x32_bf16 v[48:51], a[56:59], v[0:3], v[48:51]
  s_waitcnt lgkmcnt(2)
  buffer_store_dwordx2 v[116:117], v103, s[32:35], s87 offen sc1
  v_mfma_f32_16x16x32_bf16 v[40:43], a[60:63], v[4:7], v[40:43]
  ds_read_b128 v[0:3], v97 offset:16384
  v_mfma_f32_16x16x32_bf16 v[44:47], a[64:67], v[4:7], v[44:47]
  v_bitop3_b32 v120, v120, v4, s66 bitop3:246
  v_mfma_f32_16x16x32_bf16 v[48:51], a[68:71], v[4:7], v[48:51]
  s_waitcnt lgkmcnt(2)
  buffer_store_dwordx2 v[112:113], v103, s[36:39], s84 offen
  v_mfma_f32_16x16x32_bf16 v[40:43], a[72:75], v[8:11], v[40:43]
  ds_read_b128 v[4:7], v98 offset:16384
  v_mfma_f32_16x16x32_bf16 v[44:47], a[76:79], v[8:11], v[44:47]
  v_bitop3_b32 v120, v120, v8, s66 bitop3:246
  s_add_u32 s86, s84, s60
  v_mfma_f32_16x16x32_bf16 v[48:51], a[80:83], v[8:11], v[48:51]
  s_waitcnt lgkmcnt(2)
  v_mfma_f32_16x16x32_bf16 v[40:43], a[84:87], v[12:15], v[40:43]
  ds_read_b128 v[8:11], v99 offset:16384
  v_mfma_f32_16x16x32_bf16 v[44:47], a[88:91], v[12:15], v[44:47]
  v_bitop3_b32 v120, v120, v12, s66 bitop3:246
  v_mfma_f32_16x16x32_bf16 v[48:51], a[92:95], v[12:15], v[48:51]
  s_waitcnt lgkmcnt(2)
  buffer_store_dwordx2 v[112:113], v103, s[32:35], s86 offen sc1
  v_mfma_f32_16x16x32_bf16 v[40:43], a[96:99], v[0:3], v[40:43]
  ds_read_b128 v[12:15], v100 offset:16384
  s_and_b32 s65, s50, 3
  s_lshl_b32 s65, s65, 18
  v_mfma_f32_16x16x32_bf16 v[44:47], a[100:103], v[0:3], v[44:47]
  v_bitop3_b32 v120, v120, v0, s66 bitop3:246
  s_add_u32 s65, s65, s57
  v_mfma_f32_16x16x32_bf16 v[48:51], a[104:107], v[0:3], v[48:51]
  s_waitcnt lgkmcnt(2)
  s_lshr_b32 s54, s50, 2
  s_add_u32 s54, s54, 1
  v_mfma_f32_16x16x32_bf16 v[40:43], a[108:111], v[4:7], v[40:43]
  ds_read_b128 v[0:3], v97 offset:24576
  v_mfma_f32_16x16x32_bf16 v[44:47], a[112:115], v[4:7], v[44:47]
  v_bitop3_b32 v120, v120, v4, s66 bitop3:246
  v_mfma_f32_16x16x32_bf16 v[48:51], a[116:119], v[4:7], v[48:51]
  s_waitcnt lgkmcnt(2)
  v_mfma_f32_16x16x32_bf16 v[40:43], a[120:123], v[8:11], v[40:43]
  s_waitcnt vmcnt(6)
  s_barrier
  ds_read_b128 v[4:7], v98 offset:24576
  v_mfma_f32_16x16x32_bf16 v[44:47], a[124:127], v[8:11], v[44:47]
  v_bitop3_b32 v120, v120, v8, s66 bitop3:246
  v_mfma_f32_16x16x32_bf16 v[48:51], a[128:131], v[8:11], v[48:51]
  s_waitcnt lgkmcnt(2)
LPFs_join:
  v_mfma_f32_16x16x32_bf16 v[40:43], a[132:135], v[12:15], v[40:43]
  ds_read_b128 v[8:11], v99 offset:24576
  v_mfma_f32_16x16x32_bf16 v[44:47], a[136:139], v[12:15], v[44:47]
  v_bitop3_b32 v120, v120, v12, s66 bitop3:246
  v_mfma_f32_16x16x32_bf16 v[48:51], a[140:143], v[12:15], v[48:51]
  s_waitcnt lgkmcnt(2)
  s_mov_b64 exec, 1
  buffer_store_dword v110, off, s[32:35], s88 sc1
  s_mov_b64 exec, -1
  v_mfma_f32_16x16x32_bf16 v[40:43], a[144:147], v[0:3], v[40:43]
  ds_read_b128 v[12:15], v100 offset:24576
  s_add_u32 s88, s88, 4096
  s_cmp_ge_u32 s50, 56
  s_cselect_b32 s88, 1073741824, s88
  v_mfma_f32_16x16x32_bf16 v[44:47], a[148:151], v[0:3], v[44:47]
  v_bitop3_b32 v120, v120, v0, s66 bitop3:246
  v_lshlrev_b32 v122, 3, v96
  v_mfma_f32_16x16x32_bf16 v[48:51], a[152:155], v[0:3], v[48:51]
  s_waitcnt lgkmcnt(2)
  v_and_b32 v122, 0x380, v122
  s_add_u32 s51, s50, 2
  v_mfma_f32_16x16x32_bf16 v[40:43], a[156:159], v[4:7], v[40:43]
  ds_read_b128 v[0:3], v97 offset:4096
  s_and_b32 s51, s51, 7
  s_lshl_b32 s51, s51, 15
  v_mfma_f32_16x16x32_bf16 v[44:47], a[160:163], v[4:7], v[44:47]
  v_bitop3_b32 v120, v120, v4, s66 bitop3:246
  s_add_u32 s51, s51, s95
  v_mfma_f32_16x16x32_bf16 v[48:51], a[164:167], v[4:7], v[48:51]
  s_waitcnt lgkmcnt(2)
  buffer_load_dword v111, v122, s[32:35], s51 offen sc1
  v_mfma_f32_16x16x32_bf16 v[40:43], a[168:171], v[8:11], v[40:43]
  ds_read_b128 v[4:7], v98 offset:4096
  buffer_load_dword v111, v108, s[32:35], s91 offen offset:512 sc1
  v_mfma_f32_16x16x32_bf16 v[44:47], a[172:175], v[8:11], v[44:47]
  v_bitop3_b32 v120, v120, v8, s66 bitop3:246
  v_mfma_f32_16x16x32_bf16 v[48:51], a[176:179], v[8:11], v[48:51]
  s_waitcnt lgkmcnt(2)
  v_mfma_f32_16x16x32_bf16 v[40:43], a[180:183], v[12:15], v[40:43]
  ds_read_b128 v[8:11], v99 offset:4096
  v_mfma_f32_16x16x32_bf16 v[44:47], a[184:187], v[12:15], v[44:47]
  v_bitop3_b32 v120, v120, v12, s66 bitop3:246
  v_mfma_f32_16x16x32_bf16 v[48:51], a[188:191], v[12:15], v[48:51]
  s_waitcnt lgkmcnt(2)
  v_mfma_f32_16x16x32_bf16 v[52:55], a[0:3], v[0:3], 0
  ds_read_b128 v[12:15], v100 offset:4096
  v_mfma_f32_16x16x32_bf16 v[56:59], a[4:7], v[0:3], 0
  v_bitop3_b32 v120, v120, v0, s66 bitop3:246
  v_mfma_f32_16x16x32_bf16 v[60:63], a[8:11], v[0:3], 0
  s_waitcnt lgkmcnt(2)
  v_max_f32 v40, 0, v40
  v_max_f32 v41, 0, v41
  v_mfma_f32_16x16x32_bf16 v[52:55], a[12:15], v[4:7], v[52:55]
  ds_read_b128 v[0:3], v97 offset:12288
  v_max_f32 v42, 0, v42
  v_max_f32 v43, 0, v43
  v_mfma_f32_16x16x32_bf16 v[56:59], a[16:19], v[4:7], v[56:59]
  v_bitop3_b32 v120, v120, v4, s66 bitop3:246
  v_max_f32 v44, 0, v44
  v_mfma_f32_16x16x32_bf16 v[60:63], a[20:23], v[4:7], v[60:63]
  s_waitcnt lgkmcnt(2)
  v_max_f32 v45, 0, v45
  v_max_f32 v46, 0, v46
  v_mfma_f32_16x16x32_bf16 v[52:55], a[24:27], v[8:11], v[52:55]
  ds_read_b128 v[4:7], v98 offset:12288
  v_max_f32 v47, 0, v47
  v_cvt_pk_bf16_f32 v112, v40, v41
  v_mfma_f32_16x16x32_bf16 v[56:59], a[28:31], v[8:11], v[56:59]
  v_bitop3_b32 v120, v120, v8, s66 bitop3:246
  v_cvt_pk_bf16_f32 v113, v42, v43
  v_mfma_f32_16x16x32_bf16 v[60:63], a[32:35], v[8:11], v[60:63]
  s_waitcnt lgkmcnt(2)
  v_cvt_pk_bf16_f32 v114, v44, v45
  v_cvt_pk_bf16_f32 v115, v46, v47
  v_mfma_f32_16x16x32_bf16 v[52:55], a[36:39], v[12:15], v[52:55]
  ds_read_b128 v[8:11], v99 offset:12288
  ds_write_b128 v107, v[112:115] offset:0
  v_mfma_f32_16x16x32_bf16 v[56:59], a[40:43], v[12:15], v[56:59]
  v_bitop3_b32 v120, v120, v12, s66 bitop3:246
  v_max_f32 v48, 0, v48
  v_mfma_f32_16x16x32_bf16 v[60:63], a[44:47], v[12:15], v[60:63]
  s_waitcnt lgkmcnt(3)
  v_max_f32 v49, 0, v49
  v_max_f32 v50, 0, v50
  v_mfma_f32_16x16x32_bf16 v[52:55], a[48:51], v[0:3], v[52:55]
  ds_read_b128 v[12:15], v100 offset:12288
  v_max_f32 v51, 0, v51
  v_cvt_pk_bf16_f32 v116, v48, v49
  v_mfma_f32_16x16x32_bf16 v[56:59], a[52:55], v[0:3], v[56:59]
  v_bitop3_b32 v120, v120, v0, s66 bitop3:246
  v_cvt_pk_bf16_f32 v117, v50, v51
  v_mfma_f32_16x16x32_bf16 v[60:63], a[56:59], v[0:3], v[60:63]
  s_waitcnt lgkmcnt(3)
  ds_write_b64 v109, v[116:117] offset:1024
  v_mfma_f32_16x16x32_bf16 v[52:55], a[60:63], v[4:7], v[52:55]
  ds_read_b128 v[0:3], v97 offset:20480
  v_mfma_f32_16x16x32_bf16 v[56:59], a[64:67], v[4:7], v[56:59]
  v_bitop3_b32 v120, v120, v4, s66 bitop3:246
  v_mfma_f32_16x16x32_bf16 v[60:63], a[68:71], v[4:7], v[60:63]
  s_waitcnt lgkmcnt(4)
  v_mfma_f32_16x16x32_bf16 v[52:55], a[72:75], v[8:11], v[52:55]
  ds_read_b128 v[4:7], v98 offset:20480
  v_mfma_f32_16x16x32_bf16 v[56:59], a[76:79], v[8:11], v[56:59]
  v_bitop3_b32 v120, v120, v8, s66 bitop3:246
  v_mfma_f32_16x16x32_bf16 v[60:63], a[80:83], v[8:11], v[60:63]
  s_waitcnt lgkmcnt(3)
  s_waitcnt lgkmcnt(2)
  v_mfma_f32_16x16x32_bf16 v[52:55], a[84:87], v[12:15], v[52:55]
  ds_read_b128 v[8:11], v99 offset:20480
  s_barrier
  v_mfma_f32_16x16x32_bf16 v[56:59], a[88:91], v[12:15], v[56:59]
  v_bitop3_b32 v120, v120, v12, s66 bitop3:246
  v_mfma_f32_16x16x32_bf16 v[60:63], a[92:95], v[12:15], v[60:63]
  s_waitcnt lgkmcnt(2)
  ds_read_b128 v[16:19], v110 offset:0
  v_mfma_f32_16x16x32_bf16 v[52:55], a[96:99], v[0:3], v[52:55]
  ds_read_b128 v[12:15], v100 offset:20480
  v_mfma_f32_16x16x32_bf16 v[56:59], a[100:103], v[0:3], v[56:59]
  v_bitop3_b32 v120, v120, v0, s66 bitop3:246
  ds_read_b128 v[20:23], v110 offset:1024
  v_mfma_f32_16x16x32_bf16 v[60:63], a[104:107], v[0:3], v[60:63]
  s_waitcnt lgkmcnt(4)
  v_mfma_f32_16x16x32_bf16 v[52:55], a[108:111], v[4:7], v[52:55]
  ds_read_b128 v[0:3], v97 offset:28672
  ds_read_b128 v[24:27], v110 offset:2048
  v_mfma_f32_16x16x32_bf16 v[56:59], a[112:115], v[4:7], v[56:59]
  v_bitop3_b32 v120, v120, v4, s66 bitop3:246
  v_mfma_f32_16x16x32_bf16 v[60:63], a[116:119], v[4:7], v[60:63]
  s_waitcnt lgkmcnt(5)
  ds_read_b128 v[28:31], v110 offset:3072
  v_mfma_f32_16x16x32_bf16 v[52:55], a[120:123], v[8:11], v[52:55]
  ds_read_b128 v[4:7], v98 offset:28672
  v_mfma_f32_16x16x32_bf16 v[56:59], a[124:127], v[8:11], v[56:59]
  v_bitop3_b32 v120, v120, v8, s66 bitop3:246
  ds_read_b128 v[32:35], v110 offset:4096
  v_mfma_f32_16x16x32_bf16 v[60:63], a[128:131], v[8:11], v[60:63]
  s_waitcnt lgkmcnt(6)
  v_mfma_f32_16x16x32_bf16 v[52:55], a[132:135], v[12:15], v[52:55]
  ds_read_b128 v[8:11], v99 offset:28672
  ds_read_b128 v[36:39], v110 offset:5120
  v_mfma_f32_16x16x32_bf16 v[56:59], a[136:139], v[12:15], v[56:59]
  v_bitop3_b32 v120, v120, v12, s66 bitop3:246
  v_mfma_f32_16x16x32_bf16 v[60:63], a[140:143], v[12:15], v[60:63]
  s_waitcnt lgkmcnt(6)
  v_mfma_f32_16x16x32_bf16 v[52:55], a[144:147], v[0:3], v[52:55]
  ds_read_b128 v[12:15], v100 offset:28672
  v_mfma_f32_16x16x32_bf16 v[56:59], a[148:151], v[0:3], v[56:59]
  v_bitop3_b32 v120, v120, v0, s66 bitop3:246
  v_mfma_f32_16x16x32_bf16 v[60:63], a[152:155], v[0:3], v[60:63]
  s_waitcnt lgkmcnt(4)
  v_mfma_f32_16x16x32_bf16 v[52:55], a[156:159], v[4:7], v[52:55]
  v_mfma_f32_16x16x32_bf16 v[56:59], a[160:163], v[4:7], v[56:59]
  v_bitop3_b32 v120, v120, v4, s66 bitop3:246
  v_mfma_f32_16x16x32_bf16 v[60:63], a[164:167], v[4:7], v[60:63]
  s_waitcnt lgkmcnt(2)
  v_mfma_f32_16x16x32_bf16 v[52:55], a[168:171], v[8:11], v[52:55]
  v_mfma_f32_16x16x32_bf16 v[56:59], a[172:175], v[8:11], v[56:59]
  v_bitop3_b32 v120, v120, v8, s66 bitop3:246
  v_mfma_f32_16x16x32_bf16 v[60:63], a[176:179], v[8:11], v[60:63]
  s_waitcnt lgkmcnt(0)
  v_mfma_f32_16x16x32_bf16 v[52:55], a[180:183], v[12:15], v[52:55]
  v_mfma_f32_16x16x32_bf16 v[56:59], a[184:187], v[12:15], v[56:59]
  v_bitop3_b32 v120, v120, v12, s66 bitop3:246
  v_mfma_f32_16x16x32_bf16 v[60:63], a[188:191], v[12:15], v[60:63]
  v_and_b32 v120, 1, v120
  v_cmp_ne_u32 vcc, 0, v120
  v_mfma_f32_16x16x32_bf16 v[64:67], v[16:19], a[192:195], 0
  s_cbranch_vccnz LPFs_redo
  s_mov_b32 s92, s50
  s_add_u32 s50, s50, 2
  v_mfma_f32_16x16x32_bf16 v[68:71], v[16:19], a[196:199], 0
  s_lshl_b32 s91, s50, 8
  s_add_u32 s91, s91, s56
  s_and_b32 s90, s50, 7
  v_mfma_f32_16x16x32_bf16 v[72:75], v[16:19], a[200:203], 0
  s_lshl_b32 s90, s90, 15
  s_add_u32 s90, s90, s55
  v_mfma_f32_16x16x32_bf16 v[76:79], v[16:19], a[204:207], 0
  buffer_load_dword v111, v108, s[32:35], s91 offen sc1
  v_max_f32 v52, 0, v52
  v_mfma_f32_16x16x32_bf16 v[64:67], v[20:23], a[208:211], v[64:67]
  v_max_f32 v53, 0, v53
  v_max_f32 v54, 0, v54
  v_mfma_f32_16x16x32_bf16 v[68:71], v[20:23], a[212:215], v[68:71]
  v_max_f32 v55, 0, v55
  v_max_f32 v56, 0, v56
  v_mfma_f32_16x16x32_bf16 v[72:75], v[20:23], a[216:219], v[72:75]
  v_max_f32 v57, 0, v57
  v_max_f32 v58, 0, v58
  v_mfma_f32_16x16x32_bf16 v[76:79], v[20:23], a[220:223], v[76:79]
  v_max_f32 v59, 0, v59
  v_cvt_pk_bf16_f32 v112, v52, v53
  v_mfma_f32_16x16x32_bf16 v[64:67], v[24:27], a[224:227], v[64:67]
  v_cvt_pk_bf16_f32 v113, v54, v55
  v_cvt_pk_bf16_f32 v114, v56, v57
  v_mfma_f32_16x16x32_bf16 v[68:71], v[24:27], a[228:231], v[68:71]
  v_cvt_pk_bf16_f32 v115, v58, v59
  v_mfma_f32_16x16x32_bf16 v[72:75], v[24:27], a[232:235], v[72:75]
  ds_write_b128 v107, v[112:115] offset:6144
  v_mfma_f32_16x16x32_bf16 v[76:79], v[24:27], a[236:239], v[76:79]
  v_max_f32 v60, 0, v60
  v_max_f32 v61, 0, v61
  v_mfma_f32_16x16x32_bf16 v[64:67], v[28:31], a[240:243], v[64:67]
  v_max_f32 v62, 0, v62
  v_max_f32 v63, 0, v63
  v_mfma_f32_16x16x32_bf16 v[68:71], v[28:31], a[244:247], v[68:71]
  v_cvt_pk_bf16_f32 v116, v60, v61
  v_cvt_pk_bf16_f32 v117, v62, v63
  v_mfma_f32_16x16x32_bf16 v[72:75], v[28:31], a[248:251], v[72:75]
  ds_write_b64 v109, v[116:117] offset:7168
  s_lshl_b32 s84, s92, 15
  v_mfma_f32_16x16x32_bf16 v[76:79], v[28:31], a[252:255], v[76:79]
  s_and_b32 s86, s92, 3
  s_lshl_b32 s86, s86, 18
  s_add_u32 s86, s86, s58
  v_mfma_f32_16x16x32_bf16 v[64:67], v[32:35], v[128:131], v[64:67]
  s_lshr_b32 s85, s92, 2
  s_add_u32 s85, s85, 1
  s_and_b32 s67, s92, 7
  v_mfma_f32_16x16x32_bf16 v[68:71], v[32:35], v[132:135], v[68:71]
  s_lshl_b32 s67, s67, 16
  s_add_u32 s67, s67, s59
  s_add_u32 s52, s67, 0
  v_mfma_f32_16x16x32_bf16 v[72:75], v[32:35], v[136:139], v[72:75]
  buffer_load_dwordx4 v[44:47], v96, s[32:35], s52 offen sc1
  s_add_u32 s52, s67, 32768
  v_mfma_f32_16x16x32_bf16 v[76:79], v[32:35], v[140:143], v[76:79]
  buffer_load_dwordx4 v[52:55], v96, s[32:35], s52 offen sc1
  v_mfma_f32_16x16x32_bf16 v[64:67], v[36:39], v[144:147], v[64:67]
  s_waitcnt lgkmcnt(0)
  s_barrier
  v_mfma_f32_16x16x32_bf16 v[68:71], v[36:39], v[148:151], v[68:71]
  v_mfma_f32_16x16x32_bf16 v[72:75], v[36:39], v[152:155], v[72:75]
  s_waitcnt vmcnt(2)
  v_cmp_eq_u32 vcc, 0, v111
  v_mfma_f32_16x16x32_bf16 v[76:79], v[36:39], v[156:159], v[76:79]
  v_mfma_f32_16x16x32_bf16 v[80:83], v[16:19], v[160:163], 0
  s_mov_b32 s83, 0
  s_cmp_ge_u32 s50, 64
  s_cselect_b64 vcc, -1, vcc
  v_mfma_f32_16x16x32_bf16 v[84:87], v[16:19], v[164:167], 0
  s_cbranch_vccz LPFs_E
  v_mfma_f32_16x16x32_bf16 v[88:91], v[16:19], v[168:171], 0
  v_mfma_f32_16x16x32_bf16 v[92:95], v[16:19], v[172:175], 0
  ds_read_b128 v[16:19], v110 offset:6144
  v_cvt_pk_bf16_f32 v112, v64, v68
  v_cvt_pk_bf16_f32 v113, v72, v76
  v_mfma_f32_16x16x32_bf16 v[80:83], v[20:23], v[176:179], v[80:83]
  v_cvt_pk_bf16_f32 v114, v65, v69
  v_cvt_pk_bf16_f32 v115, v73, v77
  v_mfma_f32_16x16x32_bf16 v[84:87], v[20:23], v[180:183], v[84:87]
  v_bfi_b32 v112, 1, s54, v112
  v_mfma_f32_16x16x32_bf16 v[88:91], v[20:23], v[184:187], v[88:91]
  s_add_u32 s51, s65, 0
  buffer_store_dwordx4 v[112:115], v102, s[32:35], s51 offen offset:0 sc1
  v_mfma_f32_16x16x32_bf16 v[92:95], v[20:23], v[188:191], v[92:95]
  ds_read_b128 v[20:23], v110 offset:7168
  v_mfma_f32_16x16x32_bf16 v[80:83], v[24:27], v[192:195], v[80:83]
  v_cvt_pk_bf16_f32 v116, v66, v70
  v_cvt_pk_bf16_f32 v117, v74, v78
  v_mfma_f32_16x16x32_bf16 v[84:87], v[24:27], v[196:199], v[84:87]
  v_cvt_pk_bf16_f32 v118, v67, v71
  v_cvt_pk_bf16_f32 v119, v75, v79
  v_mfma_f32_16x16x32_bf16 v[88:91], v[24:27], v[200:203], v[88:91]
  v_bfi_b32 v116, 1, s54, v116
  v_mfma_f32_16x16x32_bf16 v[92:95], v[24:27], v[204:207], v[92:95]
  ds_read_b128 v[24:27], v110 offset:8192
  s_add_u32 s51, s65, 16384
  buffer_store_dwordx4 v[116:119], v102, s[32:35], s51 offen offset:0 sc1
  v_mfma_f32_16x16x32_bf16 v[80:83], v[28:31], v[208:211], v[80:83]
  v_mfma_f32_16x16x32_bf16 v[84:87], v[28:31], v[212:215], v[84:87]
  s_lshl_b32 s64, s92, 15
  s_add_u32 s64, s64, 16384
  s_and_b32 s87, s92, 3
  v_mfma_f32_16x16x32_bf16 v[88:91], v[28:31], v[216:219], v[88:91]
  s_lshl_b32 s87, s87, 18
  s_add_u32 s87, s87, s58
  s_add_u32 s87, s87, 131072
  v_mfma_f32_16x16x32_bf16 v[92:95], v[28:31], v[220:223], v[92:95]
  ds_read_b128 v[28:31], v110 offset:9216
  v_mfma_f32_16x16x32_bf16 v[80:83], v[32:35], v[224:227], v[80:83]
  v_mfma_f32_16x16x32_bf16 v[84:87], v[32:35], v[228:231], v[84:87]
  v_mfma_f32_16x16x32_bf16 v[88:91], v[32:35], v[232:235], v[88:91]
  v_mfma_f32_16x16x32_bf16 v[92:95], v[32:35], v[236:239], v[92:95]
  ds_read_b128 v[32:35], v110 offset:10240
  v_mfma_f32_16x16x32_bf16 v[80:83], v[36:39], v[240:243], v[80:83]
  v_mfma_f32_16x16x32_bf16 v[84:87], v[36:39], v[244:247], v[84:87]
  v_mfma_f32_16x16x32_bf16 v[88:91], v[36:39], v[248:251], v[88:91]
  v_mfma_f32_16x16x32_bf16 v[92:95], v[36:39], v[252:255], v[92:95]
  ds_read_b128 v[36:39], v110 offset:11264
  s_waitcnt lgkmcnt(5)
  v_mfma_f32_16x16x32_bf16 v[64:67], v[16:19], a[192:195], 0
  v_mfma_f32_16x16x32_bf16 v[68:71], v[16:19], a[196:199], 0
  v_mfma_f32_16x16x32_bf16 v[72:75], v[16:19], a[200:203], 0
  v_mfma_f32_16x16x32_bf16 v[76:79], v[16:19], a[204:207], 0
  s_waitcnt lgkmcnt(4)
  v_cvt_pk_bf16_f32 v112, v80, v84
  v_cvt_pk_bf16_f32 v113, v88, v92
  v_mfma_f32_16x16x32_bf16 v[64:67], v[20:23], a[208:211], v[64:67]
  v_cvt_pk_bf16_f32 v114, v81, v85
  v_cvt_pk_bf16_f32 v115, v89, v93
  v_mfma_f32_16x16x32_bf16 v[68:71], v[20:23], a[212:215], v[68:71]
  v_bfi_b32 v112, 1, s54, v112
  v_mfma_f32_16x16x32_bf16 v[72:75], v[20:23], a[216:219], v[72:75]
  s_add_u32 s51, s65, 0
  buffer_store_dwordx4 v[112:115], v102, s[32:35], s51 offen offset:2048 sc1
  v_mfma_f32_16x16x32_bf16 v[76:79], v[20:23], a[220:223], v[76:79]
  s_waitcnt lgkmcnt(3)
  v_cvt_pk_bf16_f32 v116, v82, v86
  v_cvt_pk_bf16_f32 v117, v90, v94
  v_mfma_f32_16x16x32_bf16 v[64:67], v[24:27], a[224:227], v[64:67]
  v_cvt_pk_bf16_f32 v118, v83, v87
  v_cvt_pk_bf16_f32 v119, v91, v95
  v_mfma_f32_16x16x32_bf16 v[68:71], v[24:27], a[228:231], v[68:71]
  v_bfi_b32 v116, 1, s54, v116
  v_mfma_f32_16x16x32_bf16 v[72:75], v[24:27], a[232:235], v[72:75]
  s_add_u32 s51, s65, 16384
  buffer_store_dwordx4 v[116:119], v102, s[32:35], s51 offen offset:2048 sc1
  v_mfma_f32_16x16x32_bf16 v[76:79], v[24:27], a[236:239], v[76:79]
  s_waitcnt lgkmcnt(2)
  v_mfma_f32_16x16x32_bf16 v[64:67], v[28:31], a[240:243], v[64:67]
  v_mfma_f32_16x16x32_bf16 v[68:71], v[28:31], a[244:247], v[68:71]
  v_mfma_f32_16x16x32_bf16 v[72:75], v[28:31], a[248:251], v[72:75]
  v_add_u32 v122, 78400, v96
  ds_read_b128 v[56:59], v122
  v_mfma_f32_16x16x32_bf16 v[76:79], v[28:31], a[252:255], v[76:79]
  s_waitcnt lgkmcnt(2)
  ds_read_b128 v[60:63], v122 offset:1024
  v_mfma_f32_16x16x32_bf16 v[64:67], v[32:35], v[128:131], v[64:67]
  v_mfma_f32_16x16x32_bf16 v[68:71], v[32:35], v[132:135], v[68:71]
  v_mfma_f32_16x16x32_bf16 v[72:75], v[32:35], v[136:139], v[72:75]
LPFs_EJ:
  v_mfma_f32_16x16x32_bf16 v[76:79], v[32:35], v[140:143], v[76:79]
  s_waitcnt lgkmcnt(2)
  v_mfma_f32_16x16x32_bf16 v[64:67], v[36:39], v[144:147], v[64:67]
  buffer_load_dwordx4 v[0:3], v96, s[32:35], s86 offen offset:0 sc1
  v_mfma_f32_16x16x32_bf16 v[68:71], v[36:39], v[148:151], v[68:71]
  v_mfma_f32_16x16x32_bf16 v[72:75], v[36:39], v[152:155], v[72:75]
  v_mfma_f32_16x16x32_bf16 v[76:79], v[36:39], v[156:159], v[76:79]
  v_mfma_f32_16x16x32_bf16 v[80:83], v[16:19], v[160:163], 0
  buffer_load_dwordx4 v[4:7], v96, s[32:35], s86 offen offset:1024 sc1
  v_mfma_f32_16x16x32_bf16 v[84:87], v[16:19], v[164:167], 0
  v_mfma_f32_16x16x32_bf16 v[88:91], v[16:19], v[168:171], 0
  v_mfma_f32_16x16x32_bf16 v[92:95], v[16:19], v[172:175], 0
  v_cvt_pk_bf16_f32 v112, v64, v68
  v_cvt_pk_bf16_f32 v113, v72, v76
  v_mfma_f32_16x16x32_bf16 v[80:83], v[20:23], v[176:179], v[80:83]
  v_cvt_pk_bf16_f32 v114, v65, v69
  v_cvt_pk_bf16_f32 v115, v73, v77
  v_mfma_f32_16x16x32_bf16 v[84:87], v[20:23], v[180:183], v[84:87]
  v_bfi_b32 v112, 1, s54, v112
  v_mfma_f32_16x16x32_bf16 v[88:91], v[20:23], v[184:187], v[88:91]
  s_add_u32 s51, s65, 131072
  buffer_store_dwordx4 v[112:115], v102, s[32:35], s51 offen offset:0 sc1
  v_mfma_f32_16x16x32_bf16 v[92:95], v[20:23], v[188:191], v[92:95]
  v_cvt_pk_bf16_f32 v116, v66, v70
  v_cvt_pk_bf16_f32 v117, v74, v78
  v_mfma_f32_16x16x32_bf16 v[80:83], v[24:27], v[192:195], v[80:83]
  v_cvt_pk_bf16_f32 v118, v67, v71
  v_cvt_pk_bf16_f32 v119, v75, v79
  v_mfma_f32_16x16x32_bf16 v[84:87], v[24:27], v[196:199], v[84:87]
  v_bfi_b32 v116, 1, s54, v116
  v_mfma_f32_16x16x32_bf16 v[88:91], v[24:27], v[200:203], v[88:91]
  s_add_u32 s51, s65, 147456
  buffer_store_dwordx4 v[116:119], v102, s[32:35], s51 offen offset:0 sc1
  v_mfma_f32_16x16x32_bf16 v[92:95], v[24:27], v[204:207], v[92:95]
  v_mfma_f32_16x16x32_bf16 v[80:83], v[28:31], v[208:211], v[80:83]
  v_mfma_f32_16x16x32_bf16 v[84:87], v[28:31], v[212:215], v[84:87]
  v_mfma_f32_16x16x32_bf16 v[88:91], v[28:31], v[216:219], v[88:91]
  buffer_load_dwordx4 v[8:11], v96, s[32:35], s86 offen offset:2048 sc1
  v_mfma_f32_16x16x32_bf16 v[92:95], v[28:31], v[220:223], v[92:95]
  v_mfma_f32_16x16x32_bf16 v[80:83], v[32:35], v[224:227], v[80:83]
  v_mfma_f32_16x16x32_bf16 v[84:87], v[32:35], v[228:231], v[84:87]
  v_mfma_f32_16x16x32_bf16 v[88:91], v[32:35], v[232:235], v[88:91]
  buffer_load_dwordx4 v[12:15], v96, s[32:35], s86 offen offset:3072 sc1
  v_mfma_f32_16x16x32_bf16 v[92:95], v[32:35], v[236:239], v[92:95]
  v_mfma_f32_16x16x32_bf16 v[80:83], v[36:39], v[240:243], v[80:83]
  s_waitcnt vmcnt(11)
  v_xor_b32 v120, s66, v44
  s_waitcnt vmcnt(10)
  v_mfma_f32_16x16x32_bf16 v[84:87], v[36:39], v[244:247], v[84:87]
  v_xor_b32 v121, s66, v52
  v_mfma_f32_16x16x32_bf16 v[88:91], v[36:39], v[248:251], v[88:91]
  v_mfma_f32_16x16x32_bf16 v[92:95], v[36:39], v[252:255], v[92:95]
  s_waitcnt lgkmcnt(0)
  s_waitcnt vmcnt(5)
  v_mfma_f32_16x16x32_bf16 v[44:47], v[56:59], v[0:3], v[44:47]
  v_bitop3_b32 v120, v120, v0, s85 bitop3:246
  s_waitcnt vmcnt(4)
  v_mfma_f32_16x16x32_bf16 v[44:47], v[56:59], v[4:7], v[44:47]
  v_bitop3_b32 v120, v120, v4, s85 bitop3:246
  v_cvt_pk_bf16_f32 v112, v80, v84
  v_cvt_pk_bf16_f32 v113, v88, v92
  v_cvt_pk_bf16_f32 v114, v81, v85
  v_cvt_pk_bf16_f32 v115, v89, v93
  v_bfi_b32 v112, 1, s54, v112
  s_add_u32 s51, s65, 131072
  buffer_store_dwordx4 v[112:115], v102, s[32:35], s51 offen offset:2048 sc1
  v_cvt_pk_bf16_f32 v116, v82, v86
  v_cvt_pk_bf16_f32 v117, v90, v94
  v_cvt_pk_bf16_f32 v118, v83, v87
  v_cvt_pk_bf16_f32 v119, v91, v95
  v_bfi_b32 v116, 1, s54, v116
  s_add_u32 s51, s65, 147456
  buffer_store_dwordx4 v[116:119], v102, s[32:35], s51 offen offset:2048 sc1
  s_waitcnt vmcnt(3)
  v_mfma_f32_16x16x32_bf16 v[44:47], v[60:63], v[8:11], v[44:47]
  v_bitop3_b32 v120, v120, v8, s85 bitop3:246
  s_waitcnt vmcnt(2)
  v_mfma_f32_16x16x32_bf16 v[44:47], v[60:63], v[12:15], v[44:47]
  v_bitop3_b32 v120, v120, v12, s85 bitop3:246
  v_and_b32 v120, 1, v120
  v_cmp_ne_u32 vcc, 0, v120
  s_cbranch_vccnz LPFs_c_r
LPFs_c:
  s_nop 3
  v_add_f32 v0, v44, v45
  v_mul_f32 v1, v44, v44
  v_add_f32 v2, v46, v47
  v_fmac_f32 v1, v45, v45
  v_add_f32 v0, v0, v2
  v_fmac_f32 v1, v46, v46
  v_fmac_f32 v1, v47, v47
  v_add_f32_dpp v0, v0, v0 row_ror:8 row_mask:0xf bank_mask:0xf
  v_cvt_pk_bf16_f32 v112, v44, v45
  v_add_f32_dpp v1, v1, v1 row_ror:8 row_mask:0xf bank_mask:0xf
  v_add_f32_dpp v0, v0, v0 row_ror:4 row_mask:0xf bank_mask:0xf
  v_cvt_pk_bf16_f32 v113, v46, v47
  v_add_f32_dpp v1, v1, v1 row_ror:4 row_mask:0xf bank_mask:0xf
  v_add_f32_dpp v0, v0, v0 row_ror:2 row_mask:0xf bank_mask:0xf
  s_nop 0
  v_add_f32_dpp v1, v1, v1 row_ror:2 row_mask:0xf bank_mask:0xf
  v_add_f32_dpp v0, v0, v0 row_ror:1 row_mask:0xf bank_mask:0xf
  s_nop 0
  v_add_f32_dpp v1, v1, v1 row_ror:1 row_mask:0xf bank_mask:0xf
  s_nop 1
  v_permlane32_swap_b32 v0, v1
  v_add_f32 v0, v0, v1
  ds_write_b32 v105, v0 offset:0
  s_waitcnt vmcnt(0)
  buffer_load_dwordx4 v[64:67], v96, s[32:35], s87 offen offset:0 sc1
  buffer_load_dwordx4 v[68:71], v96, s[32:35], s87 offen offset:1024 sc1
  buffer_load_dwordx4 v[72:75], v96, s[32:35], s87 offen offset:2048 sc1
  buffer_load_dwordx4 v[76:79], v96, s[32:35], s87 offen offset:3072 sc1
  s_waitcnt lgkmcnt(0)
  s_barrier
  ds_read_b128 v[0:3], v106 offset:0
  ds_read_b128 v[4:7], v106 offset:16
  s_waitcnt lgkmcnt(0)
  v_add_f32 v0, v0, v4
  v_add_f32 v1, v1, v5
  v_add_f32 v2, v2, v6
  v_add_f32 v3, v3, v7
  v_add_f32 v0, v0, v2
  v_add_f32 v1, v1, v3
  v_mul_f32 v0, 0x3b000000, v0
  v_mul_f32 v1, 0x3b000000, v1
  v_fma_f32 v1, -v0, v0, v1
  v_max_f32 v1, 0, v1
  v_add_f32 v1, 0x3727c5ac, v1
  v_rsq_f32 v1, v1
  s_add_u32 s86, s84, s61
  v_mul_f32 v0, v0, v1
  v_fma_f32 v4, v44, v1, -v0
  v_fma_f32 v5, v45, v1, -v0
  v_fma_f32 v6, v46, v1, -v0
  v_fma_f32 v7, v47, v1, -v0
  v_cvt_pk_bf16_f32 v114, v4, v5
  v_cvt_pk_bf16_f32 v115, v6, v7
  v_bfe_u32 v123, v96, 4, 1
  v_mul_u32_u24 v123, 16376, v123
  v_add_u32 v123, v123, v104
  s_waitcnt vmcnt(3)
  v_mfma_f32_16x16x32_bf16 v[52:55], v[56:59], v[64:67], v[52:55]
  v_bitop3_b32 v121, v121, v64, s85 bitop3:246
  s_waitcnt vmcnt(2)
  v_mfma_f32_16x16x32_bf16 v[52:55], v[56:59], v[68:71], v[52:55]
  v_bitop3_b32 v121, v121, v68, s85 bitop3:246
  s_waitcnt vmcnt(1)
  v_mfma_f32_16x16x32_bf16 v[52:55], v[60:63], v[72:75], v[52:55]
  v_bitop3_b32 v121, v121, v72, s85 bitop3:246
  s_waitcnt vmcnt(0)
  v_mfma_f32_16x16x32_bf16 v[52:55], v[60:63], v[76:79], v[52:55]
  v_bitop3_b32 v121, v121, v76, s85 bitop3:246
  v_and_b32 v121, 1, v121
  v_cmp_ne_u32 vcc, 0, v121
  s_cbranch_vccnz LPFs_d_r
LPFs_d:
  buffer_load_dword v111, v108, s[32:35], s91 offen sc1
  s_nop 2
  v_add_f32 v64, v52, v53
  v_mul_f32 v65, v52, v52
  v_add_f32 v66, v54, v55
  v_fmac_f32 v65, v53, v53
  v_add_f32 v64, v64, v66
  v_fmac_f32 v65, v54, v54
  v_fmac_f32 v65, v55, v55
  v_add_f32_dpp v64, v64, v64 row_ror:8 row_mask:0xf bank_mask:0xf
  v_cvt_pk_bf16_f32 v116, v52, v53
  v_add_f32_dpp v65, v65, v65 row_ror:8 row_mask:0xf bank_mask:0xf
  v_add_f32_dpp v64, v64, v64 row_ror:4 row_mask:0xf bank_mask:0xf
  v_cvt_pk_bf16_f32 v117, v54, v55
  v_add_f32_dpp v65, v65, v65 row_ror:4 row_mask:0xf bank_mask:0xf
  v_add_f32_dpp v64, v64, v64 row_ror:2 row_mask:0xf bank_mask:0xf
  s_nop 0
  v_add_f32_dpp v65, v65, v65 row_ror:2 row_mask:0xf bank_mask:0xf
  v_add_f32_dpp v64, v64, v64 row_ror:1 row_mask:0xf bank_mask:0xf
  s_nop 0
  v_add_f32_dpp v65, v65, v65 row_ror:1 row_mask:0xf bank_mask:0xf
  s_nop 1
  v_permlane32_swap_b32 v64, v65
  v_add_f32 v64, v64, v65
  ds_write_b32 v105, v64 offset:128
  v_mfma_f32_32x32x16_bf16 v[80:95], v[56:59], v[56:59], 0
  s_lshl_b32 s93, s92, 11
  s_add_u32 s93, s93, s62
  s_waitcnt lgkmcnt(0)
  v_mfma_f32_32x32x16_bf16 v[16:31], v[56:59], v[56:59], 0
  s_barrier
  ds_read_b128 v[64:67], v106 offset:128
  ds_read_b128 v[68:71], v106 offset:144
  v_xor_b32 v105, 256, v105
  v_xor_b32 v106, 256, v106
  v_mfma_f32_16x16x32_bf16 v[32:35], v[56:59], v[56:59], 0
  s_waitcnt lgkmcnt(0)
  v_pk_add_f32 v[64:65], v[64:65], v[68:69]
  v_pk_add_f32 v[66:67], v[66:67], v[70:71]
  v_pk_add_f32 v[64:65], v[64:65], v[66:67]
  v_mul_f32 v64, 0x3b000000, v64
  v_mul_f32 v65, 0x3b000000, v65
  v_fma_f32 v65, -v64, v64, v65
  v_max_f32 v65, 0, v65
  v_add_f32 v65, 0x3727c5ac, v65
  v_rsq_f32 v65, v65
  s_add_u32 s87, s64, s61
  v_mul_f32 v64, v64, v65
  v_fma_f32 v68, v52, v65, -v64
  v_fma_f32 v69, v53, v65, -v64
  v_fma_f32 v70, v54, v65, -v64
  v_fma_f32 v71, v55, v65, -v64
  v_cvt_pk_bf16_f32 v118, v68, v69
  v_cvt_pk_bf16_f32 v119, v70, v71
  s_mov_b32 vcc_lo, 0x55555555
  s_mov_b32 vcc_hi, 0x55555555
  v_cndmask_b32_dpp v124, v118, v114, vcc quad_perm:[1,0,3,2] row_mask:0xf bank_mask:0xf
  v_cndmask_b32_dpp v125, v119, v115, vcc quad_perm:[1,0,3,2] row_mask:0xf bank_mask:0xf
  s_not_b64 vcc, vcc
  v_cndmask_b32_dpp v126, v114, v118, vcc quad_perm:[1,0,3,2] row_mask:0xf bank_mask:0xf
  v_cndmask_b32_dpp v127, v115, v119, vcc quad_perm:[1,0,3,2] row_mask:0xf bank_mask:0xf
  v_or_b32 v124, 1, v124
  s_cmp_lg_u32 s83, 0
  s_cbranch_scc1 LPFs_pre2
  s_waitcnt vmcnt(0)
  v_cmp_eq_u32 vcc, 0, v111
  s_cmp_ge_u32 s50, 64
  s_cbranch_scc1 LPFs_fin
  s_cbranch_vccz LPFs_pre
  buffer_store_dwordx4 v[124:127], v123, s[32:35], s86 offen sc1
  s_mov_b64 exec, 1
  buffer_store_dword v110, off, s[32:35], s93 sc1
  s_mov_b64 exec, -1
  buffer_store_dwordx2 v[116:117], v103, s[36:39], s64 offen
  s_add_u32 s87, s64, s60
  buffer_store_dwordx2 v[116:117], v103, s[32:35], s87 offen sc1
  buffer_store_dwordx2 v[112:113], v103, s[36:39], s84 offen
  s_add_u32 s86, s84, s60
  buffer_store_dwordx2 v[112:113], v103, s[32:35], s86 offen sc1
  s_branch LPFs_poll
LPFs_fin:
  buffer_store_dwordx2 v[116:117], v103, s[36:39], s64 offen
  buffer_store_dwordx2 v[112:113], v103, s[36:39], s84 offen
  buffer_store_dwordx4 v[124:127], v123, s[32:35], s86 offen sc1
  s_add_u32 s87, s64, s60
  buffer_store_dwordx2 v[116:117], v103, s[32:35], s87 offen sc1
  s_add_u32 s86, s84, s60
  buffer_store_dwordx2 v[112:113], v103, s[32:35], s86 offen sc1
  s_waitcnt vmcnt(0)
  s_mov_b64 exec, 1
  buffer_store_dword v110, off, s[32:35], s93 sc1
  s_mov_b64 exec, -1
  s_branch L_post_done
LPFs_pre:
  s_add_u32 m0, s89, 0
  s_add_u32 s94, s90, 16384
  buffer_load_dwordx4 v101, s[32:35], s90 offen offset:0 sc1 lds
  s_add_u32 m0, s89, 7936
  s_nop 0
  buffer_load_dwordx4 v101, s[32:35], s90 offen offset:256 sc1 lds
  s_add_u32 m0, s89, 15872
  s_nop 0
  buffer_load_dwordx4 v101, s[32:35], s90 offen offset:512 sc1 lds
  s_add_u32 m0, s89, 23808
  s_nop 0
  buffer_load_dwordx4 v101, s[32:35], s90 offen offset:768 sc1 lds
  s_add_u32 m0, s89, 4096
  s_nop 0
  buffer_load_dwordx4 v101, s[32:35], s94 offen offset:0 sc1 lds
  s_add_u32 m0, s89, 12032
  s_nop 0
  buffer_load_dwordx4 v101, s[32:35], s94 offen offset:256 sc1 lds
  s_add_u32 m0, s89, 19968
  s_nop 0
  buffer_load_dwordx4 v101, s[32:35], s94 offen offset:512 sc1 lds
  s_add_u32 m0, s89, 27904
  s_nop 0
  buffer_load_dwordx4 v101, s[32:35], s94 offen offset:768 sc1 lds
LPFs_pre2:
  s_branch LPFs_go
LPFs_E:
  s_mov_b32 s83, 1
  v_mfma_f32_16x16x32_bf16 v[88:91], v[16:19], v[168:171], 0
  s_add_u32 m0, s89, 0
  s_add_u32 s94, s90, 16384
  v_mfma_f32_16x16x32_bf16 v[92:95], v[16:19], v[172:175], 0
  ds_read_b128 v[16:19], v110 offset:6144
  v_cvt_pk_bf16_f32 v112, v64, v68
  v_cvt_pk_bf16_f32 v113, v72, v76
  v_mfma_f32_16x16x32_bf16 v[80:83], v[20:23], v[176:179], v[80:83]
  v_cvt_pk_bf16_f32 v114, v65, v69
  v_cvt_pk_bf16_f32 v115, v73, v77
  v_mfma_f32_16x16x32_bf16 v[84:87], v[20:23], v[180:183], v[84:87]
  v_bfi_b32 v112, 1, s54, v112
  v_mfma_f32_16x16x32_bf16 v[88:91], v[20:23], v[184:187], v[88:91]
  s_add_u32 s51, s65, 0
  buffer_store_dwordx4 v[112:115], v102, s[32:35], s51 offen offset:0 sc1
  v_mfma_f32_16x16x32_bf16 v[92:95], v[20:23], v[188:191], v[92:95]
  ds_read_b128 v[20:23], v110 offset:7168
  buffer_load_dwordx4 v101, s[32:35], s90 offen offset:0 sc1 lds
  v_mfma_f32_16x16x32_bf16 v[80:83], v[24:27], v[192:195], v[80:83]
  v_cvt_pk_bf16_f32 v116, v66, v70
  v_cvt_pk_bf16_f32 v117, v74, v78
  v_mfma_f32_16x16x32_bf16 v[84:87], v[24:27], v[196:199], v[84:87]
  v_cvt_pk_bf16_f32 v118, v67, v71
  v_cvt_pk_bf16_f32 v119, v75, v79
  v_mfma_f32_16x16x32_bf16 v[88:91], v[24:27], v[200:203], v[88:91]
  v_bfi_b32 v116, 1, s54, v116
  s_add_u32 m0, s89, 7936
  v_mfma_f32_16x16x32_bf16 v[92:95], v[24:27], v[204:207], v[92:95]
  ds_read_b128 v[24:27], v110 offset:8192
  s_add_u32 s51, s65, 16384
  buffer_store_dwordx4 v[116:119], v102, s[32:35], s51 offen offset:0 sc1
  v_mfma_f32_16x16x32_bf16 v[80:83], v[28:31], v[208:211], v[80:83]
  buffer_load_dwordx4 v101, s[32:35], s90 offen offset:256 sc1 lds
  s_add_u32 m0, s89, 15872
  v_mfma_f32_16x16x32_bf16 v[84:87], v[28:31], v[212:215], v[84:87]
  s_lshl_b32 s64, s92, 15
  s_add_u32 s64, s64, 16384
  s_and_b32 s87, s92, 3
  v_mfma_f32_16x16x32_bf16 v[88:91], v[28:31], v[216:219], v[88:91]
  s_lshl_b32 s87, s87, 18
  s_add_u32 s87, s87, s58
  s_add_u32 s87, s87, 131072
  v_mfma_f32_16x16x32_bf16 v[92:95], v[28:31], v[220:223], v[92:95]
  ds_read_b128 v[28:31], v110 offset:9216
  buffer_load_dwordx4 v101, s[32:35], s90 offen offset:512 sc1 lds
  v_mfma_f32_16x16x32_bf16 v[80:83], v[32:35], v[224:227], v[80:83]
  v_mfma_f32_16x16x32_bf16 v[84:87], v[32:35], v[228:231], v[84:87]
  s_add_u32 m0, s89, 23808
  s_nop 0
  buffer_load_dwordx4 v101, s[32:35], s90 offen offset:768 sc1 lds
  v_mfma_f32_16x16x32_bf16 v[88:91], v[32:35], v[232:235], v[88:91]
  v_mfma_f32_16x16x32_bf16 v[92:95], v[32:35], v[236:239], v[92:95]
  ds_read_b128 v[32:35], v110 offset:10240
  v_mfma_f32_16x16x32_bf16 v[80:83], v[36:39], v[240:243], v[80:83]
  v_mfma_f32_16x16x32_bf16 v[84:87], v[36:39], v[244:247], v[84:87]
  v_mfma_f32_16x16x32_bf16 v[88:91], v[36:39], v[248:251], v[88:91]
  s_add_u32 m0, s89, 4096
  s_nop 0
  buffer_load_dwordx4 v101, s[32:35], s94 offen offset:0 sc1 lds
  v_mfma_f32_16x16x32_bf16 v[92:95], v[36:39], v[252:255], v[92:95]
  ds_read_b128 v[36:39], v110 offset:11264
  s_waitcnt lgkmcnt(5)
  v_mfma_f32_16x16x32_bf16 v[64:67], v[16:19], a[192:195], 0
  v_mfma_f32_16x16x32_bf16 v[68:71], v[16:19], a[196:199], 0
  v_mfma_f32_16x16x32_bf16 v[72:75], v[16:19], a[200:203], 0
  v_mfma_f32_16x16x32_bf16 v[76:79], v[16:19], a[204:207], 0
  s_waitcnt lgkmcnt(4)
  v_cvt_pk_bf16_f32 v112, v80, v84
  v_cvt_pk_bf16_f32 v113, v88, v92
  v_mfma_f32_16x16x32_bf16 v[64:67], v[20:23], a[208:211], v[64:67]
  v_cvt_pk_bf16_f32 v114, v81, v85
  v_cvt_pk_bf16_f32 v115, v89, v93
  v_mfma_f32_16x16x32_bf16 v[68:71], v[20:23], a[212:215], v[68:71]
  v_bfi_b32 v112, 1, s54, v112
  s_add_u32 m0, s89, 12032
  v_mfma_f32_16x16x32_bf16 v[72:75], v[20:23], a[216:219], v[72:75]
  s_add_u32 s51, s65, 0
  buffer_store_dwordx4 v[112:115], v102, s[32:35], s51 offen offset:2048 sc1
  v_mfma_f32_16x16x32_bf16 v[76:79], v[20:23], a[220:223], v[76:79]
  s_waitcnt lgkmcnt(3)
  v_cvt_pk_bf16_f32 v116, v82, v86
  v_cvt_pk_bf16_f32 v117, v90, v94
  v_mfma_f32_16x16x32_bf16 v[64:67], v[24:27], a[224:227], v[64:67]
  v_cvt_pk_bf16_f32 v118, v83, v87
  v_cvt_pk_bf16_f32 v119, v91, v95
  v_mfma_f32_16x16x32_bf16 v[68:71], v[24:27], a[228:231], v[68:71]
  v_bfi_b32 v116, 1, s54, v116
  v_mfma_f32_16x16x32_bf16 v[72:75], v[24:27], a[232:235], v[72:75]
  s_add_u32 s51, s65, 16384
  buffer_store_dwordx4 v[116:119], v102, s[32:35], s51 offen offset:2048 sc1
  v_mfma_f32_16x16x32_bf16 v[76:79], v[24:27], a[236:239], v[76:79]
  s_waitcnt lgkmcnt(2)
  buffer_load_dwordx4 v101, s[32:35], s94 offen offset:256 sc1 lds
  v_mfma_f32_16x16x32_bf16 v[64:67], v[28:31], a[240:243], v[64:67]
  s_add_u32 m0, s89, 19968
  s_nop 0
  buffer_load_dwordx4 v101, s[32:35], s94 offen offset:512 sc1 lds
  v_mfma_f32_16x16x32_bf16 v[68:71], v[28:31], a[244:247], v[68:71]
  s_add_u32 m0, s89, 27904
  s_nop 0
  buffer_load_dwordx4 v101, s[32:35], s94 offen offset:768 sc1 lds
  v_mfma_f32_16x16x32_bf16 v[72:75], v[28:31], a[248:251], v[72:75]
  v_add_u32 v122, 78400, v96
  ds_read_b128 v[56:59], v122
  v_mfma_f32_16x16x32_bf16 v[76:79], v[28:31], a[252:255], v[76:79]
  s_waitcnt lgkmcnt(2)
  ds_read_b128 v[60:63], v122 offset:1024
  v_mfma_f32_16x16x32_bf16 v[64:67], v[32:35], v[128:131], v[64:67]
  v_mfma_f32_16x16x32_bf16 v[68:71], v[32:35], v[132:135], v[68:71]
  v_mfma_f32_16x16x32_bf16 v[72:75], v[32:35], v[136:139], v[72:75]
  s_branch LPFs_EJ
LPFs_redo:
  s_cmp_lt_u32 s88, 1073741824
  s_cselect_b32 s51, 4096, 0
  s_sub_u32 s88, s88, s51
  s_waitcnt lgkmcnt(0)
  s_barrier
LPFs_again:
  s_add_u32 s53, s53, 1
  s_cmp_ge_u32 s53, 65536
  s_cbranch_scc1 L_abort
  s_sleep 1
LPFs_poll:
  buffer_load_dword v111, v108, s[32:35], s91 offen sc1
  s_waitcnt vmcnt(0)
  s_branch LPFs_chk
LPFs_c_r:
  s_add_u32 s69, s69, 1
  s_cmp_ge_u32 s69, 65536
  s_cbranch_scc1 L_abort
  s_nop 4
  s_add_u32 s52, s67, 0
  buffer_load_dwordx4 v[44:47], v96, s[32:35], s52 offen sc1
  buffer_load_dwordx4 v[0:3], v96, s[32:35], s86 offen offset:0 sc1
  buffer_load_dwordx4 v[4:7], v96, s[32:35], s86 offen offset:1024 sc1
  buffer_load_dwordx4 v[8:11], v96, s[32:35], s86 offen offset:2048 sc1
  buffer_load_dwordx4 v[12:15], v96, s[32:35], s86 offen offset:3072 sc1
  s_waitcnt vmcnt(4)
  v_xor_b32 v120, s66, v44
  s_waitcnt vmcnt(3)
  v_mfma_f32_16x16x32_bf16 v[44:47], v[56:59], v[0:3], v[44:47]
  v_bitop3_b32 v120, v120, v0, s85 bitop3:246
  s_waitcnt vmcnt(2)
  v_mfma_f32_16x16x32_bf16 v[44:47], v[56:59], v[4:7], v[44:47]
  v_bitop3_b32 v120, v120, v4, s85 bitop3:246
  s_waitcnt vmcnt(1)
  v_mfma_f32_16x16x32_bf16 v[44:47], v[60:63], v[8:11], v[44:47]
  v_bitop3_b32 v120, v120, v8, s85 bitop3:246
  s_waitcnt vmcnt(0)
  v_mfma_f32_16x16x32_bf16 v[44:47], v[60:63], v[12:15], v[44:47]
  v_bitop3_b32 v120, v120, v12, s85 bitop3:246
  v_and_b32 v120, 1, v120
  v_cmp_ne_u32 vcc, 0, v120
  s_cbranch_vccnz LPFs_c_r
  s_nop 4
  s_branch LPFs_c
LPFs_d_r:
  s_add_u32 s69, s69, 1
  s_cmp_ge_u32 s69, 65536
  s_cbranch_scc1 L_abort
  s_nop 4
  s_add_u32 s52, s67, 32768
  buffer_load_dwordx4 v[52:55], v96, s[32:35], s52 offen sc1
  buffer_load_dwordx4 v[64:67], v96, s[32:35], s87 offen offset:0 sc1
  buffer_load_dwordx4 v[68:71], v96, s[32:35], s87 offen offset:1024 sc1
  buffer_load_dwordx4 v[72:75], v96, s[32:35], s87 offen offset:2048 sc1
  buffer_load_dwordx4 v[76:79], v96, s[32:35], s87 offen offset:3072 sc1
  s_waitcnt vmcnt(4)
  v_xor_b32 v121, s66, v52
  s_waitcnt vmcnt(3)
  v_mfma_f32_16x16x32_bf16 v[52:55], v[56:59], v[64:67], v[52:55]
  v_bitop3_b32 v121, v121, v64, s85 bitop3:246
  s_waitcnt vmcnt(2)
  v_mfma_f32_16x16x32_bf16 v[52:55], v[56:59], v[68:71], v[52:55]
  v_bitop3_b32 v121, v121, v68, s85 bitop3:246
  s_waitcnt vmcnt(1)
  v_mfma_f32_16x16x32_bf16 v[52:55], v[60:63], v[72:75], v[52:55]
  v_bitop3_b32 v121, v121, v72, s85 bitop3:246
  s_waitcnt vmcnt(0)
  v_mfma_f32_16x16x32_bf16 v[52:55], v[60:63], v[76:79], v[52:55]
  v_bitop3_b32 v121, v121, v76, s85 bitop3:246
  v_and_b32 v121, 1, v121
  v_cmp_ne_u32 vcc, 0, v121
  s_cbranch_vccnz LPFs_d_r
  s_nop 4
  s_branch LPFs_d
L_post_done:
  s_branch L_end
L_chain:
  v_and_b32 v1, 63, v0
  v_lshlrev_b32 v116, 4, v1
  v_lshrrev_b32 v2, 4, v1
  v_and_b32 v3, 15, v1
  v_lshrrev_b32 v4, 2, v3
  v_and_b32 v5, 1, v3
  v_lshl_add_u32 v6, v4, 1, v5
  v_bfe_u32 v7, v3, 1, 1
  v_and_b32 v8, 3, v3
  s_lshl_b32 s60, s26, 11
  s_add_u32 s60, s60, 147456
  v_add_u32 v117, s60, v116
  s_mul_i32 s60, s26, 36864
  v_add_u32 v123, s60, v116
  s_lshr_b32 s60, s26, 1
  s_lshl_b32 s60, s60, 11
  s_and_b32 s61, s26, 1
  s_lshl_b32 s61, s61, 6
  s_add_u32 s60, s60, s61
  s_add_u32 s60, s60, 156672
  v_lshrrev_b32 v10, 1, v2
  v_xor_b32 v9, v2, v10
  v_and_b32 v9, 1, v9
  v_lshl_add_u32 v9, v9, 1, v10
  v_xor_b32 v9, v9, v4
  v_lshlrev_b32 v9, 4, v9
  v_lshl_add_u32 v9, v2, 8, v9
  v_lshl_add_u32 v9, v8, 2, v9
  v_add_u32 v118, s60, v9
  v_add_u32 v126, 4096, v118
  v_lshrrev_b32 v10, 1, v4
  v_xor_b32 v9, v4, v10
  v_and_b32 v9, 1, v9
  v_lshl_add_u32 v9, v9, 1, v10
  v_xor_b32 v9, v9, v2
  v_lshlrev_b32 v9, 4, v9
  v_lshl_add_u32 v9, v6, 7, v9
  v_add_u32 v120, s60, v9
  v_lshl_add_u32 v9, v7, 6, v9
  v_add_u32 v119, 156672, v9
  v_and_b32 v11, 1, v4
  v_lshrrev_b32 v12, 1, v4
  v_lshl_add_u32 v11, v11, 1, v12
  v_lshrrev_b32 v10, 1, v11
  v_xor_b32 v9, v11, v10
  v_and_b32 v9, 1, v9
  v_lshl_add_u32 v9, v9, 1, v10
  v_xor_b32 v9, v9, v2
  v_lshlrev_b32 v9, 4, v9
  v_lshl_add_u32 v9, v11, 8, v9
  v_lshl_add_u32 v9, v5, 7, v9
  v_lshl_add_u32 v9, v7, 6, v9
  v_add_u32 v121, 160768, v9
  v_mul_u32_u24 v9, 0xAAAA, v7
  v_add_u32 v125, 0x4444, v9
  v_add_u32 v9, 0xC, v7
  v_mov_b32 v10, 0xE
  v_cmp_gt_u32 vcc, 2, v2
  s_nop 1
  v_cndmask_b32 v11, v10, v9, vcc
  v_cndmask_b32 v12, v9, v10, vcc
  v_and_b32 v9, 0x0F0F, v125
  v_lshl_add_u32 v9, v11, 4, v9
  v_lshl_add_u32 v127, v12, 12, v9
  s_lshl_b32 s60, s26, 9
  s_add_u32 s60, s60, 147456
  v_lshrrev_b32 v9, 3, v3
  v_lshlrev_b32 v9, 8, v9
  v_lshl_add_u32 v9, v2, 6, v9
  v_and_b32 v10, 1, v4
  v_lshl_add_u32 v9, v10, 5, v9
  v_lshl_add_u32 v9, v8, 2, v9
  v_add_u32 v122, s60, v9
  s_mov_b32 s64, 0x33333333
  s_mov_b32 s65, 0x33333333
  s_mov_b32 s66, 0xcccccccc
  s_mov_b32 s67, 0xcccccccc
  v_lshlrev_b32 v9, 13, v4
  v_lshl_add_u32 v9, v2, 6, v9
  v_lshl_add_u32 v124, v8, 4, v9
  s_lshl_b32 s60, s29, 13
  s_add_u32 s60, s60, 835584
  s_lshl_b32 s61, s26, 11
  s_add_u32 s52, s60, s61
  s_lshl_b32 s61, s28, 8
  s_add_u32 s53, s60, s61
  s_lshl_b32 s60, s29, 18
  s_add_u32 s60, s60, 851968
  s_add_u32 s54, s60, s61
  s_lshl_b32 s61, s26, 16
  s_add_u32 s54, s54, s61
  s_lshl_b32 s61, s28, 13
  s_add_u32 s55, s60, s61
  s_lshl_b32 s60, s29, 5
  s_add_u32 s60, s60, s28
  s_mul_i32 s56, s60, 98304
  s_add_u32 s56, s56, 6619136
  s_lshl_b32 s61, s26, 12
  s_add_u32 s56, s56, s61
  s_lshl_b32 s58, s29, 19
  s_add_u32 s58, s58, 5570560
  s_lshl_b32 s61, s28, 8
  s_add_u32 s58, s58, s61
  s_add_u32 s57, s56, 98304
  s_mov_b32 s63, 0x3e0293ee
  s_mov_b32 s62, 0
  s_mov_b32 s68, 1109393408
  v_lshrrev_b32 v114, 8, v116
  v_bfe_u32 v115, v116, 4, 4
  v_lshrrev_b32 v96, 1, v114
  v_lshlrev_b32 v96, 4, v96
  v_and_b32 v97, 1, v114
  v_lshl_add_u32 v96, v97, 2, v96
  s_lshl_b32 s60, s28, 8
  s_lshl_b32 s61, s26, 6
  s_add_u32 s60, s60, s61
  v_lshlrev_b32 v112, 13, v96
  v_lshl_add_u32 v112, v115, 2, v112
  v_add_u32 v112, s60, v112
  s_lshl_b32 s60, s28, 17
  s_lshl_b32 s61, s26, 8
  s_add_u32 s60, s60, s61
  v_lshlrev_b32 v113, 10, v96
  v_lshl_add_u32 v113, v115, 3, v113
  v_add_u32 v113, s60, v113
  s_mov_b32 s36, s8
  s_and_b32 s37, s9, 0xffff
  s_mov_b32 s38, 4194304
  s_mov_b32 s39, 0x20000
  s_xor_b32 s60, s26, 0
  s_lshl_b32 s60, s60, 20
  s_add_u32 s61, s60, 0
  buffer_load_dword v0, v112, s[36:39], s61 offen
  s_add_u32 s61, s60, 8192
  buffer_load_dword v1, v112, s[36:39], s61 offen
  s_add_u32 s61, s60, 65536
  buffer_load_dword v2, v112, s[36:39], s61 offen
  s_add_u32 s61, s60, 73728
  buffer_load_dword v3, v112, s[36:39], s61 offen
  s_add_u32 s61, s60, 16384
  buffer_load_dword v4, v112, s[36:39], s61 offen
  s_add_u32 s61, s60, 24576
  buffer_load_dword v5, v112, s[36:39], s61 offen
  s_add_u32 s61, s60, 81920
  buffer_load_dword v6, v112, s[36:39], s61 offen
  s_add_u32 s61, s60, 90112
  buffer_load_dword v7, v112, s[36:39], s61 offen
  s_add_u32 s61, s60, 262144
  buffer_load_dword v8, v112, s[36:39], s61 offen
  s_add_u32 s61, s60, 270336
  buffer_load_dword v9, v112, s[36:39], s61 offen
  s_add_u32 s61, s60, 327680
  buffer_load_dword v10, v112, s[36:39], s61 offen
  s_add_u32 s61, s60, 335872
  buffer_load_dword v11, v112, s[36:39], s61 offen
  s_add_u32 s61, s60, 278528
  buffer_load_dword v12, v112, s[36:39], s61 offen
  s_add_u32 s61, s60, 286720
  buffer_load_dword v13, v112, s[36:39], s61 offen
  s_add_u32 s61, s60, 344064
  buffer_load_dword v14, v112, s[36:39], s61 offen
  s_add_u32 s61, s60, 352256
  buffer_load_dword v15, v112, s[36:39], s61 offen
  s_xor_b32 s60, s26, 0
  s_lshl_b32 s60, s60, 20
  s_add_u32 s61, s60, 524288
  buffer_load_dword v32, v112, s[36:39], s61 offen
  s_add_u32 s61, s60, 532480
  buffer_load_dword v33, v112, s[36:39], s61 offen
  s_add_u32 s61, s60, 589824
  buffer_load_dword v34, v112, s[36:39], s61 offen
  s_add_u32 s61, s60, 598016
  buffer_load_dword v35, v112, s[36:39], s61 offen
  s_add_u32 s61, s60, 540672
  buffer_load_dword v36, v112, s[36:39], s61 offen
  s_add_u32 s61, s60, 548864
  buffer_load_dword v37, v112, s[36:39], s61 offen
  s_add_u32 s61, s60, 606208
  buffer_load_dword v38, v112, s[36:39], s61 offen
  s_add_u32 s61, s60, 614400
  buffer_load_dword v39, v112, s[36:39], s61 offen
  s_add_u32 s61, s60, 786432
  buffer_load_dword v40, v112, s[36:39], s61 offen
  s_add_u32 s61, s60, 794624
  buffer_load_dword v41, v112, s[36:39], s61 offen
  s_add_u32 s61, s60, 851968
  buffer_load_dword v42, v112, s[36:39], s61 offen
  s_add_u32 s61, s60, 860160
  buffer_load_dword v43, v112, s[36:39], s61 offen
  s_add_u32 s61, s60, 802816
  buffer_load_dword v44, v112, s[36:39], s61 offen
  s_add_u32 s61, s60, 811008
  buffer_load_dword v45, v112, s[36:39], s61 offen
  s_add_u32 s61, s60, 868352
  buffer_load_dword v46, v112, s[36:39], s61 offen
  s_add_u32 s61, s60, 876544
  buffer_load_dword v47, v112, s[36:39], s61 offen
  s_xor_b32 s60, s26, 1
  s_lshl_b32 s60, s60, 20
  s_add_u32 s61, s60, 0
  buffer_load_dword v64, v112, s[36:39], s61 offen
  s_add_u32 s61, s60, 8192
  buffer_load_dword v65, v112, s[36:39], s61 offen
  s_add_u32 s61, s60, 65536
  buffer_load_dword v66, v112, s[36:39], s61 offen
  s_add_u32 s61, s60, 73728
  buffer_load_dword v67, v112, s[36:39], s61 offen
  s_add_u32 s61, s60, 16384
  buffer_load_dword v68, v112, s[36:39], s61 offen
  s_add_u32 s61, s60, 24576
  buffer_load_dword v69, v112, s[36:39], s61 offen
  s_add_u32 s61, s60, 81920
  buffer_load_dword v70, v112, s[36:39], s61 offen
  s_add_u32 s61, s60, 90112
  buffer_load_dword v71, v112, s[36:39], s61 offen
  s_add_u32 s61, s60, 262144
  buffer_load_dword v72, v112, s[36:39], s61 offen
  s_add_u32 s61, s60, 270336
  buffer_load_dword v73, v112, s[36:39], s61 offen
  s_add_u32 s61, s60, 327680
  buffer_load_dword v74, v112, s[36:39], s61 offen
  s_add_u32 s61, s60, 335872
  buffer_load_dword v75, v112, s[36:39], s61 offen
  s_add_u32 s61, s60, 278528
  buffer_load_dword v76, v112, s[36:39], s61 offen
  s_add_u32 s61, s60, 286720
  buffer_load_dword v77, v112, s[36:39], s61 offen
  s_add_u32 s61, s60, 344064
  buffer_load_dword v78, v112, s[36:39], s61 offen
  s_add_u32 s61, s60, 352256
  buffer_load_dword v79, v112, s[36:39], s61 offen
  s_waitcnt vmcnt(32)
  v_perm_b32 v96, v1, v0, s48
  v_perm_b32 v97, v3, v2, s48
  v_perm_b32 v98, v5, v4, s48
  v_perm_b32 v99, v7, v6, s48
  v_perm_b32 v100, v9, v8, s48
  v_perm_b32 v101, v11, v10, s48
  v_perm_b32 v102, v13, v12, s48
  v_perm_b32 v103, v15, v14, s48
  v_accvgpr_write_b32 a0, v96
  v_accvgpr_write_b32 a1, v97
  v_accvgpr_write_b32 a2, v98
  v_accvgpr_write_b32 a3, v99
  v_accvgpr_write_b32 a4, v100
  v_accvgpr_write_b32 a5, v101
  v_accvgpr_write_b32 a6, v102
  v_accvgpr_write_b32 a7, v103
  v_perm_b32 v104, v1, v0, s49
  v_perm_b32 v105, v3, v2, s49
  v_perm_b32 v106, v5, v4, s49
  v_perm_b32 v107, v7, v6, s49
  v_perm_b32 v108, v9, v8, s49
  v_perm_b32 v109, v11, v10, s49
  v_perm_b32 v110, v13, v12, s49
  v_perm_b32 v111, v15, v14, s49
  v_accvgpr_write_b32 a8, v104
  v_accvgpr_write_b32 a9, v105
  v_accvgpr_write_b32 a10, v106
  v_accvgpr_write_b32 a11, v107
  v_accvgpr_write_b32 a12, v108
  v_accvgpr_write_b32 a13, v109
  v_accvgpr_write_b32 a14, v110
  v_accvgpr_write_b32 a15, v111
  s_xor_b32 s60, s26, 1
  s_lshl_b32 s60, s60, 20
  s_add_u32 s61, s60, 524288
  buffer_load_dword v0, v112, s[36:39], s61 offen
  s_add_u32 s61, s60, 532480
  buffer_load_dword v1, v112, s[36:39], s61 offen
  s_add_u32 s61, s60, 589824
  buffer_load_dword v2, v112, s[36:39], s61 offen
  s_add_u32 s61, s60, 598016
  buffer_load_dword v3, v112, s[36:39], s61 offen
  s_add_u32 s61, s60, 540672
  buffer_load_dword v4, v112, s[36:39], s61 offen
  s_add_u32 s61, s60, 548864
  buffer_load_dword v5, v112, s[36:39], s61 offen
  s_add_u32 s61, s60, 606208
  buffer_load_dword v6, v112, s[36:39], s61 offen
  s_add_u32 s61, s60, 614400
  buffer_load_dword v7, v112, s[36:39], s61 offen
  s_add_u32 s61, s60, 786432
  buffer_load_dword v8, v112, s[36:39], s61 offen
  s_add_u32 s61, s60, 794624
  buffer_load_dword v9, v112, s[36:39], s61 offen
  s_add_u32 s61, s60, 851968
  buffer_load_dword v10, v112, s[36:39], s61 offen
  s_add_u32 s61, s60, 860160
  buffer_load_dword v11, v112, s[36:39], s61 offen
  s_add_u32 s61, s60, 802816
  buffer_load_dword v12, v112, s[36:39], s61 offen
  s_add_u32 s61, s60, 811008
  buffer_load_dword v13, v112, s[36:39], s61 offen
  s_add_u32 s61, s60, 868352
  buffer_load_dword v14, v112, s[36:39], s61 offen
  s_add_u32 s61, s60, 876544
  buffer_load_dword v15, v112, s[36:39], s61 offen
  s_waitcnt vmcnt(32)
  v_perm_b32 v96, v33, v32, s48
  v_perm_b32 v97, v35, v34, s48
  v_perm_b32 v98, v37, v36, s48
  v_perm_b32 v99, v39, v38, s48
  v_perm_b32 v100, v41, v40, s48
  v_perm_b32 v101, v43, v42, s48
  v_perm_b32 v102, v45, v44, s48
  v_perm_b32 v103, v47, v46, s48
  v_accvgpr_write_b32 a16, v96
  v_accvgpr_write_b32 a17, v97
  v_accvgpr_write_b32 a18, v98
  v_accvgpr_write_b32 a19, v99
  v_accvgpr_write_b32 a20, v100
  v_accvgpr_write_b32 a21, v101
  v_accvgpr_write_b32 a22, v102
  v_accvgpr_write_b32 a23, v103
  v_perm_b32 v104, v33, v32, s49
  v_perm_b32 v105, v35, v34, s49
  v_perm_b32 v106, v37, v36, s49
  v_perm_b32 v107, v39, v38, s49
  v_perm_b32 v108, v41, v40, s49
  v_perm_b32 v109, v43, v42, s49
  v_perm_b32 v110, v45, v44, s49
  v_perm_b32 v111, v47, v46, s49
  v_accvgpr_write_b32 a24, v104
  v_accvgpr_write_b32 a25, v105
  v_accvgpr_write_b32 a26, v106
  v_accvgpr_write_b32 a27, v107
  v_accvgpr_write_b32 a28, v108
  v_accvgpr_write_b32 a29, v109
  v_accvgpr_write_b32 a30, v110
  v_accvgpr_write_b32 a31, v111
  s_xor_b32 s60, s26, 2
  s_lshl_b32 s60, s60, 20
  s_add_u32 s61, s60, 0
  buffer_load_dword v32, v112, s[36:39], s61 offen
  s_add_u32 s61, s60, 8192
  buffer_load_dword v33, v112, s[36:39], s61 offen
  s_add_u32 s61, s60, 65536
  buffer_load_dword v34, v112, s[36:39], s61 offen
  s_add_u32 s61, s60, 73728
  buffer_load_dword v35, v112, s[36:39], s61 offen
  s_add_u32 s61, s60, 16384
  buffer_load_dword v36, v112, s[36:39], s61 offen
  s_add_u32 s61, s60, 24576
  buffer_load_dword v37, v112, s[36:39], s61 offen
  s_add_u32 s61, s60, 81920
  buffer_load_dword v38, v112, s[36:39], s61 offen
  s_add_u32 s61, s60, 90112
  buffer_load_dword v39, v112, s[36:39], s61 offen
  s_add_u32 s61, s60, 262144
  buffer_load_dword v40, v112, s[36:39], s61 offen
  s_add_u32 s61, s60, 270336
  buffer_load_dword v41, v112, s[36:39], s61 offen
  s_add_u32 s61, s60, 327680
  buffer_load_dword v42, v112, s[36:39], s61 offen
  s_add_u32 s61, s60, 335872
  buffer_load_dword v43, v112, s[36:39], s61 offen
  s_add_u32 s61, s60, 278528
  buffer_load_dword v44, v112, s[36:39], s61 offen
  s_add_u32 s61, s60, 286720
  buffer_load_dword v45, v112, s[36:39], s61 offen
  s_add_u32 s61, s60, 344064
  buffer_load_dword v46, v112, s[36:39], s61 offen
  s_add_u32 s61, s60, 352256
  buffer_load_dword v47, v112, s[36:39], s61 offen
  s_waitcnt vmcnt(32)
  v_perm_b32 v96, v65, v64, s48
  v_perm_b32 v97, v67, v66, s48
  v_perm_b32 v98, v69, v68, s48
  v_perm_b32 v99, v71, v70, s48
  v_perm_b32 v100, v73, v72, s48
  v_perm_b32 v101, v75, v74, s48
  v_perm_b32 v102, v77, v76, s48
  v_perm_b32 v103, v79, v78, s48
  v_accvgpr_write_b32 a32, v96
  v_accvgpr_write_b32 a33, v97
  v_accvgpr_write_b32 a34, v98
  v_accvgpr_write_b32 a35, v99
  v_accvgpr_write_b32 a36, v100
  v_accvgpr_write_b32 a37, v101
  v_accvgpr_write_b32 a38, v102
  v_accvgpr_write_b32 a39, v103
  v_perm_b32 v104, v65, v64, s49
  v_perm_b32 v105, v67, v66, s49
  v_perm_b32 v106, v69, v68, s49
  v_perm_b32 v107, v71, v70, s49
  v_perm_b32 v108, v73, v72, s49
  v_perm_b32 v109, v75, v74, s49
  v_perm_b32 v110, v77, v76, s49
  v_perm_b32 v111, v79, v78, s49
  v_accvgpr_write_b32 a40, v104
  v_accvgpr_write_b32 a41, v105
  v_accvgpr_write_b32 a42, v106
  v_accvgpr_write_b32 a43, v107
  v_accvgpr_write_b32 a44, v108
  v_accvgpr_write_b32 a45, v109
  v_accvgpr_write_b32 a46, v110
  v_accvgpr_write_b32 a47, v111
  s_xor_b32 s60, s26, 2
  s_lshl_b32 s60, s60, 20
  s_add_u32 s61, s60, 524288
  buffer_load_dword v64, v112, s[36:39], s61 offen
  s_add_u32 s61, s60, 532480
  buffer_load_dword v65, v112, s[36:39], s61 offen
  s_add_u32 s61, s60, 589824
  buffer_load_dword v66, v112, s[36:39], s61 offen
  s_add_u32 s61, s60, 598016
  buffer_load_dword v67, v112, s[36:39], s61 offen
  s_add_u32 s61, s60, 540672
  buffer_load_dword v68, v112, s[36:39], s61 offen
  s_add_u32 s61, s60, 548864
  buffer_load_dword v69, v112, s[36:39], s61 offen
  s_add_u32 s61, s60, 606208
  buffer_load_dword v70, v112, s[36:39], s61 offen
  s_add_u32 s61, s60, 614400
  buffer_load_dword v71, v112, s[36:39], s61 offen
  s_add_u32 s61, s60, 786432
  buffer_load_dword v72, v112, s[36:39], s61 offen
  s_add_u32 s61, s60, 794624
  buffer_load_dword v73, v112, s[36:39], s61 offen
  s_add_u32 s61, s60, 851968
  buffer_load_dword v74, v112, s[36:39], s61 offen
  s_add_u32 s61, s60, 860160
  buffer_load_dword v75, v112, s[36:39], s61 offen
  s_add_u32 s61, s60, 802816
  buffer_load_dword v76, v112, s[36:39], s61 offen
  s_add_u32 s61, s60, 811008
  buffer_load_dword v77, v112, s[36:39], s61 offen
  s_add_u32 s61, s60, 868352
  buffer_load_dword v78, v112, s[36:39], s61 offen
  s_add_u32 s61, s60, 876544
  buffer_load_dword v79, v112, s[36:39], s61 offen
  s_waitcnt vmcnt(32)
  v_perm_b32 v96, v1, v0, s48
  v_perm_b32 v97, v3, v2, s48
  v_perm_b32 v98, v5, v4, s48
  v_perm_b32 v99, v7, v6, s48
  v_perm_b32 v100, v9, v8, s48
  v_perm_b32 v101, v11, v10, s48
  v_perm_b32 v102, v13, v12, s48
  v_perm_b32 v103, v15, v14, s48
  v_accvgpr_write_b32 a48, v96
  v_accvgpr_write_b32 a49, v97
  v_accvgpr_write_b32 a50, v98
  v_accvgpr_write_b32 a51, v99
  v_accvgpr_write_b32 a52, v100
  v_accvgpr_write_b32 a53, v101
  v_accvgpr_write_b32 a54, v102
  v_accvgpr_write_b32 a55, v103
  v_perm_b32 v104, v1, v0, s49
  v_perm_b32 v105, v3, v2, s49
  v_perm_b32 v106, v5, v4, s49
  v_perm_b32 v107, v7, v6, s49
  v_perm_b32 v108, v9, v8, s49
  v_perm_b32 v109, v11, v10, s49
  v_perm_b32 v110, v13, v12, s49
  v_perm_b32 v111, v15, v14, s49
  v_accvgpr_write_b32 a56, v104
  v_accvgpr_write_b32 a57, v105
  v_accvgpr_write_b32 a58, v106
  v_accvgpr_write_b32 a59, v107
  v_accvgpr_write_b32 a60, v108
  v_accvgpr_write_b32 a61, v109
  v_accvgpr_write_b32 a62, v110
  v_accvgpr_write_b32 a63, v111
  s_xor_b32 s60, s26, 3
  s_lshl_b32 s60, s60, 20
  s_add_u32 s61, s60, 0
  buffer_load_dword v0, v112, s[36:39], s61 offen
  s_add_u32 s61, s60, 8192
  buffer_load_dword v1, v112, s[36:39], s61 offen
  s_add_u32 s61, s60, 65536
  buffer_load_dword v2, v112, s[36:39], s61 offen
  s_add_u32 s61, s60, 73728
  buffer_load_dword v3, v112, s[36:39], s61 offen
  s_add_u32 s61, s60, 16384
  buffer_load_dword v4, v112, s[36:39], s61 offen
  s_add_u32 s61, s60, 24576
  buffer_load_dword v5, v112, s[36:39], s61 offen
  s_add_u32 s61, s60, 81920
  buffer_load_dword v6, v112, s[36:39], s61 offen
  s_add_u32 s61, s60, 90112
  buffer_load_dword v7, v112, s[36:39], s61 offen
  s_add_u32 s61, s60, 262144
  buffer_load_dword v8, v112, s[36:39], s61 offen
  s_add_u32 s61, s60, 270336
  buffer_load_dword v9, v112, s[36:39], s61 offen
  s_add_u32 s61, s60, 327680
  buffer_load_dword v10, v112, s[36:39], s61 offen
  s_add_u32 s61, s60, 335872
  buffer_load_dword v11, v112, s[36:39], s61 offen
  s_add_u32 s61, s60, 278528
  buffer_load_dword v12, v112, s[36:39], s61 offen
  s_add_u32 s61, s60, 286720
  buffer_load_dword v13, v112, s[36:39], s61 offen
  s_add_u32 s61, s60, 344064
  buffer_load_dword v14, v112, s[36:39], s61 offen
  s_add_u32 s61, s60, 352256
  buffer_load_dword v15, v112, s[36:39], s61 offen
  s_cmp_lg_u32 s101, 0
  s_cbranch_scc1 LCF_4
  s_mov_b32 s101, 1
  s_waitcnt lgkmcnt(0)
  s_lshr_b32 s96, s3, s28
  s_and_b32 s96, s96, 1
  s_cmp_eq_u32 s26, 0
  s_cselect_b32 s97, 0, 8
  s_add_u32 s97, s97, 163824
  v_mov_b32 v114, s96
  v_mov_b32 v115, s97
  ds_write_b32 v115, v114
  v_mov_b32 v115, 163824
  s_waitcnt lgkmcnt(0)
  s_barrier
  ds_read_b32 v114, v115
  s_waitcnt lgkmcnt(0)
  v_readfirstlane_b32 s98, v114
  s_cmp_lg_u32 s26, 0
  s_cbranch_scc1 LCF_4n
  s_lshl_b32 s97, s27, 2
  s_add_u32 s97, s97, 32
  s_mov_b32 s96, 1
  s_atomic_add s96, s[22:23], s97
LCF_4n:
  s_cmp_lg_u32 s98, 0
  s_cbranch_scc1 LP_lost
LCF_4:
  s_waitcnt vmcnt(32)
  v_perm_b32 v96, v33, v32, s48
  v_perm_b32 v97, v35, v34, s48
  v_perm_b32 v98, v37, v36, s48
  v_perm_b32 v99, v39, v38, s48
  v_perm_b32 v100, v41, v40, s48
  v_perm_b32 v101, v43, v42, s48
  v_perm_b32 v102, v45, v44, s48
  v_perm_b32 v103, v47, v46, s48
  v_accvgpr_write_b32 a64, v96
  v_accvgpr_write_b32 a65, v97
  v_accvgpr_write_b32 a66, v98
  v_accvgpr_write_b32 a67, v99
  v_accvgpr_write_b32 a68, v100
  v_accvgpr_write_b32 a69, v101
  v_accvgpr_write_b32 a70, v102
  v_accvgpr_write_b32 a71, v103
  v_perm_b32 v104, v33, v32, s49
  v_perm_b32 v105, v35, v34, s49
  v_perm_b32 v106, v37, v36, s49
  v_perm_b32 v107, v39, v38, s49
  v_perm_b32 v108, v41, v40, s49
  v_perm_b32 v109, v43, v42, s49
  v_perm_b32 v110, v45, v44, s49
  v_perm_b32 v111, v47, v46, s49
  v_accvgpr_write_b32 a72, v104
  v_accvgpr_write_b32 a73, v105
  v_accvgpr_write_b32 a74, v106
  v_accvgpr_write_b32 a75, v107
  v_accvgpr_write_b32 a76, v108
  v_accvgpr_write_b32 a77, v109
  v_accvgpr_write_b32 a78, v110
  v_accvgpr_write_b32 a79, v111
  s_xor_b32 s60, s26, 3
  s_lshl_b32 s60, s60, 20
  s_add_u32 s61, s60, 524288
  buffer_load_dword v32, v112, s[36:39], s61 offen
  s_add_u32 s61, s60, 532480
  buffer_load_dword v33, v112, s[36:39], s61 offen
  s_add_u32 s61, s60, 589824
  buffer_load_dword v34, v112, s[36:39], s61 offen
  s_add_u32 s61, s60, 598016
  buffer_load_dword v35, v112, s[36:39], s61 offen
  s_add_u32 s61, s60, 540672
  buffer_load_dword v36, v112, s[36:39], s61 offen
  s_add_u32 s61, s60, 548864
  buffer_load_dword v37, v112, s[36:39], s61 offen
  s_add_u32 s61, s60, 606208
  buffer_load_dword v38, v112, s[36:39], s61 offen
  s_add_u32 s61, s60, 614400
  buffer_load_dword v39, v112, s[36:39], s61 offen
  s_add_u32 s61, s60, 786432
  buffer_load_dword v40, v112, s[36:39], s61 offen
  s_add_u32 s61, s60, 794624
  buffer_load_dword v41, v112, s[36:39], s61 offen
  s_add_u32 s61, s60, 851968
  buffer_load_dword v42, v112, s[36:39], s61 offen
  s_add_u32 s61, s60, 860160
  buffer_load_dword v43, v112, s[36:39], s61 offen
  s_add_u32 s61, s60, 802816
  buffer_load_dword v44, v112, s[36:39], s61 offen
  s_add_u32 s61, s60, 811008
  buffer_load_dword v45, v112, s[36:39], s61 offen
  s_add_u32 s61, s60, 868352
  buffer_load_dword v46, v112, s[36:39], s61 offen
  s_add_u32 s61, s60, 876544
  buffer_load_dword v47, v112, s[36:39], s61 offen
  s_waitcnt vmcnt(32)
  v_perm_b32 v96, v65, v64, s48
  v_perm_b32 v97, v67, v66, s48
  v_perm_b32 v98, v69, v68, s48
  v_perm_b32 v99, v71, v70, s48
  v_perm_b32 v100, v73, v72, s48
  v_perm_b32 v101, v75, v74, s48
  v_perm_b32 v102, v77, v76, s48
  v_perm_b32 v103, v79, v78, s48
  v_accvgpr_write_b32 a80, v96
  v_accvgpr_write_b32 a81, v97
  v_accvgpr_write_b32 a82, v98
  v_accvgpr_write_b32 a83, v99
  v_accvgpr_write_b32 a84, v100
  v_accvgpr_write_b32 a85, v101
  v_accvgpr_write_b32 a86, v102
  v_accvgpr_write_b32 a87, v103
  v_perm_b32 v104, v65, v64, s49
  v_perm_b32 v105, v67, v66, s49
  v_perm_b32 v106, v69, v68, s49
  v_perm_b32 v107, v71, v70, s49
  v_perm_b32 v108, v73, v72, s49
  v_perm_b32 v109, v75, v74, s49
  v_perm_b32 v110, v77, v76, s49
  v_perm_b32 v111, v79, v78, s49
  v_accvgpr_write_b32 a88, v104
  v_accvgpr_write_b32 a89, v105
  v_accvgpr_write_b32 a90, v106
  v_accvgpr_write_b32 a91, v107
  v_accvgpr_write_b32 a92, v108
  v_accvgpr_write_b32 a93, v109
  v_accvgpr_write_b32 a94, v110
  v_accvgpr_write_b32 a95, v111
  s_mov_b32 s40, s10
  s_and_b32 s41, s11, 0xffff
  s_mov_b32 s42, 4194304
  s_mov_b32 s43, 0x20000
  s_xor_b32 s60, s26, 0
  s_lshl_b32 s60, s60, 20
  s_add_u32 s61, s60, 0
  buffer_load_dword v64, v112, s[40:43], s61 offen
  s_add_u32 s61, s60, 8192
  buffer_load_dword v65, v112, s[40:43], s61 offen
  s_add_u32 s61, s60, 65536
  buffer_load_dword v66, v112, s[40:43], s61 offen
  s_add_u32 s61, s60, 73728
  buffer_load_dword v67, v112, s[40:43], s61 offen
  s_add_u32 s61, s60, 16384
  buffer_load_dword v68, v112, s[40:43], s61 offen
  s_add_u32 s61, s60, 24576
  buffer_load_dword v69, v112, s[40:43], s61 offen
  s_add_u32 s61, s60, 81920
  buffer_load_dword v70, v112, s[40:43], s61 offen
  s_add_u32 s61, s60, 90112
  buffer_load_dword v71, v112, s[40:43], s61 offen
  s_add_u32 s61, s60, 262144
  buffer_load_dword v72, v112, s[40:43], s61 offen
  s_add_u32 s61, s60, 270336
  buffer_load_dword v73, v112, s[40:43], s61 offen
  s_add_u32 s61, s60, 327680
  buffer_load_dword v74, v112, s[40:43], s61 offen
  s_add_u32 s61, s60, 335872
  buffer_load_dword v75, v112, s[40:43], s61 offen
  s_add_u32 s61, s60, 278528
  buffer_load_dword v76, v112, s[40:43], s61 offen
  s_add_u32 s61, s60, 286720
  buffer_load_dword v77, v112, s[40:43], s61 offen
  s_add_u32 s61, s60, 344064
  buffer_load_dword v78, v112, s[40:43], s61 offen
  s_add_u32 s61, s60, 352256
  buffer_load_dword v79, v112, s[40:43], s61 offen
  s_waitcnt vmcnt(32)
  v_perm_b32 v96, v1, v0, s48
  v_perm_b32 v97, v3, v2, s48
  v_perm_b32 v98, v5, v4, s48
  v_perm_b32 v99, v7, v6, s48
  v_perm_b32 v100, v9, v8, s48
  v_perm_b32 v101, v11, v10, s48
  v_perm_b32 v102, v13, v12, s48
  v_perm_b32 v103, v15, v14, s48
  ds_write_b128 v123, v[96:99] offset:6144
  ds_write_b128 v123, v[100:103] offset:7168
  v_perm_b32 v104, v1, v0, s49
  v_perm_b32 v105, v3, v2, s49
  v_perm_b32 v106, v5, v4, s49
  v_perm_b32 v107, v7, v6, s49
  v_perm_b32 v108, v9, v8, s49
  v_perm_b32 v109, v11, v10, s49
  v_perm_b32 v110, v13, v12, s49
  v_perm_b32 v111, v15, v14, s49
  ds_write_b128 v123, v[104:107] offset:4096
  ds_write_b128 v123, v[108:111] offset:5120
  s_waitcnt lgkmcnt(0)
  s_xor_b32 s60, s26, 0
  s_lshl_b32 s60, s60, 20
  s_add_u32 s61, s60, 524288
  buffer_load_dword v0, v112, s[40:43], s61 offen
  s_add_u32 s61, s60, 532480
  buffer_load_dword v1, v112, s[40:43], s61 offen
  s_add_u32 s61, s60, 589824
  buffer_load_dword v2, v112, s[40:43], s61 offen
  s_add_u32 s61, s60, 598016
  buffer_load_dword v3, v112, s[40:43], s61 offen
  s_add_u32 s61, s60, 540672
  buffer_load_dword v4, v112, s[40:43], s61 offen
  s_add_u32 s61, s60, 548864
  buffer_load_dword v5, v112, s[40:43], s61 offen
  s_add_u32 s61, s60, 606208
  buffer_load_dword v6, v112, s[40:43], s61 offen
  s_add_u32 s61, s60, 614400
  buffer_load_dword v7, v112, s[40:43], s61 offen
  s_add_u32 s61, s60, 786432
  buffer_load_dword v8, v112, s[40:43], s61 offen
  s_add_u32 s61, s60, 794624
  buffer_load_dword v9, v112, s[40:43], s61 offen
  s_add_u32 s61, s60, 851968
  buffer_load_dword v10, v112, s[40:43], s61 offen
  s_add_u32 s61, s60, 860160
  buffer_load_dword v11, v112, s[40:43], s61 offen
  s_add_u32 s61, s60, 802816
  buffer_load_dword v12, v112, s[40:43], s61 offen
  s_add_u32 s61, s60, 811008
  buffer_load_dword v13, v112, s[40:43], s61 offen
  s_add_u32 s61, s60, 868352
  buffer_load_dword v14, v112, s[40:43], s61 offen
  s_add_u32 s61, s60, 876544
  buffer_load_dword v15, v112, s[40:43], s61 offen
  s_waitcnt vmcnt(32)
  v_perm_b32 v96, v33, v32, s48
  v_perm_b32 v97, v35, v34, s48
  v_perm_b32 v98, v37, v36, s48
  v_perm_b32 v99, v39, v38, s48
  v_perm_b32 v100, v41, v40, s48
  v_perm_b32 v101, v43, v42, s48
  v_perm_b32 v102, v45, v44, s48
  v_perm_b32 v103, v47, v46, s48
  ds_write_b128 v123, v[96:99] offset:2048
  ds_write_b128 v123, v[100:103] offset:3072
  v_perm_b32 v104, v33, v32, s49
  v_perm_b32 v105, v35, v34, s49
  v_perm_b32 v106, v37, v36, s49
  v_perm_b32 v107, v39, v38, s49
  v_perm_b32 v108, v41, v40, s49
  v_perm_b32 v109, v43, v42, s49
  v_perm_b32 v110, v45, v44, s49
  v_perm_b32 v111, v47, v46, s49
  ds_write_b128 v123, v[104:107] offset:0
  ds_write_b128 v123, v[108:111] offset:1024
  s_waitcnt lgkmcnt(0)
  s_xor_b32 s60, s26, 1
  s_lshl_b32 s60, s60, 20
  s_add_u32 s61, s60, 0
  buffer_load_dword v32, v112, s[40:43], s61 offen
  s_add_u32 s61, s60, 8192
  buffer_load_dword v33, v112, s[40:43], s61 offen
  s_add_u32 s61, s60, 65536
  buffer_load_dword v34, v112, s[40:43], s61 offen
  s_add_u32 s61, s60, 73728
  buffer_load_dword v35, v112, s[40:43], s61 offen
  s_add_u32 s61, s60, 16384
  buffer_load_dword v36, v112, s[40:43], s61 offen
  s_add_u32 s61, s60, 24576
  buffer_load_dword v37, v112, s[40:43], s61 offen
  s_add_u32 s61, s60, 81920
  buffer_load_dword v38, v112, s[40:43], s61 offen
  s_add_u32 s61, s60, 90112
  buffer_load_dword v39, v112, s[40:43], s61 offen
  s_add_u32 s61, s60, 262144
  buffer_load_dword v40, v112, s[40:43], s61 offen
  s_add_u32 s61, s60, 270336
  buffer_load_dword v41, v112, s[40:43], s61 offen
  s_add_u32 s61, s60, 327680
  buffer_load_dword v42, v112, s[40:43], s61 offen
  s_add_u32 s61, s60, 335872
  buffer_load_dword v43, v112, s[40:43], s61 offen
  s_add_u32 s61, s60, 278528
  buffer_load_dword v44, v112, s[40:43], s61 offen
  s_add_u32 s61, s60, 286720
  buffer_load_dword v45, v112, s[40:43], s61 offen
  s_add_u32 s61, s60, 344064
  buffer_load_dword v46, v112, s[40:43], s61 offen
  s_add_u32 s61, s60, 352256
  buffer_load_dword v47, v112, s[40:43], s61 offen
  s_waitcnt vmcnt(32)
  v_perm_b32 v96, v65, v64, s48
  v_perm_b32 v97, v67, v66, s48
  v_perm_b32 v98, v69, v68, s48
  v_perm_b32 v99, v71, v70, s48
  v_perm_b32 v100, v73, v72, s48
  v_perm_b32 v101, v75, v74, s48
  v_perm_b32 v102, v77, v76, s48
  v_perm_b32 v103, v79, v78, s48
  v_accvgpr_write_b32 a96, v96
  v_accvgpr_write_b32 a97, v97
  v_accvgpr_write_b32 a98, v98
  v_accvgpr_write_b32 a99, v99
  v_accvgpr_write_b32 a100, v100
  v_accvgpr_write_b32 a101, v101
  v_accvgpr_write_b32 a102, v102
  v_accvgpr_write_b32 a103, v103
  v_perm_b32 v104, v65, v64, s49
  v_perm_b32 v105, v67, v66, s49
  v_perm_b32 v106, v69, v68, s49
  v_perm_b32 v107, v71, v70, s49
  v_perm_b32 v108, v73, v72, s49
  v_perm_b32 v109, v75, v74, s49
  v_perm_b32 v110, v77, v76, s49
  v_perm_b32 v111, v79, v78, s49
  v_accvgpr_write_b32 a104, v104
  v_accvgpr_write_b32 a105, v105
  v_accvgpr_write_b32 a106, v106
  v_accvgpr_write_b32 a107, v107
  v_accvgpr_write_b32 a108, v108
  v_accvgpr_write_b32 a109, v109
  v_accvgpr_write_b32 a110, v110
  v_accvgpr_write_b32 a111, v111
  s_xor_b32 s60, s26, 1
  s_lshl_b32 s60, s60, 20
  s_add_u32 s61, s60, 524288
  buffer_load_dword v64, v112, s[40:43], s61 offen
  s_add_u32 s61, s60, 532480
  buffer_load_dword v65, v112, s[40:43], s61 offen
  s_add_u32 s61, s60, 589824
  buffer_load_dword v66, v112, s[40:43], s61 offen
  s_add_u32 s61, s60, 598016
  buffer_load_dword v67, v112, s[40:43], s61 offen
  s_add_u32 s61, s60, 540672
  buffer_load_dword v68, v112, s[40:43], s61 offen
  s_add_u32 s61, s60, 548864
  buffer_load_dword v69, v112, s[40:43], s61 offen
  s_add_u32 s61, s60, 606208
  buffer_load_dword v70, v112, s[40:43], s61 offen
  s_add_u32 s61, s60, 614400
  buffer_load_dword v71, v112, s[40:43], s61 offen
  s_add_u32 s61, s60, 786432
  buffer_load_dword v72, v112, s[40:43], s61 offen
  s_add_u32 s61, s60, 794624
  buffer_load_dword v73, v112, s[40:43], s61 offen
  s_add_u32 s61, s60, 851968
  buffer_load_dword v74, v112, s[40:43], s61 offen
  s_add_u32 s61, s60, 860160
  buffer_load_dword v75, v112, s[40:43], s61 offen
  s_add_u32 s61, s60, 802816
  buffer_load_dword v76, v112, s[40:43], s61 offen
  s_add_u32 s61, s60, 811008
  buffer_load_dword v77, v112, s[40:43], s61 offen
  s_add_u32 s61, s60, 868352
  buffer_load_dword v78, v112, s[40:43], s61 offen
  s_add_u32 s61, s60, 876544
  buffer_load_dword v79, v112, s[40:43], s61 offen
  s_waitcnt vmcnt(32)
  v_perm_b32 v96, v1, v0, s48
  v_perm_b32 v97, v3, v2, s48
  v_perm_b32 v98, v5, v4, s48
  v_perm_b32 v99, v7, v6, s48
  v_perm_b32 v100, v9, v8, s48
  v_perm_b32 v101, v11, v10, s48
  v_perm_b32 v102, v13, v12, s48
  v_perm_b32 v103, v15, v14, s48
  v_accvgpr_write_b32 a112, v96
  v_accvgpr_write_b32 a113, v97
  v_accvgpr_write_b32 a114, v98
  v_accvgpr_write_b32 a115, v99
  v_accvgpr_write_b32 a116, v100
  v_accvgpr_write_b32 a117, v101
  v_accvgpr_write_b32 a118, v102
  v_accvgpr_write_b32 a119, v103
  v_perm_b32 v104, v1, v0, s49
  v_perm_b32 v105, v3, v2, s49
  v_perm_b32 v106, v5, v4, s49
  v_perm_b32 v107, v7, v6, s49
  v_perm_b32 v108, v9, v8, s49
  v_perm_b32 v109, v11, v10, s49
  v_perm_b32 v110, v13, v12, s49
  v_perm_b32 v111, v15, v14, s49
  v_accvgpr_write_b32 a120, v104
  v_accvgpr_write_b32 a121, v105
  v_accvgpr_write_b32 a122, v106
  v_accvgpr_write_b32 a123, v107
  v_accvgpr_write_b32 a124, v108
  v_accvgpr_write_b32 a125, v109
  v_accvgpr_write_b32 a126, v110
  v_accvgpr_write_b32 a127, v111
  s_xor_b32 s60, s26, 2
  s_lshl_b32 s60, s60, 20
  s_add_u32 s61, s60, 0
  buffer_load_dword v0, v112, s[40:43], s61 offen
  s_add_u32 s61, s60, 8192
  buffer_load_dword v1, v112, s[40:43], s61 offen
  s_add_u32 s61, s60, 65536
  buffer_load_dword v2, v112, s[40:43], s61 offen
  s_add_u32 s61, s60, 73728
  buffer_load_dword v3, v112, s[40:43], s61 offen
  s_add_u32 s61, s60, 16384
  buffer_load_dword v4, v112, s[40:43], s61 offen
  s_add_u32 s61, s60, 24576
  buffer_load_dword v5, v112, s[40:43], s61 offen
  s_add_u32 s61, s60, 81920
  buffer_load_dword v6, v112, s[40:43], s61 offen
  s_add_u32 s61, s60, 90112
  buffer_load_dword v7, v112, s[40:43], s61 offen
  s_add_u32 s61, s60, 262144
  buffer_load_dword v8, v112, s[40:43], s61 offen
  s_add_u32 s61, s60, 270336
  buffer_load_dword v9, v112, s[40:43], s61 offen
  s_add_u32 s61, s60, 327680
  buffer_load_dword v10, v112, s[40:43], s61 offen
  s_add_u32 s61, s60, 335872
  buffer_load_dword v11, v112, s[40:43], s61 offen
  s_add_u32 s61, s60, 278528
  buffer_load_dword v12, v112, s[40:43], s61 offen
  s_add_u32 s61, s60, 286720
  buffer_load_dword v13, v112, s[40:43], s61 offen
  s_add_u32 s61, s60, 344064
  buffer_load_dword v14, v112, s[40:43], s61 offen
  s_add_u32 s61, s60, 352256
  buffer_load_dword v15, v112, s[40:43], s61 offen
  s_waitcnt vmcnt(32)
  v_perm_b32 v96, v33, v32, s48
  v_perm_b32 v97, v35, v34, s48
  v_perm_b32 v98, v37, v36, s48
  v_perm_b32 v99, v39, v38, s48
  v_perm_b32 v100, v41, v40, s48
  v_perm_b32 v101, v43, v42, s48
  v_perm_b32 v102, v45, v44, s48
  v_perm_b32 v103, v47, v46, s48
  v_accvgpr_write_b32 a128, v96
  v_accvgpr_write_b32 a129, v97
  v_accvgpr_write_b32 a130, v98
  v_accvgpr_write_b32 a131, v99
  v_accvgpr_write_b32 a132, v100
  v_accvgpr_write_b32 a133, v101
  v_accvgpr_write_b32 a134, v102
  v_accvgpr_write_b32 a135, v103
  v_perm_b32 v104, v33, v32, s49
  v_perm_b32 v105, v35, v34, s49
  v_perm_b32 v106, v37, v36, s49
  v_perm_b32 v107, v39, v38, s49
  v_perm_b32 v108, v41, v40, s49
  v_perm_b32 v109, v43, v42, s49
  v_perm_b32 v110, v45, v44, s49
  v_perm_b32 v111, v47, v46, s49
  v_accvgpr_write_b32 a136, v104
  v_accvgpr_write_b32 a137, v105
  v_accvgpr_write_b32 a138, v106
  v_accvgpr_write_b32 a139, v107
  v_accvgpr_write_b32 a140, v108
  v_accvgpr_write_b32 a141, v109
  v_accvgpr_write_b32 a142, v110
  v_accvgpr_write_b32 a143, v111
  s_xor_b32 s60, s26, 2
  s_lshl_b32 s60, s60, 20
  s_add_u32 s61, s60, 524288
  buffer_load_dword v32, v112, s[40:43], s61 offen
  s_add_u32 s61, s60, 532480
  buffer_load_dword v33, v112, s[40:43], s61 offen
  s_add_u32 s61, s60, 589824
  buffer_load_dword v34, v112, s[40:43], s61 offen
  s_add_u32 s61, s60, 598016
  buffer_load_dword v35, v112, s[40:43], s61 offen
  s_add_u32 s61, s60, 540672
  buffer_load_dword v36, v112, s[40:43], s61 offen
  s_add_u32 s61, s60, 548864
  buffer_load_dword v37, v112, s[40:43], s61 offen
  s_add_u32 s61, s60, 606208
  buffer_load_dword v38, v112, s[40:43], s61 offen
  s_add_u32 s61, s60, 614400
  buffer_load_dword v39, v112, s[40:43], s61 offen
  s_add_u32 s61, s60, 786432
  buffer_load_dword v40, v112, s[40:43], s61 offen
  s_add_u32 s61, s60, 794624
  buffer_load_dword v41, v112, s[40:43], s61 offen
  s_add_u32 s61, s60, 851968
  buffer_load_dword v42, v112, s[40:43], s61 offen
  s_add_u32 s61, s60, 860160
  buffer_load_dword v43, v112, s[40:43], s61 offen
  s_add_u32 s61, s60, 802816
  buffer_load_dword v44, v112, s[40:43], s61 offen
  s_add_u32 s61, s60, 811008
  buffer_load_dword v45, v112, s[40:43], s61 offen
  s_add_u32 s61, s60, 868352
  buffer_load_dword v46, v112, s[40:43], s61 offen
  s_add_u32 s61, s60, 876544
  buffer_load_dword v47, v112, s[40:43], s61 offen
  s_waitcnt vmcnt(32)
  v_perm_b32 v96, v65, v64, s48
  v_perm_b32 v97, v67, v66, s48
  v_perm_b32 v98, v69, v68, s48
  v_perm_b32 v99, v71, v70, s48
  v_perm_b32 v100, v73, v72, s48
  v_perm_b32 v101, v75, v74, s48
  v_perm_b32 v102, v77, v76, s48
  v_perm_b32 v103, v79, v78, s48
  v_accvgpr_write_b32 a144, v96
  v_accvgpr_write_b32 a145, v97
  v_accvgpr_write_b32 a146, v98
  v_accvgpr_write_b32 a147, v99
  v_accvgpr_write_b32 a148, v100
  v_accvgpr_write_b32 a149, v101
  v_accvgpr_write_b32 a150, v102
  v_accvgpr_write_b32 a151, v103
  v_perm_b32 v104, v65, v64, s49
  v_perm_b32 v105, v67, v66, s49
  v_perm_b32 v106, v69, v68, s49
  v_perm_b32 v107, v71, v70, s49
  v_perm_b32 v108, v73, v72, s49
  v_perm_b32 v109, v75, v74, s49
  v_perm_b32 v110, v77, v76, s49
  v_perm_b32 v111, v79, v78, s49
  v_accvgpr_write_b32 a152, v104
  v_accvgpr_write_b32 a153, v105
  v_accvgpr_write_b32 a154, v106
  v_accvgpr_write_b32 a155, v107
  v_accvgpr_write_b32 a156, v108
  v_accvgpr_write_b32 a157, v109
  v_accvgpr_write_b32 a158, v110
  v_accvgpr_write_b32 a159, v111
  s_xor_b32 s60, s26, 3
  s_lshl_b32 s60, s60, 20
  s_add_u32 s61, s60, 0
  buffer_load_dword v64, v112, s[40:43], s61 offen
  s_add_u32 s61, s60, 8192
  buffer_load_dword v65, v112, s[40:43], s61 offen
  s_add_u32 s61, s60, 65536
  buffer_load_dword v66, v112, s[40:43], s61 offen
  s_add_u32 s61, s60, 73728
  buffer_load_dword v67, v112, s[40:43], s61 offen
  s_add_u32 s61, s60, 16384
  buffer_load_dword v68, v112, s[40:43], s61 offen
  s_add_u32 s61, s60, 24576
  buffer_load_dword v69, v112, s[40:43], s61 offen
  s_add_u32 s61, s60, 81920
  buffer_load_dword v70, v112, s[40:43], s61 offen
  s_add_u32 s61, s60, 90112
  buffer_load_dword v71, v112, s[40:43], s61 offen
  s_add_u32 s61, s60, 262144
  buffer_load_dword v72, v112, s[40:43], s61 offen
  s_add_u32 s61, s60, 270336
  buffer_load_dword v73, v112, s[40:43], s61 offen
  s_add_u32 s61, s60, 327680
  buffer_load_dword v74, v112, s[40:43], s61 offen
  s_add_u32 s61, s60, 335872
  buffer_load_dword v75, v112, s[40:43], s61 offen
  s_add_u32 s61, s60, 278528
  buffer_load_dword v76, v112, s[40:43], s61 offen
  s_add_u32 s61, s60, 286720
  buffer_load_dword v77, v112, s[40:43], s61 offen
  s_add_u32 s61, s60, 344064
  buffer_load_dword v78, v112, s[40:43], s61 offen
  s_add_u32 s61, s60, 352256
  buffer_load_dword v79, v112, s[40:43], s61 offen
  s_waitcnt vmcnt(32)
  v_perm_b32 v96, v1, v0, s48
  v_perm_b32 v97, v3, v2, s48
  v_perm_b32 v98, v5, v4, s48
  v_perm_b32 v99, v7, v6, s48
  v_perm_b32 v100, v9, v8, s48
  v_perm_b32 v101, v11, v10, s48
  v_perm_b32 v102, v13, v12, s48
  v_perm_b32 v103, v15, v14, s48
  v_accvgpr_write_b32 a160, v96
  v_accvgpr_write_b32 a161, v97
  v_accvgpr_write_b32 a162, v98
  v_accvgpr_write_b32 a163, v99
  v_accvgpr_write_b32 a164, v100
  v_accvgpr_write_b32 a165, v101
  v_accvgpr_write_b32 a166, v102
  v_accvgpr_write_b32 a167, v103
  v_perm_b32 v104, v1, v0, s49
  v_perm_b32 v105, v3, v2, s49
  v_perm_b32 v106, v5, v4, s49
  v_perm_b32 v107, v7, v6, s49
  v_perm_b32 v108, v9, v8, s49
  v_perm_b32 v109, v11, v10, s49
  v_perm_b32 v110, v13, v12, s49
  v_perm_b32 v111, v15, v14, s49
  v_accvgpr_write_b32 a168, v104
  v_accvgpr_write_b32 a169, v105
  v_accvgpr_write_b32 a170, v106
  v_accvgpr_write_b32 a171, v107
  v_accvgpr_write_b32 a172, v108
  v_accvgpr_write_b32 a173, v109
  v_accvgpr_write_b32 a174, v110
  v_accvgpr_write_b32 a175, v111
  s_xor_b32 s60, s26, 3
  s_lshl_b32 s60, s60, 20
  s_add_u32 s61, s60, 524288
  buffer_load_dword v0, v112, s[40:43], s61 offen
  s_add_u32 s61, s60, 532480
  buffer_load_dword v1, v112, s[40:43], s61 offen
  s_add_u32 s61, s60, 589824
  buffer_load_dword v2, v112, s[40:43], s61 offen
  s_add_u32 s61, s60, 598016
  buffer_load_dword v3, v112, s[40:43], s61 offen
  s_add_u32 s61, s60, 540672
  buffer_load_dword v4, v112, s[40:43], s61 offen
  s_add_u32 s61, s60, 548864
  buffer_load_dword v5, v112, s[40:43], s61 offen
  s_add_u32 s61, s60, 606208
  buffer_load_dword v6, v112, s[40:43], s61 offen
  s_add_u32 s61, s60, 614400
  buffer_load_dword v7, v112, s[40:43], s61 offen
  s_add_u32 s61, s60, 786432
  buffer_load_dword v8, v112, s[40:43], s61 offen
  s_add_u32 s61, s60, 794624
  buffer_load_dword v9, v112, s[40:43], s61 offen
  s_add_u32 s61, s60, 851968
  buffer_load_dword v10, v112, s[40:43], s61 offen
  s_add_u32 s61, s60, 860160
  buffer_load_dword v11, v112, s[40:43], s61 offen
  s_add_u32 s61, s60, 802816
  buffer_load_dword v12, v112, s[40:43], s61 offen
  s_add_u32 s61, s60, 811008
  buffer_load_dword v13, v112, s[40:43], s61 offen
  s_add_u32 s61, s60, 868352
  buffer_load_dword v14, v112, s[40:43], s61 offen
  s_add_u32 s61, s60, 876544
  buffer_load_dword v15, v112, s[40:43], s61 offen
  s_waitcnt vmcnt(32)
  v_perm_b32 v96, v33, v32, s48
  v_perm_b32 v97, v35, v34, s48
  v_perm_b32 v98, v37, v36, s48
  v_perm_b32 v99, v39, v38, s48
  v_perm_b32 v100, v41, v40, s48
  v_perm_b32 v101, v43, v42, s48
  v_perm_b32 v102, v45, v44, s48
  v_perm_b32 v103, v47, v46, s48
  v_accvgpr_write_b32 a176, v96
  v_accvgpr_write_b32 a177, v97
  v_accvgpr_write_b32 a178, v98
  v_accvgpr_write_b32 a179, v99
  v_accvgpr_write_b32 a180, v100
  v_accvgpr_write_b32 a181, v101
  v_accvgpr_write_b32 a182, v102
  v_accvgpr_write_b32 a183, v103
  v_perm_b32 v104, v33, v32, s49
  v_perm_b32 v105, v35, v34, s49
  v_perm_b32 v106, v37, v36, s49
  v_perm_b32 v107, v39, v38, s49
  v_perm_b32 v108, v41, v40, s49
  v_perm_b32 v109, v43, v42, s49
  v_perm_b32 v110, v45, v44, s49
  v_perm_b32 v111, v47, v46, s49
  v_accvgpr_write_b32 a184, v104
  v_accvgpr_write_b32 a185, v105
  v_accvgpr_write_b32 a186, v106
  v_accvgpr_write_b32 a187, v107
  v_accvgpr_write_b32 a188, v108
  v_accvgpr_write_b32 a189, v109
  v_accvgpr_write_b32 a190, v110
  v_accvgpr_write_b32 a191, v111
  s_mov_b32 s36, s12
  s_and_b32 s37, s13, 0xffff
  s_mov_b32 s38, 4194304
  s_mov_b32 s39, 0x20000
  s_xor_b32 s60, s26, 0
  s_lshl_b32 s60, s60, 20
  s_add_u32 s61, s60, 0
  buffer_load_dword v32, v112, s[36:39], s61 offen
  s_add_u32 s61, s60, 8192
  buffer_load_dword v33, v112, s[36:39], s61 offen
  s_add_u32 s61, s60, 65536
  buffer_load_dword v34, v112, s[36:39], s61 offen
  s_add_u32 s61, s60, 73728
  buffer_load_dword v35, v112, s[36:39], s61 offen
  s_add_u32 s61, s60, 16384
  buffer_load_dword v36, v112, s[36:39], s61 offen
  s_add_u32 s61, s60, 24576
  buffer_load_dword v37, v112, s[36:39], s61 offen
  s_add_u32 s61, s60, 81920
  buffer_load_dword v38, v112, s[36:39], s61 offen
  s_add_u32 s61, s60, 90112
  buffer_load_dword v39, v112, s[36:39], s61 offen
  s_add_u32 s61, s60, 262144
  buffer_load_dword v40, v112, s[36:39], s61 offen
  s_add_u32 s61, s60, 270336
  buffer_load_dword v41, v112, s[36:39], s61 offen
  s_add_u32 s61, s60, 327680
  buffer_load_dword v42, v112, s[36:39], s61 offen
  s_add_u32 s61, s60, 335872
  buffer_load_dword v43, v112, s[36:39], s61 offen
  s_add_u32 s61, s60, 278528
  buffer_load_dword v44, v112, s[36:39], s61 offen
  s_add_u32 s61, s60, 286720
  buffer_load_dword v45, v112, s[36:39], s61 offen
  s_add_u32 s61, s60, 344064
  buffer_load_dword v46, v112, s[36:39], s61 offen
  s_add_u32 s61, s60, 352256
  buffer_load_dword v47, v112, s[36:39], s61 offen
  s_waitcnt vmcnt(32)
  v_perm_b32 v96, v65, v64, s48
  v_perm_b32 v97, v67, v66, s48
  v_perm_b32 v98, v69, v68, s48
  v_perm_b32 v99, v71, v70, s48
  v_perm_b32 v100, v73, v72, s48
  v_perm_b32 v101, v75, v74, s48
  v_perm_b32 v102, v77, v76, s48
  v_perm_b32 v103, v79, v78, s48
  v_accvgpr_write_b32 a192, v96
  v_accvgpr_write_b32 a193, v97
  v_accvgpr_write_b32 a194, v98
  v_accvgpr_write_b32 a195, v99
  v_accvgpr_write_b32 a196, v100
  v_accvgpr_write_b32 a197, v101
  v_accvgpr_write_b32 a198, v102
  v_accvgpr_write_b32 a199, v103
  v_perm_b32 v104, v65, v64, s49
  v_perm_b32 v105, v67, v66, s49
  v_perm_b32 v106, v69, v68, s49
  v_perm_b32 v107, v71, v70, s49
  v_perm_b32 v108, v73, v72, s49
  v_perm_b32 v109, v75, v74, s49
  v_perm_b32 v110, v77, v76, s49
  v_perm_b32 v111, v79, v78, s49
  v_accvgpr_write_b32 a200, v104
  v_accvgpr_write_b32 a201, v105
  v_accvgpr_write_b32 a202, v106
  v_accvgpr_write_b32 a203, v107
  v_accvgpr_write_b32 a204, v108
  v_accvgpr_write_b32 a205, v109
  v_accvgpr_write_b32 a206, v110
  v_accvgpr_write_b32 a207, v111
  s_xor_b32 s60, s26, 0
  s_lshl_b32 s60, s60, 20
  s_add_u32 s61, s60, 524288
  buffer_load_dword v64, v112, s[36:39], s61 offen
  s_add_u32 s61, s60, 532480
  buffer_load_dword v65, v112, s[36:39], s61 offen
  s_add_u32 s61, s60, 589824
  buffer_load_dword v66, v112, s[36:39], s61 offen
  s_add_u32 s61, s60, 598016
  buffer_load_dword v67, v112, s[36:39], s61 offen
  s_add_u32 s61, s60, 540672
  buffer_load_dword v68, v112, s[36:39], s61 offen
  s_add_u32 s61, s60, 548864
  buffer_load_dword v69, v112, s[36:39], s61 offen
  s_add_u32 s61, s60, 606208
  buffer_load_dword v70, v112, s[36:39], s61 offen
  s_add_u32 s61, s60, 614400
  buffer_load_dword v71, v112, s[36:39], s61 offen
  s_add_u32 s61, s60, 786432
  buffer_load_dword v72, v112, s[36:39], s61 offen
  s_add_u32 s61, s60, 794624
  buffer_load_dword v73, v112, s[36:39], s61 offen
  s_add_u32 s61, s60, 851968
  buffer_load_dword v74, v112, s[36:39], s61 offen
  s_add_u32 s61, s60, 860160
  buffer_load_dword v75, v112, s[36:39], s61 offen
  s_add_u32 s61, s60, 802816
  buffer_load_dword v76, v112, s[36:39], s61 offen
  s_add_u32 s61, s60, 811008
  buffer_load_dword v77, v112, s[36:39], s61 offen
  s_add_u32 s61, s60, 868352
  buffer_load_dword v78, v112, s[36:39], s61 offen
  s_add_u32 s61, s60, 876544
  buffer_load_dword v79, v112, s[36:39], s61 offen
  s_waitcnt vmcnt(32)
  v_perm_b32 v96, v1, v0, s48
  v_perm_b32 v97, v3, v2, s48
  v_perm_b32 v98, v5, v4, s48
  v_perm_b32 v99, v7, v6, s48
  v_perm_b32 v100, v9, v8, s48
  v_perm_b32 v101, v11, v10, s48
  v_perm_b32 v102, v13, v12, s48
  v_perm_b32 v103, v15, v14, s48
  v_accvgpr_write_b32 a208, v96
  v_accvgpr_write_b32 a209, v97
  v_accvgpr_write_b32 a210, v98
  v_accvgpr_write_b32 a211, v99
  v_accvgpr_write_b32 a212, v100
  v_accvgpr_write_b32 a213, v101
  v_accvgpr_write_b32 a214, v102
  v_accvgpr_write_b32 a215, v103
  v_perm_b32 v104, v1, v0, s49
  v_perm_b32 v105, v3, v2, s49
  v_perm_b32 v106, v5, v4, s49
  v_perm_b32 v107, v7, v6, s49
  v_perm_b32 v108, v9, v8, s49
  v_perm_b32 v109, v11, v10, s49
  v_perm_b32 v110, v13, v12, s49
  v_perm_b32 v111, v15, v14, s49
  v_accvgpr_write_b32 a216, v104
  v_accvgpr_write_b32 a217, v105
  v_accvgpr_write_b32 a218, v106
  v_accvgpr_write_b32 a219, v107
  v_accvgpr_write_b32 a220, v108
  v_accvgpr_write_b32 a221, v109
  v_accvgpr_write_b32 a222, v110
  v_accvgpr_write_b32 a223, v111
  s_xor_b32 s60, s26, 1
  s_lshl_b32 s60, s60, 20
  s_add_u32 s61, s60, 0
  buffer_load_dword v0, v112, s[36:39], s61 offen
  s_add_u32 s61, s60, 8192
  buffer_load_dword v1, v112, s[36:39], s61 offen
  s_add_u32 s61, s60, 65536
  buffer_load_dword v2, v112, s[36:39], s61 offen
  s_add_u32 s61, s60, 73728
  buffer_load_dword v3, v112, s[36:39], s61 offen
  s_add_u32 s61, s60, 16384
  buffer_load_dword v4, v112, s[36:39], s61 offen
  s_add_u32 s61, s60, 24576
  buffer_load_dword v5, v112, s[36:39], s61 offen
  s_add_u32 s61, s60, 81920
  buffer_load_dword v6, v112, s[36:39], s61 offen
  s_add_u32 s61, s60, 90112
  buffer_load_dword v7, v112, s[36:39], s61 offen
  s_add_u32 s61, s60, 262144
  buffer_load_dword v8, v112, s[36:39], s61 offen
  s_add_u32 s61, s60, 270336
  buffer_load_dword v9, v112, s[36:39], s61 offen
  s_add_u32 s61, s60, 327680
  buffer_load_dword v10, v112, s[36:39], s61 offen
  s_add_u32 s61, s60, 335872
  buffer_load_dword v11, v112, s[36:39], s61 offen
  s_add_u32 s61, s60, 278528
  buffer_load_dword v12, v112, s[36:39], s61 offen
  s_add_u32 s61, s60, 286720
  buffer_load_dword v13, v112, s[36:39], s61 offen
  s_add_u32 s61, s60, 344064
  buffer_load_dword v14, v112, s[36:39], s61 offen
  s_add_u32 s61, s60, 352256
  buffer_load_dword v15, v112, s[36:39], s61 offen
  s_waitcnt vmcnt(32)
  v_perm_b32 v96, v33, v32, s48
  v_perm_b32 v97, v35, v34, s48
  v_perm_b32 v98, v37, v36, s48
  v_perm_b32 v99, v39, v38, s48
  v_perm_b32 v100, v41, v40, s48
  v_perm_b32 v101, v43, v42, s48
  v_perm_b32 v102, v45, v44, s48
  v_perm_b32 v103, v47, v46, s48
  ds_write_b128 v123, v[96:99] offset:32768
  ds_write_b128 v123, v[100:103] offset:33792
  v_perm_b32 v104, v33, v32, s49
  v_perm_b32 v105, v35, v34, s49
  v_perm_b32 v106, v37, v36, s49
  v_perm_b32 v107, v39, v38, s49
  v_perm_b32 v108, v41, v40, s49
  v_perm_b32 v109, v43, v42, s49
  v_perm_b32 v110, v45, v44, s49
  v_perm_b32 v111, v47, v46, s49
  ds_write_b128 v123, v[104:107] offset:34816
  ds_write_b128 v123, v[108:111] offset:35840
  s_waitcnt lgkmcnt(0)
  s_xor_b32 s60, s26, 1
  s_lshl_b32 s60, s60, 20
  s_add_u32 s61, s60, 524288
  buffer_load_dword v32, v112, s[36:39], s61 offen
  s_add_u32 s61, s60, 532480
  buffer_load_dword v33, v112, s[36:39], s61 offen
  s_add_u32 s61, s60, 589824
  buffer_load_dword v34, v112, s[36:39], s61 offen
  s_add_u32 s61, s60, 598016
  buffer_load_dword v35, v112, s[36:39], s61 offen
  s_add_u32 s61, s60, 540672
  buffer_load_dword v36, v112, s[36:39], s61 offen
  s_add_u32 s61, s60, 548864
  buffer_load_dword v37, v112, s[36:39], s61 offen
  s_add_u32 s61, s60, 606208
  buffer_load_dword v38, v112, s[36:39], s61 offen
  s_add_u32 s61, s60, 614400
  buffer_load_dword v39, v112, s[36:39], s61 offen
  s_add_u32 s61, s60, 786432
  buffer_load_dword v40, v112, s[36:39], s61 offen
  s_add_u32 s61, s60, 794624
  buffer_load_dword v41, v112, s[36:39], s61 offen
  s_add_u32 s61, s60, 851968
  buffer_load_dword v42, v112, s[36:39], s61 offen
  s_add_u32 s61, s60, 860160
  buffer_load_dword v43, v112, s[36:39], s61 offen
  s_add_u32 s61, s60, 802816
  buffer_load_dword v44, v112, s[36:39], s61 offen
  s_add_u32 s61, s60, 811008
  buffer_load_dword v45, v112, s[36:39], s61 offen
  s_add_u32 s61, s60, 868352
  buffer_load_dword v46, v112, s[36:39], s61 offen
  s_add_u32 s61, s60, 876544
  buffer_load_dword v47, v112, s[36:39], s61 offen
  s_waitcnt vmcnt(32)
  v_perm_b32 v96, v65, v64, s48
  v_perm_b32 v97, v67, v66, s48
  v_perm_b32 v98, v69, v68, s48
  v_perm_b32 v99, v71, v70, s48
  v_perm_b32 v100, v73, v72, s48
  v_perm_b32 v101, v75, v74, s48
  v_perm_b32 v102, v77, v76, s48
  v_perm_b32 v103, v79, v78, s48
  v_accvgpr_write_b32 a224, v96
  v_accvgpr_write_b32 a225, v97
  v_accvgpr_write_b32 a226, v98
  v_accvgpr_write_b32 a227, v99
  v_accvgpr_write_b32 a228, v100
  v_accvgpr_write_b32 a229, v101
  v_accvgpr_write_b32 a230, v102
  v_accvgpr_write_b32 a231, v103
  v_perm_b32 v104, v65, v64, s49
  v_perm_b32 v105, v67, v66, s49
  v_perm_b32 v106, v69, v68, s49
  v_perm_b32 v107, v71, v70, s49
  v_perm_b32 v108, v73, v72, s49
  v_perm_b32 v109, v75, v74, s49
  v_perm_b32 v110, v77, v76, s49
  v_perm_b32 v111, v79, v78, s49
  v_accvgpr_write_b32 a232, v104
  v_accvgpr_write_b32 a233, v105
  v_accvgpr_write_b32 a234, v106
  v_accvgpr_write_b32 a235, v107
  v_accvgpr_write_b32 a236, v108
  v_accvgpr_write_b32 a237, v109
  v_accvgpr_write_b32 a238, v110
  v_accvgpr_write_b32 a239, v111
  s_xor_b32 s60, s26, 2
  s_lshl_b32 s60, s60, 20
  s_add_u32 s61, s60, 0
  buffer_load_dword v64, v112, s[36:39], s61 offen
  s_add_u32 s61, s60, 8192
  buffer_load_dword v65, v112, s[36:39], s61 offen
  s_add_u32 s61, s60, 65536
  buffer_load_dword v66, v112, s[36:39], s61 offen
  s_add_u32 s61, s60, 73728
  buffer_load_dword v67, v112, s[36:39], s61 offen
  s_add_u32 s61, s60, 16384
  buffer_load_dword v68, v112, s[36:39], s61 offen
  s_add_u32 s61, s60, 24576
  buffer_load_dword v69, v112, s[36:39], s61 offen
  s_add_u32 s61, s60, 81920
  buffer_load_dword v70, v112, s[36:39], s61 offen
  s_add_u32 s61, s60, 90112
  buffer_load_dword v71, v112, s[36:39], s61 offen
  s_add_u32 s61, s60, 262144
  buffer_load_dword v72, v112, s[36:39], s61 offen
  s_add_u32 s61, s60, 270336
  buffer_load_dword v73, v112, s[36:39], s61 offen
  s_add_u32 s61, s60, 327680
  buffer_load_dword v74, v112, s[36:39], s61 offen
  s_add_u32 s61, s60, 335872
  buffer_load_dword v75, v112, s[36:39], s61 offen
  s_add_u32 s61, s60, 278528
  buffer_load_dword v76, v112, s[36:39], s61 offen
  s_add_u32 s61, s60, 286720
  buffer_load_dword v77, v112, s[36:39], s61 offen
  s_add_u32 s61, s60, 344064
  buffer_load_dword v78, v112, s[36:39], s61 offen
  s_add_u32 s61, s60, 352256
  buffer_load_dword v79, v112, s[36:39], s61 offen
  s_waitcnt vmcnt(32)
  v_perm_b32 v96, v1, v0, s48
  v_perm_b32 v97, v3, v2, s48
  v_perm_b32 v98, v5, v4, s48
  v_perm_b32 v99, v7, v6, s48
  v_perm_b32 v100, v9, v8, s48
  v_perm_b32 v101, v11, v10, s48
  v_perm_b32 v102, v13, v12, s48
  v_perm_b32 v103, v15, v14, s48
  v_accvgpr_write_b32 a240, v96
  v_accvgpr_write_b32 a241, v97
  v_accvgpr_write_b32 a242, v98
  v_accvgpr_write_b32 a243, v99
  v_accvgpr_write_b32 a244, v100
  v_accvgpr_write_b32 a245, v101
  v_accvgpr_write_b32 a246, v102
  v_accvgpr_write_b32 a247, v103
  v_perm_b32 v104, v1, v0, s49
  v_perm_b32 v105, v3, v2, s49
  v_perm_b32 v106, v5, v4, s49
  v_perm_b32 v107, v7, v6, s49
  v_perm_b32 v108, v9, v8, s49
  v_perm_b32 v109, v11, v10, s49
  v_perm_b32 v110, v13, v12, s49
  v_perm_b32 v111, v15, v14, s49
  v_accvgpr_write_b32 a248, v104
  v_accvgpr_write_b32 a249, v105
  v_accvgpr_write_b32 a250, v106
  v_accvgpr_write_b32 a251, v107
  v_accvgpr_write_b32 a252, v108
  v_accvgpr_write_b32 a253, v109
  v_accvgpr_write_b32 a254, v110
  v_accvgpr_write_b32 a255, v111
  s_xor_b32 s60, s26, 2
  s_lshl_b32 s60, s60, 20
  s_add_u32 s61, s60, 524288
  buffer_load_dword v0, v112, s[36:39], s61 offen
  s_add_u32 s61, s60, 532480
  buffer_load_dword v1, v112, s[36:39], s61 offen
  s_add_u32 s61, s60, 589824
  buffer_load_dword v2, v112, s[36:39], s61 offen
  s_add_u32 s61, s60, 598016
  buffer_load_dword v3, v112, s[36:39], s61 offen
  s_add_u32 s61, s60, 540672
  buffer_load_dword v4, v112, s[36:39], s61 offen
  s_add_u32 s61, s60, 548864
  buffer_load_dword v5, v112, s[36:39], s61 offen
  s_add_u32 s61, s60, 606208
  buffer_load_dword v6, v112, s[36:39], s61 offen
  s_add_u32 s61, s60, 614400
  buffer_load_dword v7, v112, s[36:39], s61 offen
  s_add_u32 s61, s60, 786432
  buffer_load_dword v8, v112, s[36:39], s61 offen
  s_add_u32 s61, s60, 794624
  buffer_load_dword v9, v112, s[36:39], s61 offen
  s_add_u32 s61, s60, 851968
  buffer_load_dword v10, v112, s[36:39], s61 offen
  s_add_u32 s61, s60, 860160
  buffer_load_dword v11, v112, s[36:39], s61 offen
  s_add_u32 s61, s60, 802816
  buffer_load_dword v12, v112, s[36:39], s61 offen
  s_add_u32 s61, s60, 811008
  buffer_load_dword v13, v112, s[36:39], s61 offen
  s_add_u32 s61, s60, 868352
  buffer_load_dword v14, v112, s[36:39], s61 offen
  s_add_u32 s61, s60, 876544
  buffer_load_dword v15, v112, s[36:39], s61 offen
  s_waitcnt vmcnt(32)
  v_perm_b32 v144, v33, v32, s48
  v_perm_b32 v145, v35, v34, s48
  v_perm_b32 v146, v37, v36, s48
  v_perm_b32 v147, v39, v38, s48
  v_perm_b32 v148, v41, v40, s48
  v_perm_b32 v149, v43, v42, s48
  v_perm_b32 v150, v45, v44, s48
  v_perm_b32 v151, v47, v46, s48
  v_perm_b32 v152, v33, v32, s49
  v_perm_b32 v153, v35, v34, s49
  v_perm_b32 v154, v37, v36, s49
  v_perm_b32 v155, v39, v38, s49
  v_perm_b32 v156, v41, v40, s49
  v_perm_b32 v157, v43, v42, s49
  v_perm_b32 v158, v45, v44, s49
  v_perm_b32 v159, v47, v46, s49
  s_xor_b32 s60, s26, 3
  s_lshl_b32 s60, s60, 20
  s_add_u32 s61, s60, 0
  buffer_load_dword v32, v112, s[36:39], s61 offen
  s_add_u32 s61, s60, 8192
  buffer_load_dword v33, v112, s[36:39], s61 offen
  s_add_u32 s61, s60, 65536
  buffer_load_dword v34, v112, s[36:39], s61 offen
  s_add_u32 s61, s60, 73728
  buffer_load_dword v35, v112, s[36:39], s61 offen
  s_add_u32 s61, s60, 16384
  buffer_load_dword v36, v112, s[36:39], s61 offen
  s_add_u32 s61, s60, 24576
  buffer_load_dword v37, v112, s[36:39], s61 offen
  s_add_u32 s61, s60, 81920
  buffer_load_dword v38, v112, s[36:39], s61 offen
  s_add_u32 s61, s60, 90112
  buffer_load_dword v39, v112, s[36:39], s61 offen
  s_add_u32 s61, s60, 262144
  buffer_load_dword v40, v112, s[36:39], s61 offen
  s_add_u32 s61, s60, 270336
  buffer_load_dword v41, v112, s[36:39], s61 offen
  s_add_u32 s61, s60, 327680
  buffer_load_dword v42, v112, s[36:39], s61 offen
  s_add_u32 s61, s60, 335872
  buffer_load_dword v43, v112, s[36:39], s61 offen
  s_add_u32 s61, s60, 278528
  buffer_load_dword v44, v112, s[36:39], s61 offen
  s_add_u32 s61, s60, 286720
  buffer_load_dword v45, v112, s[36:39], s61 offen
  s_add_u32 s61, s60, 344064
  buffer_load_dword v46, v112, s[36:39], s61 offen
  s_add_u32 s61, s60, 352256
  buffer_load_dword v47, v112, s[36:39], s61 offen
  s_waitcnt vmcnt(32)
  v_perm_b32 v160, v65, v64, s48
  v_perm_b32 v161, v67, v66, s48
  v_perm_b32 v162, v69, v68, s48
  v_perm_b32 v163, v71, v70, s48
  v_perm_b32 v164, v73, v72, s48
  v_perm_b32 v165, v75, v74, s48
  v_perm_b32 v166, v77, v76, s48
  v_perm_b32 v167, v79, v78, s48
  v_perm_b32 v168, v65, v64, s49
  v_perm_b32 v169, v67, v66, s49
  v_perm_b32 v170, v69, v68, s49
  v_perm_b32 v171, v71, v70, s49
  v_perm_b32 v172, v73, v72, s49
  v_perm_b32 v173, v75, v74, s49
  v_perm_b32 v174, v77, v76, s49
  v_perm_b32 v175, v79, v78, s49
  s_xor_b32 s60, s26, 3
  s_lshl_b32 s60, s60, 20
  s_add_u32 s61, s60, 524288
  buffer_load_dword v64, v112, s[36:39], s61 offen
  s_add_u32 s61, s60, 532480
  buffer_load_dword v65, v112, s[36:39], s61 offen
  s_add_u32 s61, s60, 589824
  buffer_load_dword v66, v112, s[36:39], s61 offen
  s_add_u32 s61, s60, 598016
  buffer_load_dword v67, v112, s[36:39], s61 offen
  s_add_u32 s61, s60, 540672
  buffer_load_dword v68, v112, s[36:39], s61 offen
  s_add_u32 s61, s60, 548864
  buffer_load_dword v69, v112, s[36:39], s61 offen
  s_add_u32 s61, s60, 606208
  buffer_load_dword v70, v112, s[36:39], s61 offen
  s_add_u32 s61, s60, 614400
  buffer_load_dword v71, v112, s[36:39], s61 offen
  s_add_u32 s61, s60, 786432
  buffer_load_dword v72, v112, s[36:39], s61 offen
  s_add_u32 s61, s60, 794624
  buffer_load_dword v73, v112, s[36:39], s61 offen
  s_add_u32 s61, s60, 851968
  buffer_load_dword v74, v112, s[36:39], s61 offen
  s_add_u32 s61, s60, 860160
  buffer_load_dword v75, v112, s[36:39], s61 offen
  s_add_u32 s61, s60, 802816
  buffer_load_dword v76, v112, s[36:39], s61 offen
  s_add_u32 s61, s60, 811008
  buffer_load_dword v77, v112, s[36:39], s61 offen
  s_add_u32 s61, s60, 868352
  buffer_load_dword v78, v112, s[36:39], s61 offen
  s_add_u32 s61, s60, 876544
  buffer_load_dword v79, v112, s[36:39], s61 offen
  s_waitcnt vmcnt(32)
  v_perm_b32 v176, v1, v0, s48
  v_perm_b32 v177, v3, v2, s48
  v_perm_b32 v178, v5, v4, s48
  v_perm_b32 v179, v7, v6, s48
  v_perm_b32 v180, v9, v8, s48
  v_perm_b32 v181, v11, v10, s48
  v_perm_b32 v182, v13, v12, s48
  v_perm_b32 v183, v15, v14, s48
  v_perm_b32 v184, v1, v0, s49
  v_perm_b32 v185, v3, v2, s49
  v_perm_b32 v186, v5, v4, s49
  v_perm_b32 v187, v7, v6, s49
  v_perm_b32 v188, v9, v8, s49
  v_perm_b32 v189, v11, v10, s49
  v_perm_b32 v190, v13, v12, s49
  v_perm_b32 v191, v15, v14, s49
  s_mov_b32 s40, s14
  s_and_b32 s41, s15, 0xffff
  s_mov_b32 s42, 4194304
  s_mov_b32 s43, 0x20000
  s_mov_b32 s61, 0
  buffer_load_dwordx2 v[0:1], v113, s[40:43], s61 offen
  s_mov_b32 s61, 1024
  buffer_load_dwordx2 v[2:3], v113, s[40:43], s61 offen
  s_mov_b32 s61, 8192
  buffer_load_dwordx2 v[4:5], v113, s[40:43], s61 offen
  s_mov_b32 s61, 9216
  buffer_load_dwordx2 v[6:7], v113, s[40:43], s61 offen
  s_mov_b32 s61, 2048
  buffer_load_dwordx2 v[8:9], v113, s[40:43], s61 offen
  s_mov_b32 s61, 3072
  buffer_load_dwordx2 v[10:11], v113, s[40:43], s61 offen
  s_mov_b32 s61, 10240
  buffer_load_dwordx2 v[12:13], v113, s[40:43], s61 offen
  s_mov_b32 s61, 11264
  buffer_load_dwordx2 v[14:15], v113, s[40:43], s61 offen
  s_mov_b32 s61, 32768
  buffer_load_dwordx2 v[16:17], v113, s[40:43], s61 offen
  s_mov_b32 s61, 33792
  buffer_load_dwordx2 v[18:19], v113, s[40:43], s61 offen
  s_mov_b32 s61, 40960
  buffer_load_dwordx2 v[20:21], v113, s[40:43], s61 offen
  s_mov_b32 s61, 41984
  buffer_load_dwordx2 v[22:23], v113, s[40:43], s61 offen
  s_mov_b32 s61, 34816
  buffer_load_dwordx2 v[24:25], v113, s[40:43], s61 offen
  s_mov_b32 s61, 35840
  buffer_load_dwordx2 v[26:27], v113, s[40:43], s61 offen
  s_mov_b32 s61, 43008
  buffer_load_dwordx2 v[28:29], v113, s[40:43], s61 offen
  s_mov_b32 s61, 44032
  buffer_load_dwordx2 v[30:31], v113, s[40:43], s61 offen
  s_waitcnt vmcnt(32)
  v_perm_b32 v192, v33, v32, s48
  v_perm_b32 v193, v35, v34, s48
  v_perm_b32 v194, v37, v36, s48
  v_perm_b32 v195, v39, v38, s48
  v_perm_b32 v196, v41, v40, s48
  v_perm_b32 v197, v43, v42, s48
  v_perm_b32 v198, v45, v44, s48
  v_perm_b32 v199, v47, v46, s48
  v_perm_b32 v200, v33, v32, s49
  v_perm_b32 v201, v35, v34, s49
  v_perm_b32 v202, v37, v36, s49
  v_perm_b32 v203, v39, v38, s49
  v_perm_b32 v204, v41, v40, s49
  v_perm_b32 v205, v43, v42, s49
  v_perm_b32 v206, v45, v44, s49
  v_perm_b32 v207, v47, v46, s49
  s_mov_b32 s61, 65536
  buffer_load_dwordx2 v[32:33], v113, s[40:43], s61 offen
  s_mov_b32 s61, 66560
  buffer_load_dwordx2 v[34:35], v113, s[40:43], s61 offen
  s_mov_b32 s61, 73728
  buffer_load_dwordx2 v[36:37], v113, s[40:43], s61 offen
  s_mov_b32 s61, 74752
  buffer_load_dwordx2 v[38:39], v113, s[40:43], s61 offen
  s_mov_b32 s61, 67584
  buffer_load_dwordx2 v[40:41], v113, s[40:43], s61 offen
  s_mov_b32 s61, 68608
  buffer_load_dwordx2 v[42:43], v113, s[40:43], s61 offen
  s_mov_b32 s61, 75776
  buffer_load_dwordx2 v[44:45], v113, s[40:43], s61 offen
  s_mov_b32 s61, 76800
  buffer_load_dwordx2 v[46:47], v113, s[40:43], s61 offen
  s_mov_b32 s61, 98304
  buffer_load_dwordx2 v[48:49], v113, s[40:43], s61 offen
  s_mov_b32 s61, 99328
  buffer_load_dwordx2 v[50:51], v113, s[40:43], s61 offen
  s_mov_b32 s61, 106496
  buffer_load_dwordx2 v[52:53], v113, s[40:43], s61 offen
  s_mov_b32 s61, 107520
  buffer_load_dwordx2 v[54:55], v113, s[40:43], s61 offen
  s_mov_b32 s61, 100352
  buffer_load_dwordx2 v[56:57], v113, s[40:43], s61 offen
  s_mov_b32 s61, 101376
  buffer_load_dwordx2 v[58:59], v113, s[40:43], s61 offen
  s_mov_b32 s61, 108544
  buffer_load_dwordx2 v[60:61], v113, s[40:43], s61 offen
  s_mov_b32 s61, 109568
  buffer_load_dwordx2 v[62:63], v113, s[40:43], s61 offen
  s_mov_b32 s44, s22
  s_and_b32 s45, s23, 0xffff
  s_mov_b32 s46, 256
  s_mov_b32 s47, 0x20000
  buffer_load_dword v115, off, s[44:47], 0 offset:160 sc1
  s_mov_b32 s44, s6
  s_and_b32 s45, s7, 0xffff
  s_mov_b32 s46, 8192
  s_mov_b32 s47, 0x20000
  v_bfe_u32 v114, v116, 6, 2
  v_bfe_u32 v128, v116, 4, 1
  v_lshl_add_u32 v114, v114, 1, v128
  v_lshlrev_b32 v114, 10, v114
  v_lshrrev_b32 v128, 8, v116
  v_lshl_add_u32 v114, v128, 5, v114
  v_bfe_u32 v128, v116, 5, 1
  v_lshl_add_u32 v129, v128, 2, v114
  v_lshl_add_u32 v114, v128, 4, v114
  s_lshl_b32 s60, s26, 8
  buffer_load_dword v136, v129, s[44:47], s60 offen offset:0
  buffer_load_dword v137, v129, s[44:47], s60 offen offset:8
  buffer_load_dword v138, v129, s[44:47], s60 offen offset:16
  buffer_load_dword v139, v129, s[44:47], s60 offen offset:24
  buffer_load_dword v140, v129, s[44:47], s60 offen offset:128
  buffer_load_dword v141, v129, s[44:47], s60 offen offset:136
  buffer_load_dword v142, v129, s[44:47], s60 offen offset:144
  buffer_load_dword v143, v129, s[44:47], s60 offen offset:152
  buffer_load_dwordx4 v[128:131], v114, s[44:47], s60 offen offset:0
  buffer_load_dwordx4 v[132:135], v114, s[44:47], s60 offen offset:128
  s_waitcnt vmcnt(32)
  v_perm_b32 v208, v65, v64, s48
  v_perm_b32 v209, v67, v66, s48
  v_perm_b32 v210, v69, v68, s48
  v_perm_b32 v211, v71, v70, s48
  v_perm_b32 v212, v73, v72, s48
  v_perm_b32 v213, v75, v74, s48
  v_perm_b32 v214, v77, v76, s48
  v_perm_b32 v215, v79, v78, s48
  v_perm_b32 v216, v65, v64, s49
  v_perm_b32 v217, v67, v66, s49
  v_perm_b32 v218, v69, v68, s49
  v_perm_b32 v219, v71, v70, s49
  v_perm_b32 v220, v73, v72, s49
  v_perm_b32 v221, v75, v74, s49
  v_perm_b32 v222, v77, v76, s49
  v_perm_b32 v223, v79, v78, s49
  s_mov_b32 s61, 128
  buffer_load_dwordx2 v[64:65], v113, s[40:43], s61 offen
  s_mov_b32 s61, 1152
  buffer_load_dwordx2 v[66:67], v113, s[40:43], s61 offen
  s_mov_b32 s61, 8320
  buffer_load_dwordx2 v[68:69], v113, s[40:43], s61 offen
  s_mov_b32 s61, 9344
  buffer_load_dwordx2 v[70:71], v113, s[40:43], s61 offen
  s_mov_b32 s61, 2176
  buffer_load_dwordx2 v[72:73], v113, s[40:43], s61 offen
  s_mov_b32 s61, 3200
  buffer_load_dwordx2 v[74:75], v113, s[40:43], s61 offen
  s_mov_b32 s61, 10368
  buffer_load_dwordx2 v[76:77], v113, s[40:43], s61 offen
  s_mov_b32 s61, 11392
  buffer_load_dwordx2 v[78:79], v113, s[40:43], s61 offen
  s_mov_b32 s61, 32896
  buffer_load_dwordx2 v[80:81], v113, s[40:43], s61 offen
  s_mov_b32 s61, 33920
  buffer_load_dwordx2 v[82:83], v113, s[40:43], s61 offen
  s_mov_b32 s61, 41088
  buffer_load_dwordx2 v[84:85], v113, s[40:43], s61 offen
  s_mov_b32 s61, 42112
  buffer_load_dwordx2 v[86:87], v113, s[40:43], s61 offen
  s_mov_b32 s61, 34944
  buffer_load_dwordx2 v[88:89], v113, s[40:43], s61 offen
  s_mov_b32 s61, 35968
  buffer_load_dwordx2 v[90:91], v113, s[40:43], s61 offen
  s_mov_b32 s61, 43136
  buffer_load_dwordx2 v[92:93], v113, s[40:43], s61 offen
  s_mov_b32 s61, 44160
  buffer_load_dwordx2 v[94:95], v113, s[40:43], s61 offen
  s_waitcnt vmcnt(32)
  v_perm_b32 v96, v2, v0, s48
  v_perm_b32 v97, v6, v4, s48
  v_perm_b32 v98, v10, v8, s48
  v_perm_b32 v99, v14, v12, s48
  v_perm_b32 v100, v18, v16, s48
  v_perm_b32 v101, v22, v20, s48
  v_perm_b32 v102, v26, v24, s48
  v_perm_b32 v103, v30, v28, s48
  ds_write_b128 v123, v[96:99] offset:8192
  ds_write_b128 v123, v[100:103] offset:9216
  v_perm_b32 v104, v2, v0, s49
  v_perm_b32 v105, v6, v4, s49
  v_perm_b32 v106, v10, v8, s49
  v_perm_b32 v107, v14, v12, s49
  v_perm_b32 v108, v18, v16, s49
  v_perm_b32 v109, v22, v20, s49
  v_perm_b32 v110, v26, v24, s49
  v_perm_b32 v111, v30, v28, s49
  ds_write_b128 v123, v[104:107] offset:10240
  ds_write_b128 v123, v[108:111] offset:11264
  s_waitcnt lgkmcnt(0)
  v_perm_b32 v96, v3, v1, s48
  v_perm_b32 v97, v7, v5, s48
  v_perm_b32 v98, v11, v9, s48
  v_perm_b32 v99, v15, v13, s48
  v_perm_b32 v100, v19, v17, s48
  v_perm_b32 v101, v23, v21, s48
  v_perm_b32 v102, v27, v25, s48
  v_perm_b32 v103, v31, v29, s48
  ds_write_b128 v123, v[96:99] offset:16384
  ds_write_b128 v123, v[100:103] offset:17408
  v_perm_b32 v224, v3, v1, s49
  v_perm_b32 v225, v7, v5, s49
  v_perm_b32 v226, v11, v9, s49
  v_perm_b32 v227, v15, v13, s49
  v_perm_b32 v228, v19, v17, s49
  v_perm_b32 v229, v23, v21, s49
  v_perm_b32 v230, v27, v25, s49
  v_perm_b32 v231, v31, v29, s49
  s_mov_b32 s61, 65664
  buffer_load_dwordx2 v[0:1], v113, s[40:43], s61 offen
  s_mov_b32 s61, 66688
  buffer_load_dwordx2 v[2:3], v113, s[40:43], s61 offen
  s_mov_b32 s61, 73856
  buffer_load_dwordx2 v[4:5], v113, s[40:43], s61 offen
  s_mov_b32 s61, 74880
  buffer_load_dwordx2 v[6:7], v113, s[40:43], s61 offen
  s_mov_b32 s61, 67712
  buffer_load_dwordx2 v[8:9], v113, s[40:43], s61 offen
  s_mov_b32 s61, 68736
  buffer_load_dwordx2 v[10:11], v113, s[40:43], s61 offen
  s_mov_b32 s61, 75904
  buffer_load_dwordx2 v[12:13], v113, s[40:43], s61 offen
  s_mov_b32 s61, 76928
  buffer_load_dwordx2 v[14:15], v113, s[40:43], s61 offen
  s_mov_b32 s61, 98432
  buffer_load_dwordx2 v[16:17], v113, s[40:43], s61 offen
  s_mov_b32 s61, 99456
  buffer_load_dwordx2 v[18:19], v113, s[40:43], s61 offen
  s_mov_b32 s61, 106624
  buffer_load_dwordx2 v[20:21], v113, s[40:43], s61 offen
  s_mov_b32 s61, 107648
  buffer_load_dwordx2 v[22:23], v113, s[40:43], s61 offen
  s_mov_b32 s61, 100480
  buffer_load_dwordx2 v[24:25], v113, s[40:43], s61 offen
  s_mov_b32 s61, 101504
  buffer_load_dwordx2 v[26:27], v113, s[40:43], s61 offen
  s_mov_b32 s61, 108672
  buffer_load_dwordx2 v[28:29], v113, s[40:43], s61 offen
  s_mov_b32 s61, 109696
  buffer_load_dwordx2 v[30:31], v113, s[40:43], s61 offen
  s_waitcnt vmcnt(32)
  v_perm_b32 v96, v34, v32, s48
  v_perm_b32 v97, v38, v36, s48
  v_perm_b32 v98, v42, v40, s48
  v_perm_b32 v99, v46, v44, s48
  v_perm_b32 v100, v50, v48, s48
  v_perm_b32 v101, v54, v52, s48
  v_perm_b32 v102, v58, v56, s48
  v_perm_b32 v103, v62, v60, s48
  ds_write_b128 v123, v[96:99] offset:12288
  ds_write_b128 v123, v[100:103] offset:13312
  v_perm_b32 v104, v34, v32, s49
  v_perm_b32 v105, v38, v36, s49
  v_perm_b32 v106, v42, v40, s49
  v_perm_b32 v107, v46, v44, s49
  v_perm_b32 v108, v50, v48, s49
  v_perm_b32 v109, v54, v52, s49
  v_perm_b32 v110, v58, v56, s49
  v_perm_b32 v111, v62, v60, s49
  ds_write_b128 v123, v[104:107] offset:14336
  ds_write_b128 v123, v[108:111] offset:15360
  s_waitcnt lgkmcnt(0)
  v_perm_b32 v96, v35, v33, s48
  v_perm_b32 v97, v39, v37, s48
  v_perm_b32 v98, v43, v41, s48
  v_perm_b32 v99, v47, v45, s48
  v_perm_b32 v100, v51, v49, s48
  v_perm_b32 v101, v55, v53, s48
  v_perm_b32 v102, v59, v57, s48
  v_perm_b32 v103, v63, v61, s48
  ds_write_b128 v123, v[96:99] offset:18432
  ds_write_b128 v123, v[100:103] offset:19456
  v_perm_b32 v232, v35, v33, s49
  v_perm_b32 v233, v39, v37, s49
  v_perm_b32 v234, v43, v41, s49
  v_perm_b32 v235, v47, v45, s49
  v_perm_b32 v236, v51, v49, s49
  v_perm_b32 v237, v55, v53, s49
  v_perm_b32 v238, v59, v57, s49
  v_perm_b32 v239, v63, v61, s49
  s_waitcnt vmcnt(16)
  v_perm_b32 v240, v66, v64, s48
  v_perm_b32 v241, v70, v68, s48
  v_perm_b32 v242, v74, v72, s48
  v_perm_b32 v243, v78, v76, s48
  v_perm_b32 v244, v82, v80, s48
  v_perm_b32 v245, v86, v84, s48
  v_perm_b32 v246, v90, v88, s48
  v_perm_b32 v247, v94, v92, s48
  v_perm_b32 v104, v66, v64, s49
  v_perm_b32 v105, v70, v68, s49
  v_perm_b32 v106, v74, v72, s49
  v_perm_b32 v107, v78, v76, s49
  v_perm_b32 v108, v82, v80, s49
  v_perm_b32 v109, v86, v84, s49
  v_perm_b32 v110, v90, v88, s49
  v_perm_b32 v111, v94, v92, s49
  ds_write_b128 v123, v[104:107] offset:20480
  ds_write_b128 v123, v[108:111] offset:21504
  s_waitcnt lgkmcnt(0)
  v_perm_b32 v96, v67, v65, s48
  v_perm_b32 v97, v71, v69, s48
  v_perm_b32 v98, v75, v73, s48
  v_perm_b32 v99, v79, v77, s48
  v_perm_b32 v100, v83, v81, s48
  v_perm_b32 v101, v87, v85, s48
  v_perm_b32 v102, v91, v89, s48
  v_perm_b32 v103, v95, v93, s48
  ds_write_b128 v123, v[96:99] offset:24576
  ds_write_b128 v123, v[100:103] offset:25600
  v_perm_b32 v104, v67, v65, s49
  v_perm_b32 v105, v71, v69, s49
  v_perm_b32 v106, v75, v73, s49
  v_perm_b32 v107, v79, v77, s49
  v_perm_b32 v108, v83, v81, s49
  v_perm_b32 v109, v87, v85, s49
  v_perm_b32 v110, v91, v89, s49
  v_perm_b32 v111, v95, v93, s49
  ds_write_b128 v123, v[104:107] offset:28672
  ds_write_b128 v123, v[108:111] offset:29696
  s_waitcnt lgkmcnt(0)
  s_waitcnt vmcnt(0)
  v_perm_b32 v248, v2, v0, s48
  v_perm_b32 v249, v6, v4, s48
  v_perm_b32 v250, v10, v8, s48
  v_perm_b32 v251, v14, v12, s48
  v_perm_b32 v252, v18, v16, s48
  v_perm_b32 v253, v22, v20, s48
  v_perm_b32 v254, v26, v24, s48
  v_perm_b32 v255, v30, v28, s48
  v_perm_b32 v104, v2, v0, s49
  v_perm_b32 v105, v6, v4, s49
  v_perm_b32 v106, v10, v8, s49
  v_perm_b32 v107, v14, v12, s49
  v_perm_b32 v108, v18, v16, s49
  v_perm_b32 v109, v22, v20, s49
  v_perm_b32 v110, v26, v24, s49
  v_perm_b32 v111, v30, v28, s49
  ds_write_b128 v123, v[104:107] offset:22528
  ds_write_b128 v123, v[108:111] offset:23552
  s_waitcnt lgkmcnt(0)
  v_perm_b32 v96, v3, v1, s48
  v_perm_b32 v97, v7, v5, s48
  v_perm_b32 v98, v11, v9, s48
  v_perm_b32 v99, v15, v13, s48
  v_perm_b32 v100, v19, v17, s48
  v_perm_b32 v101, v23, v21, s48
  v_perm_b32 v102, v27, v25, s48
  v_perm_b32 v103, v31, v29, s48
  ds_write_b128 v123, v[96:99] offset:26624
  ds_write_b128 v123, v[100:103] offset:27648
  v_perm_b32 v104, v3, v1, s49
  v_perm_b32 v105, v7, v5, s49
  v_perm_b32 v106, v11, v9, s49
  v_perm_b32 v107, v15, v13, s49
  v_perm_b32 v108, v19, v17, s49
  v_perm_b32 v109, v23, v21, s49
  v_perm_b32 v110, v27, v25, s49
  v_perm_b32 v111, v31, v29, s49
  ds_write_b128 v123, v[104:107] offset:30720
  ds_write_b128 v123, v[108:111] offset:31744
  s_waitcnt lgkmcnt(0)
  v_readfirstlane_b32 s30, v115
  s_cmp_lg_u32 s30, 0
  s_cbranch_scc1 L_cc
  s_mov_b32 s44, s22
  s_and_b32 s45, s23, 0xffff
  s_mov_b32 s46, 256
  s_mov_b32 s47, 0x20000
  v_mbcnt_lo_u32_b32 v0, -1, 0
  v_mbcnt_hi_u32_b32 v0, -1, v0
  v_lshlrev_b32 v0, 2, v0
  v_and_b32 v0, 127, v0
  s_mov_b32 s100, 0
LCENC:
  buffer_load_dword v1, off, s[44:47], 0 offset:160 sc1
  s_waitcnt vmcnt(0)
  v_readfirstlane_b32 s30, v1
  s_cmp_lg_u32 s30, 0
  s_cbranch_scc1 LCENDC
  s_add_u32 s100, s100, 1
  s_cmp_ge_u32 s100, 32768
  s_cbranch_scc1 L_abort
  s_sleep 4
  s_and_b32 s96, s100, 63
  s_min_u32 s96, s96, s28
  s_cmp_lg_u32 s96, 0
  s_cbranch_scc1 LCENC
  buffer_load_dword v1, v0, s[44:47], 0 offen sc1
  s_waitcnt vmcnt(0)
  s_mov_b32 s96, 0
  s_mov_b32 s30, 2
  v_readlane_b32 s97, v1, 8
  s_add_u32 s96, s96, s97
  s_cmp_eq_u32 s97, 32
  s_cselect_b32 s30, s30, 1
  v_readlane_b32 s97, v1, 9
  s_add_u32 s96, s96, s97
  s_cmp_eq_u32 s97, 32
  s_cselect_b32 s30, s30, 1
  v_readlane_b32 s97, v1, 10
  s_add_u32 s96, s96, s97
  s_cmp_eq_u32 s97, 32
  s_cselect_b32 s30, s30, 1
  v_readlane_b32 s97, v1, 11
  s_add_u32 s96, s96, s97
  s_cmp_eq_u32 s97, 32
  s_cselect_b32 s30, s30, 1
  v_readlane_b32 s97, v1, 12
  s_add_u32 s96, s96, s97
  s_cmp_eq_u32 s97, 32
  s_cselect_b32 s30, s30, 1
  v_readlane_b32 s97, v1, 13
  s_add_u32 s96, s96, s97
  s_cmp_eq_u32 s97, 32
  s_cselect_b32 s30, s30, 1
  v_readlane_b32 s97, v1, 14
  s_add_u32 s96, s96, s97
  s_cmp_eq_u32 s97, 32
  s_cselect_b32 s30, s30, 1
  v_readlane_b32 s97, v1, 15
  s_add_u32 s96, s96, s97
  s_cmp_eq_u32 s97, 32
  s_cselect_b32 s30, s30, 1
  v_readlane_b32 s97, v1, 25
  s_cmp_eq_u32 s97, 0
  s_cselect_b32 s30, s30, 1
  s_cmp_lt_u32 s96, 256
  s_cbranch_scc1 LCENC
  v_readlane_b32 s97, v1, 26
  s_cmp_lt_u32 s97, 160
  s_cbranch_scc1 LCENC
  v_mov_b32 v1, s30
  s_mov_b64 exec, 1
  buffer_store_dword v1, off, s[44:47], 0 offset:160 sc1
  s_mov_b64 exec, -1
LCENDC:
L_cc:
  s_cmp_eq_u32 s30, 1
  s_cbranch_scc1 L_chain_slow
  s_mov_b32 s50, 0
  s_mov_b32 s51, 0
  v_mov_b64 v[48:49], 0
  v_mov_b64 v[50:51], 0
  v_mov_b64 v[52:53], 0
  v_mov_b64 v[54:55], 0
  v_mov_b64 v[100:101], 0
  v_mov_b64 v[102:103], 0
  v_mov_b64 v[104:105], 0
  v_mov_b64 v[106:107], 0
  v_mov_b64 v[108:109], 0
  v_mov_b64 v[110:111], 0
  v_mov_b64 v[112:113], 0
  v_mov_b64 v[114:115], 0
  v_xor_b32 v88, 2048, v117
  v_xor_b32 v89, 4096, v117
  v_xor_b32 v90, 6144, v117
  v_add_u32 v91, 147456, v116
  s_mov_b32 s59, 1
  s_mov_b32 s69, s56
  v_mov_b64 v[0:1], v[128:129]
  v_mov_b64 v[2:3], v[130:131]
  v_mov_b64 v[4:5], v[132:133]
  v_mov_b64 v[6:7], v[134:135]
  ds_read_b128 v[32:35], v123 offset:0
  ds_read_b128 v[36:39], v123 offset:1024
  ds_read_b128 v[40:43], v123 offset:2048
  ds_read_b128 v[44:47], v123 offset:3072
  ds_read_b128 v[72:75], v123 offset:4096
  ds_read_b128 v[76:79], v123 offset:5120
  ds_read_b128 v[80:83], v123 offset:6144
  ds_read_b128 v[84:87], v123 offset:7168
  v_lshlrev_b32 v70, 3, v116
  buffer_load_dword v71, v70, s[32:35], s55 offen sc1
  buffer_load_dword v71, v116, s[32:35], s53 offen sc1
  s_cmp_lg_u32 s28, 0
  s_cbranch_scc1 LCf_nop0
  v_or_b32 v136, 1, v136
  v_or_b32 v138, 1, v138
  v_or_b32 v140, 1, v140
  v_or_b32 v142, 1, v142
  s_lshl_b32 s60, s26, 11
  s_add_u32 s60, s60, s58
  buffer_store_dwordx4 v[136:139], v116, s[32:35], s60 offen offset:0 sc1
  buffer_store_dwordx4 v[140:143], v116, s[32:35], s60 offen offset:1024 sc1
LCf_nop0:
LCf_kv0:
  buffer_load_dwordx4 v[128:131], v116, s[32:35], s69 offen offset:0 sc1
  buffer_load_dwordx4 v[132:135], v116, s[32:35], s69 offen offset:1024 sc1
  buffer_load_dwordx4 v[136:139], v116, s[32:35], s69 offen offset:2048 sc1
  buffer_load_dwordx4 v[140:143], v116, s[32:35], s69 offen offset:3072 sc1
  s_waitcnt vmcnt(0)
  v_bitop3_b32 v64, v128, v132, s59 bitop3:126
  v_bitop3_b32 v65, v136, v140, s59 bitop3:126
  v_bitop3_b32 v64, v64, v65, 1 bitop3:168
  v_cmp_ne_u32 vcc, 0, v64
  s_cbranch_vccz LCf_kv0ok
  s_sleep 2
  s_add_u32 s62, s62, 1
  s_cmp_lt_u32 s62, 65536
  s_cbranch_scc1 LCf_kv0
  s_branch L_abort
LCf_kv0ok:
  v_mov_b64 v[100:101], v[136:137]
  v_mov_b64 v[104:105], v[138:139]
  v_mov_b64 v[108:109], v[140:141]
  v_mov_b64 v[112:113], v[142:143]
  v_mov_b32 v138, 0x40000000
  v_mov_b32 v92, 0x3f803f80
  v_mov_b32 v93, 0x3f803f80
  v_mov_b32 v94, 0x3f803f80
  v_mov_b32 v95, 0
  v_mov_b32 v96, 0x3f803f80
  v_mov_b32 v97, 0x3f803f80
  v_mov_b32 v98, 0x3f803f80
  v_mov_b32 v99, 0
  s_cmp_lt_u32 s50, 62
  s_cselect_b32 s60, 16384, 0
  s_add_u32 s69, s69, s60
  s_cmp_eq_u32 s69, s57
  s_cselect_b32 s69, s56, s69
  s_addc_u32 s59, s59, 0
  s_lshl_b32 s46, s50, 13
  s_add_u32 s46, s46, s58
  s_waitcnt lgkmcnt(0)
  v_mov_b64 v[56:57], 0
  v_mov_b64 v[58:59], 0
  v_mov_b64 v[60:61], 0
  v_mov_b64 v[62:63], 0
  v_mov_b64 v[64:65], 0
  v_mov_b64 v[66:67], 0
  v_mov_b64 v[68:69], 0
  v_mov_b64 v[70:71], 0
  ds_write_b128 v117, v[0:3] offset:0
  s_branch LCf_haveA
.p2align 6
LCf_step:
  buffer_load_dwordx4 v[0:3], v116, s[32:35], s52 offen sc1
  buffer_load_dwordx4 v[4:7], v116, s[32:35], s52 offen offset:1024 sc1
  v_mov_b64 v[56:57], 0
  v_mov_b64 v[58:59], 0
  v_mov_b64 v[60:61], 0
  v_mov_b64 v[62:63], 0
  v_mov_b64 v[64:65], 0
  v_mov_b64 v[66:67], 0
  v_mov_b64 v[68:69], 0
  v_mov_b64 v[70:71], 0
  s_nop 15
LCf_pollA:
  buffer_load_dwordx4 v[24:27], v116, s[32:35], s52 offen sc1
  buffer_load_dwordx4 v[28:31], v116, s[32:35], s52 offen offset:1024 sc1
  s_waitcnt vmcnt(3)
  ds_write_b128 v117, v[0:3]
  v_bitop3_b32 v8, v0, v2, s51 bitop3:126
  s_waitcnt vmcnt(2)
  v_bitop3_b32 v9, v4, v6, s51 bitop3:126
  v_bitop3_b32 v8, v8, v9, 1 bitop3:168
  v_cmp_ne_u32 vcc, 0, v8
  s_cbranch_vccnz LCf_tryB
LCf_haveA:
  v_smfmac_f32_16x16x64_bf16 v[56:59], v[0:3], a[0:7], v125
  ds_write_b128 v117, v[4:7] offset:1024
  v_smfmac_f32_16x16x64_bf16 v[60:63], v[0:3], a[8:15], v125
  s_xor_b32 s51, s51, 1
  v_smfmac_f32_16x16x64_bf16 v[56:59], v[4:7], a[16:23], v125
  v_smfmac_f32_16x16x64_bf16 v[60:63], v[4:7], a[24:31], v125
  s_waitcnt lgkmcnt(0)
  s_barrier
  ds_read_b128 v[8:11], v88 offset:0
  v_smfmac_f32_16x16x64_bf16 v[64:67], v[0:3], a[96:103], v125
  ds_read_b128 v[12:15], v88 offset:1024
  ds_read_b128 v[16:19], v89 offset:0
  v_smfmac_f32_16x16x64_bf16 v[68:71], v[0:3], a[104:111], v125
  ds_read_b128 v[20:23], v89 offset:1024
  v_smfmac_f32_16x16x64_bf16 v[64:67], v[4:7], a[112:119], v125
  v_smfmac_f32_16x16x64_bf16 v[68:71], v[4:7], a[120:127], v125
LCf_rest:
  s_waitcnt lgkmcnt(3)
  v_smfmac_f32_16x16x64_bf16 v[56:59], v[8:11], a[32:39], v125
  v_smfmac_f32_16x16x64_bf16 v[60:63], v[8:11], a[40:47], v125
  s_waitcnt lgkmcnt(2)
  v_smfmac_f32_16x16x64_bf16 v[56:59], v[12:15], a[48:55], v125
  s_waitcnt vmcnt(0)
  ds_read_b128 v[24:27], v90 offset:0
  v_smfmac_f32_16x16x64_bf16 v[60:63], v[12:15], a[56:63], v125
  ds_read_b128 v[28:31], v90 offset:1024
  s_waitcnt lgkmcnt(3)
  v_smfmac_f32_16x16x64_bf16 v[56:59], v[16:19], a[64:71], v125
  buffer_store_dwordx2 v[136:137], v138, s[32:35], s46 offen sc1
  v_smfmac_f32_16x16x64_bf16 v[60:63], v[16:19], a[72:79], v125
  s_waitcnt lgkmcnt(2)
  v_smfmac_f32_16x16x64_bf16 v[56:59], v[20:23], a[80:87], v125
  buffer_load_dwordx4 v[136:139], v116, s[32:35], s69 offen offset:2048 sc1
  v_smfmac_f32_16x16x64_bf16 v[60:63], v[20:23], a[88:95], v125
  s_waitcnt lgkmcnt(1)
  v_smfmac_f32_16x16x64_bf16 v[56:59], v[24:27], v[80:87], v125
  buffer_load_dwordx4 v[140:143], v116, s[32:35], s69 offen offset:3072 sc1
  v_smfmac_f32_16x16x64_bf16 v[60:63], v[24:27], v[72:79], v125
  s_waitcnt lgkmcnt(0)
  v_smfmac_f32_16x16x64_bf16 v[56:59], v[28:31], v[40:47], v125
  v_smfmac_f32_16x16x64_bf16 v[60:63], v[28:31], v[32:39], v125
  v_smfmac_f32_16x16x64_bf16 v[64:67], v[8:11], a[128:135], v125
  v_add_f32 v80, v56, v58
  v_add_f32 v81, v57, v59
  v_smfmac_f32_16x16x64_bf16 v[68:71], v[8:11], a[136:143], v125
  v_add_f32 v82, v60, v62
  v_add_f32 v83, v61, v63
  v_smfmac_f32_16x16x64_bf16 v[64:67], v[12:15], a[144:151], v125
  v_cvt_pk_bf16_f32 v80, v80, v82
  v_cvt_pk_bf16_f32 v81, v81, v83
  v_smfmac_f32_16x16x64_bf16 v[68:71], v[12:15], a[152:159], v125
  ds_write2_b32 v118, v80, v81 offset0:0 offset1:32
  v_smfmac_f32_16x16x64_bf16 v[64:67], v[16:19], a[160:167], v125
  s_mov_b64 exec, s[64:65]
  ds_read_b128 v[48:51], v120
  s_mov_b64 exec, -1
  v_smfmac_f32_16x16x64_bf16 v[68:71], v[16:19], a[168:175], v125
  s_mov_b64 exec, s[66:67]
  ds_read_b128 v[52:55], v120
  s_mov_b64 exec, -1
  v_smfmac_f32_16x16x64_bf16 v[64:67], v[20:23], a[176:183], v125
  ds_read_b128 v[32:35], v123 offset:32768
  v_mov_b64 v[56:57], 0
  v_smfmac_f32_16x16x64_bf16 v[68:71], v[20:23], a[184:191], v125
  ds_read_b128 v[36:39], v123 offset:33792
  v_mov_b64 v[58:59], 0
  v_smfmac_f32_16x16x64_bf16 v[64:67], v[24:27], a[192:199], v125
  ds_read_b128 v[40:43], v123 offset:34816
  v_mov_b64 v[60:61], 0
  v_smfmac_f32_16x16x64_bf16 v[68:71], v[24:27], a[200:207], v125
  ds_read_b128 v[44:47], v123 offset:35840
  s_waitcnt lgkmcnt(4)
  v_mov_b64 v[62:63], 0
  v_mfma_f32_16x16x32_bf16 v[72:75], v[128:131], v[48:51], 0
  v_mfma_f32_16x16x32_bf16 v[72:75], v[132:135], v[52:55], v[72:75]
  buffer_load_dwordx4 v[128:131], v116, s[32:35], s69 offen offset:0 sc1
  v_smfmac_f32_16x16x64_bf16 v[64:67], v[28:31], a[208:215], v125
  v_smfmac_f32_16x16x64_bf16 v[68:71], v[28:31], a[216:223], v125
  buffer_load_dwordx4 v[132:135], v116, s[32:35], s69 offen offset:1024 sc1
  v_smfmac_f32_16x16x64_bf16 v[56:59], v[4:7], a[224:231], v125
  ds_write_b128 v117, v[72:75] offset:8192
  v_smfmac_f32_16x16x64_bf16 v[60:63], v[4:7], a[232:239], v125
  v_add_f32 v80, v64, v66
  v_add_f32 v81, v65, v67
  v_add_f32 v82, v68, v70
  v_add_f32 v83, v69, v71
  v_cvt_pk_bf16_f32 v80, v80, v82
  v_cvt_pk_bf16_f32 v81, v81, v83
  v_smfmac_f32_16x16x64_bf16 v[56:59], v[8:11], a[240:247], v125
  ds_write2_b32 v126, v80, v81 offset0:0 offset1:32
  v_smfmac_f32_16x16x64_bf16 v[60:63], v[8:11], a[248:255], v125
  s_waitcnt lgkmcnt(2)
  v_mov_b64 v[64:65], 0
  v_smfmac_f32_16x16x64_bf16 v[56:59], v[0:3], v[32:39], v125
  v_mov_b64 v[66:67], 0
  v_smfmac_f32_16x16x64_bf16 v[60:63], v[0:3], v[40:47], v125
  v_mov_b64 v[68:69], 0
  v_smfmac_f32_16x16x64_bf16 v[56:59], v[12:15], v[144:151], v125
  s_waitcnt lgkmcnt(0)
  v_smfmac_f32_16x16x64_bf16 v[60:63], v[12:15], v[152:159], v125
  s_barrier
  ds_read_b128 v[40:43], v121
  v_smfmac_f32_16x16x64_bf16 v[56:59], v[16:19], v[160:167], v125
  ds_read_b128 v[32:35], v119
  ds_read_b128 v[44:47], v121 offset:2048
  v_mov_b64 v[70:71], 0
  v_smfmac_f32_16x16x64_bf16 v[60:63], v[16:19], v[168:175], v125
  ds_read_b128 v[36:39], v119 offset:2048
  ds_read_b128 v[76:79], v88 offset:8192
  v_mov_b64 v[8:9], 0
  v_smfmac_f32_16x16x64_bf16 v[56:59], v[20:23], v[176:183], v125
  ds_read_b128 v[80:83], v89 offset:8192
  v_mov_b64 v[10:11], 0
  v_smfmac_f32_16x16x64_bf16 v[60:63], v[20:23], v[184:191], v125
  ds_read_b128 v[84:87], v90 offset:8192
  v_smfmac_f32_16x16x64_bf16 v[56:59], v[24:27], v[192:199], v125
  s_waitcnt lgkmcnt(5)
  v_mfma_f32_16x16x32_bf16 v[4:7], v[40:43], v[32:35], 0
  v_smfmac_f32_16x16x64_bf16 v[60:63], v[24:27], v[200:207], v125
  s_waitcnt lgkmcnt(3)
  v_mfma_f32_16x16x32_bf16 v[4:7], v[44:47], v[36:39], v[4:7]
  s_waitcnt lgkmcnt(2)
  v_add_f32 v72, v72, v76
  v_add_f32 v73, v73, v77
  v_smfmac_f32_16x16x64_bf16 v[56:59], v[28:31], v[208:215], v125
  v_add_f32 v74, v74, v78
  v_smfmac_f32_16x16x64_bf16 v[60:63], v[28:31], v[216:223], v125
  s_waitcnt lgkmcnt(0)
  ds_read_b128 v[32:35], v123 offset:8192
  v_add_f32 v75, v75, v79
  v_cndmask_b32 v5, v5, v6, s[66:67]
  v_cndmask_b32 v4, v4, v7, s[66:67]
  v_pk_add_f32 v[80:81], v[80:81], v[84:85]
  v_pk_add_f32 v[82:83], v[82:83], v[86:87]
  v_add_f32_dpp v4, v5, v4 quad_perm:[2,3,0,1] row_mask:0xf bank_mask:0xf
  v_pk_add_f32 v[72:73], v[72:73], v[80:81]
  v_pk_add_f32 v[74:75], v[74:75], v[82:83]
  v_mul_f32 v4, s63, v4
  v_exp_f32 v80, v72
  v_exp_f32 v81, v73
  v_exp_f32 v6, v4
  v_exp_f32 v82, v74
  v_exp_f32 v83, v75
  v_cvt_pk_bf16_f32 v76, v80, v81
  v_cvt_pk_bf16_f32 v77, v6, 0
  v_cvt_pk_bf16_f32 v79, v6, 0
  v_cvt_pk_bf16_f32 v78, v82, v83
  v_pk_add_f32 v[56:57], v[56:57], v[58:59]
  v_pk_add_f32 v[60:61], v[60:61], v[62:63]
  v_cvt_pk_bf16_f32 v102, v56, v57
  v_cvt_pk_bf16_f32 v106, v56, v57
  v_cvt_pk_bf16_f32 v110, v60, v61
  v_smfmac_f32_16x16x64_bf16 v[8:11], v[76:79], v[92:99], v127
  ds_read_b128 v[36:39], v123 offset:9216
  ds_read_b128 v[40:43], v123 offset:10240
  v_cvt_pk_bf16_f32 v114, v60, v61
  v_smfmac_f32_16x16x64_bf16 v[64:67], v[76:79], v[100:107], v127
  ds_read_b128 v[44:47], v123 offset:11264
  ds_read_b128 v[16:19], v123 offset:12288
  v_max3_f32 v84, abs(v72), abs(v73), abs(v4)
  v_smfmac_f32_16x16x64_bf16 v[68:71], v[76:79], v[108:115], v127
  ds_read_b128 v[20:23], v123 offset:13312
  v_add_f32 v8, v8, v10
  v_add_f32 v9, v9, v11
  v_rcp_f32 v8, v8
  v_rcp_f32 v9, v9
  v_pk_add_f32 v[64:65], v[64:65], v[66:67]
  v_max3_f32 v84, abs(v74), abs(v75), v84
  v_cmp_nge_f32 vcc, s68, v84
  v_pk_add_f32 v[68:69], v[68:69], v[70:71]
  s_cbranch_vccnz LCf_big
LCf_bigr:
  v_pk_mul_f32 v[64:65], v[64:65], v[8:9]
  v_pk_mul_f32 v[68:69], v[68:69], v[8:9]
  v_cvt_pk_bf16_f32 v96, v64, v68
  v_cvt_pk_bf16_f32 v97, v65, v69
  ds_write2_b32 v122, v96, v97 offset0:0 offset1:4
  v_mov_b64 v[12:13], 0
  ds_read_b128 v[24:27], v123 offset:14336
  v_mov_b64 v[14:15], 0
  ds_read_b128 v[28:31], v123 offset:15360
  s_add_u32 s61, s54, 0x8000
  v_mov_b32 v118, v118
  s_waitcnt lgkmcnt(2)
  v_mfma_f32_32x32x16_bf16 v[72:87], v[12:15], v[12:15], 0
  s_barrier
  ds_read_b128 v[92:95], v91
  ds_read_b128 v[96:99], v91 offset:1024
  v_mfma_f32_32x32x16_bf16 v[56:71], v[12:15], v[12:15], 0
  ds_read_b128 v[0:3], v123 offset:16384
  ds_read_b128 v[4:7], v123 offset:17408
  ds_read_b128 v[8:11], v123 offset:18432
  ds_read_b128 v[12:15], v123 offset:19456
  v_mov_b32 v118, v118
  s_waitcnt lgkmcnt(5)
  v_smfmac_f32_16x16x64_bf16 v[72:75], v[92:95], v[32:39], v125
  ds_read_b128 v[32:35], v123 offset:20480
  v_smfmac_f32_16x16x64_bf16 v[76:79], v[92:95], v[40:47], v125
  ds_read_b128 v[36:39], v123 offset:21504
  s_waitcnt lgkmcnt(6)
  v_smfmac_f32_16x16x64_bf16 v[72:75], v[96:99], v[16:23], v125
  ds_read_b128 v[40:43], v123 offset:22528
  v_smfmac_f32_16x16x64_bf16 v[76:79], v[96:99], v[24:31], v125
  ds_read_b128 v[44:47], v123 offset:23552
  s_waitcnt lgkmcnt(6)
  v_smfmac_f32_16x16x64_bf16 v[80:83], v[92:95], v[0:7], v125
  ds_read_b128 v[16:19], v123 offset:24576
  s_waitcnt lgkmcnt(5)
  v_add_f32 v72, v72, v74
  v_smfmac_f32_16x16x64_bf16 v[80:83], v[96:99], v[8:15], v125
  ds_read_b128 v[20:23], v123 offset:25600
  v_add_f32 v73, v73, v75
  v_smfmac_f32_16x16x64_bf16 v[84:87], v[92:95], v[224:231], v125
  ds_read_b128 v[24:27], v123 offset:26624
  v_add_f32 v76, v76, v78
  v_add_f32 v77, v77, v79
  v_smfmac_f32_16x16x64_bf16 v[84:87], v[96:99], v[232:239], v125
  ds_read_b128 v[28:31], v123 offset:27648
  v_cvt_pk_bf16_f32 v74, v73, v77
  v_cvt_pk_bf16_f32 v72, v72, v76
  v_smfmac_f32_16x16x64_bf16 v[56:59], v[92:95], v[240:247], v125
  ds_read_b128 v[0:3], v123 offset:28672
  v_add_f32 v80, v80, v82
  v_add_f32 v81, v81, v83
  v_smfmac_f32_16x16x64_bf16 v[56:59], v[96:99], v[248:255], v125
  ds_read_b128 v[4:7], v123 offset:29696
  s_waitcnt lgkmcnt(8)
  v_bfi_b32 v72, 1, s51, v72
  v_add_f32 v84, v84, v86
  v_smfmac_f32_16x16x64_bf16 v[60:63], v[92:95], v[32:39], v125
  ds_read_b128 v[8:11], v123 offset:30720
  s_waitcnt lgkmcnt(7)
  v_add_f32 v85, v85, v87
  v_cvt_pk_bf16_f32 v73, v80, v84
  v_smfmac_f32_16x16x64_bf16 v[60:63], v[96:99], v[40:47], v125
  ds_read_b128 v[12:15], v123 offset:31744
  s_waitcnt lgkmcnt(6)
  v_cvt_pk_bf16_f32 v75, v81, v85
  v_smfmac_f32_16x16x64_bf16 v[64:67], v[92:95], v[16:23], v125
  s_waitcnt lgkmcnt(4)
  buffer_store_dwordx4 v[72:75], v124, s[32:35], s54 offen
  v_add_f32 v56, v56, v58
  v_smfmac_f32_16x16x64_bf16 v[64:67], v[96:99], v[24:31], v125
  s_waitcnt lgkmcnt(2)
  v_add_f32 v57, v57, v59
  v_add_f32 v60, v60, v62
  v_smfmac_f32_16x16x64_bf16 v[68:71], v[92:95], v[0:7], v125
  s_waitcnt lgkmcnt(0)
  v_add_f32 v61, v61, v63
  v_smfmac_f32_16x16x64_bf16 v[68:71], v[96:99], v[8:15], v125
  v_cvt_pk_bf16_f32 v58, v57, v61
  v_cvt_pk_bf16_f32 v56, v56, v60
  v_add_f32 v64, v64, v66
  v_add_f32 v65, v65, v67
  v_bfi_b32 v56, 1, s51, v56
  s_nop 2
  v_pk_add_f32 v[68:69], v[68:69], v[70:71]
  v_cvt_pk_bf16_f32 v57, v64, v68
  v_cvt_pk_bf16_f32 v59, v65, v69
  buffer_store_dwordx4 v[56:59], v124, s[32:35], s61 offen
LCf_tail:
  s_cmp_lg_u32 s26, 0
  s_cbranch_scc1 LCf_side
  s_add_u32 s61, s55, 4096
  ds_read_b128 v[32:35], v123 offset:0
  ds_read_b128 v[36:39], v123 offset:1024
  ds_read_b128 v[40:43], v123 offset:2048
  ds_read_b128 v[44:47], v123 offset:3072
  ds_read_b128 v[72:75], v123 offset:4096
  ds_read_b128 v[76:79], v123 offset:5120
  ds_read_b128 v[80:83], v123 offset:6144
  ds_read_b128 v[84:87], v123 offset:7168
  v_bfe_u32 v68, v116, 5, 3
  v_and_b32 v69, 16, v116
  v_mov_b32 v70, 0x3f80
  v_lshlrev_b32 v70, v69, v70
  v_cmp_eq_u32 s[36:37], 0, v68
  v_cmp_eq_u32 s[38:39], 1, v68
  v_cmp_eq_u32 s[40:41], 2, v68
  v_cmp_eq_u32 s[42:43], 3, v68
  v_cndmask_b32 v60, 0, v70, s[36:37]
  v_cndmask_b32 v61, 0, v70, s[38:39]
  v_cndmask_b32 v62, 0, v70, s[40:41]
  v_cndmask_b32 v63, 0, v70, s[42:43]
  v_and_b32 v69, 0xe0, v116
  v_bfe_u32 v70, v116, 8, 1
  v_lshl_add_u32 v69, v70, 4, v69
  v_bfe_u32 v70, v116, 4, 1
  v_lshl_add_u32 v69, v70, 3, v69
  s_waitcnt vmcnt(0)
  buffer_load_dwordx4 v[0:3], v116, s[32:35], s55 offen offset:0 sc1
  buffer_load_dwordx4 v[4:7], v116, s[32:35], s55 offen offset:1024 sc1
  buffer_load_dwordx4 v[8:11], v116, s[32:35], s55 offen offset:2048 sc1
  buffer_load_dwordx4 v[12:15], v116, s[32:35], s55 offen offset:3072 sc1
  buffer_load_dwordx4 v[16:19], v116, s[32:35], s61 offen offset:0 sc1
  buffer_load_dwordx4 v[20:23], v116, s[32:35], s61 offen offset:1024 sc1
  buffer_load_dwordx4 v[24:27], v116, s[32:35], s61 offen offset:2048 sc1
  buffer_load_dwordx4 v[28:31], v116, s[32:35], s61 offen offset:3072 sc1
  s_waitcnt vmcnt(10)
  v_bitop3_b32 v64, v128, v132, s59 bitop3:126
  v_bitop3_b32 v65, v136, v140, s59 bitop3:126
  v_bitop3_b32 v64, v64, v65, 1 bitop3:168
  v_cmp_ne_u32 vcc, 0, v64
  s_cbranch_vccnz LCf_kvw0
LCf_kvok0:
  v_mov_b64 v[100:101], v[136:137]
  v_mov_b64 v[104:105], v[138:139]
  v_mov_b64 v[108:109], v[140:141]
  v_mov_b64 v[112:113], v[142:143]
  v_mov_b32 v138, 0x40000000
  v_mov_b32 v92, 0x3f803f80
  v_mov_b32 v93, 0x3f803f80
  v_mov_b32 v94, 0x3f803f80
  v_mov_b32 v95, 0
  v_mov_b32 v96, 0x3f803f80
  v_mov_b32 v97, 0x3f803f80
  v_mov_b32 v98, 0x3f803f80
  v_mov_b32 v99, 0
  s_add_u32 s50, s50, 1
  s_cmp_lt_u32 s50, 62
  s_cselect_b32 s60, 16384, 0
  s_add_u32 s69, s69, s60
  s_cmp_eq_u32 s69, s57
  s_cselect_b32 s69, s56, s69
  s_addc_u32 s59, s59, 0
  s_lshl_b32 s46, s50, 13
  s_add_u32 s46, s46, s58
LCf_sumB:
  v_mov_b32 v68, 0
  s_waitcnt vmcnt(7)
  v_mfma_f32_16x16x32_bf16 v[64:67], v[60:63], v[0:3], 0
  v_bitop3_b32 v68, v68, v0, s51 bitop3:246
  s_waitcnt vmcnt(6)
  v_mfma_f32_16x16x32_bf16 v[64:67], v[60:63], v[4:7], v[64:67]
  v_bitop3_b32 v68, v68, v4, s51 bitop3:246
  s_waitcnt vmcnt(5)
  v_mfma_f32_16x16x32_bf16 v[64:67], v[60:63], v[8:11], v[64:67]
  v_bitop3_b32 v68, v68, v8, s51 bitop3:246
  s_waitcnt vmcnt(4)
  v_mfma_f32_16x16x32_bf16 v[64:67], v[60:63], v[12:15], v[64:67]
  v_bitop3_b32 v68, v68, v12, s51 bitop3:246
  s_waitcnt vmcnt(3)
  v_mfma_f32_16x16x32_bf16 v[64:67], v[60:63], v[16:19], v[64:67]
  v_bitop3_b32 v68, v68, v16, s51 bitop3:246
  s_waitcnt vmcnt(2)
  v_mfma_f32_16x16x32_bf16 v[64:67], v[60:63], v[20:23], v[64:67]
  v_bitop3_b32 v68, v68, v20, s51 bitop3:246
  s_waitcnt vmcnt(1)
  v_mfma_f32_16x16x32_bf16 v[64:67], v[60:63], v[24:27], v[64:67]
  v_bitop3_b32 v68, v68, v24, s51 bitop3:246
  s_waitcnt vmcnt(0)
  v_mfma_f32_16x16x32_bf16 v[64:67], v[60:63], v[28:31], v[64:67]
  v_bitop3_b32 v68, v68, v28, s51 bitop3:246
  v_and_b32 v68, 1, v68
  v_cmp_ne_u32 vcc, 0, v68
  s_cbranch_vccnz LCf_retryB
  s_mov_b32 exec_hi, 0
  s_mov_b32 vcc_lo, 0xaaaaaaaa
  v_and_b32 v138, 0xd0, v69
  v_bfe_u32 v139, v116, 4, 1
  v_cvt_pk_bf16_f32 v70, v64, v65
  v_cvt_pk_bf16_f32 v71, v66, v67
  v_bfi_b32 v70, 1, s51, v70
  buffer_store_dwordx2 v[70:71], v69, s[32:35], s53 offen
  s_barrier
  v_cndmask_b32 v68, v71, v70, vcc
  v_lshl_add_u32 v138, v139, 5, v138
  v_bfe_u32 v139, v116, 5, 1
  v_mov_b32_dpp v68, v68 quad_perm:[1,0,3,2] row_mask:0xf bank_mask:0xf
  v_lshl_add_u32 v138, v139, 3, v138
  v_cndmask_b32 v136, v70, v68, vcc
  v_cndmask_b32 v137, v68, v71, vcc
  v_or_b32 v136, 1, v136
  s_mov_b64 exec, -1
LCf_join:
  s_cmp_eq_u32 s50, 63
  s_cbranch_scc1 LCf_last
  s_branch LCf_step
LCf_side:
  s_waitcnt vmcnt(2)
  v_bitop3_b32 v60, v128, v132, s59 bitop3:126
  v_bitop3_b32 v61, v136, v140, s59 bitop3:126
  v_bitop3_b32 v60, v60, v61, 1 bitop3:168
  v_cmp_ne_u32 vcc, 0, v60
  s_cbranch_vccnz LCf_kvw
LCf_kvok:
  v_mov_b64 v[100:101], v[136:137]
  v_mov_b64 v[104:105], v[138:139]
  v_mov_b64 v[108:109], v[140:141]
  v_mov_b64 v[112:113], v[142:143]
  v_mov_b32 v138, 0x40000000
  v_mov_b32 v92, 0x3f803f80
  v_mov_b32 v93, 0x3f803f80
  v_mov_b32 v94, 0x3f803f80
  v_mov_b32 v95, 0
  v_mov_b32 v96, 0x3f803f80
  v_mov_b32 v97, 0x3f803f80
  v_mov_b32 v98, 0x3f803f80
  v_mov_b32 v99, 0
  ds_read_b128 v[32:35], v123 offset:0
  ds_read_b128 v[36:39], v123 offset:1024
  ds_read_b128 v[40:43], v123 offset:2048
  ds_read_b128 v[44:47], v123 offset:3072
  ds_read_b128 v[72:75], v123 offset:4096
  ds_read_b128 v[76:79], v123 offset:5120
  ds_read_b128 v[80:83], v123 offset:6144
  ds_read_b128 v[84:87], v123 offset:7168
  s_add_u32 s50, s50, 1
  s_cmp_lt_u32 s50, 62
  s_cselect_b32 s60, 16384, 0
  s_add_u32 s69, s69, s60
  s_cmp_eq_u32 s69, s57
  s_cselect_b32 s69, s56, s69
  s_addc_u32 s59, s59, 0
  s_lshl_b32 s46, s50, 13
  s_add_u32 s46, s46, s58
  s_barrier
  s_branch LCf_join
LCf_tryB:
  buffer_load_dwordx4 v[0:3], v116, s[32:35], s52 offen sc1
  buffer_load_dwordx4 v[4:7], v116, s[32:35], s52 offen offset:1024 sc1
  s_waitcnt vmcnt(3)
  ds_write_b128 v117, v[24:27]
  v_bitop3_b32 v8, v24, v26, s51 bitop3:126
  s_waitcnt vmcnt(2)
  v_bitop3_b32 v9, v28, v30, s51 bitop3:126
  v_bitop3_b32 v8, v8, v9, 1 bitop3:168
  v_cmp_ne_u32 vcc, 0, v8
  s_cbranch_vccnz LCf_retryA
  v_smfmac_f32_16x16x64_bf16 v[56:59], v[24:27], a[0:7], v125
  ds_write_b128 v117, v[28:31] offset:1024
  v_smfmac_f32_16x16x64_bf16 v[60:63], v[24:27], a[8:15], v125
  s_xor_b32 s51, s51, 1
  v_smfmac_f32_16x16x64_bf16 v[56:59], v[28:31], a[16:23], v125
  v_smfmac_f32_16x16x64_bf16 v[60:63], v[28:31], a[24:31], v125
  s_waitcnt lgkmcnt(0)
  s_barrier
  ds_read_b128 v[8:11], v88 offset:0
  v_smfmac_f32_16x16x64_bf16 v[64:67], v[24:27], a[96:103], v125
  ds_read_b128 v[12:15], v88 offset:1024
  ds_read_b128 v[16:19], v89 offset:0
  v_smfmac_f32_16x16x64_bf16 v[68:71], v[24:27], a[104:111], v125
  ds_read_b128 v[20:23], v89 offset:1024
  v_smfmac_f32_16x16x64_bf16 v[64:67], v[28:31], a[112:119], v125
  v_smfmac_f32_16x16x64_bf16 v[68:71], v[28:31], a[120:127], v125
  s_branch LCf_rest
LCf_retryA:
  s_add_u32 s62, s62, 1
  s_cmp_lt_u32 s62, 65536
  s_cbranch_scc1 LCf_pollA
  s_branch L_abort
LCf_retryB:
  buffer_load_dwordx4 v[0:3], v116, s[32:35], s55 offen offset:0 sc1
  buffer_load_dwordx4 v[4:7], v116, s[32:35], s55 offen offset:1024 sc1
  buffer_load_dwordx4 v[8:11], v116, s[32:35], s55 offen offset:2048 sc1
  buffer_load_dwordx4 v[12:15], v116, s[32:35], s55 offen offset:3072 sc1
  buffer_load_dwordx4 v[16:19], v116, s[32:35], s61 offen offset:0 sc1
  buffer_load_dwordx4 v[20:23], v116, s[32:35], s61 offen offset:1024 sc1
  buffer_load_dwordx4 v[24:27], v116, s[32:35], s61 offen offset:2048 sc1
  buffer_load_dwordx4 v[28:31], v116, s[32:35], s61 offen offset:3072 sc1
  s_add_u32 s62, s62, 1
  s_cmp_lt_u32 s62, 65536
  s_cbranch_scc1 LCf_sumB
  s_branch L_abort
LCf_big:
  v_max3_f32 v84, v72, v73, v4
  v_max3_f32 v84, v74, v75, v84
  v_mov_b64 v[64:65], 0
  v_mov_b64 v[66:67], 0
  v_mov_b64 v[68:69], 0
  v_mov_b64 v[70:71], 0
  v_mov_b64 v[8:9], 0
  v_mov_b64 v[10:11], 0
  v_max_f32_dpp v84, v84, v84 quad_perm:[2,3,0,1] row_mask:0xf bank_mask:0xf
  v_mov_b32 v85, v84
  s_nop 1
  v_permlane16_swap_b32 v84, v85
  v_max_f32 v84, v84, v85
  v_mov_b32 v85, v84
  s_nop 1
  v_permlane32_swap_b32 v84, v85
  v_max_f32 v84, v84, v85
  v_sub_f32 v80, v72, v84
  v_sub_f32 v81, v73, v84
  v_sub_f32 v82, v74, v84
  v_sub_f32 v83, v75, v84
  v_sub_f32 v6, v4, v84
  v_exp_f32 v80, v80
  v_exp_f32 v81, v81
  v_exp_f32 v6, v6
  v_exp_f32 v82, v82
  v_exp_f32 v83, v83
  v_cvt_pk_bf16_f32 v76, v80, v81
  v_cvt_pk_bf16_f32 v77, v6, 0
  v_cvt_pk_bf16_f32 v79, v6, 0
  v_cvt_pk_bf16_f32 v78, v82, v83
  s_nop 1
  v_smfmac_f32_16x16x64_bf16 v[8:11], v[76:79], v[92:99], v127
  v_smfmac_f32_16x16x64_bf16 v[64:67], v[76:79], v[100:107], v127
  v_smfmac_f32_16x16x64_bf16 v[68:71], v[76:79], v[108:115], v127
  v_add_f32 v8, v8, v10
  v_add_f32 v9, v9, v11
  v_rcp_f32 v8, v8
  v_rcp_f32 v9, v9
  v_pk_add_f32 v[64:65], v[64:65], v[66:67]
  s_nop 2
  v_pk_add_f32 v[68:69], v[68:69], v[70:71]
  s_branch LCf_bigr
LCf_last:
  buffer_store_dwordx2 v[136:137], v138, s[32:35], s46 offen sc1
  s_branch L_chain_done
LCf_kvw:
  buffer_load_dwordx4 v[128:131], v116, s[32:35], s69 offen offset:0 sc1
  buffer_load_dwordx4 v[132:135], v116, s[32:35], s69 offen offset:1024 sc1
  buffer_load_dwordx4 v[136:139], v116, s[32:35], s69 offen offset:2048 sc1
  buffer_load_dwordx4 v[140:143], v116, s[32:35], s69 offen offset:3072 sc1
  s_waitcnt vmcnt(0)
  v_bitop3_b32 v64, v128, v132, s59 bitop3:126
  v_bitop3_b32 v65, v136, v140, s59 bitop3:126
  v_bitop3_b32 v64, v64, v65, 1 bitop3:168
  v_cmp_ne_u32 vcc, 0, v64
  s_cbranch_vccz LCf_kvok
  s_sleep 2
  s_add_u32 s62, s62, 1
  s_cmp_lt_u32 s62, 65536
  s_cbranch_scc1 LCf_kvw
  s_branch L_abort
LCf_kvw0:
  buffer_load_dwordx4 v[128:131], v116, s[32:35], s69 offen offset:0 sc1
  buffer_load_dwordx4 v[132:135], v116, s[32:35], s69 offen offset:1024 sc1
  buffer_load_dwordx4 v[136:139], v116, s[32:35], s69 offen offset:2048 sc1
  buffer_load_dwordx4 v[140:143], v116, s[32:35], s69 offen offset:3072 sc1
  s_waitcnt vmcnt(0)
  v_bitop3_b32 v64, v128, v132, s59 bitop3:126
  v_bitop3_b32 v65, v136, v140, s59 bitop3:126
  v_bitop3_b32 v64, v64, v65, 1 bitop3:168
  v_cmp_ne_u32 vcc, 0, v64
  s_cbranch_vccz LCf_kvok0
  s_sleep 2
  s_add_u32 s62, s62, 1
  s_cmp_lt_u32 s62, 65536
  s_cbranch_scc1 LCf_kvw0
  s_branch L_abort
L_chain_slow:
  s_mov_b32 s50, 0
  s_mov_b32 s51, 0
  v_mov_b64 v[48:49], 0
  v_mov_b64 v[50:51], 0
  v_mov_b64 v[52:53], 0
  v_mov_b64 v[54:55], 0
  v_mov_b64 v[100:101], 0
  v_mov_b64 v[102:103], 0
  v_mov_b64 v[104:105], 0
  v_mov_b64 v[106:107], 0
  v_mov_b64 v[108:109], 0
  v_mov_b64 v[110:111], 0
  v_mov_b64 v[112:113], 0
  v_mov_b64 v[114:115], 0
  v_xor_b32 v88, 2048, v117
  v_xor_b32 v89, 4096, v117
  v_xor_b32 v90, 6144, v117
  v_add_u32 v91, 147456, v116
  s_mov_b32 s59, 1
  s_mov_b32 s69, s56
  v_mov_b64 v[0:1], v[128:129]
  v_mov_b64 v[2:3], v[130:131]
  v_mov_b64 v[4:5], v[132:133]
  v_mov_b64 v[6:7], v[134:135]
  ds_read_b128 v[32:35], v123 offset:0
  ds_read_b128 v[36:39], v123 offset:1024
  ds_read_b128 v[40:43], v123 offset:2048
  ds_read_b128 v[44:47], v123 offset:3072
  ds_read_b128 v[72:75], v123 offset:4096
  ds_read_b128 v[76:79], v123 offset:5120
  ds_read_b128 v[80:83], v123 offset:6144
  ds_read_b128 v[84:87], v123 offset:7168
  v_lshlrev_b32 v70, 3, v116
  buffer_load_dword v71, v70, s[32:35], s55 offen sc1
  buffer_load_dword v71, v116, s[32:35], s53 offen sc1
  s_cmp_lg_u32 s28, 0
  s_cbranch_scc1 LCs_nop0
  v_or_b32 v136, 1, v136
  v_or_b32 v138, 1, v138
  v_or_b32 v140, 1, v140
  v_or_b32 v142, 1, v142
  s_lshl_b32 s60, s26, 11
  s_add_u32 s60, s60, s58
  buffer_store_dwordx4 v[136:139], v116, s[32:35], s60 offen offset:0 sc1
  buffer_store_dwordx4 v[140:143], v116, s[32:35], s60 offen offset:1024 sc1
LCs_nop0:
LCs_kv0:
  buffer_load_dwordx4 v[128:131], v116, s[32:35], s69 offen offset:0 sc1
  buffer_load_dwordx4 v[132:135], v116, s[32:35], s69 offen offset:1024 sc1
  buffer_load_dwordx4 v[136:139], v116, s[32:35], s69 offen offset:2048 sc1
  buffer_load_dwordx4 v[140:143], v116, s[32:35], s69 offen offset:3072 sc1
  s_waitcnt vmcnt(0)
  v_bitop3_b32 v64, v128, v132, s59 bitop3:126
  v_bitop3_b32 v65, v136, v140, s59 bitop3:126
  v_bitop3_b32 v64, v64, v65, 1 bitop3:168
  v_cmp_ne_u32 vcc, 0, v64
  s_cbranch_vccz LCs_kv0ok
  s_sleep 2
  s_add_u32 s62, s62, 1
  s_cmp_lt_u32 s62, 65536
  s_cbranch_scc1 LCs_kv0
  s_branch L_abort
LCs_kv0ok:
  v_mov_b64 v[100:101], v[136:137]
  v_mov_b64 v[104:105], v[138:139]
  v_mov_b64 v[108:109], v[140:141]
  v_mov_b64 v[112:113], v[142:143]
  v_mov_b32 v138, 0x40000000
  v_mov_b32 v92, 0x3f803f80
  v_mov_b32 v93, 0x3f803f80
  v_mov_b32 v94, 0x3f803f80
  v_mov_b32 v95, 0
  v_mov_b32 v96, 0x3f803f80
  v_mov_b32 v97, 0x3f803f80
  v_mov_b32 v98, 0x3f803f80
  v_mov_b32 v99, 0
  s_cmp_lt_u32 s50, 62
  s_cselect_b32 s60, 16384, 0
  s_add_u32 s69, s69, s60
  s_cmp_eq_u32 s69, s57
  s_cselect_b32 s69, s56, s69
  s_addc_u32 s59, s59, 0
  s_lshl_b32 s46, s50, 13
  s_add_u32 s46, s46, s58
  s_waitcnt lgkmcnt(0)
  v_mov_b64 v[56:57], 0
  v_mov_b64 v[58:59], 0
  v_mov_b64 v[60:61], 0
  v_mov_b64 v[62:63], 0
  v_mov_b64 v[64:65], 0
  v_mov_b64 v[66:67], 0
  v_mov_b64 v[68:69], 0
  v_mov_b64 v[70:71], 0
  ds_write_b128 v117, v[0:3] offset:0
  s_branch LCs_haveA
.p2align 6
LCs_step:
  buffer_load_dwordx4 v[0:3], v116, s[32:35], s52 offen sc1
  buffer_load_dwordx4 v[4:7], v116, s[32:35], s52 offen offset:1024 sc1
  v_mov_b64 v[56:57], 0
  v_mov_b64 v[58:59], 0
  v_mov_b64 v[60:61], 0
  v_mov_b64 v[62:63], 0
  v_mov_b64 v[64:65], 0
  v_mov_b64 v[66:67], 0
  v_mov_b64 v[68:69], 0
  v_mov_b64 v[70:71], 0
  s_nop 15
LCs_pollA:
  buffer_load_dwordx4 v[24:27], v116, s[32:35], s52 offen sc1
  buffer_load_dwordx4 v[28:31], v116, s[32:35], s52 offen offset:1024 sc1
  s_waitcnt vmcnt(3)
  ds_write_b128 v117, v[0:3]
  v_bitop3_b32 v8, v0, v2, s51 bitop3:126
  s_waitcnt vmcnt(2)
  v_bitop3_b32 v9, v4, v6, s51 bitop3:126
  v_bitop3_b32 v8, v8, v9, 1 bitop3:168
  v_cmp_ne_u32 vcc, 0, v8
  s_cbranch_vccnz LCs_tryB
LCs_haveA:
  v_smfmac_f32_16x16x64_bf16 v[56:59], v[0:3], a[0:7], v125
  ds_write_b128 v117, v[4:7] offset:1024
  v_smfmac_f32_16x16x64_bf16 v[60:63], v[0:3], a[8:15], v125
  s_xor_b32 s51, s51, 1
  v_smfmac_f32_16x16x64_bf16 v[56:59], v[4:7], a[16:23], v125
  v_smfmac_f32_16x16x64_bf16 v[60:63], v[4:7], a[24:31], v125
  s_waitcnt lgkmcnt(0)
  s_barrier
  ds_read_b128 v[8:11], v88 offset:0
  v_smfmac_f32_16x16x64_bf16 v[64:67], v[0:3], a[96:103], v125
  ds_read_b128 v[12:15], v88 offset:1024
  ds_read_b128 v[16:19], v89 offset:0
  v_smfmac_f32_16x16x64_bf16 v[68:71], v[0:3], a[104:111], v125
  ds_read_b128 v[20:23], v89 offset:1024
  v_smfmac_f32_16x16x64_bf16 v[64:67], v[4:7], a[112:119], v125
  v_smfmac_f32_16x16x64_bf16 v[68:71], v[4:7], a[120:127], v125
LCs_rest:
  s_waitcnt lgkmcnt(3)
  v_smfmac_f32_16x16x64_bf16 v[56:59], v[8:11], a[32:39], v125
  v_smfmac_f32_16x16x64_bf16 v[60:63], v[8:11], a[40:47], v125
  s_waitcnt lgkmcnt(2)
  v_smfmac_f32_16x16x64_bf16 v[56:59], v[12:15], a[48:55], v125
  s_waitcnt vmcnt(0)
  ds_read_b128 v[24:27], v90 offset:0
  v_smfmac_f32_16x16x64_bf16 v[60:63], v[12:15], a[56:63], v125
  ds_read_b128 v[28:31], v90 offset:1024
  s_waitcnt lgkmcnt(3)
  v_smfmac_f32_16x16x64_bf16 v[56:59], v[16:19], a[64:71], v125
  buffer_store_dwordx2 v[136:137], v138, s[32:35], s46 offen sc1
  v_smfmac_f32_16x16x64_bf16 v[60:63], v[16:19], a[72:79], v125
  s_waitcnt lgkmcnt(2)
  v_smfmac_f32_16x16x64_bf16 v[56:59], v[20:23], a[80:87], v125
  buffer_load_dwordx4 v[136:139], v116, s[32:35], s69 offen offset:2048 sc1
  v_smfmac_f32_16x16x64_bf16 v[60:63], v[20:23], a[88:95], v125
  s_waitcnt lgkmcnt(1)
  v_smfmac_f32_16x16x64_bf16 v[56:59], v[24:27], v[80:87], v125
  buffer_load_dwordx4 v[140:143], v116, s[32:35], s69 offen offset:3072 sc1
  v_smfmac_f32_16x16x64_bf16 v[60:63], v[24:27], v[72:79], v125
  s_waitcnt lgkmcnt(0)
  v_smfmac_f32_16x16x64_bf16 v[56:59], v[28:31], v[40:47], v125
  v_smfmac_f32_16x16x64_bf16 v[60:63], v[28:31], v[32:39], v125
  v_smfmac_f32_16x16x64_bf16 v[64:67], v[8:11], a[128:135], v125
  v_add_f32 v80, v56, v58
  v_add_f32 v81, v57, v59
  v_smfmac_f32_16x16x64_bf16 v[68:71], v[8:11], a[136:143], v125
  v_add_f32 v82, v60, v62
  v_add_f32 v83, v61, v63
  v_smfmac_f32_16x16x64_bf16 v[64:67], v[12:15], a[144:151], v125
  v_cvt_pk_bf16_f32 v80, v80, v82
  v_cvt_pk_bf16_f32 v81, v81, v83
  v_smfmac_f32_16x16x64_bf16 v[68:71], v[12:15], a[152:159], v125
  ds_write2_b32 v118, v80, v81 offset0:0 offset1:32
  v_smfmac_f32_16x16x64_bf16 v[64:67], v[16:19], a[160:167], v125
  s_mov_b64 exec, s[64:65]
  ds_read_b128 v[48:51], v120
  s_mov_b64 exec, -1
  v_smfmac_f32_16x16x64_bf16 v[68:71], v[16:19], a[168:175], v125
  s_mov_b64 exec, s[66:67]
  ds_read_b128 v[52:55], v120
  s_mov_b64 exec, -1
  v_smfmac_f32_16x16x64_bf16 v[64:67], v[20:23], a[176:183], v125
  ds_read_b128 v[32:35], v123 offset:32768
  v_mov_b64 v[56:57], 0
  v_smfmac_f32_16x16x64_bf16 v[68:71], v[20:23], a[184:191], v125
  ds_read_b128 v[36:39], v123 offset:33792
  v_mov_b64 v[58:59], 0
  v_smfmac_f32_16x16x64_bf16 v[64:67], v[24:27], a[192:199], v125
  ds_read_b128 v[40:43], v123 offset:34816
  v_mov_b64 v[60:61], 0
  v_smfmac_f32_16x16x64_bf16 v[68:71], v[24:27], a[200:207], v125
  ds_read_b128 v[44:47], v123 offset:35840
  s_waitcnt lgkmcnt(4)
  v_mov_b64 v[62:63], 0
  v_mfma_f32_16x16x32_bf16 v[72:75], v[128:131], v[48:51], 0
  v_mfma_f32_16x16x32_bf16 v[72:75], v[132:135], v[52:55], v[72:75]
  buffer_load_dwordx4 v[128:131], v116, s[32:35], s69 offen offset:0 sc1
  v_smfmac_f32_16x16x64_bf16 v[64:67], v[28:31], a[208:215], v125
  v_smfmac_f32_16x16x64_bf16 v[68:71], v[28:31], a[216:223], v125
  buffer_load_dwordx4 v[132:135], v116, s[32:35], s69 offen offset:1024 sc1
  v_smfmac_f32_16x16x64_bf16 v[56:59], v[4:7], a[224:231], v125
  ds_write_b128 v117, v[72:75] offset:8192
  v_smfmac_f32_16x16x64_bf16 v[60:63], v[4:7], a[232:239], v125
  v_add_f32 v80, v64, v66
  v_add_f32 v81, v65, v67
  v_add_f32 v82, v68, v70
  v_add_f32 v83, v69, v71
  v_cvt_pk_bf16_f32 v80, v80, v82
  v_cvt_pk_bf16_f32 v81, v81, v83
  v_smfmac_f32_16x16x64_bf16 v[56:59], v[8:11], a[240:247], v125
  ds_write2_b32 v126, v80, v81 offset0:0 offset1:32
  v_smfmac_f32_16x16x64_bf16 v[60:63], v[8:11], a[248:255], v125
  s_waitcnt lgkmcnt(2)
  v_mov_b64 v[64:65], 0
  v_smfmac_f32_16x16x64_bf16 v[56:59], v[0:3], v[32:39], v125
  v_mov_b64 v[66:67], 0
  v_smfmac_f32_16x16x64_bf16 v[60:63], v[0:3], v[40:47], v125
  v_mov_b64 v[68:69], 0
  v_smfmac_f32_16x16x64_bf16 v[56:59], v[12:15], v[144:151], v125
  s_waitcnt lgkmcnt(0)
  v_smfmac_f32_16x16x64_bf16 v[60:63], v[12:15], v[152:159], v125
  s_barrier
  ds_read_b128 v[40:43], v121
  v_smfmac_f32_16x16x64_bf16 v[56:59], v[16:19], v[160:167], v125
  ds_read_b128 v[32:35], v119
  ds_read_b128 v[44:47], v121 offset:2048
  v_mov_b64 v[70:71], 0
  v_smfmac_f32_16x16x64_bf16 v[60:63], v[16:19], v[168:175], v125
  ds_read_b128 v[36:39], v119 offset:2048
  ds_read_b128 v[76:79], v88 offset:8192
  v_mov_b64 v[8:9], 0
  v_smfmac_f32_16x16x64_bf16 v[56:59], v[20:23], v[176:183], v125
  ds_read_b128 v[80:83], v89 offset:8192
  v_mov_b64 v[10:11], 0
  v_smfmac_f32_16x16x64_bf16 v[60:63], v[20:23], v[184:191], v125
  ds_read_b128 v[84:87], v90 offset:8192
  v_smfmac_f32_16x16x64_bf16 v[56:59], v[24:27], v[192:199], v125
  s_waitcnt lgkmcnt(5)
  v_mfma_f32_16x16x32_bf16 v[4:7], v[40:43], v[32:35], 0
  v_smfmac_f32_16x16x64_bf16 v[60:63], v[24:27], v[200:207], v125
  s_waitcnt lgkmcnt(3)
  v_mfma_f32_16x16x32_bf16 v[4:7], v[44:47], v[36:39], v[4:7]
  s_waitcnt lgkmcnt(2)
  v_add_f32 v72, v72, v76
  v_add_f32 v73, v73, v77
  v_smfmac_f32_16x16x64_bf16 v[56:59], v[28:31], v[208:215], v125
  v_add_f32 v74, v74, v78
  v_smfmac_f32_16x16x64_bf16 v[60:63], v[28:31], v[216:223], v125
  s_waitcnt lgkmcnt(0)
  ds_read_b128 v[32:35], v123 offset:8192
  v_add_f32 v75, v75, v79
  v_cndmask_b32 v5, v5, v6, s[66:67]
  v_cndmask_b32 v4, v4, v7, s[66:67]
  v_pk_add_f32 v[80:81], v[80:81], v[84:85]
  v_pk_add_f32 v[82:83], v[82:83], v[86:87]
  v_add_f32_dpp v4, v5, v4 quad_perm:[2,3,0,1] row_mask:0xf bank_mask:0xf
  v_pk_add_f32 v[72:73], v[72:73], v[80:81]
  v_pk_add_f32 v[74:75], v[74:75], v[82:83]
  v_mul_f32 v4, s63, v4
  v_exp_f32 v80, v72
  v_exp_f32 v81, v73
  v_exp_f32 v6, v4
  v_exp_f32 v82, v74
  v_exp_f32 v83, v75
  v_cvt_pk_bf16_f32 v76, v80, v81
  v_cvt_pk_bf16_f32 v77, v6, 0
  v_cvt_pk_bf16_f32 v79, v6, 0
  v_cvt_pk_bf16_f32 v78, v82, v83
  v_pk_add_f32 v[56:57], v[56:57], v[58:59]
  v_pk_add_f32 v[60:61], v[60:61], v[62:63]
  v_cvt_pk_bf16_f32 v102, v56, v57
  v_cvt_pk_bf16_f32 v106, v56, v57
  v_cvt_pk_bf16_f32 v110, v60, v61
  v_smfmac_f32_16x16x64_bf16 v[8:11], v[76:79], v[92:99], v127
  ds_read_b128 v[36:39], v123 offset:9216
  ds_read_b128 v[40:43], v123 offset:10240
  v_cvt_pk_bf16_f32 v114, v60, v61
  v_smfmac_f32_16x16x64_bf16 v[64:67], v[76:79], v[100:107], v127
  ds_read_b128 v[44:47], v123 offset:11264
  ds_read_b128 v[16:19], v123 offset:12288
  v_max3_f32 v84, abs(v72), abs(v73), abs(v4)
  v_smfmac_f32_16x16x64_bf16 v[68:71], v[76:79], v[108:115], v127
  ds_read_b128 v[20:23], v123 offset:13312
  v_add_f32 v8, v8, v10
  v_add_f32 v9, v9, v11
  v_rcp_f32 v8, v8
  v_rcp_f32 v9, v9
  v_pk_add_f32 v[64:65], v[64:65], v[66:67]
  v_max3_f32 v84, abs(v74), abs(v75), v84
  v_cmp_nge_f32 vcc, s68, v84
  v_pk_add_f32 v[68:69], v[68:69], v[70:71]
  s_cbranch_vccnz LCs_big
LCs_bigr:
  v_pk_mul_f32 v[64:65], v[64:65], v[8:9]
  v_pk_mul_f32 v[68:69], v[68:69], v[8:9]
  v_cvt_pk_bf16_f32 v96, v64, v68
  v_cvt_pk_bf16_f32 v97, v65, v69
  ds_write2_b32 v122, v96, v97 offset0:0 offset1:4
  v_mov_b64 v[12:13], 0
  ds_read_b128 v[24:27], v123 offset:14336
  v_mov_b64 v[14:15], 0
  ds_read_b128 v[28:31], v123 offset:15360
  s_add_u32 s61, s54, 0x8000
  v_mov_b32 v118, v118
  s_waitcnt lgkmcnt(2)
  v_mfma_f32_32x32x16_bf16 v[72:87], v[12:15], v[12:15], 0
  s_barrier
  ds_read_b128 v[92:95], v91
  ds_read_b128 v[96:99], v91 offset:1024
  v_mfma_f32_32x32x16_bf16 v[56:71], v[12:15], v[12:15], 0
  ds_read_b128 v[0:3], v123 offset:16384
  ds_read_b128 v[4:7], v123 offset:17408
  ds_read_b128 v[8:11], v123 offset:18432
  ds_read_b128 v[12:15], v123 offset:19456
  v_mov_b32 v118, v118
  s_waitcnt lgkmcnt(5)
  v_smfmac_f32_16x16x64_bf16 v[72:75], v[92:95], v[32:39], v125
  ds_read_b128 v[32:35], v123 offset:20480
  v_smfmac_f32_16x16x64_bf16 v[76:79], v[92:95], v[40:47], v125
  ds_read_b128 v[36:39], v123 offset:21504
  s_waitcnt lgkmcnt(6)
  v_smfmac_f32_16x16x64_bf16 v[72:75], v[96:99], v[16:23], v125
  ds_read_b128 v[40:43], v123 offset:22528
  v_smfmac_f32_16x16x64_bf16 v[76:79], v[96:99], v[24:31], v125
  ds_read_b128 v[44:47], v123 offset:23552
  s_waitcnt lgkmcnt(6)
  v_smfmac_f32_16x16x64_bf16 v[80:83], v[92:95], v[0:7], v125
  ds_read_b128 v[16:19], v123 offset:24576
  s_waitcnt lgkmcnt(5)
  v_add_f32 v72, v72, v74
  v_smfmac_f32_16x16x64_bf16 v[80:83], v[96:99], v[8:15], v125
  ds_read_b128 v[20:23], v123 offset:25600
  v_add_f32 v73, v73, v75
  v_smfmac_f32_16x16x64_bf16 v[84:87], v[92:95], v[224:231], v125
  ds_read_b128 v[24:27], v123 offset:26624
  v_add_f32 v76, v76, v78
  v_add_f32 v77, v77, v79
  v_smfmac_f32_16x16x64_bf16 v[84:87], v[96:99], v[232:239], v125
  ds_read_b128 v[28:31], v123 offset:27648
  v_cvt_pk_bf16_f32 v74, v73, v77
  v_cvt_pk_bf16_f32 v72, v72, v76
  v_smfmac_f32_16x16x64_bf16 v[56:59], v[92:95], v[240:247], v125
  ds_read_b128 v[0:3], v123 offset:28672
  v_add_f32 v80, v80, v82
  v_add_f32 v81, v81, v83
  v_smfmac_f32_16x16x64_bf16 v[56:59], v[96:99], v[248:255], v125
  ds_read_b128 v[4:7], v123 offset:29696
  s_waitcnt lgkmcnt(8)
  v_bfi_b32 v72, 1, s51, v72
  v_add_f32 v84, v84, v86
  v_smfmac_f32_16x16x64_bf16 v[60:63], v[92:95], v[32:39], v125
  ds_read_b128 v[8:11], v123 offset:30720
  s_waitcnt lgkmcnt(7)
  v_add_f32 v85, v85, v87
  v_cvt_pk_bf16_f32 v73, v80, v84
  v_smfmac_f32_16x16x64_bf16 v[60:63], v[96:99], v[40:47], v125
  ds_read_b128 v[12:15], v123 offset:31744
  s_waitcnt lgkmcnt(6)
  v_cvt_pk_bf16_f32 v75, v81, v85
  v_smfmac_f32_16x16x64_bf16 v[64:67], v[92:95], v[16:23], v125
  s_waitcnt lgkmcnt(4)
  buffer_store_dwordx4 v[72:75], v124, s[32:35], s54 offen sc1
  v_add_f32 v56, v56, v58
  v_smfmac_f32_16x16x64_bf16 v[64:67], v[96:99], v[24:31], v125
  s_waitcnt lgkmcnt(2)
  v_add_f32 v57, v57, v59
  v_add_f32 v60, v60, v62
  v_smfmac_f32_16x16x64_bf16 v[68:71], v[92:95], v[0:7], v125
  s_waitcnt lgkmcnt(0)
  v_add_f32 v61, v61, v63
  v_smfmac_f32_16x16x64_bf16 v[68:71], v[96:99], v[8:15], v125
  v_cvt_pk_bf16_f32 v58, v57, v61
  v_cvt_pk_bf16_f32 v56, v56, v60
  v_add_f32 v64, v64, v66
  v_add_f32 v65, v65, v67
  v_bfi_b32 v56, 1, s51, v56
  s_nop 2
  v_pk_add_f32 v[68:69], v[68:69], v[70:71]
  v_cvt_pk_bf16_f32 v57, v64, v68
  v_cvt_pk_bf16_f32 v59, v65, v69
  buffer_store_dwordx4 v[56:59], v124, s[32:35], s61 offen sc1
LCs_tail:
  s_cmp_lg_u32 s26, 0
  s_cbranch_scc1 LCs_side
  s_add_u32 s61, s55, 4096
  ds_read_b128 v[32:35], v123 offset:0
  ds_read_b128 v[36:39], v123 offset:1024
  ds_read_b128 v[40:43], v123 offset:2048
  ds_read_b128 v[44:47], v123 offset:3072
  ds_read_b128 v[72:75], v123 offset:4096
  ds_read_b128 v[76:79], v123 offset:5120
  ds_read_b128 v[80:83], v123 offset:6144
  ds_read_b128 v[84:87], v123 offset:7168
  v_bfe_u32 v68, v116, 5, 3
  v_and_b32 v69, 16, v116
  v_mov_b32 v70, 0x3f80
  v_lshlrev_b32 v70, v69, v70
  v_cmp_eq_u32 s[36:37], 0, v68
  v_cmp_eq_u32 s[38:39], 1, v68
  v_cmp_eq_u32 s[40:41], 2, v68
  v_cmp_eq_u32 s[42:43], 3, v68
  v_cndmask_b32 v60, 0, v70, s[36:37]
  v_cndmask_b32 v61, 0, v70, s[38:39]
  v_cndmask_b32 v62, 0, v70, s[40:41]
  v_cndmask_b32 v63, 0, v70, s[42:43]
  v_and_b32 v69, 0xe0, v116
  v_bfe_u32 v70, v116, 8, 1
  v_lshl_add_u32 v69, v70, 4, v69
  v_bfe_u32 v70, v116, 4, 1
  v_lshl_add_u32 v69, v70, 3, v69
  s_waitcnt vmcnt(0)
  buffer_load_dwordx4 v[0:3], v116, s[32:35], s55 offen offset:0 sc1
  buffer_load_dwordx4 v[4:7], v116, s[32:35], s55 offen offset:1024 sc1
  buffer_load_dwordx4 v[8:11], v116, s[32:35], s55 offen offset:2048 sc1
  buffer_load_dwordx4 v[12:15], v116, s[32:35], s55 offen offset:3072 sc1
  buffer_load_dwordx4 v[16:19], v116, s[32:35], s61 offen offset:0 sc1
  buffer_load_dwordx4 v[20:23], v116, s[32:35], s61 offen offset:1024 sc1
  buffer_load_dwordx4 v[24:27], v116, s[32:35], s61 offen offset:2048 sc1
  buffer_load_dwordx4 v[28:31], v116, s[32:35], s61 offen offset:3072 sc1
  s_waitcnt vmcnt(10)
  v_bitop3_b32 v64, v128, v132, s59 bitop3:126
  v_bitop3_b32 v65, v136, v140, s59 bitop3:126
  v_bitop3_b32 v64, v64, v65, 1 bitop3:168
  v_cmp_ne_u32 vcc, 0, v64
  s_cbranch_vccnz LCs_kvw0
LCs_kvok0:
  v_mov_b64 v[100:101], v[136:137]
  v_mov_b64 v[104:105], v[138:139]
  v_mov_b64 v[108:109], v[140:141]
  v_mov_b64 v[112:113], v[142:143]
  v_mov_b32 v138, 0x40000000
  v_mov_b32 v92, 0x3f803f80
  v_mov_b32 v93, 0x3f803f80
  v_mov_b32 v94, 0x3f803f80
  v_mov_b32 v95, 0
  v_mov_b32 v96, 0x3f803f80
  v_mov_b32 v97, 0x3f803f80
  v_mov_b32 v98, 0x3f803f80
  v_mov_b32 v99, 0
  s_add_u32 s50, s50, 1
  s_cmp_lt_u32 s50, 62
  s_cselect_b32 s60, 16384, 0
  s_add_u32 s69, s69, s60
  s_cmp_eq_u32 s69, s57
  s_cselect_b32 s69, s56, s69
  s_addc_u32 s59, s59, 0
  s_lshl_b32 s46, s50, 13
  s_add_u32 s46, s46, s58
LCs_sumB:
  v_mov_b32 v68, 0
  s_waitcnt vmcnt(7)
  v_mfma_f32_16x16x32_bf16 v[64:67], v[60:63], v[0:3], 0
  v_bitop3_b32 v68, v68, v0, s51 bitop3:246
  s_waitcnt vmcnt(6)
  v_mfma_f32_16x16x32_bf16 v[64:67], v[60:63], v[4:7], v[64:67]
  v_bitop3_b32 v68, v68, v4, s51 bitop3:246
  s_waitcnt vmcnt(5)
  v_mfma_f32_16x16x32_bf16 v[64:67], v[60:63], v[8:11], v[64:67]
  v_bitop3_b32 v68, v68, v8, s51 bitop3:246
  s_waitcnt vmcnt(4)
  v_mfma_f32_16x16x32_bf16 v[64:67], v[60:63], v[12:15], v[64:67]
  v_bitop3_b32 v68, v68, v12, s51 bitop3:246
  s_waitcnt vmcnt(3)
  v_mfma_f32_16x16x32_bf16 v[64:67], v[60:63], v[16:19], v[64:67]
  v_bitop3_b32 v68, v68, v16, s51 bitop3:246
  s_waitcnt vmcnt(2)
  v_mfma_f32_16x16x32_bf16 v[64:67], v[60:63], v[20:23], v[64:67]
  v_bitop3_b32 v68, v68, v20, s51 bitop3:246
  s_waitcnt vmcnt(1)
  v_mfma_f32_16x16x32_bf16 v[64:67], v[60:63], v[24:27], v[64:67]
  v_bitop3_b32 v68, v68, v24, s51 bitop3:246
  s_waitcnt vmcnt(0)
  v_mfma_f32_16x16x32_bf16 v[64:67], v[60:63], v[28:31], v[64:67]
  v_bitop3_b32 v68, v68, v28, s51 bitop3:246
  v_and_b32 v68, 1, v68
  v_cmp_ne_u32 vcc, 0, v68
  s_cbranch_vccnz LCs_retryB
  s_mov_b32 exec_hi, 0
  s_mov_b32 vcc_lo, 0xaaaaaaaa
  v_and_b32 v138, 0xd0, v69
  v_bfe_u32 v139, v116, 4, 1
  v_cvt_pk_bf16_f32 v70, v64, v65
  v_cvt_pk_bf16_f32 v71, v66, v67
  v_bfi_b32 v70, 1, s51, v70
  buffer_store_dwordx2 v[70:71], v69, s[32:35], s53 offen sc1
  s_barrier
  v_cndmask_b32 v68, v71, v70, vcc
  v_lshl_add_u32 v138, v139, 5, v138
  v_bfe_u32 v139, v116, 5, 1
  v_mov_b32_dpp v68, v68 quad_perm:[1,0,3,2] row_mask:0xf bank_mask:0xf
  v_lshl_add_u32 v138, v139, 3, v138
  v_cndmask_b32 v136, v70, v68, vcc
  v_cndmask_b32 v137, v68, v71, vcc
  v_or_b32 v136, 1, v136
  s_mov_b64 exec, -1
LCs_join:
  s_cmp_eq_u32 s50, 63
  s_cbranch_scc1 LCs_last
  s_branch LCs_step
LCs_side:
  s_waitcnt vmcnt(2)
  v_bitop3_b32 v60, v128, v132, s59 bitop3:126
  v_bitop3_b32 v61, v136, v140, s59 bitop3:126
  v_bitop3_b32 v60, v60, v61, 1 bitop3:168
  v_cmp_ne_u32 vcc, 0, v60
  s_cbranch_vccnz LCs_kvw
LCs_kvok:
  v_mov_b64 v[100:101], v[136:137]
  v_mov_b64 v[104:105], v[138:139]
  v_mov_b64 v[108:109], v[140:141]
  v_mov_b64 v[112:113], v[142:143]
  v_mov_b32 v138, 0x40000000
  v_mov_b32 v92, 0x3f803f80
  v_mov_b32 v93, 0x3f803f80
  v_mov_b32 v94, 0x3f803f80
  v_mov_b32 v95, 0
  v_mov_b32 v96, 0x3f803f80
  v_mov_b32 v97, 0x3f803f80
  v_mov_b32 v98, 0x3f803f80
  v_mov_b32 v99, 0
  ds_read_b128 v[32:35], v123 offset:0
  ds_read_b128 v[36:39], v123 offset:1024
  ds_read_b128 v[40:43], v123 offset:2048
  ds_read_b128 v[44:47], v123 offset:3072
  ds_read_b128 v[72:75], v123 offset:4096
  ds_read_b128 v[76:79], v123 offset:5120
  ds_read_b128 v[80:83], v123 offset:6144
  ds_read_b128 v[84:87], v123 offset:7168
  s_add_u32 s50, s50, 1
  s_cmp_lt_u32 s50, 62
  s_cselect_b32 s60, 16384, 0
  s_add_u32 s69, s69, s60
  s_cmp_eq_u32 s69, s57
  s_cselect_b32 s69, s56, s69
  s_addc_u32 s59, s59, 0
  s_lshl_b32 s46, s50, 13
  s_add_u32 s46, s46, s58
  s_barrier
  s_branch LCs_join
LCs_tryB:
  buffer_load_dwordx4 v[0:3], v116, s[32:35], s52 offen sc1
  buffer_load_dwordx4 v[4:7], v116, s[32:35], s52 offen offset:1024 sc1
  s_waitcnt vmcnt(3)
  ds_write_b128 v117, v[24:27]
  v_bitop3_b32 v8, v24, v26, s51 bitop3:126
  s_waitcnt vmcnt(2)
  v_bitop3_b32 v9, v28, v30, s51 bitop3:126
  v_bitop3_b32 v8, v8, v9, 1 bitop3:168
  v_cmp_ne_u32 vcc, 0, v8
  s_cbranch_vccnz LCs_retryA
  v_smfmac_f32_16x16x64_bf16 v[56:59], v[24:27], a[0:7], v125
  ds_write_b128 v117, v[28:31] offset:1024
  v_smfmac_f32_16x16x64_bf16 v[60:63], v[24:27], a[8:15], v125
  s_xor_b32 s51, s51, 1
  v_smfmac_f32_16x16x64_bf16 v[56:59], v[28:31], a[16:23], v125
  v_smfmac_f32_16x16x64_bf16 v[60:63], v[28:31], a[24:31], v125
  s_waitcnt lgkmcnt(0)
  s_barrier
  ds_read_b128 v[8:11], v88 offset:0
  v_smfmac_f32_16x16x64_bf16 v[64:67], v[24:27], a[96:103], v125
  ds_read_b128 v[12:15], v88 offset:1024
  ds_read_b128 v[16:19], v89 offset:0
  v_smfmac_f32_16x16x64_bf16 v[68:71], v[24:27], a[104:111], v125
  ds_read_b128 v[20:23], v89 offset:1024
  v_smfmac_f32_16x16x64_bf16 v[64:67], v[28:31], a[112:119], v125
  v_smfmac_f32_16x16x64_bf16 v[68:71], v[28:31], a[120:127], v125
  s_branch LCs_rest
LCs_retryA:
  s_add_u32 s62, s62, 1
  s_cmp_lt_u32 s62, 65536
  s_cbranch_scc1 LCs_pollA
  s_branch L_abort
LCs_retryB:
  buffer_load_dwordx4 v[0:3], v116, s[32:35], s55 offen offset:0 sc1
  buffer_load_dwordx4 v[4:7], v116, s[32:35], s55 offen offset:1024 sc1
  buffer_load_dwordx4 v[8:11], v116, s[32:35], s55 offen offset:2048 sc1
  buffer_load_dwordx4 v[12:15], v116, s[32:35], s55 offen offset:3072 sc1
  buffer_load_dwordx4 v[16:19], v116, s[32:35], s61 offen offset:0 sc1
  buffer_load_dwordx4 v[20:23], v116, s[32:35], s61 offen offset:1024 sc1
  buffer_load_dwordx4 v[24:27], v116, s[32:35], s61 offen offset:2048 sc1
  buffer_load_dwordx4 v[28:31], v116, s[32:35], s61 offen offset:3072 sc1
  s_add_u32 s62, s62, 1
  s_cmp_lt_u32 s62, 65536
  s_cbranch_scc1 LCs_sumB
  s_branch L_abort
LCs_big:
  v_max3_f32 v84, v72, v73, v4
  v_max3_f32 v84, v74, v75, v84
  v_mov_b64 v[64:65], 0
  v_mov_b64 v[66:67], 0
  v_mov_b64 v[68:69], 0
  v_mov_b64 v[70:71], 0
  v_mov_b64 v[8:9], 0
  v_mov_b64 v[10:11], 0
  v_max_f32_dpp v84, v84, v84 quad_perm:[2,3,0,1] row_mask:0xf bank_mask:0xf
  v_mov_b32 v85, v84
  s_nop 1
  v_permlane16_swap_b32 v84, v85
  v_max_f32 v84, v84, v85
  v_mov_b32 v85, v84
  s_nop 1
  v_permlane32_swap_b32 v84, v85
  v_max_f32 v84, v84, v85
  v_sub_f32 v80, v72, v84
  v_sub_f32 v81, v73, v84
  v_sub_f32 v82, v74, v84
  v_sub_f32 v83, v75, v84
  v_sub_f32 v6, v4, v84
  v_exp_f32 v80, v80
  v_exp_f32 v81, v81
  v_exp_f32 v6, v6
  v_exp_f32 v82, v82
  v_exp_f32 v83, v83
  v_cvt_pk_bf16_f32 v76, v80, v81
  v_cvt_pk_bf16_f32 v77, v6, 0
  v_cvt_pk_bf16_f32 v79, v6, 0
  v_cvt_pk_bf16_f32 v78, v82, v83
  s_nop 1
  v_smfmac_f32_16x16x64_bf16 v[8:11], v[76:79], v[92:99], v127
  v_smfmac_f32_16x16x64_bf16 v[64:67], v[76:79], v[100:107], v127
  v_smfmac_f32_16x16x64_bf16 v[68:71], v[76:79], v[108:115], v127
  v_add_f32 v8, v8, v10
  v_add_f32 v9, v9, v11
  v_rcp_f32 v8, v8
  v_rcp_f32 v9, v9
  v_pk_add_f32 v[64:65], v[64:65], v[66:67]
  s_nop 2
  v_pk_add_f32 v[68:69], v[68:69], v[70:71]
  s_branch LCs_bigr
LCs_last:
  buffer_store_dwordx2 v[136:137], v138, s[32:35], s46 offen sc1
  s_branch L_chain_done
LCs_kvw:
  buffer_load_dwordx4 v[128:131], v116, s[32:35], s69 offen offset:0 sc1
  buffer_load_dwordx4 v[132:135], v116, s[32:35], s69 offen offset:1024 sc1
  buffer_load_dwordx4 v[136:139], v116, s[32:35], s69 offen offset:2048 sc1
  buffer_load_dwordx4 v[140:143], v116, s[32:35], s69 offen offset:3072 sc1
  s_waitcnt vmcnt(0)
  v_bitop3_b32 v64, v128, v132, s59 bitop3:126
  v_bitop3_b32 v65, v136, v140, s59 bitop3:126
  v_bitop3_b32 v64, v64, v65, 1 bitop3:168
  v_cmp_ne_u32 vcc, 0, v64
  s_cbranch_vccz LCs_kvok
  s_sleep 2
  s_add_u32 s62, s62, 1
  s_cmp_lt_u32 s62, 65536
  s_cbranch_scc1 LCs_kvw
  s_branch L_abort
LCs_kvw0:
  buffer_load_dwordx4 v[128:131], v116, s[32:35], s69 offen offset:0 sc1
  buffer_load_dwordx4 v[132:135], v116, s[32:35], s69 offen offset:1024 sc1
  buffer_load_dwordx4 v[136:139], v116, s[32:35], s69 offen offset:2048 sc1
  buffer_load_dwordx4 v[140:143], v116, s[32:35], s69 offen offset:3072 sc1
  s_waitcnt vmcnt(0)
  v_bitop3_b32 v64, v128, v132, s59 bitop3:126
  v_bitop3_b32 v65, v136, v140, s59 bitop3:126
  v_bitop3_b32 v64, v64, v65, 1 bitop3:168
  v_cmp_ne_u32 vcc, 0, v64
  s_cbranch_vccz LCs_kvok0
  s_sleep 2
  s_add_u32 s62, s62, 1
  s_cmp_lt_u32 s62, 65536
  s_cbranch_scc1 LCs_kvw0
  s_branch L_abort
L_chain_done:
  s_branch L_end
L_abort:
  s_waitcnt vmcnt(0) lgkmcnt(0)
  s_mov_b32 s44, s22
  s_and_b32 s45, s23, 0xffff
  s_mov_b32 s46, 256
  s_mov_b32 s47, 0x20000
  s_mov_b64 exec, 1
  v_mov_b32 v1, 128
  v_mov_b32 v2, 1
  buffer_atomic_add v2, v1, s[44:47], 0 offen
L_end:
  s_endpgm
.section .rodata,"a"
.p2align 6
.amdhsa_kernel interleave_layers__memory_aug_recurrent_mem_tr__dense_activation_relu__prompt_kernel
  .amdhsa_next_free_vgpr 512
  .amdhsa_next_free_sgpr 102
  .amdhsa_accum_offset 256
  .amdhsa_group_segment_fixed_size 0
  .amdhsa_kernarg_size 104
  .amdhsa_user_sgpr_count 2
  .amdhsa_user_sgpr_kernarg_segment_ptr 1
  .amdhsa_system_sgpr_workgroup_id_x 1
  .amdhsa_float_denorm_mode_32 3
.end_amdhsa_kernel
```
